```python
import torch

def _softmax(x, axis=-1):
    return torch.softmax(x, dim=axis)
def _gelu(x):
    return torch.nn.functional.gelu(x, approximate="tanh")
def _silu(x):
    return torch.nn.functional.silu(x)
def _sigmoid(x):
    return torch.sigmoid(x)
def _layernorm(x, axis=-1, eps=1e-5):
    m = x.mean(dim=axis, keepdim=True)
    v = x.var(dim=axis, keepdim=True, unbiased=False)
    return (x - m) / torch.sqrt(v + eps)
def _scatter_add(tgt, idx, src, axis=0):
    return tgt.clone().index_add_(axis, idx, src)
def _segment_sum(src, seg, n):
    out = torch.zeros((n,) + src.shape[1:], dtype=src.dtype)
    return out.index_add_(0, seg, src)
def _pad(x, pw):
    flat = tuple(v for pair in reversed(pw) for v in pair)
    return torch.nn.functional.pad(x, flat)

kernel_name = 'interleave_layers__spectral_gfnet__ssm_conv_s4__prompt'

def setup_inputs():

    _w = (lambda a: (lambda t: t.to(torch.bfloat16) if t.is_floating_point() else t)(torch.as_tensor(a)))
    def _A_setup():
        B, S, D = 1, 2048, 512
        Df = D // 2 + 1
        return {
            "x": _w((lambda *s: torch.randn(*s, dtype=torch.bfloat16) * 0.05)(B, S, D)),
            "w_r": _w((lambda *s: torch.randn(*s, dtype=torch.bfloat16) * 1.6)(S, Df) * 0.02),
            "w_i": _w((lambda *s: torch.randn(*s, dtype=torch.bfloat16) * 1.6)(S, Df) * 0.02),
        }
    _A_in = _A_setup()

    def _B_setup():
        B, L, D, N = 1, 2048, 512, 128
        A_re = -(lambda _x: torch.exp(torch.as_tensor(_x)))((lambda *s: torch.randn(*s, dtype=torch.bfloat16) * 6.4)(D, N))
        A_im = torch.pi * (lambda *s: torch.randn(*s, dtype=torch.bfloat16) * 0.05)(D, N)
        B_re = (lambda *s: torch.randn(*s, dtype=torch.bfloat16) * 0.05)(D, N)
        B_im = (lambda *s: torch.randn(*s, dtype=torch.bfloat16) * 0.05)(D, N)
        C_re = (lambda *s: torch.randn(*s, dtype=torch.bfloat16) * 0.05)(D, N)
        C_im = (lambda *s: torch.randn(*s, dtype=torch.bfloat16) * 0.05)(D, N)
        log_dt = (lambda *s: torch.randn(*s, dtype=torch.bfloat16) * 0.05)(D) * 0.5 - 4.0
        Dskip = (lambda *s: torch.randn(*s, dtype=torch.bfloat16) * 0.05)(D)
        return {
            "u": _w((lambda *s: torch.randn(*s, dtype=torch.bfloat16) * 0.05)(B, L, D)),
            "A_re": _w(A_re),
            "A_im": _w(A_im),
            "B_re": _w(B_re),
            "B_im": _w(B_im),
            "C_re": _w(C_re),
            "C_im": _w(C_im),
            "log_dt": _w(log_dt),
            "Dskip": _w(Dskip),
        }
    _B_in = _B_setup()

    return {
        "A_x": _A_in["x"],
        "A_w_r": _A_in["w_r"],
        "A_w_i": _A_in["w_i"],
        "B_u": _B_in["u"],
        "B_A_re": _B_in["A_re"],
        "B_A_im": _B_in["A_im"],
        "B_B_re": _B_in["B_re"],
        "B_B_im": _B_in["B_im"],
        "B_C_re": _B_in["C_re"],
        "B_C_im": _B_in["C_im"],
        "B_log_dt": _B_in["log_dt"],
        "B_Dskip": _B_in["Dskip"],
    }

def reference(A_x, A_w_r, A_w_i, B_u, B_A_re, B_A_im, B_B_re, B_B_im, B_C_re, B_C_im, B_log_dt, B_Dskip):
    def _A_ref(x, w_r, w_i):
        B, S, D = x.shape
        X = (lambda x, axes=(-2,-1): torch.fft.rfft2(x.float(), dim=axes))(x, axes=(-2, -1))
        W = w_r + 1j * w_i
        X = X * W
        y = (lambda x, s, axes=(-2,-1): torch.fft.irfft2(x, s=s, dim=axes).to(torch.bfloat16))(X, (S, D), axes=(-2, -1))
        return y

    def _B_ref(u, A_re, A_im, B_re, B_im, C_re, C_im, log_dt, Dskip):
        Bsz, L, D = u.shape
        dt = torch.exp(log_dt)[:, None]
        A = A_re + 1j * A_im
        Bc = B_re + 1j * B_im
        Cc = C_re + 1j * C_im
        logdA = dt * A
        dB = dt * Bc
        l = (lambda x, dt: x.to(dt))(torch.arange(L), A_re.dtype)
        P = torch.exp(logdA[:, :, None] * l[None, None, :])
        K = torch.einsum("dn,dnl,dn->dl", Cc, P, dB).real
        L2 = 2 * L
        Kp = _pad(K, ((0, 0), (0, L)))
        up = (lambda x, *d: x.permute(*d))(u, 0, 2, 1)
        up = _pad(up, ((0, 0), (0, 0), (0, L)))
        Kf = (lambda x, axes=(-2,-1): torch.fft.rfft2(x.float(), dim=axes))(Kp[:, None, :], axes=(-2, -1))
        Uf = (lambda x, axes=(-2,-1): torch.fft.rfft2(x.float(), dim=axes))(up[:, :, None, :], axes=(-2, -1))
        Yf = Uf * Kf[None, :, :, :]
        y = (lambda x, s, axes=(-2,-1): torch.fft.irfft2(x, s=s, dim=axes).to(torch.bfloat16))(Yf, (1, L2), axes=(-2, -1))[:, :, 0, :L]
        y = (lambda x, *d: x.permute(*d))(y, 0, 2, 1) + u * Dskip[None, None, :]
        return y

    x = A_x
    x = x + _A_ref(_layernorm(x, axis=-1), A_w_r, A_w_i)
    x = x + _B_ref(_layernorm(x, axis=-1), B_A_re, B_A_im, B_B_re, B_B_im, B_C_re, B_C_im, B_log_dt, B_Dskip)
    x = x + _A_ref(_layernorm(x, axis=-1), A_w_r, A_w_i)
    x = x + _B_ref(_layernorm(x, axis=-1), B_A_re, B_A_im, B_B_re, B_B_im, B_C_re, B_C_im, B_log_dt, B_Dskip)
    return x
```

```asm
; @launch grid=(256,1,1) block=(256,1,1) lds=76800
.amdgcn_target "amdgcn-amd-amdhsa--gfx950"
.text
.globl interleave_layers__spectral_gfnet__ssm_conv_s4__prompt_kernel
.p2align 8
.type interleave_layers__spectral_gfnet__ssm_conv_s4__prompt_kernel,@function
interleave_layers__spectral_gfnet__ssm_conv_s4__prompt_kernel:
  s_cmp_ge_u32 s2, 256
  s_cbranch_scc1 main_exit
  s_load_dwordx16 s[44:59], s[0:1], 0
  s_load_dwordx2 s[4:5], s[0:1], 112
  s_load_dwordx8 s[88:95], s[0:1], 64
  s_load_dwordx4 s[36:39], s[0:1], 96
  s_and_b32 s24, s2, 7
  s_lshl_b32 s24, s24, 5
  s_lshr_b32 s34, s2, 3
  s_add_u32 s24, s24, s34
  s_lshr_b32 s34, s24, 6
  s_lshl_b32 s34, s34, 9
  s_and_b32 s35, s24, 1
  s_lshl_b32 s35, s35, 8
  v_lshrrev_b32 v136, 6, v0
  s_add_u32 s34, s34, s35
  s_bfe_u32 s35, s24, 0x50001
  v_readfirstlane_b32 s25, v136
  s_add_u32 s27, s34, s35
  s_lshl_b32 s28, s25, 6
  s_add_u32 s28, s28, s27
  s_lshl_b32 s28, s28, 10
  s_add_u32 s29, s28, 0x8000
  s_lshr_b32 s35, s24, 2
  s_and_b32 s33, s24, 3
  s_lshl_b32 s33, s33, 9
  s_add_u32 s35, s35, s33
  s_lshl_b32 s33, s25, 7
  s_add_u32 s32, s35, s33
  v_and_b32 v137, 63, v0
  s_mul_i32 s32, s32, 514
  v_lshlrev_b32 v15, 4, v137
  v_lshlrev_b32 v148, 3, v137
  s_add_u32 s33, s32, 32896
  s_waitcnt lgkmcnt(0)
  s_mov_b32 s8, s4
  s_and_b32 s9, s5, 0xffff
  s_mov_b32 s10, 0x900000
  s_mov_b32 s11, 0x20000
  s_mul_i32 s30, s24, 8320
  v_lshlrev_b32 v2, 4, v0
  v_mov_b32 v56, 0
  v_mov_b32 v57, 0
  v_mov_b32 v58, 0
  v_mov_b32 v59, 0
  s_add_u32 s30, s30, 0x0
  s_add_u32 s31, s30, 0x1000
  buffer_store_dwordx4 v[56:59], v2, s[8:11], s30 offen sc1
  s_mul_i32 s30, s24, 8320
  buffer_store_dwordx4 v[56:59], v2, s[8:11], s31 offen sc1
  s_add_u32 s30, s30, 0x2a0000
  s_add_u32 s31, s30, 0x1000
  buffer_store_dwordx4 v[56:59], v2, s[8:11], s30 offen sc1
  buffer_store_dwordx4 v[56:59], v2, s[8:11], s31 offen sc1
  s_mov_b32 s60, s44
  s_and_b32 s61, s45, 0xffff
  s_mov_b32 s62, 0x200000
  s_mov_b32 s63, 0x20000
  s_mov_b32 s4, s46
  s_and_b32 s5, s47, 0xffff
  s_mov_b32 s6, 0x101000
  s_mov_b32 s7, 0x20000
  buffer_load_dwordx4 v[32:35], v15, s[60:63], s28 offen
  s_mov_b32 s12, s48
  buffer_load_dwordx4 v[36:39], v15, s[60:63], s29 offen
  s_and_b32 s13, s49, 0xffff
  s_mov_b32 s14, 0x101000
  buffer_load_dwordx2 v[120:121], v148, s[4:7], s32 offen
  s_mov_b32 s15, 0x20000
  buffer_load_dwordx2 v[122:123], v148, s[4:7], s33 offen
  buffer_load_dwordx2 v[124:125], v148, s[12:15], s32 offen
  buffer_load_dwordx2 v[126:127], v148, s[12:15], s33 offen
  s_cmp_lg_u32 s25, 0
  s_cbranch_scc1 nosp_ld_1
  v_and_b32 v149, 7, v0
  v_lshl_add_u32 v150, v149, 6, s35
  v_sub_u32 v151, 0x800, v150
  v_and_b32 v151, 0x7ff, v151
  v_mul_u32_u24 v150, 514, v150
  v_mul_u32_u24 v151, 514, v151
  s_mov_b64 exec, 0xff
  buffer_load_ushort v64, v150, s[4:7], 0 offen
  buffer_load_ushort v66, v150, s[4:7], 0 offen offset:512
  buffer_load_ushort v68, v151, s[4:7], 0 offen
  buffer_load_ushort v70, v151, s[4:7], 0 offen offset:512
  buffer_load_ushort v65, v150, s[12:15], 0 offen
  buffer_load_ushort v67, v150, s[12:15], 0 offen offset:512
  buffer_load_ushort v69, v151, s[12:15], 0 offen
  buffer_load_ushort v71, v151, s[12:15], 0 offen offset:512
  s_mov_b64 exec, -1
nosp_ld_1:
  s_mov_b32 s26, 40000
  s_mov_b64 s[40:41], 1
  s_lshr_b32 s34, s2, 3
  s_lshl_b32 s34, s34, 2
  s_add_u32 s34, s34, s25
  v_and_b32 v138, 15, v0
  v_bfe_u32 v139, v0, 4, 2
  v_lshrrev_b32 v140, 1, v0
  v_and_b32 v141, 1, v0
  v_lshlrev_b32 v2, 4, v0
  v_mov_b32 v56, 0
  v_mov_b32 v57, 0
  v_mov_b32 v58, 0
  v_mov_b32 v59, 0
  s_mul_i32 s34, s34, 1152
  v_lshlrev_b32 v156, 3, v15
  s_nop 1
  s_getpc_b64 s[16:17]
main_pf:
  s_add_u32 s16, s16, interleave_layers__spectral_gfnet__ssm_conv_s4__prompt_kernel-main_pf
  s_addc_u32 s17, s17, -1
  s_and_b32 s17, s17, 0xffff
  s_mov_b32 s18, dft_tables+108544-interleave_layers__spectral_gfnet__ssm_conv_s4__prompt_kernel
  s_mov_b32 s19, 0x20000
  s_mov_b64 exec, 0x1ff
  buffer_load_dword v48, v156, s[16:19], s34 offen
  s_mov_b64 exec, -1
  v_and_b32 v142, 1, v139
  v_lshrrev_b32 v143, 1, v139
  v_lshlrev_b32 v142, 1, v142
  v_mul_u32_u24 v143, 12, v143
  v_add_u32 v142, v142, v143
  v_xor_b32 v142, v142, v138
  v_lshlrev_b32 v143, 9, v139
  v_lshl_add_u32 v6, v142, 4, v143
  v_and_b32 v142, 1, v139
  v_lshlrev_b32 v142, 1, v142
  s_mul_i32 s34, s25, 20480
  v_xor_b32 v142, v142, v138
  v_add_u32 v16, s34, v15
  v_lshlrev_b32 v3, 6, v138
  v_lshl_add_u32 v9, v142, 4, v143
  v_lshl_add_u32 v3, v139, 4, v3
  s_lshl_b32 s34, s25, 11
  v_xor_b32 v142, 12, v142
  v_add_u32 v3, s34, v3
  v_lshl_add_u32 v97, v142, 4, v143
  v_lshrrev_b32 v142, 2, v138
  s_lshl_b32 s34, s25, 2
  v_add_u32 v143, s34, v142
  v_lshlrev_b32 v7, 9, v143
  v_lshrrev_b32 v143, 3, v138
  v_mul_u32_u24 v143, 12, v143
  v_lshlrev_b32 v144, 2, v139
  v_xor_b32 v143, v143, v144
  v_lshl_add_u32 v7, v143, 4, v7
  v_and_b32 v143, 3, v138
  v_and_b32 v142, 1, v142
  v_lshl_add_u32 v7, v143, 2, v7
  v_lshlrev_b32 v142, 1, v142
  v_xor_b32 v143, 2, v142
  v_lshl_add_u32 v96, v143, 4, v7
  v_lshrrev_b32 v143, 6, v140
  v_lshlrev_b32 v143, 1, v143
  v_and_b32 v144, 1, v140
  v_add_u32 v143, v143, v144
  v_lshl_add_u32 v144, v143, 1, v141
  v_and_b32 v145, 3, v144
  v_and_b32 v5, 1, v145
  v_lshrrev_b32 v146, 1, v145
  v_lshlrev_b32 v5, 1, v5
  v_mul_u32_u24 v146, 12, v146
  v_and_b32 v145, 1, v143
  v_add_u32 v5, v5, v146
  v_lshl_add_u32 v145, v141, 1, v145
  v_lshl_add_u32 v7, v142, 4, v7
  v_and_b32 v8, 1, v145
  v_lshrrev_b32 v146, 1, v145
  v_and_b32 v142, 63, v140
  v_lshlrev_b32 v8, 1, v8
  v_mul_u32_u24 v146, 12, v146
  v_lshrrev_b32 v142, 1, v142
  v_add_u32 v8, v8, v146
  v_xor_b32 v8, v8, v142
  v_lshlrev_b32 v8, 4, v8
  v_lshl_add_u32 v8, v143, 9, v8
  v_xor_b32 v5, v5, v142
  v_bfe_u32 v143, v0, 4, 1
  v_lshlrev_b32 v142, 5, v140
  v_xor_b32 v143, v143, v141
  v_lshl_add_u32 v4, v143, 4, v142
  v_bfe_u32 v143, v0, 3, 1
  v_xor_b32 v143, v143, v141
  v_lshl_add_u32 v98, v143, 4, v142
  v_lshl_add_u32 v142, v139, 6, v138
  v_lshlrev_b32 v12, 4, v142
  s_lshl_b32 s34, s25, 2
  v_add_u32 v12, s34, v12
  v_lshlrev_b32 v5, 4, v5
  s_and_b32 s34, s25, 1
  v_lshl_add_u32 v5, v144, 9, v5
  s_lshl_b32 s34, s34, 3
  v_lshlrev_b32 v142, 5, v142
  s_lshr_b32 s35, s25, 1
  v_bfe_u32 v143, v0, 3, 1
  v_bfe_u32 v144, v0, 2, 1
  v_add_u32 v142, s34, v142
  v_xor_b32 v143, s35, v143
  v_xor_b32 v144, s35, v144
  v_lshl_add_u32 v10, v143, 4, v142
  v_lshl_add_u32 v11, v144, 4, v142
  v_lshrrev_b32 v142, 1, v138
  v_lshl_add_u32 v142, v139, 5, v142
  v_lshlrev_b32 v13, 5, v142
  v_lshl_add_u32 v13, v143, 4, v13
  v_and_b32 v144, 1, v138
  s_and_b32 s34, s25, 1
  v_lshl_add_u32 v13, v144, 3, v13
  s_lshl_b32 s34, s34, 2
  v_add_u32 v13, s34, v13
  s_lshl_b32 s34, s25, 4
  v_add_u32 v142, s34, v138
  v_lshrrev_b32 v143, 1, v139
  v_lshl_add_u32 v142, v142, 2, v143
  v_and_b32 v143, 1, v139
  v_lshlrev_b32 v143, 4, v143
  v_mul_u32_u24 v20, 8320, v142
  v_lshl_add_u32 v21, v142, 5, v143
  v_add_u32 v20, v20, v143
  v_lshrrev_b32 v142, 1, v137
  s_lshl_b32 s34, s25, 6
  v_add_u32 v143, s34, v142
  s_lshl_b32 s34, s25, 2
  s_mov_b32 s12, s36
  s_and_b32 s13, s37, 0xffff
  s_mov_b32 s14, 0x200000
  s_mov_b32 s15, 0x20000
  s_mov_b32 s96, s38
  s_and_b32 s97, s39, 0xffff
  v_mul_u32_u24 v99, 8320, v143
  v_and_b32 v142, 3, v137
  s_mov_b32 s98, 0x100
  v_and_b32 v100, 1, v142
  v_lshrrev_b32 v143, 1, v142
  s_mov_b32 s99, 0x20000
  v_lshlrev_b32 v100, 1, v100
  v_mul_u32_u24 v143, 12, v143
  s_mov_b32 s20, s94
  v_add_u32 v100, v100, v143
  s_and_b32 s21, s95, 0xffff
  v_cmp_gt_u32 vcc, 16, v137
  v_lshrrev_b32 v143, 2, v137
  s_mov_b32 s22, 0x400
  v_xor_b32 v100, v100, v143
  s_mov_b32 s23, 0x20000
  v_mul_u32_u24 v1, 8320, v140
  v_mov_b32 v17, 0
  v_mov_b32 v145, 0xffff0000
  v_lshlrev_b32 v100, 4, v100
  v_add_u32 v142, s34, v142
  s_mov_b32 s36, 0x3b000000
  v_lshl_add_u32 v1, v141, 4, v1
  v_add_u32 v97, 0x1000, v97
  v_lshl_add_u32 v8, v141, 12, v8
  v_lshlrev_b32 v14, 31, v144
  v_cndmask_b32 v17, v17, v145, vcc
  v_lshl_add_u32 v99, v141, 4, v99
  v_lshl_add_u32 v100, v142, 9, v100
  s_mov_b32 s37, 0x3727c5ac
  s_nop 0
  s_getpc_b64 s[16:17]
main_pc:
  s_add_u32 s16, s16, dft_tables-main_pc
  s_addc_u32 s17, s17, 0
  s_and_b32 s17, s17, 0xffff
  s_mov_b32 s18, 0x1a800
  s_mov_b32 s19, 0x20000
  s_waitcnt vmcnt(7)
  s_barrier
  s_cmp_lg_u32 s25, 0
  s_cbranch_scc1 noarrive_2
  s_mov_b64 exec, 1
  s_lshr_b32 s34, s2, 3
  s_and_b32 s34, s34, 15
  s_lshl_b32 s34, s34, 4
  v_mov_b32 v23, s34
  v_mov_b32 v22, 1
  buffer_atomic_add v22, v23, s[96:99], 0 offen offset:0 sc1
  s_mov_b64 exec, -1
noarrive_2:
  v_mul_u32_u24 v232, 9, v15
  s_lshl_b32 s34, s25, 3
  s_waitcnt vmcnt(4)
  v_lshlrev_b32 v136, 16, v120
  s_waitcnt vmcnt(3)
  v_lshlrev_b32 v140, 16, v122
  s_waitcnt vmcnt(2)
  v_lshlrev_b32 v144, 16, v124
  s_waitcnt vmcnt(1)
  v_lshlrev_b32 v148, 16, v126
  v_add_u32 v232, s34, v232
  v_mov_b32 v233, 42048
  v_cvt_pk_f16_f32 v168, v136, v144
  v_cvt_pk_f16_f32 v169, v140, v148
  v_cndmask_b32 v233, v232, v233, s[40:41]
  ds_write_b64 v233, v[168:169] offset:0
  v_and_b32 v137, 0xffff0000, v120
  v_and_b32 v141, 0xffff0000, v122
  v_and_b32 v145, 0xffff0000, v124
  v_and_b32 v149, 0xffff0000, v126
  v_cvt_pk_f16_f32 v170, v137, v145
  v_cvt_pk_f16_f32 v171, v141, v149
  ds_write_b64 v232, v[170:171] offset:32
  v_lshlrev_b32 v138, 16, v121
  v_lshlrev_b32 v142, 16, v123
  v_lshlrev_b32 v146, 16, v125
  v_lshlrev_b32 v150, 16, v127
  v_cvt_pk_f16_f32 v172, v138, v146
  v_cvt_pk_f16_f32 v173, v142, v150
  ds_write_b64 v232, v[172:173] offset:64
  v_and_b32 v139, 0xffff0000, v121
  v_and_b32 v143, 0xffff0000, v123
  v_and_b32 v147, 0xffff0000, v125
  v_and_b32 v151, 0xffff0000, v127
  v_cvt_pk_f16_f32 v174, v139, v147
  v_cvt_pk_f16_f32 v175, v143, v151
  ds_write_b64 v232, v[174:175] offset:96
  s_cmp_lg_u32 s25, 0
  s_cbranch_scc1 nosp_3
  v_lshlrev_b32 v64, 16, v64
  v_lshlrev_b32 v65, 16, v65
  v_lshlrev_b32 v66, 16, v66
  v_lshlrev_b32 v67, 16, v67
  v_lshlrev_b32 v68, 16, v68
  v_lshlrev_b32 v69, 16, v69
  v_lshlrev_b32 v70, 16, v70
  v_lshlrev_b32 v71, 16, v71
  v_add_f32 v200, v64, v68
  v_sub_f32 v201, v65, v69
  v_add_f32 v202, v66, v70
  v_sub_f32 v203, v67, v71
  v_add_f32 v204, v200, v202
  v_add_f32 v205, v201, v203
  v_sub_f32 v206, v200, v202
  v_sub_f32 v207, v201, v203
  v_mul_f32 v204, 0x3e000000, v204
  v_mul_f32 v205, 0x3e000000, v205
  v_mul_f32 v206, 0x3e000000, v206
  v_mul_f32 v207, 0x3e000000, v207
  v_cvt_pk_f16_f32 v208, v204, v205
  v_cvt_pk_f16_f32 v209, v206, v207
  v_lshrrev_b32 v210, 2, v15
  s_mov_b64 exec, 0xff
  ds_write_b32 v210, v208 offset:0
  ds_write_b32 v210, v209 offset:41984
  s_mov_b64 exec, -1
nosp_3:
  s_waitcnt lgkmcnt(0)
  s_barrier
  v_lshrrev_b32 v232, 1, v0
  v_lshlrev_b32 v232, 5, v232
  v_lshrrev_b32 v233, 3, v0
  v_lshl_add_u32 v232, v233, 4, v232
  v_and_b32 v233, 1, v0
  v_lshl_add_u32 v232, v233, 4, v232
  ds_read_b128 v[216:219], v232 offset:0
  s_mul_i32 s30, s24, 8320
  s_add_u32 s30, s30, 0x540000
  s_add_u32 s31, s30, 0x1000
  ds_read_b128 v[220:223], v232 offset:4608
  s_waitcnt lgkmcnt(1)
  buffer_store_dwordx4 v[216:219], v2, s[8:11], s30 offen sc1
  s_waitcnt lgkmcnt(0)
  buffer_store_dwordx4 v[220:223], v2, s[8:11], s31 offen sc1
  s_cmp_lg_u32 s25, 0
  s_nop 0
  s_cbranch_scc1 nosp2_4
  ds_read_b128 v[200:203], v15 offset:41984
  s_mov_b64 exec, 3
  s_lshl_b32 s34, s24, 5
  s_add_u32 s34, s34, 0x7e0000
  s_waitcnt lgkmcnt(0)
  buffer_store_dwordx4 v[200:203], v15, s[8:11], s34 offen sc1
  s_mov_b64 exec, -1
  s_nop 0
nosp2_4:
  s_mov_b32 s34, 0x2000
  buffer_load_dwordx4 a[96:99], v15, s[16:19], s34 offen offset:0
  buffer_load_dwordx4 a[100:103], v15, s[16:19], s34 offen offset:1024
  buffer_load_dwordx4 a[104:107], v15, s[16:19], s34 offen offset:2048
  buffer_load_dwordx4 a[108:111], v15, s[16:19], s34 offen offset:3072
  s_mov_b32 s34, 0x3000
  buffer_load_dwordx4 a[112:115], v15, s[16:19], s34 offen offset:0
  s_mov_b32 s34, 0x3400
  buffer_load_dwordx4 a[116:119], v15, s[16:19], s34 offen offset:0
  s_mov_b32 s34, 0x3800
  buffer_load_dwordx4 v[40:43], v15, s[16:19], s34 offen offset:0
  buffer_load_dwordx4 v[44:47], v15, s[16:19], s34 offen offset:1024
  s_lshl_b32 s34, s25, 11
  v_add_u32 v244, s34, v15
  ds_write_b128 v244, v[32:35] offset:12288
  ds_write_b128 v244, v[36:39] offset:13312
  v_lshrrev_b32 v245, 1, v15
  v_add_u32 v245, s34, v245
  ds_read_b64_tr_b16 v[136:137], v245 offset:12288
  s_lshr_b32 s34, s25, 1
  s_lshl_b32 s35, s24, 1
  ds_read_b64_tr_b16 v[140:141], v245 offset:13312
  s_add_u32 s35, s35, s34
  s_lshl_b32 s28, s35, 1
  ds_read_b64_tr_b16 v[138:139], v245 offset:12800
  s_and_b32 s34, s25, 1
  s_lshl_b32 s34, s34, 6
  ds_read_b64_tr_b16 v[142:143], v245 offset:13824
  s_lshl_b32 s35, s35, 7
  s_add_u32 s35, s35, s34
  s_lshl_b32 s29, s35, 1
  s_mov_b32 s6, 0x20000
  s_mov_b32 s7, 0x20000
  s_mov_b32 s4, s52
  s_and_b32 s5, s53, 0xffff
  s_waitcnt lgkmcnt(3)
  v_and_b32 v105, 0xffff0000, v136
  v_lshlrev_b32 v104, 16, v136
  v_and_b32 v107, 0xffff0000, v137
  s_waitcnt lgkmcnt(2)
  v_lshlrev_b32 v112, 16, v140
  v_and_b32 v113, 0xffff0000, v140
  v_pk_mul_f32 v[238:239], v[112:113], v[112:113]
  s_waitcnt lgkmcnt(1)
  v_lshlrev_b32 v108, 16, v138
  v_lshlrev_b32 v110, 16, v139
  s_waitcnt lgkmcnt(0)
  v_lshlrev_b32 v116, 16, v142
  v_and_b32 v117, 0xffff0000, v142
  v_lshlrev_b32 v118, 16, v143
  v_lshlrev_b32 v114, 16, v141
  v_and_b32 v119, 0xffff0000, v143
  v_and_b32 v115, 0xffff0000, v141
  v_lshlrev_b32 v106, 16, v137
  v_pk_add_f32 v[232:233], v[104:105], v[106:107]
  v_pk_mul_f32 v[234:235], v[104:105], v[104:105]
  v_pk_fma_f32 v[234:235], v[106:107], v[106:107], v[234:235]
  v_pk_add_f32 v[236:237], v[112:113], v[114:115]
  v_and_b32 v109, 0xffff0000, v138
  v_pk_add_f32 v[232:233], v[232:233], v[108:109]
  v_pk_fma_f32 v[238:239], v[114:115], v[114:115], v[238:239]
  v_pk_fma_f32 v[238:239], v[116:117], v[116:117], v[238:239]
  v_pk_fma_f32 v[234:235], v[108:109], v[108:109], v[234:235]
  v_pk_add_f32 v[236:237], v[236:237], v[116:117]
  v_pk_add_f32 v[236:237], v[236:237], v[118:119]
  v_and_b32 v111, 0xffff0000, v139
  v_pk_fma_f32 v[234:235], v[110:111], v[110:111], v[234:235]
  v_pk_add_f32 v[232:233], v[232:233], v[110:111]
  v_add_f32 v236, v236, v237
  v_add_f32 v232, v232, v233
  v_add_f32 v234, v234, v235
  v_pk_fma_f32 v[238:239], v[118:119], v[118:119], v[238:239]
  v_add_f32 v238, v238, v239
  v_permlane32_swap_b32 v232, v236
  v_add_f32 v240, v232, v236
  v_permlane32_swap_b32 v234, v238
  v_add_f32 v242, v234, v238
  s_nop 1
  v_permlane16_swap_b32 v240, v242
  v_add_f32 v240, v240, v242
  s_nop 1
  v_add_f32 v240, v240, v240 row_ror:8
  s_nop 1
  v_add_f32 v240, v240, v240 row_ror:4
  s_nop 1
  v_add_f32 v240, v240, v240 row_ror:2
  s_nop 1
  v_add_f32 v240, v240, v240 row_ror:1
  v_mov_b32 v242, v240
  s_nop 1
  v_permlane16_swap_b32 v240, v242
  v_mul_f32 v242, s36, v242
  v_mul_f32 v240, s36, v240
  v_fma_f32 v242, -v240, v240, v242
  v_max_f32 v242, 0, v242
  v_add_f32 v242, s37, v242
  v_rsq_f32 v242, v242
  s_nop 0
  v_mov_b32 v232, v242
  v_mul_f32 v240, v240, v242
  v_mov_b32 v234, v240
  v_permlane32_swap_b32 v242, v232
  s_nop 0
  v_permlane32_swap_b32 v240, v234
  v_pk_fma_f32 v[156:157], v[116:117], v[232:233], v[234:235] op_sel_hi:[1,0,0] neg_lo:[0,0,1] neg_hi:[0,0,1]
  v_pk_fma_f32 v[154:155], v[114:115], v[232:233], v[234:235] op_sel_hi:[1,0,0] neg_lo:[0,0,1] neg_hi:[0,0,1]
  v_pk_fma_f32 v[150:151], v[110:111], v[242:243], v[240:241] op_sel_hi:[1,0,0] neg_lo:[0,0,1] neg_hi:[0,0,1]
  v_pk_fma_f32 v[158:159], v[118:119], v[232:233], v[234:235] op_sel_hi:[1,0,0] neg_lo:[0,0,1] neg_hi:[0,0,1]
  v_pk_fma_f32 v[148:149], v[108:109], v[242:243], v[240:241] op_sel_hi:[1,0,0] neg_lo:[0,0,1] neg_hi:[0,0,1]
  v_pk_fma_f32 v[144:145], v[104:105], v[242:243], v[240:241] op_sel_hi:[1,0,0] neg_lo:[0,0,1] neg_hi:[0,0,1]
  v_cvt_pk_f16_f32 v200, v144, v145
  v_cvt_pk_f16_f32 v205, v154, v155
  v_cvt_pk_f16_f32 v202, v148, v149
  v_cvt_pk_f16_f32 v207, v158, v159
  v_cvt_pk_f16_f32 v203, v150, v151
  v_pk_fma_f32 v[152:153], v[112:113], v[232:233], v[234:235] op_sel_hi:[1,0,0] neg_lo:[0,0,1] neg_hi:[0,0,1]
  v_pk_fma_f32 v[146:147], v[106:107], v[242:243], v[240:241] op_sel_hi:[1,0,0] neg_lo:[0,0,1] neg_hi:[0,0,1]
  v_cvt_pk_f16_f32 v201, v146, v147
  v_cvt_pk_f16_f32 v206, v156, v157
  v_cvt_pk_f16_f32 v204, v152, v153
  s_waitcnt vmcnt(6)
  v_mfma_f32_16x16x32_f16 v[172:175], v[200:203], a[100:103], 0
  v_lshrrev_b32 v232, 3, v15
  buffer_load_ushort v72, v232, s[4:7], s29 offen
  v_mfma_f32_16x16x32_f16 v[184:187], v[204:207], a[96:99], 0
  s_mov_b32 s4, s54
  s_and_b32 s5, s55, 0xffff
  buffer_load_ushort v73, v232, s[4:7], s29 offen
  v_mfma_f32_16x16x32_f16 v[168:171], v[200:203], a[96:99], 0
  s_mov_b32 s4, s56
  s_and_b32 s5, s57, 0xffff
  buffer_load_ushort v74, v232, s[4:7], s29 offen
  v_mfma_f32_16x16x32_f16 v[188:191], v[204:207], a[100:103], 0
  s_mov_b32 s4, s58
  s_and_b32 s5, s59, 0xffff
  buffer_load_ushort v75, v232, s[4:7], s29 offen
  s_waitcnt vmcnt(9)
  v_mfma_f32_16x16x32_f16 v[192:195], v[204:207], a[104:107], 0
  s_mov_b32 s4, s88
  v_cvt_pk_f16_f32 v171, v171, v175
  v_cvt_pk_f16_f32 v168, v168, v172
  s_waitcnt vmcnt(8)
  v_mfma_f32_16x16x32_f16 v[196:199], v[204:207], a[108:111], 0
  s_and_b32 s5, s89, 0xffff
  v_cvt_pk_f16_f32 v186, v186, v190
  v_cvt_pk_f16_f32 v185, v185, v189
  v_cvt_pk_f16_f32 v187, v187, v191
  s_waitcnt vmcnt(5)
  v_pk_mul_f16 v219, v187, v43 op_sel:[0,0] op_sel_hi:[0,1]
  v_pk_mul_f16 v217, v185, v41 op_sel:[0,0] op_sel_hi:[0,1]
  v_pk_mul_f16 v208, v168, v40 op_sel:[0,0] op_sel_hi:[0,1]
  v_pk_fma_f16 v208, v168, v40, v208 op_sel:[1,1,0] op_sel_hi:[1,0,1] neg_lo:[1,0,0]
  v_cvt_pk_f16_f32 v169, v169, v173
  v_pk_mul_f16 v209, v169, v41 op_sel:[0,0] op_sel_hi:[0,1]
  v_pk_fma_f16 v209, v169, v41, v209 op_sel:[1,1,0] op_sel_hi:[1,0,1] neg_lo:[1,0,0]
  v_pk_mul_f16 v218, v186, v42 op_sel:[0,0] op_sel_hi:[0,1]
  v_pk_fma_f16 v218, v186, v42, v218 op_sel:[1,1,0] op_sel_hi:[1,0,1] neg_lo:[1,0,0]
  v_cvt_pk_f16_f32 v184, v184, v188
  v_pk_mul_f16 v216, v184, v40 op_sel:[0,0] op_sel_hi:[0,1]
  v_pk_fma_f16 v216, v184, v40, v216 op_sel:[1,1,0] op_sel_hi:[1,0,1] neg_lo:[1,0,0]
  v_mfma_f32_16x16x32_f16 v[180:183], v[200:203], a[108:111], 0
  buffer_load_ushort v76, v232, s[4:7], s29 offen
  v_pk_fma_f16 v217, v185, v41, v217 op_sel:[1,1,0] op_sel_hi:[1,0,1] neg_lo:[1,0,0]
  v_cvt_pk_f16_f32 v170, v170, v174
  v_pk_mul_f16 v210, v170, v42 op_sel:[0,0] op_sel_hi:[0,1]
  v_pk_fma_f16 v210, v170, v42, v210 op_sel:[1,1,0] op_sel_hi:[1,0,1] neg_lo:[1,0,0]
  v_pk_mul_f16 v211, v171, v43 op_sel:[0,0] op_sel_hi:[0,1]
  v_pk_fma_f16 v211, v171, v43, v211 op_sel:[1,1,0] op_sel_hi:[1,0,1] neg_lo:[1,0,0]
  v_mfma_f32_16x16x32_f16 v[176:179], v[200:203], a[104:107], 0
  s_mov_b32 s4, s90
  v_pk_fma_f16 v219, v187, v43, v219 op_sel:[1,1,0] op_sel_hi:[1,0,1] neg_lo:[1,0,0]
  v_cvt_pk_f16_f32 v193, v193, v197
  v_mfma_f32_16x16x32_f16 v[152:155], a[116:119], v[208:211], 0
  s_and_b32 s5, s91, 0xffff
  v_cvt_pk_f16_f32 v195, v195, v199
  v_cvt_pk_f16_f32 v194, v194, v198
  v_mfma_f32_16x16x32_f16 v[156:159], a[116:119], v[216:219], 0
  buffer_load_ushort v77, v232, s[4:7], s29 offen
  v_cvt_pk_f16_f32 v176, v176, v180
  v_cvt_pk_f16_f32 v178, v178, v182
  v_mfma_f32_16x16x32_f16 v[136:139], a[112:115], v[208:211], 0
  s_mov_b32 s4, s92
  v_cvt_pk_f16_f32 v177, v177, v181
  s_waitcnt vmcnt(6)
  v_pk_mul_f16 v214, v178, v46 op_sel:[0,0] op_sel_hi:[0,1]
  v_mfma_f32_16x16x32_f16 v[144:147], a[112:115], v[216:219], 0
  s_and_b32 s5, s93, 0xffff
  v_pk_mul_f16 v213, v177, v45 op_sel:[0,0] op_sel_hi:[0,1]
  v_pk_mul_f16 v212, v176, v44 op_sel:[0,0] op_sel_hi:[0,1]
  v_pk_mul_f16 v223, v195, v47 op_sel:[0,0] op_sel_hi:[0,1]
  v_cndmask_b32 v137, v137, v153, s[40:41]
  v_cvt_pk_f16_f32 v224, v136, v137
  v_pk_fma_f16 v223, v195, v47, v223 op_sel:[1,1,0] op_sel_hi:[1,0,1] neg_lo:[1,0,0]
  v_pk_fma_f16 v213, v177, v45, v213 op_sel:[1,1,0] op_sel_hi:[1,0,1] neg_lo:[1,0,0]
  v_cndmask_b32 v145, v145, v157, s[40:41]
  v_cvt_pk_f16_f32 v225, v144, v145
  v_cvt_pk_f16_f32 v179, v179, v183
  v_pk_mul_f16 v215, v179, v47 op_sel:[0,0] op_sel_hi:[0,1]
  v_cvt_pk_f16_f32 v192, v192, v196
  v_pk_mul_f16 v220, v192, v44 op_sel:[0,0] op_sel_hi:[0,1]
  v_pk_fma_f16 v220, v192, v44, v220 op_sel:[1,1,0] op_sel_hi:[1,0,1] neg_lo:[1,0,0]
  v_pk_mul_f16 v221, v193, v45 op_sel:[0,0] op_sel_hi:[0,1]
  v_pk_fma_f16 v221, v193, v45, v221 op_sel:[1,1,0] op_sel_hi:[1,0,1] neg_lo:[1,0,0]
  v_pk_mul_f16 v222, v194, v46 op_sel:[0,0] op_sel_hi:[0,1]
  v_pk_fma_f16 v222, v194, v46, v222 op_sel:[1,1,0] op_sel_hi:[1,0,1] neg_lo:[1,0,0]
  v_pk_fma_f16 v215, v179, v47, v215 op_sel:[1,1,0] op_sel_hi:[1,0,1] neg_lo:[1,0,0]
  v_pk_fma_f16 v212, v176, v44, v212 op_sel:[1,1,0] op_sel_hi:[1,0,1] neg_lo:[1,0,0]
  v_mfma_f32_16x16x32_f16 v[148:151], a[112:115], v[220:223], 0
  ds_write_b64 v11, v[224:225] offset:29696
  s_mov_b32 s6, 1024
  v_pk_fma_f16 v214, v178, v46, v214 op_sel:[1,1,0] op_sel_hi:[1,0,1] neg_lo:[1,0,0]
  v_cvt_pk_f16_f32 v226, v138, v139
  v_cvt_pk_f16_f32 v227, v146, v147
  v_mfma_f32_16x16x32_f16 v[140:143], a[112:115], v[212:215], 0
  ds_write_b64 v11, v[226:227] offset:30720
  s_nop 0
  v_cvt_pk_f16_f32 v229, v148, v149
  v_cvt_pk_f16_f32 v231, v150, v151
  s_nop 3
  v_cvt_pk_f16_f32 v228, v140, v141
  ds_write_b64 v11, v[228:229] offset:30208
  v_cvt_pk_f16_f32 v230, v142, v143
  ds_write_b64 v11, v[230:231] offset:31232
  v_mov_b32 v233, 0
  buffer_load_ushort v78, v233, s[4:7], s28 offen
  s_waitcnt vmcnt(7)
  s_waitcnt lgkmcnt(0)
  s_barrier
  ds_read_b128 v[244:247], v98 offset:29696
  s_mul_i32 s30, s24, 8320
  s_add_u32 s30, s30, 0x0
  s_add_u32 s31, s30, 0x1000
  ds_read_b128 v[248:251], v98 offset:33792
  s_waitcnt lgkmcnt(1)
  v_or_b32 v244, 1, v244
  v_or_b32 v246, 1, v246
  buffer_store_dwordx4 v[244:247], v2, s[8:11], s30 offen sc1
  s_waitcnt lgkmcnt(0)
  v_or_b32 v248, 1, v248
  v_or_b32 v250, 1, v250
  buffer_store_dwordx4 v[248:251], v2, s[8:11], s31 offen sc1
  s_cmp_lg_u32 s25, 0
  s_nop 0
  s_cbranch_scc1 nocl_5
  s_mov_b64 exec, 0xffff
  buffer_load_dword v22, v15, s[96:99], 0 offen offset:0 sc1
  s_mov_b64 exec, -1
nocl_5:
  s_mov_b32 s34, 0x6800
  buffer_load_dwordx4 a[0:3], v16, s[16:19], s34 offen offset:0
  buffer_load_dwordx4 a[4:7], v16, s[16:19], s34 offen offset:1024
  buffer_load_dwordx4 a[8:11], v16, s[16:19], s34 offen offset:2048
  buffer_load_dwordx4 a[12:15], v16, s[16:19], s34 offen offset:3072
  s_mov_b32 s34, 0x7800
  buffer_load_dwordx4 a[16:19], v16, s[16:19], s34 offen offset:0
  buffer_load_dwordx4 a[20:23], v16, s[16:19], s34 offen offset:1024
  buffer_load_dwordx4 a[24:27], v16, s[16:19], s34 offen offset:2048
  buffer_load_dwordx4 a[28:31], v16, s[16:19], s34 offen offset:3072
  s_mov_b32 s34, 0x8800
  buffer_load_dwordx4 v[24:27], v16, s[16:19], s34 offen offset:0
  buffer_load_dwordx4 v[28:31], v16, s[16:19], s34 offen offset:1024
  s_mov_b32 s34, 0x0
  buffer_load_dwordx4 a[32:35], v15, s[16:19], s34 offen offset:0
  buffer_load_dwordx4 a[36:39], v15, s[16:19], s34 offen offset:1024
  buffer_load_dwordx4 a[40:43], v15, s[16:19], s34 offen offset:2048
  buffer_load_dwordx4 a[44:47], v15, s[16:19], s34 offen offset:3072
  s_mov_b32 s34, 0x1000
  buffer_load_dwordx4 a[48:51], v15, s[16:19], s34 offen offset:0
  buffer_load_dwordx4 a[52:55], v15, s[16:19], s34 offen offset:1024
  buffer_load_dwordx4 a[56:59], v15, s[16:19], s34 offen offset:2048
  buffer_load_dwordx4 a[60:63], v15, s[16:19], s34 offen offset:3072
  s_waitcnt vmcnt(22)
  v_lshlrev_b32 v76, 16, v76
  v_lshlrev_b32 v75, 16, v75
  s_mov_b32 s38, 0x3fb8aa3b
  s_waitcnt vmcnt(20)
  v_lshlrev_b32 v78, 16, v78
  v_mul_f32 v78, s38, v78
  v_exp_f32 v78, v78
  v_lshlrev_b32 v77, 16, v77
  v_cvt_pk_bf16_f32 v78, v78, v78
  v_lshlrev_b32 v73, 16, v73
  v_lshlrev_b32 v78, 16, v78
  v_mul_f32 v73, v78, v73
  v_lshlrev_b32 v74, 16, v74
  v_mul_f32 v74, v78, v74
  v_mul_f32 v80, v76, v74
  v_mul_f32 v75, v78, v75
  v_fma_f32 v80, -v77, v75, v80
  v_and_b32 v82, 0x7fffffff, v80
  v_mul_f32 v81, v76, v75
  v_fma_f32 v81, v77, v74, v81
  v_and_b32 v83, 0x7fffffff, v81
  v_add_f32 v82, v82, v83
  v_mov_b32 v83, v80
  v_lshlrev_b32 v72, 16, v72
  v_mul_f32 v72, v78, v72
  v_permlane32_swap_b32 v82, v83
  v_add_f32 v82, v82, v83
  v_mov_b32 v136, v82
  s_mov_b32 s39, 0x3e22f983
  v_mul_f32 v138, s39, v73
  v_permlane16_swap_b32 v82, v136
  v_add_f32 v82, v82, v136
  v_fract_f32 v140, v138
  v_mul_f32 v138, 0x42000000, v138
  v_add_f32 v82, v82, v82 row_ror:8
  v_cos_f32 v142, v140
  s_nop 0
  v_add_f32 v82, v82, v82 row_ror:4
  s_mov_b32 s35, 0x0da24260
  v_sin_f32 v143, v140
  v_add_f32 v82, v82, v82 row_ror:2
  v_mul_f32 v137, s38, v72
  v_exp_f32 v139, v137
  v_add_f32 v82, v82, v82 row_ror:1
  v_mul_f32 v142, v139, v142
  v_mov_b32 v83, v82
  v_mul_f32 v137, 0x42000000, v137
  v_mul_f32 v143, v139, v143
  v_exp_f32 v139, v137
  v_permlane32_swap_b32 v82, v83
  v_max_f32 v82, s35, v82
  v_rcp_f32 v136, v82
  v_fract_f32 v140, v138
  v_mul_f32 v83, v83, v136
  v_mul_f32 v81, v81, v136
  v_mul_f32 v80, v80, v136
  v_cos_f32 v84, v140
  v_sin_f32 v85, v140
  v_mul_f32 v84, v139, v84
  v_mul_f32 v85, v139, v85
  s_cmp_lg_u32 s25, 0
  s_nop 0
  s_cbranch_scc1 cntdone_7
  s_waitcnt vmcnt(0)
  s_mov_b64 exec, 0xffff
  v_cmp_gt_u32 vcc, 16, v22
  s_mov_b64 exec, -1
  s_cbranch_vccz cntdone_7
cnt_6:
  s_cmp_eq_u32 s26, 0
  s_cbranch_scc1 cntdone_7
  s_sub_u32 s26, s26, 1
  s_mov_b64 exec, 0xffff
  buffer_load_dword v22, v15, s[96:99], 0 offen offset:0 sc1
  s_waitcnt vmcnt(0)
  v_cmp_gt_u32 vcc, 16, v22
  s_mov_b64 exec, -1
  s_cbranch_vccnz cnt_6
cntdone_7:
  s_barrier
  s_lshl_b32 s28, s24, 5
  s_add_u32 s28, s28, 0x0
  s_add_u32 s29, s28, 0x41000
  buffer_load_dwordx4 v[244:247], v99, s[8:11], s28 offen sc1
  buffer_load_dwordx4 v[248:251], v99, s[8:11], s29 offen sc1
  v_mov_b32 v86, v142
  s_mul_i32 s33, s25, 8704
  s_add_u32 s33, s33, 41984
  s_mov_b32 m0, s33
  v_mov_b32 v87, v143
  v_pk_mul_f32 v[144:145], v[86:87], v[142:143] op_sel:[0,0] op_sel_hi:[0,1]
  v_cvt_pk_f16_f32 v146, v86, -v87
  ds_write_addtid_b32 v146 offset:0
  v_pk_fma_f32 v[86:87], v[86:87], v[142:143], v[144:145] op_sel:[1,1,0] op_sel_hi:[1,0,1] neg_lo:[1,0,0]
  v_cvt_pk_f16_f32 v147, v86, -v87
  v_pk_mul_f32 v[144:145], v[86:87], v[142:143] op_sel:[0,0] op_sel_hi:[0,1]
  v_pk_fma_f32 v[86:87], v[86:87], v[142:143], v[144:145] op_sel:[1,1,0] op_sel_hi:[1,0,1] neg_lo:[1,0,0]
  v_cvt_pk_f16_f32 v148, v86, -v87
  v_pk_mul_f32 v[144:145], v[86:87], v[142:143] op_sel:[0,0] op_sel_hi:[0,1]
  v_pk_fma_f32 v[86:87], v[86:87], v[142:143], v[144:145] op_sel:[1,1,0] op_sel_hi:[1,0,1] neg_lo:[1,0,0]
  v_pk_mul_f32 v[144:145], v[86:87], v[142:143] op_sel:[0,0] op_sel_hi:[0,1]
  ds_write_addtid_b32 v147 offset:272
  v_cvt_pk_f16_f32 v149, v86, -v87
  ds_write_addtid_b32 v148 offset:544
  ds_write_addtid_b32 v149 offset:816
  v_pk_fma_f32 v[86:87], v[86:87], v[142:143], v[144:145] op_sel:[1,1,0] op_sel_hi:[1,0,1] neg_lo:[1,0,0]
  v_cvt_pk_f16_f32 v146, v86, -v87
  ds_write_addtid_b32 v146 offset:1088
  v_pk_mul_f32 v[144:145], v[86:87], v[142:143] op_sel:[0,0] op_sel_hi:[0,1]
  v_pk_fma_f32 v[86:87], v[86:87], v[142:143], v[144:145] op_sel:[1,1,0] op_sel_hi:[1,0,1] neg_lo:[1,0,0]
  v_pk_mul_f32 v[144:145], v[86:87], v[142:143] op_sel:[0,0] op_sel_hi:[0,1]
  v_cvt_pk_f16_f32 v147, v86, -v87
  v_pk_fma_f32 v[86:87], v[86:87], v[142:143], v[144:145] op_sel:[1,1,0] op_sel_hi:[1,0,1] neg_lo:[1,0,0]
  ds_write_addtid_b32 v147 offset:1360
  v_pk_mul_f32 v[144:145], v[86:87], v[142:143] op_sel:[0,0] op_sel_hi:[0,1]
  v_cvt_pk_f16_f32 v148, v86, -v87
  v_pk_fma_f32 v[86:87], v[86:87], v[142:143], v[144:145] op_sel:[1,1,0] op_sel_hi:[1,0,1] neg_lo:[1,0,0]
  v_pk_mul_f32 v[144:145], v[86:87], v[142:143] op_sel:[0,0] op_sel_hi:[0,1]
  v_cvt_pk_f16_f32 v149, v86, -v87
  ds_write_addtid_b32 v148 offset:1632
  ds_write_addtid_b32 v149 offset:1904
  v_pk_fma_f32 v[86:87], v[86:87], v[142:143], v[144:145] op_sel:[1,1,0] op_sel_hi:[1,0,1] neg_lo:[1,0,0]
  v_pk_mul_f32 v[144:145], v[86:87], v[142:143] op_sel:[0,0] op_sel_hi:[0,1]
  v_cvt_pk_f16_f32 v146, v86, -v87
  ds_write_addtid_b32 v146 offset:2176
  v_pk_fma_f32 v[86:87], v[86:87], v[142:143], v[144:145] op_sel:[1,1,0] op_sel_hi:[1,0,1] neg_lo:[1,0,0]
  v_cvt_pk_f16_f32 v147, v86, -v87
  v_pk_mul_f32 v[144:145], v[86:87], v[142:143] op_sel:[0,0] op_sel_hi:[0,1]
  v_pk_fma_f32 v[86:87], v[86:87], v[142:143], v[144:145] op_sel:[1,1,0] op_sel_hi:[1,0,1] neg_lo:[1,0,0]
  v_pk_mul_f32 v[144:145], v[86:87], v[142:143] op_sel:[0,0] op_sel_hi:[0,1]
  v_cvt_pk_f16_f32 v148, v86, -v87
  v_pk_fma_f32 v[86:87], v[86:87], v[142:143], v[144:145] op_sel:[1,1,0] op_sel_hi:[1,0,1] neg_lo:[1,0,0]
  v_cvt_pk_f16_f32 v149, v86, -v87
  ds_write_addtid_b32 v147 offset:2448
  ds_write_addtid_b32 v148 offset:2720
  ds_write_addtid_b32 v149 offset:2992
  v_pk_mul_f32 v[144:145], v[86:87], v[142:143] op_sel:[0,0] op_sel_hi:[0,1]
  v_pk_fma_f32 v[86:87], v[86:87], v[142:143], v[144:145] op_sel:[1,1,0] op_sel_hi:[1,0,1] neg_lo:[1,0,0]
  v_cvt_pk_f16_f32 v146, v86, -v87
  ds_write_addtid_b32 v146 offset:3264
  v_pk_mul_f32 v[144:145], v[86:87], v[142:143] op_sel:[0,0] op_sel_hi:[0,1]
  v_pk_fma_f32 v[86:87], v[86:87], v[142:143], v[144:145] op_sel:[1,1,0] op_sel_hi:[1,0,1] neg_lo:[1,0,0]
  v_pk_mul_f32 v[144:145], v[86:87], v[142:143] op_sel:[0,0] op_sel_hi:[0,1]
  v_cvt_pk_f16_f32 v147, v86, -v87
  v_pk_fma_f32 v[86:87], v[86:87], v[142:143], v[144:145] op_sel:[1,1,0] op_sel_hi:[1,0,1] neg_lo:[1,0,0]
  v_pk_mul_f32 v[144:145], v[86:87], v[142:143] op_sel:[0,0] op_sel_hi:[0,1]
  v_cvt_pk_f16_f32 v148, v86, -v87
  v_pk_fma_f32 v[86:87], v[86:87], v[142:143], v[144:145] op_sel:[1,1,0] op_sel_hi:[1,0,1] neg_lo:[1,0,0]
  v_cvt_pk_f16_f32 v149, v86, -v87
  v_pk_mul_f32 v[144:145], v[86:87], v[142:143] op_sel:[0,0] op_sel_hi:[0,1]
  ds_write_addtid_b32 v147 offset:3536
  ds_write_addtid_b32 v148 offset:3808
  ds_write_addtid_b32 v149 offset:4080
  v_pk_fma_f32 v[86:87], v[86:87], v[142:143], v[144:145] op_sel:[1,1,0] op_sel_hi:[1,0,1] neg_lo:[1,0,0]
  v_cvt_pk_f16_f32 v146, v86, -v87
  ds_write_addtid_b32 v146 offset:4352
  v_pk_mul_f32 v[144:145], v[86:87], v[142:143] op_sel:[0,0] op_sel_hi:[0,1]
  v_pk_fma_f32 v[86:87], v[86:87], v[142:143], v[144:145] op_sel:[1,1,0] op_sel_hi:[1,0,1] neg_lo:[1,0,0]
  v_cvt_pk_f16_f32 v147, v86, -v87
  v_pk_mul_f32 v[144:145], v[86:87], v[142:143] op_sel:[0,0] op_sel_hi:[0,1]
  v_pk_fma_f32 v[86:87], v[86:87], v[142:143], v[144:145] op_sel:[1,1,0] op_sel_hi:[1,0,1] neg_lo:[1,0,0]
  v_pk_mul_f32 v[144:145], v[86:87], v[142:143] op_sel:[0,0] op_sel_hi:[0,1]
  ds_write_addtid_b32 v147 offset:4624
  v_cvt_pk_f16_f32 v148, v86, -v87
  v_pk_fma_f32 v[86:87], v[86:87], v[142:143], v[144:145] op_sel:[1,1,0] op_sel_hi:[1,0,1] neg_lo:[1,0,0]
  v_cvt_pk_f16_f32 v149, v86, -v87
  ds_write_addtid_b32 v148 offset:4896
  ds_write_addtid_b32 v149 offset:5168
  v_pk_mul_f32 v[144:145], v[86:87], v[142:143] op_sel:[0,0] op_sel_hi:[0,1]
  v_pk_fma_f32 v[86:87], v[86:87], v[142:143], v[144:145] op_sel:[1,1,0] op_sel_hi:[1,0,1] neg_lo:[1,0,0]
  v_cvt_pk_f16_f32 v146, v86, -v87
  ds_write_addtid_b32 v146 offset:5440
  v_pk_mul_f32 v[144:145], v[86:87], v[142:143] op_sel:[0,0] op_sel_hi:[0,1]
  v_pk_fma_f32 v[86:87], v[86:87], v[142:143], v[144:145] op_sel:[1,1,0] op_sel_hi:[1,0,1] neg_lo:[1,0,0]
  v_cvt_pk_f16_f32 v147, v86, -v87
  v_and_b32 v151, 15, v0
  ds_write_addtid_b32 v147 offset:5712
  v_pk_mul_f32 v[144:145], v[86:87], v[142:143] op_sel:[0,0] op_sel_hi:[0,1]
  v_pk_fma_f32 v[86:87], v[86:87], v[142:143], v[144:145] op_sel:[1,1,0] op_sel_hi:[1,0,1] neg_lo:[1,0,0]
  v_cvt_pk_f16_f32 v148, v86, -v87
  ds_write_addtid_b32 v148 offset:5984
  v_pk_mul_f32 v[144:145], v[86:87], v[142:143] op_sel:[0,0] op_sel_hi:[0,1]
  v_pk_fma_f32 v[86:87], v[86:87], v[142:143], v[144:145] op_sel:[1,1,0] op_sel_hi:[1,0,1] neg_lo:[1,0,0]
  v_pk_mul_f32 v[144:145], v[86:87], v[142:143] op_sel:[0,0] op_sel_hi:[0,1]
  v_cvt_pk_f16_f32 v149, v86, -v87
  v_pk_fma_f32 v[86:87], v[86:87], v[142:143], v[144:145] op_sel:[1,1,0] op_sel_hi:[1,0,1] neg_lo:[1,0,0]
  v_pk_mul_f32 v[144:145], v[86:87], v[142:143] op_sel:[0,0] op_sel_hi:[0,1]
  v_cvt_pk_f16_f32 v146, v86, -v87
  v_pk_fma_f32 v[86:87], v[86:87], v[142:143], v[144:145] op_sel:[1,1,0] op_sel_hi:[1,0,1] neg_lo:[1,0,0]
  v_pk_mul_f32 v[144:145], v[86:87], v[142:143] op_sel:[0,0] op_sel_hi:[0,1]
  v_cvt_pk_f16_f32 v147, v86, -v87
  v_pk_fma_f32 v[86:87], v[86:87], v[142:143], v[144:145] op_sel:[1,1,0] op_sel_hi:[1,0,1] neg_lo:[1,0,0]
  v_cvt_pk_f16_f32 v148, v86, -v87
  ds_write_addtid_b32 v149 offset:6256
  ds_write_addtid_b32 v146 offset:6528
  ds_write_addtid_b32 v147 offset:6800
  ds_write_addtid_b32 v148 offset:7072
  v_pk_mul_f32 v[144:145], v[86:87], v[142:143] op_sel:[0,0] op_sel_hi:[0,1]
  v_pk_fma_f32 v[86:87], v[86:87], v[142:143], v[144:145] op_sel:[1,1,0] op_sel_hi:[1,0,1] neg_lo:[1,0,0]
  v_cvt_pk_f16_f32 v149, v86, -v87
  v_pk_mul_f32 v[144:145], v[86:87], v[142:143] op_sel:[0,0] op_sel_hi:[0,1]
  v_pk_fma_f32 v[86:87], v[86:87], v[142:143], v[144:145] op_sel:[1,1,0] op_sel_hi:[1,0,1] neg_lo:[1,0,0]
  v_cvt_pk_f16_f32 v146, v86, -v87
  v_pk_mul_f32 v[144:145], v[86:87], v[142:143] op_sel:[0,0] op_sel_hi:[0,1]
  v_pk_fma_f32 v[86:87], v[86:87], v[142:143], v[144:145] op_sel:[1,1,0] op_sel_hi:[1,0,1] neg_lo:[1,0,0]
  v_pk_mul_f32 v[144:145], v[86:87], v[142:143] op_sel:[0,0] op_sel_hi:[0,1]
  v_cvt_pk_f16_f32 v147, v86, -v87
  v_pk_fma_f32 v[86:87], v[86:87], v[142:143], v[144:145] op_sel:[1,1,0] op_sel_hi:[1,0,1] neg_lo:[1,0,0]
  v_pk_mul_f32 v[144:145], v[86:87], v[142:143] op_sel:[0,0] op_sel_hi:[0,1]
  ds_write_addtid_b32 v149 offset:7344
  ds_write_addtid_b32 v146 offset:7616
  ds_write_addtid_b32 v147 offset:7888
  v_bfe_u32 v152, v0, 4, 2
  s_waitcnt vmcnt(0)
  v_and_b32 v253, v248, v250
  v_cvt_pk_f16_f32 v148, v86, -v87
  v_pk_fma_f32 v[86:87], v[86:87], v[142:143], v[144:145] op_sel:[1,1,0] op_sel_hi:[1,0,1] neg_lo:[1,0,0]
  ds_write_addtid_b32 v148 offset:8160
  v_cvt_pk_f16_f32 v149, v86, -v87
  v_mov_b32 v87, v81
  v_mov_b32 v86, v80
  ds_write_addtid_b32 v149 offset:8432
  v_mul_u32_u24 v150, 272, v151
  v_lshl_add_u32 v150, v152, 4, v150
  v_add_u32 v150, s33, v150
  ds_read_b128 a[168:171], v150 offset:4352
  ds_read_b128 a[164:167], v150 offset:192
  ds_read_b128 a[156:159], v150 offset:64
  ds_read_b128 a[160:163], v150 offset:128
  ds_read_b128 a[176:179], v150 offset:4480
  ds_read_b128 a[172:175], v150 offset:4416
  ds_read_b128 a[180:183], v150 offset:4544
  v_and_b32 v252, v244, v246
  v_and_b32 v252, v252, v253
  v_and_b32 v252, 1, v252
  v_cmp_eq_u32 vcc, 0, v252
  ds_read_b128 a[152:155], v150 offset:0
  s_cbranch_vccz polldone_9
poll_8:
  s_cmp_eq_u32 s26, 0
  s_cbranch_scc1 polldone_9
  s_sub_u32 s26, s26, 1
  s_mov_b64 exec, vcc
  buffer_load_dwordx4 v[244:247], v99, s[8:11], s28 offen sc1
  buffer_load_dwordx4 v[248:251], v99, s[8:11], s29 offen sc1
  s_waitcnt vmcnt(0)
  v_and_b32 v252, v244, v246
  v_and_b32 v253, v248, v250
  v_and_b32 v252, v252, v253
  v_and_b32 v252, 1, v252
  v_cmp_eq_u32 vcc, 0, v252
  s_nop 0
  s_cbranch_vccnz poll_8
polldone_9:
  s_mov_b64 exec, -1
  s_lshl_b32 s42, s24, 5
  s_add_u32 s42, s42, 0x540000
  s_add_u32 s43, s42, 0x4100
  buffer_load_dwordx4 v[56:59], v20, s[8:11], s42 offen sc1
  buffer_load_dwordx4 v[60:63], v20, s[8:11], s43 offen sc1
  s_mov_b32 s65, 0
layer_loop:
  ds_write_b128 v100, v[244:247] offset:0
  ds_write_b128 v100, v[248:251] offset:256
  s_waitcnt lgkmcnt(0)
  s_barrier
  s_cmp_eq_u32 s24, 0
  s_cbranch_scc1 ca_sp_10
  ds_read_b128 v[136:139], v6 offset:0
  ds_read_b128 v[152:155], v6 offset:256
  ds_read_b128 v[140:143], v6 offset:2048
  ds_read_b128 v[144:147], v6 offset:4096
  ds_read_b128 v[156:159], v6 offset:2304
  ds_read_b128 v[160:163], v6 offset:4352
  ds_read_b128 v[164:167], v6 offset:6400
  s_waitcnt lgkmcnt(6)
  v_mfma_f32_16x16x32_f16 v[168:171], v[136:139], a[0:3], 0
  ds_read_b128 v[148:151], v6 offset:6144
  v_mfma_f32_16x16x32_f16 v[176:179], v[136:139], a[16:19], 0
  s_waitcnt lgkmcnt(5)
  v_mfma_f32_16x16x32_f16 v[176:179], v[140:143], a[20:23], v[176:179]
  v_mfma_f32_16x16x32_f16 v[180:183], v[152:155], a[16:19], 0
  v_mfma_f32_16x16x32_f16 v[168:171], v[140:143], a[4:7], v[168:171]
  v_mfma_f32_16x16x32_f16 v[172:175], v[152:155], a[0:3], 0
  s_waitcnt lgkmcnt(4)
  v_mfma_f32_16x16x32_f16 v[168:171], v[144:147], a[8:11], v[168:171]
  v_mfma_f32_16x16x32_f16 v[176:179], v[144:147], a[24:27], v[176:179]
  s_waitcnt lgkmcnt(3)
  v_mfma_f32_16x16x32_f16 v[180:183], v[156:159], a[20:23], v[180:183]
  v_mfma_f32_16x16x32_f16 v[172:175], v[156:159], a[4:7], v[172:175]
  s_waitcnt lgkmcnt(0)
  v_mfma_f32_16x16x32_f16 v[176:179], v[148:151], a[28:31], v[176:179]
  v_mfma_f32_16x16x32_f16 v[168:171], v[148:151], a[12:15], v[168:171]
  v_mfma_f32_16x16x32_f16 v[172:175], v[160:163], a[8:11], v[172:175]
  v_mfma_f32_16x16x32_f16 v[180:183], v[160:163], a[24:27], v[180:183]
  s_nop 5
  v_cvt_pk_f16_f32 v169, v169, v177
  v_cvt_pk_f16_f32 v168, v168, v176
  v_mfma_f32_16x16x32_f16 v[172:175], v[164:167], a[12:15], v[172:175]
  v_cvt_pk_f16_f32 v171, v171, v179
  v_pk_mul_f16 v200, v168, v24 op_sel:[0,0] op_sel_hi:[0,1]
  v_mfma_f32_16x16x32_f16 v[180:183], v[164:167], a[28:31], v[180:183]
  v_pk_fma_f16 v200, v168, v24, v200 op_sel:[1,1,0] op_sel_hi:[1,0,1] neg_lo:[1,0,0]
  v_cvt_pk_f16_f32 v170, v170, v178
  v_pk_mul_f16 v202, v170, v26 op_sel:[0,0] op_sel_hi:[0,1]
  v_pk_mul_f16 v201, v169, v25 op_sel:[0,0] op_sel_hi:[0,1]
  v_pk_fma_f16 v201, v169, v25, v201 op_sel:[1,1,0] op_sel_hi:[1,0,1] neg_lo:[1,0,0]
  v_pk_mul_f16 v203, v171, v27 op_sel:[0,0] op_sel_hi:[0,1]
  v_pk_fma_f16 v203, v171, v27, v203 op_sel:[1,1,0] op_sel_hi:[1,0,1] neg_lo:[1,0,0]
  s_nop 0
  v_cvt_pk_f16_f32 v174, v174, v182
  v_pk_fma_f16 v202, v170, v26, v202 op_sel:[1,1,0] op_sel_hi:[1,0,1] neg_lo:[1,0,0]
  v_pk_mul_f16 v206, v174, v30 op_sel:[0,0] op_sel_hi:[0,1]
  v_cvt_pk_f16_f32 v173, v173, v181
  v_mfma_f32_16x16x32_f16 v[184:187], a[32:35], v[200:203], 0
  v_cvt_pk_f16_f32 v175, v175, v183
  v_pk_mul_f16 v207, v175, v31 op_sel:[0,0] op_sel_hi:[0,1]
  v_pk_mul_f16 v205, v173, v29 op_sel:[0,0] op_sel_hi:[0,1]
  v_pk_fma_f16 v206, v174, v30, v206 op_sel:[1,1,0] op_sel_hi:[1,0,1] neg_lo:[1,0,0]
  v_pk_fma_f16 v205, v173, v29, v205 op_sel:[1,1,0] op_sel_hi:[1,0,1] neg_lo:[1,0,0]
  v_cvt_pk_f16_f32 v172, v172, v180
  v_mfma_f32_16x16x32_f16 v[188:191], a[40:43], v[200:203], 0
  v_pk_mul_f16 v204, v172, v28 op_sel:[0,0] op_sel_hi:[0,1]
  v_pk_fma_f16 v204, v172, v28, v204 op_sel:[1,1,0] op_sel_hi:[1,0,1] neg_lo:[1,0,0]
  v_mfma_f32_16x16x32_f16 v[192:195], a[48:51], v[200:203], 0
  v_pk_fma_f16 v207, v175, v31, v207 op_sel:[1,1,0] op_sel_hi:[1,0,1] neg_lo:[1,0,0]
  v_mfma_f32_16x16x32_f16 v[196:199], a[56:59], v[200:203], 0
  s_nop 0
  v_mfma_f32_16x16x32_f16 v[184:187], a[36:39], v[204:207], v[184:187]
  v_mfma_f32_16x16x32_f16 v[188:191], a[44:47], v[204:207], v[188:191]
  v_mfma_f32_16x16x32_f16 v[192:195], a[52:55], v[204:207], v[192:195]
  s_nop 5
  v_cvt_pk_f16_f32 v184, v184, v185
  s_waitcnt vmcnt(1)
  v_pk_mul_f16 v208, v184, v56 op_sel:[0,0] op_sel_hi:[0,1] neg_hi:[0,1]
  v_mfma_f32_16x16x32_f16 v[196:199], a[60:63], v[204:207], v[196:199]
  v_cvt_pk_f16_f32 v188, v188, v189
  v_cvt_pk_f16_f32 v190, v190, v191
  v_pk_fma_f16 v208, v184, v56, v208 op_sel:[1,1,0] op_sel_hi:[1,0,1] neg_lo:[1,0,0] neg_hi:[1,0,0]
  v_cvt_pk_f16_f32 v186, v186, v187
  v_pk_mul_f16 v209, v186, v57 op_sel:[0,0] op_sel_hi:[0,1] neg_hi:[0,1]
  v_pk_fma_f16 v209, v186, v57, v209 op_sel:[1,1,0] op_sel_hi:[1,0,1] neg_lo:[1,0,0] neg_hi:[1,0,0]
  v_pk_mul_f16 v211, v190, v59 op_sel:[0,0] op_sel_hi:[0,1] neg_hi:[0,1]
  v_pk_fma_f16 v211, v190, v59, v211 op_sel:[1,1,0] op_sel_hi:[1,0,1] neg_lo:[1,0,0] neg_hi:[1,0,0]
  v_pk_mul_f16 v210, v188, v58 op_sel:[0,0] op_sel_hi:[0,1] neg_hi:[0,1]
  v_cvt_pk_f16_f32 v198, v198, v199
  v_pk_fma_f16 v210, v188, v58, v210 op_sel:[1,1,0] op_sel_hi:[1,0,1] neg_lo:[1,0,0] neg_hi:[1,0,0]
  v_cvt_pk_f16_f32 v194, v194, v195
  s_waitcnt vmcnt(0)
  v_pk_mul_f16 v213, v194, v61 op_sel:[0,0] op_sel_hi:[0,1] neg_hi:[0,1]
  v_cvt_pk_f16_f32 v192, v192, v193
  v_cvt_pk_f16_f32 v196, v196, v197
  v_pk_mul_f16 v214, v196, v62 op_sel:[0,0] op_sel_hi:[0,1] neg_hi:[0,1]
  v_mfma_f32_16x16x32_f16 v[168:171], a[32:35], v[208:211], 0
  v_pk_mul_f16 v212, v192, v60 op_sel:[0,0] op_sel_hi:[0,1] neg_hi:[0,1]
  v_pk_fma_f16 v214, v196, v62, v214 op_sel:[1,1,0] op_sel_hi:[1,0,1] neg_lo:[1,0,0] neg_hi:[1,0,0]
  v_pk_mul_f16 v215, v198, v63 op_sel:[0,0] op_sel_hi:[0,1] neg_hi:[0,1]
  v_pk_fma_f16 v215, v198, v63, v215 op_sel:[1,1,0] op_sel_hi:[1,0,1] neg_lo:[1,0,0] neg_hi:[1,0,0]
  v_pk_fma_f16 v212, v192, v60, v212 op_sel:[1,1,0] op_sel_hi:[1,0,1] neg_lo:[1,0,0] neg_hi:[1,0,0]
  v_pk_fma_f16 v213, v194, v61, v213 op_sel:[1,1,0] op_sel_hi:[1,0,1] neg_lo:[1,0,0] neg_hi:[1,0,0]
  v_mfma_f32_16x16x32_f16 v[172:175], a[40:43], v[208:211], 0
  s_nop 0
  v_mfma_f32_16x16x32_f16 v[168:171], a[36:39], v[212:215], v[168:171]
  v_mfma_f32_16x16x32_f16 v[172:175], a[44:47], v[212:215], v[172:175]
  v_mfma_f32_16x16x32_f16 v[176:179], a[48:51], v[208:211], 0
  s_nop 5
  v_cvt_pk_f16_f32 v170, v170, v171
  v_cvt_pk_f16_f32 v168, v168, v169
  v_pk_mul_f16 v216, v168, v24 op_sel:[0,0] op_sel_hi:[0,1]
  v_pk_fma_f16 v216, v168, v24, v216 op_sel:[1,1,0] op_sel_hi:[1,0,1] neg_lo:[1,0,0]
  ds_write_b32 v7, v216 offset:12288
  v_mfma_f32_16x16x32_f16 v[176:179], a[52:55], v[212:215], v[176:179]
  v_pk_mul_f16 v217, v170, v25 op_sel:[0,0] op_sel_hi:[0,1]
  v_pk_fma_f16 v217, v170, v25, v217 op_sel:[1,1,0] op_sel_hi:[1,0,1] neg_lo:[1,0,0]
  ds_write_b32 v7, v217 offset:12304
  v_mfma_f32_16x16x32_f16 v[180:183], a[56:59], v[208:211], 0
  v_cvt_pk_f16_f32 v172, v172, v173
  v_pk_mul_f16 v218, v172, v26 op_sel:[0,0] op_sel_hi:[0,1]
  v_pk_fma_f16 v218, v172, v26, v218 op_sel:[1,1,0] op_sel_hi:[1,0,1] neg_lo:[1,0,0]
  ds_write_b32 v96, v218 offset:12288
  v_mfma_f32_16x16x32_f16 v[180:183], a[60:63], v[212:215], v[180:183]
  v_cvt_pk_f16_f32 v174, v174, v175
  v_pk_mul_f16 v219, v174, v27 op_sel:[0,0] op_sel_hi:[0,1]
  v_pk_fma_f16 v219, v174, v27, v219 op_sel:[1,1,0] op_sel_hi:[1,0,1] neg_lo:[1,0,0]
  ds_write_b32 v96, v219 offset:12304
  v_cvt_pk_f16_f32 v176, v176, v177
  v_pk_mul_f16 v220, v176, v28 op_sel:[0,0] op_sel_hi:[0,1]
  v_pk_fma_f16 v220, v176, v28, v220 op_sel:[1,1,0] op_sel_hi:[1,0,1] neg_lo:[1,0,0]
  ds_write_b32 v7, v220 offset:12544
  v_cvt_pk_f16_f32 v180, v180, v181
  v_cvt_pk_f16_f32 v178, v178, v179
  v_pk_mul_f16 v221, v178, v29 op_sel:[0,0] op_sel_hi:[0,1]
  v_pk_fma_f16 v221, v178, v29, v221 op_sel:[1,1,0] op_sel_hi:[1,0,1] neg_lo:[1,0,0]
  ds_write_b32 v7, v221 offset:12560
  v_pk_mul_f16 v222, v180, v30 op_sel:[0,0] op_sel_hi:[0,1]
  v_pk_fma_f16 v222, v180, v30, v222 op_sel:[1,1,0] op_sel_hi:[1,0,1] neg_lo:[1,0,0]
  ds_write_b32 v96, v222 offset:12544
  v_cvt_pk_f16_f32 v182, v182, v183
  v_pk_mul_f16 v223, v182, v31 op_sel:[0,0] op_sel_hi:[0,1]
  v_pk_fma_f16 v223, v182, v31, v223 op_sel:[1,1,0] op_sel_hi:[1,0,1] neg_lo:[1,0,0]
  ds_write_b32 v96, v223 offset:12560
  s_waitcnt lgkmcnt(0)
  s_barrier
  ds_read_b128 v[136:139], v6 offset:12288
  s_mul_i32 s30, s24, 8320
  ds_read_b128 v[156:159], v6 offset:14592
  s_add_u32 s30, s30, 0x2a0000
  ds_read_b128 v[152:155], v6 offset:12544
  s_add_u32 s31, s30, 0x1000
  ds_read_b128 v[140:143], v6 offset:14336
  ds_read_b128 v[144:147], v6 offset:16384
  ds_read_b128 v[160:163], v6 offset:16640
  ds_read_b128 v[148:151], v6 offset:18432
  s_waitcnt lgkmcnt(6)
  v_mfma_f32_16x16x32_f16 v[192:195], a[16:19], v[136:139], 0
  ds_read_b128 v[164:167], v6 offset:18688
  v_mfma_f32_16x16x32_f16 v[184:187], a[0:3], v[136:139], 0
  s_waitcnt lgkmcnt(5)
  v_mfma_f32_16x16x32_f16 v[188:191], a[0:3], v[152:155], 0
  v_mfma_f32_16x16x32_f16 v[188:191], a[4:7], v[156:159], v[188:191]
  s_waitcnt lgkmcnt(4)
  v_mfma_f32_16x16x32_f16 v[192:195], a[20:23], v[140:143], v[192:195]
  s_waitcnt lgkmcnt(3)
  v_mfma_f32_16x16x32_f16 v[192:195], a[24:27], v[144:147], v[192:195]
  s_waitcnt lgkmcnt(2)
  v_mfma_f32_16x16x32_f16 v[188:191], a[8:11], v[160:163], v[188:191]
  v_mfma_f32_16x16x32_f16 v[196:199], a[16:19], v[152:155], 0
  v_mfma_f32_16x16x32_f16 v[184:187], a[4:7], v[140:143], v[184:187]
  v_mfma_f32_16x16x32_f16 v[184:187], a[8:11], v[144:147], v[184:187]
  s_waitcnt lgkmcnt(1)
  v_mfma_f32_16x16x32_f16 v[184:187], a[12:15], v[148:151], v[184:187]
  v_mfma_f32_16x16x32_f16 v[192:195], a[28:31], v[148:151], v[192:195]
  v_mfma_f32_16x16x32_f16 v[196:199], a[20:23], v[156:159], v[196:199]
  v_mfma_f32_16x16x32_f16 v[196:199], a[24:27], v[160:163], v[196:199]
  s_nop 5
  v_cvt_pk_f16_f32 v235, v187, -v195
  s_waitcnt lgkmcnt(0)
  v_mfma_f32_16x16x32_f16 v[188:191], a[12:15], v[164:167], v[188:191]
  v_cvt_pk_f16_f32 v234, v186, -v194
  v_mfma_f32_16x16x32_f16 v[196:199], a[28:31], v[164:167], v[196:199]
  v_cvt_pk_f16_f32 v233, v185, -v193
  v_or_b32 v234, 1, v234
  v_cvt_pk_f16_f32 v232, v184, -v192
  v_or_b32 v232, 1, v232
  buffer_store_dwordx4 v[232:235], v3, s[8:11], s30 offen sc1
  s_nop 2
  v_cvt_pk_f16_f32 v237, v189, -v197
  v_cvt_pk_f16_f32 v238, v190, -v198
  v_cvt_pk_f16_f32 v239, v191, -v199
  v_cvt_pk_f16_f32 v236, v188, -v196
  v_or_b32 v236, 1, v236
  v_or_b32 v238, 1, v238
  buffer_store_dwordx4 v[236:239], v3, s[8:11], s30 offen offset:1024 sc1
  s_nop 1
ca_join_11:
  s_cmp_lg_u32 s65, 0
  s_cbranch_scc1 lay1_a_12
  s_mov_b32 s34, 0x4000
  buffer_load_dwordx4 a[120:123], v15, s[16:19], s34 offen offset:0
  buffer_load_dwordx4 a[124:127], v15, s[16:19], s34 offen offset:1024
  buffer_load_dwordx4 a[128:131], v15, s[16:19], s34 offen offset:2048
  buffer_load_dwordx4 a[132:135], v15, s[16:19], s34 offen offset:3072
  s_mov_b32 s34, 0x5000
  buffer_load_dwordx4 a[136:139], v15, s[16:19], s34 offen offset:0
  buffer_load_dwordx4 a[140:143], v15, s[16:19], s34 offen offset:1024
  buffer_load_dwordx4 a[144:147], v15, s[16:19], s34 offen offset:2048
  buffer_load_dwordx4 a[148:151], v15, s[16:19], s34 offen offset:3072
  s_mov_b32 s34, 0x6000
  buffer_load_dwordx4 v[48:51], v15, s[16:19], s34 offen offset:0
  buffer_load_dwordx4 v[52:55], v15, s[16:19], s34 offen offset:1024
  s_mul_i32 s33, s25, 8704
  s_add_u32 s33, s33, 41984
  s_mov_b32 m0, s33
  v_pk_mul_f32 v[144:145], v[86:87], v[84:85] op_sel:[0,0] op_sel_hi:[0,1]
  v_cvt_pk_f16_f32 v146, v86, v87
  ds_write_addtid_b32 v146 offset:0
  v_pk_fma_f32 v[86:87], v[86:87], v[84:85], v[144:145] op_sel:[1,1,0] op_sel_hi:[1,0,1] neg_lo:[1,0,0]
  v_pk_mul_f32 v[144:145], v[86:87], v[84:85] op_sel:[0,0] op_sel_hi:[0,1]
  v_cvt_pk_f16_f32 v147, v86, v87
  ds_write_addtid_b32 v147 offset:272
  v_pk_fma_f32 v[86:87], v[86:87], v[84:85], v[144:145] op_sel:[1,1,0] op_sel_hi:[1,0,1] neg_lo:[1,0,0]
  v_cvt_pk_f16_f32 v148, v86, v87
  v_pk_mul_f32 v[144:145], v[86:87], v[84:85] op_sel:[0,0] op_sel_hi:[0,1]
  v_pk_fma_f32 v[86:87], v[86:87], v[84:85], v[144:145] op_sel:[1,1,0] op_sel_hi:[1,0,1] neg_lo:[1,0,0]
  ds_write_addtid_b32 v148 offset:544
  v_cvt_pk_f16_f32 v149, v86, v87
  ds_write_addtid_b32 v149 offset:816
  v_pk_mul_f32 v[144:145], v[86:87], v[84:85] op_sel:[0,0] op_sel_hi:[0,1]
  v_pk_fma_f32 v[86:87], v[86:87], v[84:85], v[144:145] op_sel:[1,1,0] op_sel_hi:[1,0,1] neg_lo:[1,0,0]
  v_pk_mul_f32 v[144:145], v[86:87], v[84:85] op_sel:[0,0] op_sel_hi:[0,1]
  v_cvt_pk_f16_f32 v146, v86, v87
  v_pk_fma_f32 v[86:87], v[86:87], v[84:85], v[144:145] op_sel:[1,1,0] op_sel_hi:[1,0,1] neg_lo:[1,0,0]
  v_pk_mul_f32 v[144:145], v[86:87], v[84:85] op_sel:[0,0] op_sel_hi:[0,1]
  ds_write_addtid_b32 v146 offset:1088
  v_cvt_pk_f16_f32 v147, v86, v87
  ds_write_addtid_b32 v147 offset:1360
  v_pk_fma_f32 v[86:87], v[86:87], v[84:85], v[144:145] op_sel:[1,1,0] op_sel_hi:[1,0,1] neg_lo:[1,0,0]
  v_pk_mul_f32 v[144:145], v[86:87], v[84:85] op_sel:[0,0] op_sel_hi:[0,1]
  v_cvt_pk_f16_f32 v148, v86, v87
  ds_write_addtid_b32 v148 offset:1632
  v_pk_fma_f32 v[86:87], v[86:87], v[84:85], v[144:145] op_sel:[1,1,0] op_sel_hi:[1,0,1] neg_lo:[1,0,0]
  v_cvt_pk_f16_f32 v149, v86, v87
  v_pk_mul_f32 v[144:145], v[86:87], v[84:85] op_sel:[0,0] op_sel_hi:[0,1]
  v_pk_fma_f32 v[86:87], v[86:87], v[84:85], v[144:145] op_sel:[1,1,0] op_sel_hi:[1,0,1] neg_lo:[1,0,0]
  v_cvt_pk_f16_f32 v146, v86, v87
  ds_write_addtid_b32 v149 offset:1904
  v_pk_mul_f32 v[144:145], v[86:87], v[84:85] op_sel:[0,0] op_sel_hi:[0,1]
  ds_write_addtid_b32 v146 offset:2176
  v_pk_fma_f32 v[86:87], v[86:87], v[84:85], v[144:145] op_sel:[1,1,0] op_sel_hi:[1,0,1] neg_lo:[1,0,0]
  v_pk_mul_f32 v[144:145], v[86:87], v[84:85] op_sel:[0,0] op_sel_hi:[0,1]
  v_cvt_pk_f16_f32 v147, v86, v87
  ds_write_addtid_b32 v147 offset:2448
  v_pk_fma_f32 v[86:87], v[86:87], v[84:85], v[144:145] op_sel:[1,1,0] op_sel_hi:[1,0,1] neg_lo:[1,0,0]
  v_cvt_pk_f16_f32 v148, v86, v87
  ds_write_addtid_b32 v148 offset:2720
  v_pk_mul_f32 v[144:145], v[86:87], v[84:85] op_sel:[0,0] op_sel_hi:[0,1]
  v_pk_fma_f32 v[86:87], v[86:87], v[84:85], v[144:145] op_sel:[1,1,0] op_sel_hi:[1,0,1] neg_lo:[1,0,0]
  v_pk_mul_f32 v[144:145], v[86:87], v[84:85] op_sel:[0,0] op_sel_hi:[0,1]
  v_cvt_pk_f16_f32 v149, v86, v87
  ds_write_addtid_b32 v149 offset:2992
  v_pk_fma_f32 v[86:87], v[86:87], v[84:85], v[144:145] op_sel:[1,1,0] op_sel_hi:[1,0,1] neg_lo:[1,0,0]
  v_cvt_pk_f16_f32 v146, v86, v87
  ds_write_addtid_b32 v146 offset:3264
  v_pk_mul_f32 v[144:145], v[86:87], v[84:85] op_sel:[0,0] op_sel_hi:[0,1]
  v_pk_fma_f32 v[86:87], v[86:87], v[84:85], v[144:145] op_sel:[1,1,0] op_sel_hi:[1,0,1] neg_lo:[1,0,0]
  v_cvt_pk_f16_f32 v147, v86, v87
  ds_write_addtid_b32 v147 offset:3536
  v_pk_mul_f32 v[144:145], v[86:87], v[84:85] op_sel:[0,0] op_sel_hi:[0,1]
  v_pk_fma_f32 v[86:87], v[86:87], v[84:85], v[144:145] op_sel:[1,1,0] op_sel_hi:[1,0,1] neg_lo:[1,0,0]
  v_pk_mul_f32 v[144:145], v[86:87], v[84:85] op_sel:[0,0] op_sel_hi:[0,1]
  v_cvt_pk_f16_f32 v148, v86, v87
  ds_write_addtid_b32 v148 offset:3808
  v_pk_fma_f32 v[86:87], v[86:87], v[84:85], v[144:145] op_sel:[1,1,0] op_sel_hi:[1,0,1] neg_lo:[1,0,0]
  v_pk_mul_f32 v[144:145], v[86:87], v[84:85] op_sel:[0,0] op_sel_hi:[0,1]
  v_cvt_pk_f16_f32 v149, v86, v87
  ds_write_addtid_b32 v149 offset:4080
  v_pk_fma_f32 v[86:87], v[86:87], v[84:85], v[144:145] op_sel:[1,1,0] op_sel_hi:[1,0,1] neg_lo:[1,0,0]
  v_cvt_pk_f16_f32 v146, v86, v87
  v_pk_mul_f32 v[144:145], v[86:87], v[84:85] op_sel:[0,0] op_sel_hi:[0,1]
  v_pk_fma_f32 v[86:87], v[86:87], v[84:85], v[144:145] op_sel:[1,1,0] op_sel_hi:[1,0,1] neg_lo:[1,0,0]
  v_cvt_pk_f16_f32 v147, v86, v87
  ds_write_addtid_b32 v146 offset:4352
  ds_write_addtid_b32 v147 offset:4624
  v_pk_mul_f32 v[144:145], v[86:87], v[84:85] op_sel:[0,0] op_sel_hi:[0,1]
  v_pk_fma_f32 v[86:87], v[86:87], v[84:85], v[144:145] op_sel:[1,1,0] op_sel_hi:[1,0,1] neg_lo:[1,0,0]
  v_pk_mul_f32 v[144:145], v[86:87], v[84:85] op_sel:[0,0] op_sel_hi:[0,1]
  v_cvt_pk_f16_f32 v148, v86, v87
  ds_write_addtid_b32 v148 offset:4896
  v_pk_fma_f32 v[86:87], v[86:87], v[84:85], v[144:145] op_sel:[1,1,0] op_sel_hi:[1,0,1] neg_lo:[1,0,0]
  v_pk_mul_f32 v[144:145], v[86:87], v[84:85] op_sel:[0,0] op_sel_hi:[0,1]
  v_cvt_pk_f16_f32 v149, v86, v87
  ds_write_addtid_b32 v149 offset:5168
  v_pk_fma_f32 v[86:87], v[86:87], v[84:85], v[144:145] op_sel:[1,1,0] op_sel_hi:[1,0,1] neg_lo:[1,0,0]
  v_cvt_pk_f16_f32 v146, v86, v87
  ds_write_addtid_b32 v146 offset:5440
  v_pk_mul_f32 v[144:145], v[86:87], v[84:85] op_sel:[0,0] op_sel_hi:[0,1]
  v_pk_fma_f32 v[86:87], v[86:87], v[84:85], v[144:145] op_sel:[1,1,0] op_sel_hi:[1,0,1] neg_lo:[1,0,0]
  v_pk_mul_f32 v[144:145], v[86:87], v[84:85] op_sel:[0,0] op_sel_hi:[0,1]
  v_cvt_pk_f16_f32 v147, v86, v87
  ds_write_addtid_b32 v147 offset:5712
  v_pk_fma_f32 v[86:87], v[86:87], v[84:85], v[144:145] op_sel:[1,1,0] op_sel_hi:[1,0,1] neg_lo:[1,0,0]
  v_pk_mul_f32 v[144:145], v[86:87], v[84:85] op_sel:[0,0] op_sel_hi:[0,1]
  v_cvt_pk_f16_f32 v148, v86, v87
  ds_write_addtid_b32 v148 offset:5984
  v_pk_fma_f32 v[86:87], v[86:87], v[84:85], v[144:145] op_sel:[1,1,0] op_sel_hi:[1,0,1] neg_lo:[1,0,0]
  v_cvt_pk_f16_f32 v149, v86, v87
  ds_write_addtid_b32 v149 offset:6256
  v_pk_mul_f32 v[144:145], v[86:87], v[84:85] op_sel:[0,0] op_sel_hi:[0,1]
  v_pk_fma_f32 v[86:87], v[86:87], v[84:85], v[144:145] op_sel:[1,1,0] op_sel_hi:[1,0,1] neg_lo:[1,0,0]
  v_pk_mul_f32 v[144:145], v[86:87], v[84:85] op_sel:[0,0] op_sel_hi:[0,1]
  v_cvt_pk_f16_f32 v146, v86, v87
  ds_write_addtid_b32 v146 offset:6528
  v_pk_fma_f32 v[86:87], v[86:87], v[84:85], v[144:145] op_sel:[1,1,0] op_sel_hi:[1,0,1] neg_lo:[1,0,0]
  v_cvt_pk_f16_f32 v147, v86, v87
  v_pk_mul_f32 v[144:145], v[86:87], v[84:85] op_sel:[0,0] op_sel_hi:[0,1]
  ds_write_addtid_b32 v147 offset:6800
  v_pk_fma_f32 v[86:87], v[86:87], v[84:85], v[144:145] op_sel:[1,1,0] op_sel_hi:[1,0,1] neg_lo:[1,0,0]
  v_pk_mul_f32 v[144:145], v[86:87], v[84:85] op_sel:[0,0] op_sel_hi:[0,1]
  v_cvt_pk_f16_f32 v148, v86, v87
  ds_write_addtid_b32 v148 offset:7072
  v_pk_fma_f32 v[86:87], v[86:87], v[84:85], v[144:145] op_sel:[1,1,0] op_sel_hi:[1,0,1] neg_lo:[1,0,0]
  v_cvt_pk_f16_f32 v149, v86, v87
  v_pk_mul_f32 v[144:145], v[86:87], v[84:85] op_sel:[0,0] op_sel_hi:[0,1]
  v_pk_fma_f32 v[86:87], v[86:87], v[84:85], v[144:145] op_sel:[1,1,0] op_sel_hi:[1,0,1] neg_lo:[1,0,0]
  v_cvt_pk_f16_f32 v146, v86, v87
  ds_write_addtid_b32 v149 offset:7344
  v_pk_mul_f32 v[144:145], v[86:87], v[84:85] op_sel:[0,0] op_sel_hi:[0,1]
  ds_write_addtid_b32 v146 offset:7616
  v_pk_fma_f32 v[86:87], v[86:87], v[84:85], v[144:145] op_sel:[1,1,0] op_sel_hi:[1,0,1] neg_lo:[1,0,0]
  v_cvt_pk_f16_f32 v147, v86, v87
  v_pk_mul_f32 v[144:145], v[86:87], v[84:85] op_sel:[0,0] op_sel_hi:[0,1]
  v_pk_fma_f32 v[86:87], v[86:87], v[84:85], v[144:145] op_sel:[1,1,0] op_sel_hi:[1,0,1] neg_lo:[1,0,0]
  v_cvt_pk_f16_f32 v148, v86, v87
  ds_write_addtid_b32 v147 offset:7888
  ds_write_addtid_b32 v148 offset:8160
  v_pk_mul_f32 v[144:145], v[86:87], v[84:85] op_sel:[0,0] op_sel_hi:[0,1]
  v_pk_fma_f32 v[86:87], v[86:87], v[84:85], v[144:145] op_sel:[1,1,0] op_sel_hi:[1,0,1] neg_lo:[1,0,0]
  v_cvt_pk_f16_f32 v149, v86, v87
  ds_write_addtid_b32 v149 offset:8432
  v_bfe_u32 v152, v0, 4, 2
  v_and_b32 v151, 15, v0
  v_mul_u32_u24 v150, 272, v151
  v_lshl_add_u32 v150, v152, 4, v150
  v_add_u32 v150, s33, v150
  ds_read_b128 v[156:159], v150 offset:0
  ds_read_b128 v[160:163], v150 offset:64
  ds_read_b128 v[176:179], v150 offset:4416
  ds_read_b128 v[172:175], v150 offset:4352
  ds_read_b128 v[164:167], v150 offset:128
  ds_read_b128 v[180:183], v150 offset:4480
  ds_read_b128 v[184:187], v150 offset:4544
  s_waitcnt lgkmcnt(6)
  v_mfma_f32_16x16x32_f16 a[188:191], v[156:159], a[168:171], 0
  ds_read_b128 v[168:171], v150 offset:192
  v_mfma_f32_16x16x32_f16 a[184:187], v[156:159], a[152:155], 0
  v_pk_mul_f32 v[144:145], v[86:87], v[84:85] op_sel:[0,0] op_sel_hi:[0,1]
  s_waitcnt lgkmcnt(6)
  v_mfma_f32_16x16x32_f16 a[188:191], v[160:163], a[172:175], a[188:191]
  v_pk_fma_f32 v[86:87], v[86:87], v[84:85], v[144:145] op_sel:[1,1,0] op_sel_hi:[1,0,1] neg_lo:[1,0,0]
  s_waitcnt lgkmcnt(4)
  v_mfma_f32_16x16x32_f16 a[196:199], v[172:175], a[168:171], 0
  v_mfma_f32_16x16x32_f16 a[192:195], v[172:175], a[152:155], 0
  v_mfma_f32_16x16x32_f16 a[196:199], v[176:179], a[172:175], a[196:199]
  v_mfma_f32_16x16x32_f16 a[192:195], v[176:179], a[156:159], a[192:195]
  s_waitcnt lgkmcnt(2)
  v_mfma_f32_16x16x32_f16 a[196:199], v[180:183], a[176:179], a[196:199]
  v_mfma_f32_16x16x32_f16 a[184:187], v[160:163], a[156:159], a[184:187]
  v_mfma_f32_16x16x32_f16 a[184:187], v[164:167], a[160:163], a[184:187]
  v_mfma_f32_16x16x32_f16 a[188:191], v[164:167], a[176:179], a[188:191]
  s_waitcnt lgkmcnt(0)
  v_mfma_f32_16x16x32_f16 a[184:187], v[168:171], a[164:167], a[184:187]
  v_mfma_f32_16x16x32_f16 a[192:195], v[180:183], a[160:163], a[192:195]
  v_mfma_f32_16x16x32_f16 a[192:195], v[184:187], a[164:167], a[192:195]
  v_mfma_f32_16x16x32_f16 a[188:191], v[168:171], a[180:183], a[188:191]
  v_mfma_f32_16x16x32_f16 a[196:199], v[184:187], a[180:183], a[196:199]
  s_mul_i32 s33, s25, 8704
  s_add_u32 s33, s33, 41984
  s_mov_b32 m0, s33
  v_cvt_pk_f16_f32 v146, v86, v87
  v_pk_mul_f32 v[144:145], v[86:87], v[84:85] op_sel:[0,0] op_sel_hi:[0,1]
  ds_write_addtid_b32 v146 offset:0
  s_lshl_b32 s28, s24, 5
  v_pk_fma_f32 v[86:87], v[86:87], v[84:85], v[144:145] op_sel:[1,1,0] op_sel_hi:[1,0,1] neg_lo:[1,0,0]
  v_cvt_pk_f16_f32 v147, v86, v87
  v_pk_mul_f32 v[144:145], v[86:87], v[84:85] op_sel:[0,0] op_sel_hi:[0,1]
  ds_write_addtid_b32 v147 offset:272
  s_add_u32 s28, s28, 0x2a0000
  v_pk_fma_f32 v[86:87], v[86:87], v[84:85], v[144:145] op_sel:[1,1,0] op_sel_hi:[1,0,1] neg_lo:[1,0,0]
  v_cvt_pk_f16_f32 v148, v86, v87
  v_pk_mul_f32 v[144:145], v[86:87], v[84:85] op_sel:[0,0] op_sel_hi:[0,1]
  ds_write_addtid_b32 v148 offset:544
  s_add_u32 s29, s28, 0x104000
  v_pk_fma_f32 v[86:87], v[86:87], v[84:85], v[144:145] op_sel:[1,1,0] op_sel_hi:[1,0,1] neg_lo:[1,0,0]
  v_cvt_pk_f16_f32 v149, v86, v87
  v_pk_mul_f32 v[144:145], v[86:87], v[84:85] op_sel:[0,0] op_sel_hi:[0,1]
  ds_write_addtid_b32 v149 offset:816
  buffer_load_dwordx4 v[244:247], v1, s[8:11], s28 offen sc1
  v_pk_fma_f32 v[86:87], v[86:87], v[84:85], v[144:145] op_sel:[1,1,0] op_sel_hi:[1,0,1] neg_lo:[1,0,0]
  v_cvt_pk_f16_f32 v146, v86, v87
  v_pk_mul_f32 v[144:145], v[86:87], v[84:85] op_sel:[0,0] op_sel_hi:[0,1]
  ds_write_addtid_b32 v146 offset:1088
  buffer_load_dwordx4 v[248:251], v1, s[8:11], s29 offen sc1
  v_pk_fma_f32 v[86:87], v[86:87], v[84:85], v[144:145] op_sel:[1,1,0] op_sel_hi:[1,0,1] neg_lo:[1,0,0]
  v_cvt_pk_f16_f32 v147, v86, v87
  v_pk_mul_f32 v[144:145], v[86:87], v[84:85] op_sel:[0,0] op_sel_hi:[0,1]
  ds_write_addtid_b32 v147 offset:1360
  v_pk_fma_f32 v[86:87], v[86:87], v[84:85], v[144:145] op_sel:[1,1,0] op_sel_hi:[1,0,1] neg_lo:[1,0,0]
  v_cvt_pk_f16_f32 v148, v86, v87
  v_pk_mul_f32 v[144:145], v[86:87], v[84:85] op_sel:[0,0] op_sel_hi:[0,1]
  ds_write_addtid_b32 v148 offset:1632
  v_pk_fma_f32 v[86:87], v[86:87], v[84:85], v[144:145] op_sel:[1,1,0] op_sel_hi:[1,0,1] neg_lo:[1,0,0]
  v_cvt_pk_f16_f32 v149, v86, v87
  v_pk_mul_f32 v[144:145], v[86:87], v[84:85] op_sel:[0,0] op_sel_hi:[0,1]
  ds_write_addtid_b32 v149 offset:1904
  v_pk_fma_f32 v[86:87], v[86:87], v[84:85], v[144:145] op_sel:[1,1,0] op_sel_hi:[1,0,1] neg_lo:[1,0,0]
  v_cvt_pk_f16_f32 v146, v86, v87
  v_pk_mul_f32 v[144:145], v[86:87], v[84:85] op_sel:[0,0] op_sel_hi:[0,1]
  ds_write_addtid_b32 v146 offset:2176
  v_pk_fma_f32 v[86:87], v[86:87], v[84:85], v[144:145] op_sel:[1,1,0] op_sel_hi:[1,0,1] neg_lo:[1,0,0]
  v_cvt_pk_f16_f32 v147, v86, v87
  v_pk_mul_f32 v[144:145], v[86:87], v[84:85] op_sel:[0,0] op_sel_hi:[0,1]
  ds_write_addtid_b32 v147 offset:2448
  v_pk_fma_f32 v[86:87], v[86:87], v[84:85], v[144:145] op_sel:[1,1,0] op_sel_hi:[1,0,1] neg_lo:[1,0,0]
  v_cvt_pk_f16_f32 v148, v86, v87
  v_pk_mul_f32 v[144:145], v[86:87], v[84:85] op_sel:[0,0] op_sel_hi:[0,1]
  ds_write_addtid_b32 v148 offset:2720
  v_pk_fma_f32 v[86:87], v[86:87], v[84:85], v[144:145] op_sel:[1,1,0] op_sel_hi:[1,0,1] neg_lo:[1,0,0]
  v_cvt_pk_f16_f32 v149, v86, v87
  v_pk_mul_f32 v[144:145], v[86:87], v[84:85] op_sel:[0,0] op_sel_hi:[0,1]
  ds_write_addtid_b32 v149 offset:2992
  v_pk_fma_f32 v[86:87], v[86:87], v[84:85], v[144:145] op_sel:[1,1,0] op_sel_hi:[1,0,1] neg_lo:[1,0,0]
  v_cvt_pk_f16_f32 v146, v86, v87
  v_pk_mul_f32 v[144:145], v[86:87], v[84:85] op_sel:[0,0] op_sel_hi:[0,1]
  ds_write_addtid_b32 v146 offset:3264
  v_pk_fma_f32 v[86:87], v[86:87], v[84:85], v[144:145] op_sel:[1,1,0] op_sel_hi:[1,0,1] neg_lo:[1,0,0]
  v_cvt_pk_f16_f32 v147, v86, v87
  v_pk_mul_f32 v[144:145], v[86:87], v[84:85] op_sel:[0,0] op_sel_hi:[0,1]
  ds_write_addtid_b32 v147 offset:3536
  v_pk_fma_f32 v[86:87], v[86:87], v[84:85], v[144:145] op_sel:[1,1,0] op_sel_hi:[1,0,1] neg_lo:[1,0,0]
  v_cvt_pk_f16_f32 v148, v86, v87
  v_pk_mul_f32 v[144:145], v[86:87], v[84:85] op_sel:[0,0] op_sel_hi:[0,1]
  ds_write_addtid_b32 v148 offset:3808
  v_pk_fma_f32 v[86:87], v[86:87], v[84:85], v[144:145] op_sel:[1,1,0] op_sel_hi:[1,0,1] neg_lo:[1,0,0]
  v_cvt_pk_f16_f32 v149, v86, v87
  v_pk_mul_f32 v[144:145], v[86:87], v[84:85] op_sel:[0,0] op_sel_hi:[0,1]
  ds_write_addtid_b32 v149 offset:4080
  v_pk_fma_f32 v[86:87], v[86:87], v[84:85], v[144:145] op_sel:[1,1,0] op_sel_hi:[1,0,1] neg_lo:[1,0,0]
  v_cvt_pk_f16_f32 v146, v86, v87
  v_pk_mul_f32 v[144:145], v[86:87], v[84:85] op_sel:[0,0] op_sel_hi:[0,1]
  ds_write_addtid_b32 v146 offset:4352
  v_pk_fma_f32 v[86:87], v[86:87], v[84:85], v[144:145] op_sel:[1,1,0] op_sel_hi:[1,0,1] neg_lo:[1,0,0]
  v_cvt_pk_f16_f32 v147, v86, v87
  v_pk_mul_f32 v[144:145], v[86:87], v[84:85] op_sel:[0,0] op_sel_hi:[0,1]
  ds_write_addtid_b32 v147 offset:4624
  v_pk_fma_f32 v[86:87], v[86:87], v[84:85], v[144:145] op_sel:[1,1,0] op_sel_hi:[1,0,1] neg_lo:[1,0,0]
  v_cvt_pk_f16_f32 v148, v86, v87
  v_pk_mul_f32 v[144:145], v[86:87], v[84:85] op_sel:[0,0] op_sel_hi:[0,1]
  ds_write_addtid_b32 v148 offset:4896
  v_pk_fma_f32 v[86:87], v[86:87], v[84:85], v[144:145] op_sel:[1,1,0] op_sel_hi:[1,0,1] neg_lo:[1,0,0]
  v_cvt_pk_f16_f32 v149, v86, v87
  v_pk_mul_f32 v[144:145], v[86:87], v[84:85] op_sel:[0,0] op_sel_hi:[0,1]
  ds_write_addtid_b32 v149 offset:5168
  v_pk_fma_f32 v[86:87], v[86:87], v[84:85], v[144:145] op_sel:[1,1,0] op_sel_hi:[1,0,1] neg_lo:[1,0,0]
  v_cvt_pk_f16_f32 v146, v86, v87
  v_pk_mul_f32 v[144:145], v[86:87], v[84:85] op_sel:[0,0] op_sel_hi:[0,1]
  ds_write_addtid_b32 v146 offset:5440
  v_pk_fma_f32 v[86:87], v[86:87], v[84:85], v[144:145] op_sel:[1,1,0] op_sel_hi:[1,0,1] neg_lo:[1,0,0]
  v_cvt_pk_f16_f32 v147, v86, v87
  v_pk_mul_f32 v[144:145], v[86:87], v[84:85] op_sel:[0,0] op_sel_hi:[0,1]
  ds_write_addtid_b32 v147 offset:5712
  v_pk_fma_f32 v[86:87], v[86:87], v[84:85], v[144:145] op_sel:[1,1,0] op_sel_hi:[1,0,1] neg_lo:[1,0,0]
  v_cvt_pk_f16_f32 v148, v86, v87
  v_pk_mul_f32 v[144:145], v[86:87], v[84:85] op_sel:[0,0] op_sel_hi:[0,1]
  ds_write_addtid_b32 v148 offset:5984
  v_pk_fma_f32 v[86:87], v[86:87], v[84:85], v[144:145] op_sel:[1,1,0] op_sel_hi:[1,0,1] neg_lo:[1,0,0]
  v_cvt_pk_f16_f32 v149, v86, v87
  v_pk_mul_f32 v[144:145], v[86:87], v[84:85] op_sel:[0,0] op_sel_hi:[0,1]
  ds_write_addtid_b32 v149 offset:6256
  v_pk_fma_f32 v[86:87], v[86:87], v[84:85], v[144:145] op_sel:[1,1,0] op_sel_hi:[1,0,1] neg_lo:[1,0,0]
  v_cvt_pk_f16_f32 v146, v86, v87
  v_pk_mul_f32 v[144:145], v[86:87], v[84:85] op_sel:[0,0] op_sel_hi:[0,1]
  ds_write_addtid_b32 v146 offset:6528
  v_pk_fma_f32 v[86:87], v[86:87], v[84:85], v[144:145] op_sel:[1,1,0] op_sel_hi:[1,0,1] neg_lo:[1,0,0]
  v_cvt_pk_f16_f32 v147, v86, v87
  v_pk_mul_f32 v[144:145], v[86:87], v[84:85] op_sel:[0,0] op_sel_hi:[0,1]
  ds_write_addtid_b32 v147 offset:6800
  v_pk_fma_f32 v[86:87], v[86:87], v[84:85], v[144:145] op_sel:[1,1,0] op_sel_hi:[1,0,1] neg_lo:[1,0,0]
  v_cvt_pk_f16_f32 v148, v86, v87
  v_pk_mul_f32 v[144:145], v[86:87], v[84:85] op_sel:[0,0] op_sel_hi:[0,1]
  ds_write_addtid_b32 v148 offset:7072
  v_pk_fma_f32 v[86:87], v[86:87], v[84:85], v[144:145] op_sel:[1,1,0] op_sel_hi:[1,0,1] neg_lo:[1,0,0]
  v_cvt_pk_f16_f32 v149, v86, v87
  v_pk_mul_f32 v[144:145], v[86:87], v[84:85] op_sel:[0,0] op_sel_hi:[0,1]
  ds_write_addtid_b32 v149 offset:7344
  v_pk_fma_f32 v[86:87], v[86:87], v[84:85], v[144:145] op_sel:[1,1,0] op_sel_hi:[1,0,1] neg_lo:[1,0,0]
  v_cvt_pk_f16_f32 v146, v86, v87
  v_pk_mul_f32 v[144:145], v[86:87], v[84:85] op_sel:[0,0] op_sel_hi:[0,1]
  ds_write_addtid_b32 v146 offset:7616
  v_pk_fma_f32 v[86:87], v[86:87], v[84:85], v[144:145] op_sel:[1,1,0] op_sel_hi:[1,0,1] neg_lo:[1,0,0]
  v_cvt_pk_f16_f32 v147, v86, v87
  v_pk_mul_f32 v[144:145], v[86:87], v[84:85] op_sel:[0,0] op_sel_hi:[0,1]
  ds_write_addtid_b32 v147 offset:7888
  v_pk_fma_f32 v[86:87], v[86:87], v[84:85], v[144:145] op_sel:[1,1,0] op_sel_hi:[1,0,1] neg_lo:[1,0,0]
  v_cvt_pk_f16_f32 v148, v86, v87
  v_pk_mul_f32 v[144:145], v[86:87], v[84:85] op_sel:[0,0] op_sel_hi:[0,1]
  ds_write_addtid_b32 v148 offset:8160
  v_pk_fma_f32 v[86:87], v[86:87], v[84:85], v[144:145] op_sel:[1,1,0] op_sel_hi:[1,0,1] neg_lo:[1,0,0]
  v_and_b32 v151, 15, v0
  v_cvt_pk_f16_f32 v149, v86, v87
  v_bfe_u32 v152, v0, 4, 2
  v_mul_u32_u24 v150, 272, v151
  ds_write_addtid_b32 v149 offset:8432
  v_lshl_add_u32 v150, v152, 4, v150
  v_add_u32 v150, s33, v150
  ds_read_b128 v[156:159], v150 offset:0
  ds_read_b128 v[172:175], v150 offset:4352
  ds_read_b128 v[160:163], v150 offset:64
  ds_read_b128 v[176:179], v150 offset:4416
  ds_read_b128 v[164:167], v150 offset:128
  ds_read_b128 v[180:183], v150 offset:4480
  ds_read_b128 v[168:171], v150 offset:192
  s_waitcnt lgkmcnt(6)
  v_mfma_f32_16x16x32_f16 a[200:203], v[156:159], a[152:155], 0
  ds_read_b128 v[184:187], v150 offset:4544
  v_mfma_f32_16x16x32_f16 a[204:207], v[156:159], a[168:171], 0
  s_waitcnt lgkmcnt(6)
  v_mfma_f32_16x16x32_f16 a[208:211], v[172:175], a[152:155], 0
  v_mfma_f32_16x16x32_f16 a[212:215], v[172:175], a[168:171], 0
  s_waitcnt lgkmcnt(5)
  v_mfma_f32_16x16x32_f16 a[200:203], v[160:163], a[156:159], a[200:203]
  v_mfma_f32_16x16x32_f16 a[204:207], v[160:163], a[172:175], a[204:207]
  s_waitcnt lgkmcnt(4)
  v_mfma_f32_16x16x32_f16 a[208:211], v[176:179], a[156:159], a[208:211]
  v_mfma_f32_16x16x32_f16 a[212:215], v[176:179], a[172:175], a[212:215]
  s_waitcnt lgkmcnt(3)
  v_mfma_f32_16x16x32_f16 a[200:203], v[164:167], a[160:163], a[200:203]
  v_mfma_f32_16x16x32_f16 a[204:207], v[164:167], a[176:179], a[204:207]
  s_waitcnt lgkmcnt(2)
  v_mfma_f32_16x16x32_f16 a[208:211], v[180:183], a[160:163], a[208:211]
  v_mfma_f32_16x16x32_f16 a[212:215], v[180:183], a[176:179], a[212:215]
  s_waitcnt lgkmcnt(1)
  v_mfma_f32_16x16x32_f16 a[200:203], v[168:171], a[164:167], a[200:203]
  v_mfma_f32_16x16x32_f16 a[204:207], v[168:171], a[180:183], a[204:207]
  s_waitcnt lgkmcnt(0)
  v_mfma_f32_16x16x32_f16 a[208:211], v[184:187], a[164:167], a[208:211]
  v_mfma_f32_16x16x32_f16 a[212:215], v[184:187], a[180:183], a[212:215]
  v_and_b32 v151, 15, v0
  s_mul_i32 s33, s25, 8704
  s_add_u32 s33, s33, 41984
  v_bfe_u32 v152, v0, 4, 2
  v_mul_u32_u24 v150, 272, v151
  v_lshl_add_u32 v151, v152, 7, v151
  v_add_u32 v151, 1, v151
  v_lshlrev_b32 v151, 2, v151
  v_add_u32 v151, s33, v151
  ds_write2_b32 v151, a184, a185 offset0:0 offset1:32
  s_mov_b32 m0, s33
  ds_write2_b32 v151, a186, a187 offset0:64 offset1:96
  ds_write2_b32 v151, a188, a189 offset0:16 offset1:48
  ds_write2_b32 v151, a190, a191 offset0:80 offset1:112
  v_add_u32 v160, 2048, v151
  ds_write2_b32 v160, a192, a193 offset0:0 offset1:32
  ds_write2_b32 v160, a194, a195 offset0:64 offset1:96
  ds_write2_b32 v160, a196, a197 offset0:16 offset1:48
  ds_write2_b32 v160, a198, a199 offset0:80 offset1:112
  v_add_u32 v161, 4096, v151
  v_add_u32 v162, 6144, v151
  v_lshl_add_u32 v150, v152, 4, v150
  ds_write2_b32 v161, a200, a201 offset0:0 offset1:32
  ds_write2_b32 v161, a202, a203 offset0:64 offset1:96
  ds_write2_b32 v161, a204, a205 offset0:16 offset1:48
  ds_write2_b32 v161, a206, a207 offset0:80 offset1:112
  v_mov_b32 v152, s33
  ds_write2_b32 v162, a208, a209 offset0:0 offset1:32
  s_waitcnt vmcnt(1)
  v_and_b32 v252, v244, v246
  ds_write2_b32 v162, a210, a211 offset0:64 offset1:96
  ds_write2_b32 v162, a212, a213 offset0:16 offset1:48
  ds_write2_b32 v162, a214, a215 offset0:80 offset1:112
  ds_write_b32 v152, v83
  ds_write_b32 v152, v82 offset:8200
  v_add_u32 v150, s33, v150
  s_waitcnt vmcnt(0)
  v_and_b32 v253, v248, v250
  v_and_b32 v252, v252, v253
  v_and_b32 v252, 1, v252
  v_cmp_eq_u32 vcc, 0, v252
  s_nop 0
  s_cbranch_vccz polldone_15
poll_14:
  s_cmp_eq_u32 s26, 0
  s_cbranch_scc1 polldone_15
  s_sub_u32 s26, s26, 1
  s_mov_b64 exec, vcc
  buffer_load_dwordx4 v[244:247], v1, s[8:11], s28 offen sc1
  buffer_load_dwordx4 v[248:251], v1, s[8:11], s29 offen sc1
  s_waitcnt vmcnt(0)
  v_and_b32 v252, v244, v246
  v_and_b32 v253, v248, v250
  v_and_b32 v252, v252, v253
  v_and_b32 v252, 1, v252
  v_cmp_eq_u32 vcc, 0, v252
  s_nop 0
  s_cbranch_vccnz poll_14
polldone_15:
  s_mov_b64 exec, -1
  s_branch join_a_13
lay1_a_12:
  s_lshl_b32 s28, s24, 5
  s_add_u32 s28, s28, 0x2a0000
  s_add_u32 s29, s28, 0x104000
  s_waitcnt vmcnt(0)
  buffer_load_dwordx4 v[244:247], v1, s[8:11], s28 offen sc1
  buffer_load_dwordx4 v[248:251], v1, s[8:11], s29 offen sc1
  s_waitcnt vmcnt(1)
  v_and_b32 v252, v244, v246
  s_waitcnt vmcnt(0)
  v_and_b32 v253, v248, v250
  v_and_b32 v252, v252, v253
  v_and_b32 v252, 1, v252
  v_cmp_eq_u32 vcc, 0, v252
  s_nop 0
  s_cbranch_vccz polldone_17
poll_16:
  s_cmp_eq_u32 s26, 0
  s_cbranch_scc1 polldone_17
  s_sub_u32 s26, s26, 1
  s_mov_b64 exec, vcc
  buffer_load_dwordx4 v[244:247], v1, s[8:11], s28 offen sc1
  buffer_load_dwordx4 v[248:251], v1, s[8:11], s29 offen sc1
  s_waitcnt vmcnt(0)
  v_and_b32 v252, v244, v246
  v_and_b32 v253, v248, v250
  v_and_b32 v252, v252, v253
  v_and_b32 v252, 1, v252
  v_cmp_eq_u32 vcc, 0, v252
  s_nop 0
  s_cbranch_vccnz poll_16
polldone_17:
  s_mov_b64 exec, -1
join_a_13:
  ds_write_b128 v4, v[244:247] offset:0
  ds_write_b128 v4, v[248:251] offset:4096
  s_waitcnt lgkmcnt(0)
  s_barrier
  ds_read_b64 v[136:137], v10 offset:0
  s_lshl_b32 s34, s25, 3
  ds_read_b64 v[138:139], v10 offset:1024
  ds_read_b64 v[142:143], v10 offset:1536
  ds_read_b64 v[140:141], v10 offset:512
  v_mov_b32 v146, s34
  ds_read_b64 v[144:145], v146 offset:0
  s_waitcnt lgkmcnt(3)
  v_mfma_f32_16x16x32_f16 v[168:171], v[136:139], a[120:123], 0
  v_mfma_f32_16x16x32_f16 v[172:175], v[136:139], a[124:127], 0
  v_mfma_f32_16x16x32_f16 v[184:187], v[136:139], a[128:131], 0
  s_waitcnt lgkmcnt(0)
  v_xor_b32 v145, v145, v14
  v_xor_b32 v144, v144, v14
  v_mfma_f32_16x16x32_f16 v[188:191], v[136:139], a[132:135], 0
  s_nop 2
  v_cvt_pk_f16_f32 v168, v168, v172
  v_cvt_pk_f16_f32 v170, v170, v174
  v_mfma_f32_16x16x32_f16 v[196:199], v[140:143], a[132:135], 0
  v_pk_mul_f16 v200, v168, v48 op_sel:[0,0] op_sel_hi:[0,1]
  v_cvt_pk_f16_f32 v169, v169, v173
  v_mfma_f32_16x16x32_f16 v[176:179], v[140:143], a[120:123], 0
  v_cvt_pk_f16_f32 v184, v184, v188
  v_cvt_pk_f16_f32 v186, v186, v190
  v_mfma_f32_16x16x32_f16 v[192:195], v[140:143], a[128:131], 0
  v_cvt_pk_f16_f32 v185, v185, v189
  v_pk_mul_f16 v210, v186, v50 op_sel:[0,0] op_sel_hi:[0,1]
  v_mfma_f32_16x16x32_f16 v[180:183], v[140:143], a[124:127], 0
  v_cvt_pk_f16_f32 v187, v187, v191
  v_pk_mul_f16 v211, v187, v51 op_sel:[0,0] op_sel_hi:[0,1]
  v_pk_fma_f16 v211, v187, v51, v211 op_sel:[1,1,0] op_sel_hi:[1,0,1] neg_lo:[1,0,0]
  v_pk_mul_f16 v202, v170, v50 op_sel:[0,0] op_sel_hi:[0,1]
  v_pk_mul_f16 v201, v169, v49 op_sel:[0,0] op_sel_hi:[0,1]
  v_cvt_pk_f16_f32 v171, v171, v175
  v_pk_mul_f16 v208, v184, v48 op_sel:[0,0] op_sel_hi:[0,1]
  v_pk_fma_f16 v208, v184, v48, v208 op_sel:[1,1,0] op_sel_hi:[1,0,1] neg_lo:[1,0,0]
  v_bfi_b32 v208, v17, v145, v208
  v_pk_fma_f16 v202, v170, v50, v202 op_sel:[1,1,0] op_sel_hi:[1,0,1] neg_lo:[1,0,0]
  v_cvt_pk_f16_f32 v179, v179, v183
  v_cvt_pk_f16_f32 v194, v194, v198
  v_pk_fma_f16 v210, v186, v50, v210 op_sel:[1,1,0] op_sel_hi:[1,0,1] neg_lo:[1,0,0]
  v_pk_mul_f16 v203, v171, v51 op_sel:[0,0] op_sel_hi:[0,1]
  v_cvt_pk_f16_f32 v178, v178, v182
  v_pk_fma_f16 v200, v168, v48, v200 op_sel:[1,1,0] op_sel_hi:[1,0,1] neg_lo:[1,0,0]
  v_cvt_pk_f16_f32 v192, v192, v196
  v_pk_fma_f16 v201, v169, v49, v201 op_sel:[1,1,0] op_sel_hi:[1,0,1] neg_lo:[1,0,0]
  v_pk_mul_f16 v207, v179, v55 op_sel:[0,0] op_sel_hi:[0,1]
  v_bfi_b32 v200, v17, v144, v200
  v_pk_fma_f16 v203, v171, v51, v203 op_sel:[1,1,0] op_sel_hi:[1,0,1] neg_lo:[1,0,0]
  v_cvt_pk_f16_f32 v193, v193, v197
  v_pk_mul_f16 v209, v185, v49 op_sel:[0,0] op_sel_hi:[0,1]
  v_pk_fma_f16 v209, v185, v49, v209 op_sel:[1,1,0] op_sel_hi:[1,0,1] neg_lo:[1,0,0]
  v_cvt_pk_f16_f32 v177, v177, v181
  v_mfma_f32_16x16x32_f16 v[108:111], a[144:147], v[200:203], v[108:111]
  v_pk_mul_f16 v206, v178, v54 op_sel:[0,0] op_sel_hi:[0,1]
  v_cvt_pk_f16_f32 v176, v176, v180
  v_mfma_f32_16x16x32_f16 v[112:115], a[136:139], v[208:211], v[112:115]
  v_cvt_pk_f16_f32 v195, v195, v199
  v_pk_fma_f16 v206, v178, v54, v206 op_sel:[1,1,0] op_sel_hi:[1,0,1] neg_lo:[1,0,0]
  v_pk_mul_f16 v205, v177, v53 op_sel:[0,0] op_sel_hi:[0,1]
  v_pk_mul_f16 v214, v194, v54 op_sel:[0,0] op_sel_hi:[0,1]
  v_pk_mul_f16 v204, v176, v52 op_sel:[0,0] op_sel_hi:[0,1]
  v_pk_mul_f16 v212, v192, v52 op_sel:[0,0] op_sel_hi:[0,1]
  v_pk_fma_f16 v212, v192, v52, v212 op_sel:[1,1,0] op_sel_hi:[1,0,1] neg_lo:[1,0,0]
  v_pk_mul_f16 v215, v195, v55 op_sel:[0,0] op_sel_hi:[0,1]
  v_pk_fma_f16 v215, v195, v55, v215 op_sel:[1,1,0] op_sel_hi:[1,0,1] neg_lo:[1,0,0]
  v_pk_fma_f16 v204, v176, v52, v204 op_sel:[1,1,0] op_sel_hi:[1,0,1] neg_lo:[1,0,0]
  v_pk_mul_f16 v213, v193, v53 op_sel:[0,0] op_sel_hi:[0,1]
  v_pk_fma_f16 v213, v193, v53, v213 op_sel:[1,1,0] op_sel_hi:[1,0,1] neg_lo:[1,0,0]
  v_mfma_f32_16x16x32_f16 v[104:107], a[136:139], v[200:203], v[104:107]
  v_pk_fma_f16 v207, v179, v55, v207 op_sel:[1,1,0] op_sel_hi:[1,0,1] neg_lo:[1,0,0]
  v_pk_fma_f16 v214, v194, v54, v214 op_sel:[1,1,0] op_sel_hi:[1,0,1] neg_lo:[1,0,0]
  v_mfma_f32_16x16x32_f16 v[116:119], a[144:147], v[208:211], v[116:119]
  v_pk_fma_f16 v205, v177, v53, v205 op_sel:[1,1,0] op_sel_hi:[1,0,1] neg_lo:[1,0,0]
  v_mfma_f32_16x16x32_f16 v[112:115], a[140:143], v[212:215], v[112:115]
  s_nop 0
  v_mfma_f32_16x16x32_f16 v[104:107], a[140:143], v[204:207], v[104:107]
  v_mfma_f32_16x16x32_f16 v[116:119], a[148:151], v[212:215], v[116:119]
  s_nop 4
  v_pk_mul_f32 v[238:239], v[112:113], v[112:113]
  v_pk_add_f32 v[236:237], v[112:113], v[114:115]
  v_mfma_f32_16x16x32_f16 v[108:111], a[148:151], v[204:207], v[108:111]
  v_pk_mul_f32 v[234:235], v[104:105], v[104:105]
  v_pk_fma_f32 v[234:235], v[106:107], v[106:107], v[234:235]
  v_pk_fma_f32 v[238:239], v[114:115], v[114:115], v[238:239]
  v_pk_add_f32 v[236:237], v[236:237], v[116:117]
  v_pk_fma_f32 v[238:239], v[116:117], v[116:117], v[238:239]
  v_pk_fma_f32 v[238:239], v[118:119], v[118:119], v[238:239]
  v_pk_add_f32 v[232:233], v[104:105], v[106:107]
  s_nop 0
  v_pk_add_f32 v[232:233], v[232:233], v[108:109]
  v_pk_fma_f32 v[234:235], v[108:109], v[108:109], v[234:235]
  v_pk_add_f32 v[232:233], v[232:233], v[110:111]
  v_pk_fma_f32 v[234:235], v[110:111], v[110:111], v[234:235]
  v_add_f32 v234, v234, v235
  v_pk_add_f32 v[236:237], v[236:237], v[118:119]
  v_add_f32 v238, v238, v239
  v_add_f32 v236, v236, v237
  v_add_f32 v232, v232, v233
  v_permlane32_swap_b32 v234, v238
  v_add_f32 v242, v234, v238
  v_permlane32_swap_b32 v232, v236
  v_add_f32 v240, v232, v236
  s_nop 1
  v_permlane16_swap_b32 v240, v242
  v_add_f32 v240, v240, v242
  s_nop 1
  v_add_f32 v240, v240, v240 row_ror:8
  s_nop 1
  v_add_f32 v240, v240, v240 row_ror:4
  s_nop 1
  v_add_f32 v240, v240, v240 row_ror:2
  s_nop 1
  v_add_f32 v240, v240, v240 row_ror:1
  v_mov_b32 v242, v240
  s_nop 1
  v_permlane16_swap_b32 v240, v242
  v_mul_f32 v240, s36, v240
  v_mul_f32 v242, s36, v242
  v_fma_f32 v242, -v240, v240, v242
  v_max_f32 v242, 0, v242
  v_add_f32 v242, s37, v242
  v_rsq_f32 v242, v242
  s_nop 0
  v_mul_f32 v240, v240, v242
  v_mov_b32 v234, v240
  v_mov_b32 v232, v242
  s_nop 0
  v_permlane32_swap_b32 v240, v234
  v_permlane32_swap_b32 v242, v232
  v_pk_fma_f32 v[120:121], v[104:105], v[242:243], v[240:241] op_sel_hi:[1,0,0] neg_lo:[0,0,1] neg_hi:[0,0,1]
  v_pk_fma_f32 v[128:129], v[112:113], v[232:233], v[234:235] op_sel_hi:[1,0,0] neg_lo:[0,0,1] neg_hi:[0,0,1]
  v_cvt_pk_f16_f32 v216, v120, v128
  ds_write_b32 v12, v216 offset:29696
  v_cvt_pk_f16_f32 v217, v121, v129
  ds_write_b32 v12, v217 offset:29952
  v_pk_fma_f32 v[130:131], v[114:115], v[232:233], v[234:235] op_sel_hi:[1,0,0] neg_lo:[0,0,1] neg_hi:[0,0,1]
  v_pk_fma_f32 v[122:123], v[106:107], v[242:243], v[240:241] op_sel_hi:[1,0,0] neg_lo:[0,0,1] neg_hi:[0,0,1]
  v_cvt_pk_f16_f32 v218, v122, v130
  ds_write_b32 v12, v218 offset:30208
  v_cvt_pk_f16_f32 v219, v123, v131
  ds_write_b32 v12, v219 offset:30464
  v_pk_fma_f32 v[124:125], v[108:109], v[242:243], v[240:241] op_sel_hi:[1,0,0] neg_lo:[0,0,1] neg_hi:[0,0,1]
  v_pk_fma_f32 v[132:133], v[116:117], v[232:233], v[234:235] op_sel_hi:[1,0,0] neg_lo:[0,0,1] neg_hi:[0,0,1]
  v_cvt_pk_f16_f32 v220, v124, v132
  ds_write_b32 v12, v220 offset:33792
  v_cvt_pk_f16_f32 v221, v125, v133
  ds_write_b32 v12, v221 offset:34048
  v_pk_fma_f32 v[134:135], v[118:119], v[232:233], v[234:235] op_sel_hi:[1,0,0] neg_lo:[0,0,1] neg_hi:[0,0,1]
  v_pk_fma_f32 v[126:127], v[110:111], v[242:243], v[240:241] op_sel_hi:[1,0,0] neg_lo:[0,0,1] neg_hi:[0,0,1]
  v_cvt_pk_f16_f32 v222, v126, v134
  ds_write_b32 v12, v222 offset:34304
  v_cvt_pk_f16_f32 v223, v127, v135
  ds_write_b32 v12, v223 offset:34560
  s_waitcnt lgkmcnt(0)
  s_barrier
  ds_read_b128 v[244:247], v2 offset:29696
  s_mul_i32 s30, s24, 8320
  s_add_u32 s30, s30, 0x0
  s_add_u32 s31, s30, 0x1000
  ds_read_b128 v[248:251], v2 offset:33792
  s_waitcnt lgkmcnt(1)
  v_and_b32 v244, -2, v244
  v_and_b32 v246, -2, v246
  buffer_store_dwordx4 v[244:247], v2, s[8:11], s30 offen sc1
  s_waitcnt lgkmcnt(0)
  v_and_b32 v248, -2, v248
  v_and_b32 v250, -2, v250
  buffer_store_dwordx4 v[248:251], v2, s[8:11], s31 offen sc1
  s_cmp_lg_u32 s65, 0
  s_nop 0
  s_cbranch_scc1 lay1_b_18
  s_mov_b32 s34, 0x9000
  buffer_load_dwordx4 a[64:67], v16, s[16:19], s34 offen offset:0
  buffer_load_dwordx4 a[68:71], v16, s[16:19], s34 offen offset:1024
  buffer_load_dwordx4 a[72:75], v16, s[16:19], s34 offen offset:2048
  buffer_load_dwordx4 a[76:79], v16, s[16:19], s34 offen offset:3072
  s_mov_b32 s34, 0xb000
  buffer_load_dwordx4 v[32:35], v16, s[16:19], s34 offen offset:0
  buffer_load_dwordx4 v[36:39], v16, s[16:19], s34 offen offset:1024
  s_mov_b32 s34, 0xa000
  buffer_load_dwordx4 a[80:83], v16, s[16:19], s34 offen offset:0
  buffer_load_dwordx4 a[84:87], v16, s[16:19], s34 offen offset:1024
  buffer_load_dwordx4 a[88:91], v16, s[16:19], s34 offen offset:2048
  buffer_load_dwordx4 a[92:95], v16, s[16:19], s34 offen offset:3072
  v_and_b32 v156, 31, v0
  v_lshrrev_b32 v157, 5, v0
  v_lshl_add_u32 v158, v157, 8, v156
  v_mov_b32 v159, 41984
  v_add_u32 v136, 0, v158
  v_add_u32 v137, 32, v158
  v_add_u32 v138, 64, v158
  v_add_u32 v139, 96, v158
  v_add_u32 v140, 128, v158
  v_add_u32 v141, 160, v158
  v_add_u32 v142, 192, v158
  v_add_u32 v143, 224, v158
  ds_read_b32 v148, v159 offset:8200
  ds_read_b32 v149, v159 offset:16904
  v_cvt_f32_u32 v136, v136
  v_cvt_f32_u32 v137, v137
  v_cvt_f32_u32 v138, v138
  v_cvt_f32_u32 v139, v139
  v_cvt_f32_u32 v140, v140
  v_cvt_f32_u32 v141, v141
  v_cvt_f32_u32 v142, v142
  v_cvt_f32_u32 v143, v143
  v_cvt_pk_bf16_f32 v144, v136, v137
  v_cvt_pk_bf16_f32 v145, v138, v139
  v_cvt_pk_bf16_f32 v146, v140, v141
  v_cvt_pk_bf16_f32 v147, v142, v143
  v_lshlrev_b32 v136, 16, v144
  v_and_b32 v137, 0xffff0000, v144
  v_lshlrev_b32 v138, 16, v145
  v_and_b32 v139, 0xffff0000, v145
  v_lshlrev_b32 v140, 16, v146
  v_and_b32 v141, 0xffff0000, v146
  v_lshlrev_b32 v142, 16, v147
  v_and_b32 v143, 0xffff0000, v147
  v_cvt_u32_f32 v136, v136
  v_cvt_u32_f32 v137, v137
  v_cvt_u32_f32 v138, v138
  v_cvt_u32_f32 v139, v139
  v_cvt_u32_f32 v140, v140
  v_cvt_u32_f32 v141, v141
  v_cvt_u32_f32 v142, v142
  v_cvt_u32_f32 v143, v143
  v_lshl_add_u32 v136, v136, 2, v159
  v_lshl_add_u32 v137, v137, 2, v159
  v_lshl_add_u32 v138, v138, 2, v159
  v_lshl_add_u32 v139, v139, 2, v159
  v_lshl_add_u32 v140, v140, 2, v159
  v_lshl_add_u32 v141, v141, 2, v159
  v_lshl_add_u32 v142, v142, 2, v159
  v_lshl_add_u32 v143, v143, 2, v159
  ds_read_b32 v168, v136 offset:0
  ds_read_b32 v169, v137 offset:0
  ds_read_b32 v170, v138 offset:0
  ds_read_b32 v171, v139 offset:0
  ds_read_b32 v172, v140 offset:0
  ds_read_b32 v173, v141 offset:0
  ds_read_b32 v174, v142 offset:0
  ds_read_b32 v175, v143 offset:0
  ds_read_b32 v176, v136 offset:8704
  ds_read_b32 v177, v137 offset:8704
  ds_read_b32 v178, v138 offset:8704
  ds_read_b32 v179, v139 offset:8704
  ds_read_b32 v180, v140 offset:8704
  ds_read_b32 v181, v141 offset:8704
  ds_read_b32 v182, v142 offset:8704
  ds_read_b32 v183, v143 offset:8704
  ds_read_b32 v150, v159 offset:25608
  ds_read_b32 v151, v159 offset:34312
  ds_read_b32 v184, v136 offset:17408
  ds_read_b32 v185, v137 offset:17408
  ds_read_b32 v186, v138 offset:17408
  ds_read_b32 v187, v139 offset:17408
  ds_read_b32 v188, v140 offset:17408
  ds_read_b32 v189, v141 offset:17408
  ds_read_b32 v190, v142 offset:17408
  ds_read_b32 v191, v143 offset:17408
  ds_read_b32 v192, v136 offset:26112
  ds_read_b32 v193, v137 offset:26112
  ds_read_b32 v194, v138 offset:26112
  ds_read_b32 v195, v139 offset:26112
  ds_read_b32 v196, v140 offset:26112
  ds_read_b32 v197, v141 offset:26112
  ds_read_b32 v198, v142 offset:26112
  ds_read_b32 v199, v143 offset:26112
  s_waitcnt lgkmcnt(15)
  v_add_f32 v18, v148, v149
  v_rcp_f32 v152, v18
  v_and_b32 v158, 1, v157
  v_mul_f32 v148, v148, v152
  v_lshlrev_b32 v158, 1, v158
  v_mul_f32 v149, v149, v152
  v_mul_f32 v168, v168, v148
  v_mul_f32 v169, v169, v148
  v_mul_f32 v170, v170, v148
  v_mul_f32 v171, v171, v148
  v_mul_f32 v172, v172, v148
  v_mul_f32 v173, v173, v148
  v_mul_f32 v174, v174, v148
  v_mul_f32 v175, v175, v148
  v_xor_b32 v156, v156, v158
  v_fmac_f32 v168, v176, v149
  v_fmac_f32 v169, v177, v149
  v_fmac_f32 v170, v178, v149
  v_fmac_f32 v171, v179, v149
  v_fmac_f32 v172, v180, v149
  v_fmac_f32 v173, v181, v149
  v_fmac_f32 v174, v182, v149
  v_fmac_f32 v175, v183, v149
  v_xor_b32 v158, 12, v156
  v_lshlrev_b32 v157, 9, v157
  v_cvt_pk_f16_f32 v200, v168, v169
  v_cvt_pk_f16_f32 v201, v170, v171
  v_cvt_pk_f16_f32 v202, v172, v173
  v_cvt_pk_f16_f32 v203, v174, v175
  v_lshl_add_u32 v156, v156, 4, v157
  ds_write_b128 v156, v[200:203] offset:12288
  v_add_f32 v19, v150, v151
  v_rcp_f32 v153, v19
  v_lshl_add_u32 v158, v158, 4, v157
  v_mul_f32 v150, v150, v153
  v_mul_f32 v151, v151, v153
  v_mul_f32 v184, v184, v150
  s_waitcnt lgkmcnt(15)
  v_mul_f32 v185, v185, v150
  s_waitcnt lgkmcnt(14)
  v_mul_f32 v186, v186, v150
  s_waitcnt lgkmcnt(13)
  v_mul_f32 v187, v187, v150
  s_waitcnt lgkmcnt(12)
  v_mul_f32 v188, v188, v150
  s_waitcnt lgkmcnt(11)
  v_mul_f32 v189, v189, v150
  s_waitcnt lgkmcnt(10)
  v_mul_f32 v190, v190, v150
  s_waitcnt lgkmcnt(9)
  v_mul_f32 v191, v191, v150
  s_waitcnt lgkmcnt(8)
  v_fmac_f32 v184, v192, v151
  s_waitcnt lgkmcnt(7)
  v_fmac_f32 v185, v193, v151
  s_waitcnt lgkmcnt(6)
  v_fmac_f32 v186, v194, v151
  s_waitcnt lgkmcnt(5)
  v_fmac_f32 v187, v195, v151
  s_waitcnt lgkmcnt(4)
  v_fmac_f32 v188, v196, v151
  s_waitcnt lgkmcnt(3)
  v_fmac_f32 v189, v197, v151
  s_waitcnt lgkmcnt(2)
  v_fmac_f32 v190, v198, v151
  s_waitcnt lgkmcnt(1)
  v_fmac_f32 v191, v199, v151
  v_cvt_pk_f16_f32 v204, v184, v185
  v_cvt_pk_f16_f32 v205, v186, v187
  v_cvt_pk_f16_f32 v206, v188, v189
  v_cvt_pk_f16_f32 v207, v190, v191
  ds_write_b128 v158, v[204:207] offset:16384
  v_mul_f32 v18, 0x41800000, v18
  v_mul_f32 v19, 0x41800000, v19
  s_waitcnt lgkmcnt(0)
  s_barrier
  s_lshl_b32 s28, s24, 5
  s_add_u32 s28, s28, 0x0
  s_add_u32 s29, s28, 0x104000
  buffer_load_dwordx4 v[244:247], v1, s[8:11], s28 offen sc1
  buffer_load_dwordx4 v[248:251], v1, s[8:11], s29 offen sc1
  ds_read_b128 v[152:155], v97 offset:12288
  ds_read_b128 v[136:139], v9 offset:12288
  ds_read_b128 v[160:163], v97 offset:12544
  ds_read_b128 v[144:147], v9 offset:12544
  ds_read_b128 v[156:159], v97 offset:14336
  ds_read_b128 v[164:167], v97 offset:14592
  ds_read_b128 v[148:151], v9 offset:14592
  s_waitcnt vmcnt(9) lgkmcnt(6)
  v_mfma_f32_16x16x32_f16 v[192:195], v[152:155], a[72:75], 0
  ds_read_b128 v[140:143], v9 offset:14336
  s_waitcnt lgkmcnt(6)
  v_mfma_f32_16x16x32_f16 v[176:179], v[136:139], a[72:75], 0
  s_waitcnt lgkmcnt(5)
  v_mfma_f32_16x16x32_f16 v[188:191], v[160:163], a[64:67], 0
  s_waitcnt lgkmcnt(4)
  v_mfma_f32_16x16x32_f16 v[180:183], v[144:147], a[72:75], 0
  s_waitcnt vmcnt(8) lgkmcnt(3)
  v_mfma_f32_16x16x32_f16 v[192:195], v[156:159], a[76:79], v[192:195]
  v_mfma_f32_16x16x32_f16 v[184:187], v[152:155], a[64:67], 0
  v_mfma_f32_16x16x32_f16 v[184:187], v[156:159], a[68:71], v[184:187]
  s_waitcnt lgkmcnt(0)
  v_mfma_f32_16x16x32_f16 v[176:179], v[140:143], a[76:79], v[176:179]
  v_mfma_f32_16x16x32_f16 v[196:199], v[160:163], a[72:75], 0
  s_nop 4
  v_cvt_pk_f16_f32 v184, v184, v192
  v_cvt_pk_f16_f32 v187, v187, v195
  v_mfma_f32_16x16x32_f16 v[196:199], v[164:167], a[76:79], v[196:199]
  s_waitcnt vmcnt(7)
  v_pk_mul_f16 v211, v187, v35 op_sel:[0,0] op_sel_hi:[0,1]
  v_cvt_pk_f16_f32 v186, v186, v194
  v_mfma_f32_16x16x32_f16 v[172:175], v[144:147], a[64:67], 0
  v_pk_mul_f16 v208, v184, v32 op_sel:[0,0] op_sel_hi:[0,1]
  v_pk_fma_f16 v208, v184, v32, v208 op_sel:[1,1,0] op_sel_hi:[1,0,1] neg_lo:[1,0,0]
  v_mfma_f32_16x16x32_f16 v[168:171], v[136:139], a[64:67], 0
  v_pk_mul_f16 v210, v186, v34 op_sel:[0,0] op_sel_hi:[0,1]
  v_pk_fma_f16 v210, v186, v34, v210 op_sel:[1,1,0] op_sel_hi:[1,0,1] neg_lo:[1,0,0]
  v_mfma_f32_16x16x32_f16 v[168:171], v[140:143], a[68:71], v[168:171]
  v_pk_fma_f16 v211, v187, v35, v211 op_sel:[1,1,0] op_sel_hi:[1,0,1] neg_lo:[1,0,0]
  v_cvt_pk_f16_f32 v185, v185, v193
  v_mfma_f32_16x16x32_f16 v[188:191], v[164:167], a[68:71], v[188:191]
  v_pk_mul_f16 v209, v185, v33 op_sel:[0,0] op_sel_hi:[0,1]
  v_pk_fma_f16 v209, v185, v33, v209 op_sel:[1,1,0] op_sel_hi:[1,0,1] neg_lo:[1,0,0]
  v_mfma_f32_16x16x32_f16 v[180:183], v[148:151], a[76:79], v[180:183]
  s_nop 1
  v_cvt_pk_f16_f32 v169, v169, v177
  v_cvt_pk_f16_f32 v170, v170, v178
  v_mfma_f32_16x16x32_f16 v[172:175], v[148:151], a[68:71], v[172:175]
  v_pk_mul_f16 v202, v170, v34 op_sel:[0,0] op_sel_hi:[0,1]
  v_cvt_pk_f16_f32 v171, v171, v179
  v_pk_mul_f16 v203, v171, v35 op_sel:[0,0] op_sel_hi:[0,1]
  v_mfma_f32_16x16x32_f16 v[156:159], a[40:43], v[208:211], 0
  v_cvt_pk_f16_f32 v191, v191, v199
  v_pk_fma_f16 v202, v170, v34, v202 op_sel:[1,1,0] op_sel_hi:[1,0,1] neg_lo:[1,0,0]
  s_nop 1
  v_cvt_pk_f16_f32 v175, v175, v183
  v_mfma_f32_16x16x32_f16 v[164:167], a[56:59], v[208:211], 0
  v_pk_mul_f16 v201, v169, v33 op_sel:[0,0] op_sel_hi:[0,1]
  v_cvt_pk_f16_f32 v168, v168, v176
  v_pk_fma_f16 v201, v169, v33, v201 op_sel:[1,1,0] op_sel_hi:[1,0,1] neg_lo:[1,0,0]
  v_cvt_pk_f16_f32 v173, v173, v181
  v_cvt_pk_f16_f32 v188, v188, v196
  s_waitcnt vmcnt(6)
  v_pk_mul_f16 v212, v188, v36 op_sel:[0,0] op_sel_hi:[0,1]
  v_pk_mul_f16 v205, v173, v37 op_sel:[0,0] op_sel_hi:[0,1]
  v_mfma_f32_16x16x32_f16 v[152:155], a[32:35], v[208:211], 0
  v_pk_mul_f16 v200, v168, v32 op_sel:[0,0] op_sel_hi:[0,1]
  v_cvt_pk_f16_f32 v174, v174, v182
  v_mfma_f32_16x16x32_f16 v[160:163], a[48:51], v[208:211], 0
  v_pk_fma_f16 v205, v173, v37, v205 op_sel:[1,1,0] op_sel_hi:[1,0,1] neg_lo:[1,0,0]
  v_pk_mul_f16 v207, v175, v39 op_sel:[0,0] op_sel_hi:[0,1]
  v_pk_fma_f16 v207, v175, v39, v207 op_sel:[1,1,0] op_sel_hi:[1,0,1] neg_lo:[1,0,0]
  v_pk_fma_f16 v203, v171, v35, v203 op_sel:[1,1,0] op_sel_hi:[1,0,1] neg_lo:[1,0,0]
  v_cvt_pk_f16_f32 v172, v172, v180
  v_pk_mul_f16 v204, v172, v36 op_sel:[0,0] op_sel_hi:[0,1]
  v_pk_fma_f16 v204, v172, v36, v204 op_sel:[1,1,0] op_sel_hi:[1,0,1] neg_lo:[1,0,0]
  v_pk_mul_f16 v206, v174, v38 op_sel:[0,0] op_sel_hi:[0,1]
  v_pk_fma_f16 v206, v174, v38, v206 op_sel:[1,1,0] op_sel_hi:[1,0,1] neg_lo:[1,0,0]
  v_pk_fma_f16 v200, v168, v32, v200 op_sel:[1,1,0] op_sel_hi:[1,0,1] neg_lo:[1,0,0]
  v_cvt_pk_f16_f32 v190, v190, v198
  v_pk_mul_f16 v214, v190, v38 op_sel:[0,0] op_sel_hi:[0,1]
  v_mfma_f32_16x16x32_f16 v[148:151], a[56:59], v[200:203], 0
  v_pk_fma_f16 v214, v190, v38, v214 op_sel:[1,1,0] op_sel_hi:[1,0,1] neg_lo:[1,0,0]
  v_pk_mul_f16 v215, v191, v39 op_sel:[0,0] op_sel_hi:[0,1]
  v_mfma_f32_16x16x32_f16 v[136:139], a[32:35], v[200:203], 0
  v_pk_fma_f16 v215, v191, v39, v215 op_sel:[1,1,0] op_sel_hi:[1,0,1] neg_lo:[1,0,0]
  v_cvt_pk_f16_f32 v189, v189, v197
  v_mfma_f32_16x16x32_f16 v[140:143], a[40:43], v[200:203], 0
  v_pk_mul_f16 v213, v189, v37 op_sel:[0,0] op_sel_hi:[0,1]
  v_pk_fma_f16 v213, v189, v37, v213 op_sel:[1,1,0] op_sel_hi:[1,0,1] neg_lo:[1,0,0]
  v_mfma_f32_16x16x32_f16 v[140:143], a[44:47], v[204:207], v[140:143]
  v_pk_fma_f16 v212, v188, v36, v212 op_sel:[1,1,0] op_sel_hi:[1,0,1] neg_lo:[1,0,0]
  v_mfma_f32_16x16x32_f16 v[148:151], a[60:63], v[204:207], v[148:151]
  s_waitcnt vmcnt(0)
  v_or3_b32 v252, v244, v246, v248
  v_or_b32 v252, v252, v250
  v_mfma_f32_16x16x32_f16 v[144:147], a[48:51], v[200:203], 0
  v_and_b32 v252, 1, v252
  v_cmp_ne_u32 vcc, 0, v252
  v_mfma_f32_16x16x32_f16 v[144:147], a[52:55], v[204:207], v[144:147]
  s_nop 0
  v_cvt_pk_f16_f32 v79, v150, v151
  v_cvt_pk_f16_f32 v78, v148, v149
  v_mfma_f32_16x16x32_f16 v[136:139], a[36:39], v[204:207], v[136:139]
  v_cvt_pk_f16_f32 v75, v142, v143
  v_cvt_pk_f16_f32 v74, v140, v141
  v_mfma_f32_16x16x32_f16 v[152:155], a[36:39], v[212:215], v[152:155]
  s_nop 0
  v_cvt_pk_f16_f32 v76, v144, v145
  v_cvt_pk_f16_f32 v77, v146, v147
  v_mfma_f32_16x16x32_f16 v[156:159], a[44:47], v[212:215], v[156:159]
  s_nop 0
  v_cvt_pk_f16_f32 v72, v136, v137
  v_cvt_pk_f16_f32 v73, v138, v139
  v_mfma_f32_16x16x32_f16 v[164:167], a[60:63], v[212:215], v[164:167]
  v_cvt_pk_f16_f32 v80, v152, v153
  v_cvt_pk_f16_f32 v81, v154, v155
  v_mfma_f32_16x16x32_f16 v[160:163], a[52:55], v[212:215], v[160:163]
  s_nop 0
  v_cvt_pk_f16_f32 v83, v158, v159
  v_cvt_pk_f16_f32 v82, v156, v157
  s_nop 1
  v_cvt_pk_f16_f32 v87, v166, v167
  v_cvt_pk_f16_f32 v86, v164, v165
  s_nop 0
  v_cvt_pk_f16_f32 v85, v162, v163
  v_cvt_pk_f16_f32 v84, v160, v161
  s_nop 1
  s_cbranch_vccz polldone_21
poll_20:
  s_cmp_eq_u32 s26, 0
  s_cbranch_scc1 polldone_21
  s_sub_u32 s26, s26, 1
  s_mov_b64 exec, vcc
  buffer_load_dwordx4 v[244:247], v1, s[8:11], s28 offen sc1
  buffer_load_dwordx4 v[248:251], v1, s[8:11], s29 offen sc1
  s_waitcnt vmcnt(0)
  v_or3_b32 v252, v244, v246, v248
  v_or_b32 v252, v252, v250
  v_and_b32 v252, 1, v252
  v_cmp_ne_u32 vcc, 0, v252
  s_nop 0
  s_cbranch_vccnz poll_20
polldone_21:
  s_mov_b64 exec, -1
  s_branch join_b_19
lay1_b_18:
  s_lshl_b32 s34, s25, 3
  v_pk_fma_f32 v[114:115], v[130:131], v[90:91], v[114:115]
  v_pk_fma_f32 v[106:107], v[122:123], v[90:91], v[106:107]
  v_mov_b32 v140, v106
  v_pk_fma_f32 v[108:109], v[124:125], v[92:93], v[108:109]
  v_pk_fma_f32 v[104:105], v[120:121], v[88:89], v[104:105]
  v_mov_b32 v138, v105
  v_pk_fma_f32 v[116:117], v[132:133], v[92:93], v[116:117]
  v_mov_b32 v136, v104
  v_and_b32 v232, 15, v0
  v_mov_b32 v143, v115
  v_bfe_u32 v233, v0, 4, 2
  v_lshl_add_u32 v232, v233, 6, v232
  v_lshlrev_b32 v232, 5, v232
  v_add_u32 v232, s34, v232
  v_pk_fma_f32 v[112:113], v[128:129], v[88:89], v[112:113]
  v_mov_b32 v137, v112
  ds_write_b64 v232, v[136:137] offset:12288
  v_mov_b32 v139, v113
  ds_write_b64 v232, v[138:139] offset:12800
  v_mov_b32 v141, v114
  ds_write_b64 v232, v[140:141] offset:13312
  v_mov_b32 v147, v117
  v_pk_fma_f32 v[110:111], v[126:127], v[94:95], v[110:111]
  v_mov_b32 v142, v107
  ds_write_b64 v232, v[142:143] offset:13824
  v_mov_b32 v148, v110
  v_and_b32 v234, 1, v0
  v_mov_b32 v150, v111
  v_mov_b32 v144, v108
  v_lshrrev_b32 v233, 1, v0
  v_lshlrev_b32 v233, 6, v233
  v_lshl_add_u32 v233, v234, 4, v233
  v_mov_b32 v145, v116
  ds_write_b64 v232, v[144:145] offset:20480
  v_mov_b32 v146, v109
  ds_write_b64 v232, v[146:147] offset:20992
  v_pk_fma_f32 v[118:119], v[134:135], v[94:95], v[118:119]
  v_mov_b32 v149, v118
  ds_write_b64 v232, v[148:149] offset:21504
  v_mov_b32 v151, v119
  ds_write_b64 v232, v[150:151] offset:22016
  s_waitcnt lgkmcnt(0)
  s_barrier
  s_lshl_b32 s34, s27, 10
  s_add_u32 s44, s34, 0
  s_add_u32 s45, s34, 512
  s_add_u32 s46, s34, 32768
  s_add_u32 s47, s34, 33280
  s_add_u32 s48, s34, 65536
  s_add_u32 s49, s34, 66048
  s_add_u32 s50, s34, 98304
  ds_read_b128 v[104:107], v233 offset:12288
  s_add_u32 s51, s34, 98816
  s_lshl_b32 s28, s24, 5
  s_add_u32 s28, s28, 0x0
  ds_read_b128 v[108:111], v233 offset:12320
  s_add_u32 s29, s28, 0x104000
  ds_read_b128 v[112:115], v233 offset:20480
  ds_read_b128 v[116:119], v233 offset:20512
  v_and_b32 v124, 1, v0
  v_lshlrev_b32 v124, 17, v124
  v_lshrrev_b32 v125, 1, v0
  v_lshl_add_u32 v124, v125, 2, v124
  s_waitcnt vmcnt(0)
  buffer_load_dwordx4 v[244:247], v1, s[8:11], s28 offen sc1
  buffer_load_dwordx4 v[248:251], v1, s[8:11], s29 offen sc1
  s_waitcnt vmcnt(0)
  v_or3_b32 v252, v244, v246, v248
  v_or_b32 v252, v252, v250
  v_and_b32 v252, 1, v252
  v_cmp_ne_u32 vcc, 0, v252
  s_nop 0
  s_cbranch_vccz polldone_23
poll_22:
  s_cmp_eq_u32 s26, 0
  s_cbranch_scc1 polldone_23
  s_sub_u32 s26, s26, 1
  s_mov_b64 exec, vcc
  buffer_load_dwordx4 v[244:247], v1, s[8:11], s28 offen sc1
  buffer_load_dwordx4 v[248:251], v1, s[8:11], s29 offen sc1
  s_waitcnt vmcnt(0)
  v_or3_b32 v252, v244, v246, v248
  v_or_b32 v252, v252, v250
  v_and_b32 v252, 1, v252
  v_cmp_ne_u32 vcc, 0, v252
  s_nop 0
  s_cbranch_vccnz poll_22
polldone_23:
  s_mov_b64 exec, -1
join_b_19:
  ds_write_b128 v8, v[244:247] offset:0
  ds_write_b128 v8, v[248:251] offset:2048
  s_waitcnt lgkmcnt(0)
  s_barrier
  ds_read_b128 v[136:139], v9 offset:0
  ds_read_b128 v[140:143], v9 offset:2048
  ds_read_b128 v[144:147], v9 offset:256
  ds_read_b128 v[148:151], v9 offset:2304
  ds_read_b128 v[152:155], v97 offset:0
  ds_read_b128 v[156:159], v97 offset:2048
  ds_read_b128 v[160:163], v97 offset:256
  s_waitcnt lgkmcnt(6)
  v_mfma_f32_16x16x32_f16 v[168:171], v[136:139], a[64:67], 0
  ds_read_b128 v[164:167], v97 offset:2304
  v_mfma_f32_16x16x32_f16 v[176:179], v[136:139], a[72:75], 0
  s_waitcnt lgkmcnt(6)
  v_mfma_f32_16x16x32_f16 v[168:171], v[140:143], a[68:71], v[168:171]
  v_mfma_f32_16x16x32_f16 v[176:179], v[140:143], a[76:79], v[176:179]
  s_waitcnt lgkmcnt(5)
  v_mfma_f32_16x16x32_f16 v[172:175], v[144:147], a[64:67], 0
  v_mfma_f32_16x16x32_f16 v[180:183], v[144:147], a[72:75], 0
  s_nop 4
  v_cvt_pk_f16_f32 v168, v168, v176
  v_cvt_pk_f16_f32 v169, v169, v177
  s_waitcnt lgkmcnt(4)
  v_mfma_f32_16x16x32_f16 v[172:175], v[148:151], a[68:71], v[172:175]
  v_cvt_pk_f16_f32 v170, v170, v178
  v_cvt_pk_f16_f32 v171, v171, v179
  v_mfma_f32_16x16x32_f16 v[180:183], v[148:151], a[76:79], v[180:183]
  v_pk_mul_f16 v200, v168, v32 op_sel:[0,0] op_sel_hi:[0,1]
  v_pk_mul_f16 v201, v169, v33 op_sel:[0,0] op_sel_hi:[0,1]
  v_pk_mul_f16 v202, v170, v34 op_sel:[0,0] op_sel_hi:[0,1]
  v_pk_mul_f16 v203, v171, v35 op_sel:[0,0] op_sel_hi:[0,1]
  v_pk_fma_f16 v200, v168, v32, v200 op_sel:[1,1,0] op_sel_hi:[1,0,1] neg_lo:[1,0,0]
  v_pk_fma_f16 v201, v169, v33, v201 op_sel:[1,1,0] op_sel_hi:[1,0,1] neg_lo:[1,0,0]
  v_pk_fma_f16 v202, v170, v34, v202 op_sel:[1,1,0] op_sel_hi:[1,0,1] neg_lo:[1,0,0]
  v_pk_fma_f16 v203, v171, v35, v203 op_sel:[1,1,0] op_sel_hi:[1,0,1] neg_lo:[1,0,0]
  v_cvt_pk_f16_f32 v172, v172, v180
  v_cvt_pk_f16_f32 v173, v173, v181
  v_cvt_pk_f16_f32 v174, v174, v182
  v_cvt_pk_f16_f32 v175, v175, v183
  v_pk_mul_f16 v204, v172, v36 op_sel:[0,0] op_sel_hi:[0,1]
  v_pk_mul_f16 v205, v173, v37 op_sel:[0,0] op_sel_hi:[0,1]
  v_pk_mul_f16 v206, v174, v38 op_sel:[0,0] op_sel_hi:[0,1]
  v_pk_mul_f16 v207, v175, v39 op_sel:[0,0] op_sel_hi:[0,1]
  v_mfma_f32_16x16x32_f16 v[136:139], a[32:35], v[200:203], 0
  v_pk_fma_f16 v204, v172, v36, v204 op_sel:[1,1,0] op_sel_hi:[1,0,1] neg_lo:[1,0,0]
  v_pk_fma_f16 v205, v173, v37, v205 op_sel:[1,1,0] op_sel_hi:[1,0,1] neg_lo:[1,0,0]
  v_mfma_f32_16x16x32_f16 v[140:143], a[40:43], v[200:203], 0
  v_pk_fma_f16 v206, v174, v38, v206 op_sel:[1,1,0] op_sel_hi:[1,0,1] neg_lo:[1,0,0]
  v_pk_fma_f16 v207, v175, v39, v207 op_sel:[1,1,0] op_sel_hi:[1,0,1] neg_lo:[1,0,0]
  v_mfma_f32_16x16x32_f16 v[144:147], a[48:51], v[200:203], 0
  v_mfma_f32_16x16x32_f16 v[148:151], a[56:59], v[200:203], 0
  v_mfma_f32_16x16x32_f16 v[136:139], a[36:39], v[204:207], v[136:139]
  v_mfma_f32_16x16x32_f16 v[140:143], a[44:47], v[204:207], v[140:143]
  v_mfma_f32_16x16x32_f16 v[144:147], a[52:55], v[204:207], v[144:147]
  s_nop 5
  v_cvt_pk_f16_f32 v136, v136, v137
  v_cvt_pk_f16_f32 v138, v138, v139
  v_mfma_f32_16x16x32_f16 v[148:151], a[60:63], v[204:207], v[148:151]
  v_cvt_pk_f16_f32 v140, v140, v141
  v_cvt_pk_f16_f32 v142, v142, v143
  v_pk_mul_f16 v216, v136, v72 op_sel:[0,0] op_sel_hi:[0,1] neg_hi:[0,1]
  v_pk_mul_f16 v217, v138, v73 op_sel:[0,0] op_sel_hi:[0,1] neg_hi:[0,1]
  v_pk_mul_f16 v218, v140, v74 op_sel:[0,0] op_sel_hi:[0,1] neg_hi:[0,1]
  v_pk_mul_f16 v219, v142, v75 op_sel:[0,0] op_sel_hi:[0,1] neg_hi:[0,1]
  v_pk_fma_f16 v216, v136, v72, v216 op_sel:[1,1,0] op_sel_hi:[1,0,1] neg_lo:[1,0,0] neg_hi:[1,0,0]
  v_pk_fma_f16 v217, v138, v73, v217 op_sel:[1,1,0] op_sel_hi:[1,0,1] neg_lo:[1,0,0] neg_hi:[1,0,0]
  v_pk_fma_f16 v218, v140, v74, v218 op_sel:[1,1,0] op_sel_hi:[1,0,1] neg_lo:[1,0,0] neg_hi:[1,0,0]
  v_pk_fma_f16 v219, v142, v75, v219 op_sel:[1,1,0] op_sel_hi:[1,0,1] neg_lo:[1,0,0] neg_hi:[1,0,0]
  s_waitcnt lgkmcnt(3)
  v_mfma_f32_16x16x32_f16 v[184:187], v[152:155], a[64:67], 0
  v_cvt_pk_f16_f32 v144, v144, v145
  v_cvt_pk_f16_f32 v146, v146, v147
  v_mfma_f32_16x16x32_f16 v[192:195], v[152:155], a[72:75], 0
  v_cvt_pk_f16_f32 v148, v148, v149
  v_cvt_pk_f16_f32 v150, v150, v151
  v_pk_mul_f16 v220, v144, v76 op_sel:[0,0] op_sel_hi:[0,1] neg_hi:[0,1]
  v_pk_mul_f16 v221, v146, v77 op_sel:[0,0] op_sel_hi:[0,1] neg_hi:[0,1]
  v_pk_mul_f16 v222, v148, v78 op_sel:[0,0] op_sel_hi:[0,1] neg_hi:[0,1]
  v_pk_mul_f16 v223, v150, v79 op_sel:[0,0] op_sel_hi:[0,1] neg_hi:[0,1]
  v_mfma_f32_16x16x32_f16 v[168:171], a[32:35], v[216:219], 0
  v_pk_fma_f16 v220, v144, v76, v220 op_sel:[1,1,0] op_sel_hi:[1,0,1] neg_lo:[1,0,0] neg_hi:[1,0,0]
  v_pk_fma_f16 v221, v146, v77, v221 op_sel:[1,1,0] op_sel_hi:[1,0,1] neg_lo:[1,0,0] neg_hi:[1,0,0]
  v_pk_fma_f16 v222, v148, v78, v222 op_sel:[1,1,0] op_sel_hi:[1,0,1] neg_lo:[1,0,0] neg_hi:[1,0,0]
  v_pk_fma_f16 v223, v150, v79, v223 op_sel:[1,1,0] op_sel_hi:[1,0,1] neg_lo:[1,0,0] neg_hi:[1,0,0]
  s_waitcnt lgkmcnt(2)
  v_mfma_f32_16x16x32_f16 v[184:187], v[156:159], a[68:71], v[184:187]
  v_mfma_f32_16x16x32_f16 v[192:195], v[156:159], a[76:79], v[192:195]
  s_waitcnt lgkmcnt(1)
  v_mfma_f32_16x16x32_f16 v[188:191], v[160:163], a[64:67], 0
  v_mfma_f32_16x16x32_f16 v[196:199], v[160:163], a[72:75], 0
  s_nop 4
  v_cvt_pk_f16_f32 v184, v184, v192
  v_cvt_pk_f16_f32 v185, v185, v193
  v_mfma_f32_16x16x32_f16 v[168:171], a[36:39], v[220:223], v[168:171]
  v_cvt_pk_f16_f32 v186, v186, v194
  v_cvt_pk_f16_f32 v187, v187, v195
  s_waitcnt lgkmcnt(0)
  v_mfma_f32_16x16x32_f16 v[188:191], v[164:167], a[68:71], v[188:191]
  v_pk_mul_f16 v208, v184, v32 op_sel:[0,0] op_sel_hi:[0,1]
  v_pk_mul_f16 v209, v185, v33 op_sel:[0,0] op_sel_hi:[0,1]
  v_mfma_f32_16x16x32_f16 v[196:199], v[164:167], a[76:79], v[196:199]
  v_pk_mul_f16 v210, v186, v34 op_sel:[0,0] op_sel_hi:[0,1]
  v_pk_mul_f16 v211, v187, v35 op_sel:[0,0] op_sel_hi:[0,1]
  v_mfma_f32_16x16x32_f16 v[172:175], a[40:43], v[216:219], 0
  v_pk_fma_f16 v208, v184, v32, v208 op_sel:[1,1,0] op_sel_hi:[1,0,1] neg_lo:[1,0,0]
  v_pk_fma_f16 v209, v185, v33, v209 op_sel:[1,1,0] op_sel_hi:[1,0,1] neg_lo:[1,0,0]
  v_mfma_f32_16x16x32_f16 v[172:175], a[44:47], v[220:223], v[172:175]
  v_pk_fma_f16 v210, v186, v34, v210 op_sel:[1,1,0] op_sel_hi:[1,0,1] neg_lo:[1,0,0]
  v_pk_fma_f16 v211, v187, v35, v211 op_sel:[1,1,0] op_sel_hi:[1,0,1] neg_lo:[1,0,0]
  v_cvt_pk_f16_f32 v168, v168, v169
  v_pk_mul_f16 v200, v168, v32 op_sel:[0,0] op_sel_hi:[0,1]
  v_cvt_pk_f16_f32 v188, v188, v196
  v_cvt_pk_f16_f32 v189, v189, v197
  v_cvt_pk_f16_f32 v190, v190, v198
  v_cvt_pk_f16_f32 v191, v191, v199
  v_pk_fma_f16 v200, v168, v32, v200 op_sel:[1,1,0] op_sel_hi:[1,0,1] neg_lo:[1,0,0]
  v_pk_mul_f16 v212, v188, v36 op_sel:[0,0] op_sel_hi:[0,1]
  v_pk_mul_f16 v213, v189, v37 op_sel:[0,0] op_sel_hi:[0,1]
  v_pk_mul_f16 v214, v190, v38 op_sel:[0,0] op_sel_hi:[0,1]
  v_pk_mul_f16 v215, v191, v39 op_sel:[0,0] op_sel_hi:[0,1]
  v_mfma_f32_16x16x32_f16 v[152:155], a[32:35], v[208:211], 0
  ds_write_b32 v7, v200 offset:12288
  v_mfma_f32_16x16x32_f16 v[156:159], a[40:43], v[208:211], 0
  v_pk_fma_f16 v212, v188, v36, v212 op_sel:[1,1,0] op_sel_hi:[1,0,1] neg_lo:[1,0,0]
  v_pk_fma_f16 v213, v189, v37, v213 op_sel:[1,1,0] op_sel_hi:[1,0,1] neg_lo:[1,0,0]
  v_pk_fma_f16 v214, v190, v38, v214 op_sel:[1,1,0] op_sel_hi:[1,0,1] neg_lo:[1,0,0]
  v_pk_fma_f16 v215, v191, v39, v215 op_sel:[1,1,0] op_sel_hi:[1,0,1] neg_lo:[1,0,0]
  v_mfma_f32_16x16x32_f16 v[176:179], a[48:51], v[216:219], 0
  v_cvt_pk_f16_f32 v170, v170, v171
  v_pk_mul_f16 v201, v170, v33 op_sel:[0,0] op_sel_hi:[0,1]
  v_pk_fma_f16 v201, v170, v33, v201 op_sel:[1,1,0] op_sel_hi:[1,0,1] neg_lo:[1,0,0]
  v_mfma_f32_16x16x32_f16 v[160:163], a[48:51], v[208:211], 0
  ds_write_b32 v7, v201 offset:12304
  v_mfma_f32_16x16x32_f16 v[164:167], a[56:59], v[208:211], 0
  v_cvt_pk_f16_f32 v172, v172, v173
  v_pk_mul_f16 v202, v172, v34 op_sel:[0,0] op_sel_hi:[0,1]
  v_mfma_f32_16x16x32_f16 v[152:155], a[36:39], v[212:215], v[152:155]
  v_pk_fma_f16 v202, v172, v34, v202 op_sel:[1,1,0] op_sel_hi:[1,0,1] neg_lo:[1,0,0]
  ds_write_b32 v96, v202 offset:12288
  v_mfma_f32_16x16x32_f16 v[156:159], a[44:47], v[212:215], v[156:159]
  v_cvt_pk_f16_f32 v174, v174, v175
  v_mfma_f32_16x16x32_f16 v[176:179], a[52:55], v[220:223], v[176:179]
  v_pk_mul_f16 v203, v174, v35 op_sel:[0,0] op_sel_hi:[0,1]
  v_pk_fma_f16 v203, v174, v35, v203 op_sel:[1,1,0] op_sel_hi:[1,0,1] neg_lo:[1,0,0]
  v_mfma_f32_16x16x32_f16 v[160:163], a[52:55], v[212:215], v[160:163]
  ds_write_b32 v96, v203 offset:12304
  v_mfma_f32_16x16x32_f16 v[164:167], a[60:63], v[212:215], v[164:167]
  v_cvt_pk_f16_f32 v152, v152, v153
  v_cvt_pk_f16_f32 v154, v154, v155
  v_mfma_f32_16x16x32_f16 v[180:183], a[56:59], v[216:219], 0
  v_cvt_pk_f16_f32 v156, v156, v157
  v_cvt_pk_f16_f32 v158, v158, v159
  v_mfma_f32_16x16x32_f16 v[180:183], a[60:63], v[220:223], v[180:183]
  v_pk_mul_f16 v224, v152, v80 op_sel:[0,0] op_sel_hi:[0,1] neg_hi:[0,1]
  v_pk_mul_f16 v225, v154, v81 op_sel:[0,0] op_sel_hi:[0,1] neg_hi:[0,1]
  v_pk_mul_f16 v226, v156, v82 op_sel:[0,0] op_sel_hi:[0,1] neg_hi:[0,1]
  v_pk_mul_f16 v227, v158, v83 op_sel:[0,0] op_sel_hi:[0,1] neg_hi:[0,1]
  v_cvt_pk_f16_f32 v176, v176, v177
  v_pk_fma_f16 v224, v152, v80, v224 op_sel:[1,1,0] op_sel_hi:[1,0,1] neg_lo:[1,0,0] neg_hi:[1,0,0]
  v_pk_fma_f16 v225, v154, v81, v225 op_sel:[1,1,0] op_sel_hi:[1,0,1] neg_lo:[1,0,0] neg_hi:[1,0,0]
  v_pk_fma_f16 v226, v156, v82, v226 op_sel:[1,1,0] op_sel_hi:[1,0,1] neg_lo:[1,0,0] neg_hi:[1,0,0]
  v_pk_fma_f16 v227, v158, v83, v227 op_sel:[1,1,0] op_sel_hi:[1,0,1] neg_lo:[1,0,0] neg_hi:[1,0,0]
  v_pk_mul_f16 v204, v176, v36 op_sel:[0,0] op_sel_hi:[0,1]
  v_pk_fma_f16 v204, v176, v36, v204 op_sel:[1,1,0] op_sel_hi:[1,0,1] neg_lo:[1,0,0]
  v_cvt_pk_f16_f32 v160, v160, v161
  v_cvt_pk_f16_f32 v162, v162, v163
  v_cvt_pk_f16_f32 v164, v164, v165
  v_cvt_pk_f16_f32 v166, v166, v167
  ds_write_b32 v7, v204 offset:12544
  v_mfma_f32_16x16x32_f16 v[184:187], a[32:35], v[224:227], 0
  v_pk_mul_f16 v228, v160, v84 op_sel:[0,0] op_sel_hi:[0,1] neg_hi:[0,1]
  v_pk_mul_f16 v229, v162, v85 op_sel:[0,0] op_sel_hi:[0,1] neg_hi:[0,1]
  v_pk_mul_f16 v230, v164, v86 op_sel:[0,0] op_sel_hi:[0,1] neg_hi:[0,1]
  v_pk_mul_f16 v231, v166, v87 op_sel:[0,0] op_sel_hi:[0,1] neg_hi:[0,1]
  v_cvt_pk_f16_f32 v178, v178, v179
  v_pk_fma_f16 v228, v160, v84, v228 op_sel:[1,1,0] op_sel_hi:[1,0,1] neg_lo:[1,0,0] neg_hi:[1,0,0]
  v_pk_fma_f16 v229, v162, v85, v229 op_sel:[1,1,0] op_sel_hi:[1,0,1] neg_lo:[1,0,0] neg_hi:[1,0,0]
  v_pk_fma_f16 v230, v164, v86, v230 op_sel:[1,1,0] op_sel_hi:[1,0,1] neg_lo:[1,0,0] neg_hi:[1,0,0]
  v_pk_fma_f16 v231, v166, v87, v231 op_sel:[1,1,0] op_sel_hi:[1,0,1] neg_lo:[1,0,0] neg_hi:[1,0,0]
  v_pk_mul_f16 v205, v178, v37 op_sel:[0,0] op_sel_hi:[0,1]
  v_pk_fma_f16 v205, v178, v37, v205 op_sel:[1,1,0] op_sel_hi:[1,0,1] neg_lo:[1,0,0]
  ds_write_b32 v7, v205 offset:12560
  v_mfma_f32_16x16x32_f16 v[184:187], a[36:39], v[228:231], v[184:187]
  v_cvt_pk_f16_f32 v180, v180, v181
  v_pk_mul_f16 v206, v180, v38 op_sel:[0,0] op_sel_hi:[0,1]
  v_pk_fma_f16 v206, v180, v38, v206 op_sel:[1,1,0] op_sel_hi:[1,0,1] neg_lo:[1,0,0]
  ds_write_b32 v96, v206 offset:12544
  v_mfma_f32_16x16x32_f16 v[188:191], a[40:43], v[224:227], 0
  v_cvt_pk_f16_f32 v182, v182, v183
  v_pk_mul_f16 v207, v182, v39 op_sel:[0,0] op_sel_hi:[0,1]
  v_pk_fma_f16 v207, v182, v39, v207 op_sel:[1,1,0] op_sel_hi:[1,0,1] neg_lo:[1,0,0]
  ds_write_b32 v96, v207 offset:12560
  v_mfma_f32_16x16x32_f16 v[188:191], a[44:47], v[228:231], v[188:191]
  v_cvt_pk_f16_f32 v184, v184, v185
  v_pk_mul_f16 v208, v184, v32 op_sel:[0,0] op_sel_hi:[0,1]
  v_pk_fma_f16 v208, v184, v32, v208 op_sel:[1,1,0] op_sel_hi:[1,0,1] neg_lo:[1,0,0]
  ds_write_b32 v7, v208 offset:20480
  v_mfma_f32_16x16x32_f16 v[192:195], a[48:51], v[224:227], 0
  v_cvt_pk_f16_f32 v186, v186, v187
  v_pk_mul_f16 v209, v186, v33 op_sel:[0,0] op_sel_hi:[0,1]
  v_pk_fma_f16 v209, v186, v33, v209 op_sel:[1,1,0] op_sel_hi:[1,0,1] neg_lo:[1,0,0]
  ds_write_b32 v7, v209 offset:20496
  v_mfma_f32_16x16x32_f16 v[192:195], a[52:55], v[228:231], v[192:195]
  v_cvt_pk_f16_f32 v188, v188, v189
  v_pk_mul_f16 v210, v188, v34 op_sel:[0,0] op_sel_hi:[0,1]
  v_pk_fma_f16 v210, v188, v34, v210 op_sel:[1,1,0] op_sel_hi:[1,0,1] neg_lo:[1,0,0]
  ds_write_b32 v96, v210 offset:20480
  v_mfma_f32_16x16x32_f16 v[196:199], a[56:59], v[224:227], 0
  v_cvt_pk_f16_f32 v190, v190, v191
  v_pk_mul_f16 v211, v190, v35 op_sel:[0,0] op_sel_hi:[0,1]
  v_pk_fma_f16 v211, v190, v35, v211 op_sel:[1,1,0] op_sel_hi:[1,0,1] neg_lo:[1,0,0]
  ds_write_b32 v96, v211 offset:20496
  v_mfma_f32_16x16x32_f16 v[196:199], a[60:63], v[228:231], v[196:199]
  v_cvt_pk_f16_f32 v192, v192, v193
  v_pk_mul_f16 v212, v192, v36 op_sel:[0,0] op_sel_hi:[0,1]
  v_pk_fma_f16 v212, v192, v36, v212 op_sel:[1,1,0] op_sel_hi:[1,0,1] neg_lo:[1,0,0]
  ds_write_b32 v7, v212 offset:20736
  v_cvt_pk_f16_f32 v194, v194, v195
  v_pk_mul_f16 v213, v194, v37 op_sel:[0,0] op_sel_hi:[0,1]
  v_pk_fma_f16 v213, v194, v37, v213 op_sel:[1,1,0] op_sel_hi:[1,0,1] neg_lo:[1,0,0]
  ds_write_b32 v7, v213 offset:20752
  v_cvt_pk_f16_f32 v196, v196, v197
  v_pk_mul_f16 v214, v196, v38 op_sel:[0,0] op_sel_hi:[0,1]
  v_pk_fma_f16 v214, v196, v38, v214 op_sel:[1,1,0] op_sel_hi:[1,0,1] neg_lo:[1,0,0]
  ds_write_b32 v96, v214 offset:20736
  v_cvt_pk_f16_f32 v198, v198, v199
  v_pk_mul_f16 v215, v198, v39 op_sel:[0,0] op_sel_hi:[0,1]
  v_pk_fma_f16 v215, v198, v39, v215 op_sel:[1,1,0] op_sel_hi:[1,0,1] neg_lo:[1,0,0]
  ds_write_b32 v96, v215 offset:20752
  s_waitcnt lgkmcnt(0)
  s_barrier
  ds_read_b128 v[136:139], v6 offset:12288
  s_mul_i32 s30, s24, 8320
  s_add_u32 s30, s30, 0x2a0000
  s_add_u32 s31, s30, 0x1000
  ds_read_b128 v[200:203], v6 offset:20480
  ds_read_b128 v[216:219], v6 offset:20736
  ds_read_b128 v[152:155], v6 offset:12544
  ds_read_b128 v[140:143], v6 offset:14336
  ds_read_b128 v[204:207], v6 offset:22528
  ds_read_b128 v[220:223], v6 offset:22784
  s_waitcnt lgkmcnt(6)
  v_mfma_f32_16x16x32_f16 v[168:171], a[80:83], v[136:139], 0
  ds_read_b128 v[156:159], v6 offset:14592
  s_waitcnt lgkmcnt(6)
  v_mfma_f32_16x16x32_f16 v[176:179], a[80:83], v[200:203], 0
  ds_read_b128 v[144:147], v6 offset:16384
  s_waitcnt lgkmcnt(6)
  v_mfma_f32_16x16x32_f16 v[180:183], a[80:83], v[216:219], 0
  ds_read_b128 v[224:227], v6 offset:24832
  s_waitcnt lgkmcnt(6)
  v_mfma_f32_16x16x32_f16 v[172:175], a[80:83], v[152:155], 0
  ds_read_b128 v[208:211], v6 offset:24576
  s_waitcnt lgkmcnt(6)
  v_mfma_f32_16x16x32_f16 v[168:171], a[84:87], v[140:143], v[168:171]
  ds_read_b128 v[160:163], v6 offset:16640
  s_waitcnt lgkmcnt(6)
  v_mfma_f32_16x16x32_f16 v[176:179], a[84:87], v[204:207], v[176:179]
  ds_read_b128 v[212:215], v6 offset:26624
  s_waitcnt lgkmcnt(6)
  v_mfma_f32_16x16x32_f16 v[180:183], a[84:87], v[220:223], v[180:183]
  ds_read_b128 v[164:167], v6 offset:18688
  s_waitcnt lgkmcnt(6)
  v_mfma_f32_16x16x32_f16 v[172:175], a[84:87], v[156:159], v[172:175]
  ds_read_b128 v[228:231], v6 offset:26880
  s_waitcnt lgkmcnt(6)
  v_mfma_f32_16x16x32_f16 v[168:171], a[88:91], v[144:147], v[168:171]
  ds_read_b128 v[148:151], v6 offset:18432
  s_waitcnt lgkmcnt(6)
  v_mfma_f32_16x16x32_f16 v[180:183], a[88:91], v[224:227], v[180:183]
  s_waitcnt lgkmcnt(5)
  v_mfma_f32_16x16x32_f16 v[176:179], a[88:91], v[208:211], v[176:179]
  s_waitcnt lgkmcnt(4)
  v_mfma_f32_16x16x32_f16 v[172:175], a[88:91], v[160:163], v[172:175]
  s_waitcnt lgkmcnt(3)
  v_mfma_f32_16x16x32_f16 v[176:179], a[92:95], v[212:215], v[176:179]
  s_waitcnt lgkmcnt(2)
  v_mfma_f32_16x16x32_f16 v[172:175], a[92:95], v[164:167], v[172:175]
  s_waitcnt lgkmcnt(1)
  v_mfma_f32_16x16x32_f16 v[180:183], a[92:95], v[228:231], v[180:183]
  s_nop 3
  v_fma_mixlo_f16 v235, v178, v19, 0
  v_fma_mixlo_f16 v234, v176, v19, 0
  s_waitcnt lgkmcnt(0)
  v_mfma_f32_16x16x32_f16 v[168:171], a[92:95], v[148:151], v[168:171]
  v_fma_mixhi_f16 v234, v177, v19, 0
  v_fma_mixlo_f16 v236, v172, v18, 0
  v_fma_mixlo_f16 v237, v174, v18, 0
  v_fma_mixlo_f16 v238, v180, v19, 0
  v_fma_mixlo_f16 v239, v182, v19, 0
  v_fma_mixhi_f16 v235, v179, v19, 0
  v_fma_mixhi_f16 v239, v183, v19, 0
  s_nop 0
  v_fma_mixlo_f16 v233, v170, v18, 0
  v_fma_mixlo_f16 v232, v168, v18, 0
  v_fma_mixhi_f16 v237, v175, v18, 0
  v_fma_mixhi_f16 v232, v169, v18, 0
  v_and_b32 v234, -2, v234
  v_fma_mixhi_f16 v233, v171, v18, 0
  v_fma_mixhi_f16 v236, v173, v18, 0
  v_fma_mixhi_f16 v238, v181, v19, 0
  v_and_b32 v236, -2, v236
  v_and_b32 v232, -2, v232
  buffer_store_dwordx4 v[232:235], v3, s[8:11], s30 offen sc1
  v_and_b32 v238, -2, v238
  buffer_store_dwordx4 v[236:239], v3, s[8:11], s30 offen offset:1024 sc1
  s_cmp_lg_u32 s65, 0
  s_nop 0
  s_cbranch_scc1 lay1_c_24
  v_and_b32 v232, 15, v0
  v_bfe_u32 v233, v0, 4, 2
  v_lshl_add_u32 v232, v233, 6, v232
  v_lshlrev_b32 v233, 1, v232
  buffer_load_ushort v88, v233, s[20:23], 0 offen offset:0
  buffer_load_ushort v89, v233, s[20:23], 0 offen offset:32
  buffer_load_ushort v90, v233, s[20:23], 0 offen offset:64
  buffer_load_ushort v91, v233, s[20:23], 0 offen offset:96
  buffer_load_ushort v92, v233, s[20:23], 0 offen offset:512
  buffer_load_ushort v93, v233, s[20:23], 0 offen offset:544
  buffer_load_ushort v94, v233, s[20:23], 0 offen offset:576
  buffer_load_ushort v95, v233, s[20:23], 0 offen offset:608
  s_lshl_b32 s28, s24, 5
  s_add_u32 s28, s28, 0x2a0000
  s_add_u32 s29, s28, 0x104000
  s_waitcnt vmcnt(7)
  v_lshlrev_b32 v88, 16, v88
  s_waitcnt vmcnt(6)
  v_lshlrev_b32 v89, 16, v89
  s_waitcnt vmcnt(5)
  v_lshlrev_b32 v90, 16, v90
  s_waitcnt vmcnt(4)
  v_lshlrev_b32 v91, 16, v91
  s_waitcnt vmcnt(3)
  v_lshlrev_b32 v92, 16, v92
  s_waitcnt vmcnt(2)
  v_lshlrev_b32 v93, 16, v93
  s_waitcnt vmcnt(1)
  v_lshlrev_b32 v94, 16, v94
  s_waitcnt vmcnt(0)
  v_lshlrev_b32 v95, 16, v95
  v_pk_fma_f32 v[104:105], v[120:121], v[88:89], v[104:105]
  v_pk_fma_f32 v[106:107], v[122:123], v[90:91], v[106:107]
  v_pk_fma_f32 v[108:109], v[124:125], v[92:93], v[108:109]
  v_pk_fma_f32 v[110:111], v[126:127], v[94:95], v[110:111]
  v_pk_fma_f32 v[112:113], v[128:129], v[88:89], v[112:113]
  v_pk_fma_f32 v[114:115], v[130:131], v[90:91], v[114:115]
  v_pk_fma_f32 v[116:117], v[132:133], v[92:93], v[116:117]
  v_pk_fma_f32 v[118:119], v[134:135], v[94:95], v[118:119]
  s_waitcnt vmcnt(0)
  buffer_load_dwordx4 v[244:247], v1, s[8:11], s28 offen sc1
  buffer_load_dwordx4 v[248:251], v1, s[8:11], s29 offen sc1
  s_waitcnt vmcnt(0)
  v_or3_b32 v252, v244, v246, v248
  v_or_b32 v252, v252, v250
  v_and_b32 v252, 1, v252
  v_cmp_ne_u32 vcc, 0, v252
  s_nop 0
  s_cbranch_vccz polldone_26
poll_25:
  s_cmp_eq_u32 s26, 0
  s_cbranch_scc1 polldone_26
  s_sub_u32 s26, s26, 1
  s_mov_b64 exec, vcc
  buffer_load_dwordx4 v[244:247], v1, s[8:11], s28 offen sc1
  buffer_load_dwordx4 v[248:251], v1, s[8:11], s29 offen sc1
  s_waitcnt vmcnt(0)
  v_or3_b32 v252, v244, v246, v248
  v_or_b32 v252, v252, v250
  v_and_b32 v252, 1, v252
  v_cmp_ne_u32 vcc, 0, v252
  s_nop 0
  s_cbranch_vccnz poll_25
polldone_26:
  s_mov_b64 exec, -1
  ds_write_b128 v98, v[244:247] offset:0
  ds_write_b128 v98, v[248:251] offset:4096
  s_waitcnt lgkmcnt(0)
  s_barrier
  ds_read_b32 v136, v13 offset:0
  ds_read_b32 v137, v13 offset:256
  ds_read_b32 v142, v13 offset:4608
  ds_read_b32 v141, v13 offset:4352
  ds_read_b32 v139, v13 offset:768
  ds_read_b32 v140, v13 offset:4096
  ds_read_b32 v143, v13 offset:4864
  ds_read_b32 v138, v13 offset:512
  s_waitcnt lgkmcnt(7)
  v_fma_mix_f32 v112, v136, 1.0, v112 op_sel:[1,0,0] op_sel_hi:[1,0,0]
  v_fma_mix_f32 v104, v136, 1.0, v104 op_sel:[0,0,0] op_sel_hi:[1,0,0]
  s_waitcnt lgkmcnt(6)
  v_fma_mix_f32 v113, v137, 1.0, v113 op_sel:[1,0,0] op_sel_hi:[1,0,0]
  v_pk_mul_f32 v[238:239], v[112:113], v[112:113]
  v_fma_mix_f32 v105, v137, 1.0, v105 op_sel:[0,0,0] op_sel_hi:[1,0,0]
  v_pk_mul_f32 v[234:235], v[104:105], v[104:105]
  s_waitcnt lgkmcnt(5)
  v_fma_mix_f32 v118, v142, 1.0, v118 op_sel:[1,0,0] op_sel_hi:[1,0,0]
  s_waitcnt lgkmcnt(4)
  v_fma_mix_f32 v109, v141, 1.0, v109 op_sel:[0,0,0] op_sel_hi:[1,0,0]
  v_fma_mix_f32 v117, v141, 1.0, v117 op_sel:[1,0,0] op_sel_hi:[1,0,0]
  s_waitcnt lgkmcnt(3)
  v_fma_mix_f32 v107, v139, 1.0, v107 op_sel:[0,0,0] op_sel_hi:[1,0,0]
  v_fma_mix_f32 v115, v139, 1.0, v115 op_sel:[1,0,0] op_sel_hi:[1,0,0]
  s_waitcnt lgkmcnt(2)
  v_fma_mix_f32 v108, v140, 1.0, v108 op_sel:[0,0,0] op_sel_hi:[1,0,0]
  v_fma_mix_f32 v116, v140, 1.0, v116 op_sel:[1,0,0] op_sel_hi:[1,0,0]
  s_waitcnt lgkmcnt(1)
  v_fma_mix_f32 v119, v143, 1.0, v119 op_sel:[1,0,0] op_sel_hi:[1,0,0]
  v_fma_mix_f32 v110, v142, 1.0, v110 op_sel:[0,0,0] op_sel_hi:[1,0,0]
  s_waitcnt lgkmcnt(0)
  v_fma_mix_f32 v114, v138, 1.0, v114 op_sel:[1,0,0] op_sel_hi:[1,0,0]
  v_fma_mix_f32 v106, v138, 1.0, v106 op_sel:[0,0,0] op_sel_hi:[1,0,0]
  v_pk_add_f32 v[232:233], v[104:105], v[106:107]
  v_pk_add_f32 v[236:237], v[112:113], v[114:115]
  v_pk_add_f32 v[232:233], v[232:233], v[108:109]
  v_pk_fma_f32 v[238:239], v[114:115], v[114:115], v[238:239]
  v_pk_fma_f32 v[238:239], v[116:117], v[116:117], v[238:239]
  v_fma_mix_f32 v111, v143, 1.0, v111 op_sel:[0,0,0] op_sel_hi:[1,0,0]
  v_pk_fma_f32 v[234:235], v[106:107], v[106:107], v[234:235]
  v_pk_fma_f32 v[234:235], v[108:109], v[108:109], v[234:235]
  v_pk_fma_f32 v[234:235], v[110:111], v[110:111], v[234:235]
  v_add_f32 v234, v234, v235
  v_pk_add_f32 v[236:237], v[236:237], v[116:117]
  v_pk_add_f32 v[236:237], v[236:237], v[118:119]
  v_add_f32 v236, v236, v237
  v_pk_add_f32 v[232:233], v[232:233], v[110:111]
  v_pk_fma_f32 v[238:239], v[118:119], v[118:119], v[238:239]
  v_add_f32 v238, v238, v239
  v_add_f32 v232, v232, v233
  s_nop 0
  v_permlane32_swap_b32 v234, v238
  v_permlane32_swap_b32 v232, v236
  v_add_f32 v240, v232, v236
  v_add_f32 v242, v234, v238
  s_nop 1
  v_permlane16_swap_b32 v240, v242
  v_add_f32 v240, v240, v242
  s_nop 1
  v_add_f32 v240, v240, v240 row_ror:8
  s_nop 1
  v_add_f32 v240, v240, v240 row_ror:4
  s_nop 1
  v_add_f32 v240, v240, v240 row_ror:2
  s_nop 1
  v_add_f32 v240, v240, v240 row_ror:1
  v_mov_b32 v242, v240
  s_nop 1
  v_permlane16_swap_b32 v240, v242
  v_mul_f32 v240, s36, v240
  v_mul_f32 v242, s36, v242
  v_fma_f32 v242, -v240, v240, v242
  v_max_f32 v242, 0, v242
  v_add_f32 v242, s37, v242
  v_rsq_f32 v242, v242
  s_nop 0
  v_mov_b32 v232, v242
  v_mul_f32 v240, v240, v242
  v_mov_b32 v234, v240
  v_permlane32_swap_b32 v242, v232
  s_nop 0
  v_permlane32_swap_b32 v240, v234
  v_pk_fma_f32 v[148:149], v[108:109], v[242:243], v[240:241] op_sel_hi:[1,0,0] neg_lo:[0,0,1] neg_hi:[0,0,1]
  v_pk_fma_f32 v[154:155], v[114:115], v[232:233], v[234:235] op_sel_hi:[1,0,0] neg_lo:[0,0,1] neg_hi:[0,0,1]
  v_pk_fma_f32 v[158:159], v[118:119], v[232:233], v[234:235] op_sel_hi:[1,0,0] neg_lo:[0,0,1] neg_hi:[0,0,1]
  v_pk_fma_f32 v[144:145], v[104:105], v[242:243], v[240:241] op_sel_hi:[1,0,0] neg_lo:[0,0,1] neg_hi:[0,0,1]
  v_pk_fma_f32 v[146:147], v[106:107], v[242:243], v[240:241] op_sel_hi:[1,0,0] neg_lo:[0,0,1] neg_hi:[0,0,1]
  v_cvt_pk_f16_f32 v201, v146, v147
  v_cvt_pk_f16_f32 v205, v154, v155
  v_cvt_pk_f16_f32 v200, v144, v145
  v_cvt_pk_f16_f32 v202, v148, v149
  v_pk_fma_f32 v[152:153], v[112:113], v[232:233], v[234:235] op_sel_hi:[1,0,0] neg_lo:[0,0,1] neg_hi:[0,0,1]
  v_cvt_pk_f16_f32 v204, v152, v153
  v_pk_fma_f32 v[150:151], v[110:111], v[242:243], v[240:241] op_sel_hi:[1,0,0] neg_lo:[0,0,1] neg_hi:[0,0,1]
  v_cvt_pk_f16_f32 v203, v150, v151
  v_cvt_pk_f16_f32 v207, v158, v159
  s_nop 0
  v_mfma_f32_16x16x32_f16 v[168:171], v[200:203], a[96:99], 0
  v_pk_fma_f32 v[156:157], v[116:117], v[232:233], v[234:235] op_sel_hi:[1,0,0] neg_lo:[0,0,1] neg_hi:[0,0,1]
  v_cvt_pk_f16_f32 v206, v156, v157
  v_mfma_f32_16x16x32_f16 v[172:175], v[200:203], a[100:103], 0
  s_nop 0
  v_mfma_f32_16x16x32_f16 v[188:191], v[204:207], a[100:103], 0
  v_mfma_f32_16x16x32_f16 v[184:187], v[204:207], a[96:99], 0
  s_nop 4
  v_cvt_pk_f16_f32 v170, v170, v174
  v_pk_mul_f16 v210, v170, v42 op_sel:[0,0] op_sel_hi:[0,1]
  v_mfma_f32_16x16x32_f16 v[180:183], v[200:203], a[108:111], 0
  v_pk_fma_f16 v210, v170, v42, v210 op_sel:[1,1,0] op_sel_hi:[1,0,1] neg_lo:[1,0,0]
  v_cvt_pk_f16_f32 v171, v171, v175
  v_cvt_pk_f16_f32 v184, v184, v188
  v_cvt_pk_f16_f32 v187, v187, v191
  v_mfma_f32_16x16x32_f16 v[192:195], v[204:207], a[104:107], 0
  v_pk_mul_f16 v216, v184, v40 op_sel:[0,0] op_sel_hi:[0,1]
  v_cvt_pk_f16_f32 v185, v185, v189
  v_pk_mul_f16 v217, v185, v41 op_sel:[0,0] op_sel_hi:[0,1]
  v_cvt_pk_f16_f32 v168, v168, v172
  v_pk_mul_f16 v208, v168, v40 op_sel:[0,0] op_sel_hi:[0,1]
  v_pk_fma_f16 v208, v168, v40, v208 op_sel:[1,1,0] op_sel_hi:[1,0,1] neg_lo:[1,0,0]
  v_mfma_f32_16x16x32_f16 v[176:179], v[200:203], a[104:107], 0
  v_pk_mul_f16 v211, v171, v43 op_sel:[0,0] op_sel_hi:[0,1]
  v_pk_mul_f16 v219, v187, v43 op_sel:[0,0] op_sel_hi:[0,1]
  v_pk_fma_f16 v219, v187, v43, v219 op_sel:[1,1,0] op_sel_hi:[1,0,1] neg_lo:[1,0,0]
  v_cvt_pk_f16_f32 v186, v186, v190
  v_pk_mul_f16 v218, v186, v42 op_sel:[0,0] op_sel_hi:[0,1]
  v_pk_fma_f16 v218, v186, v42, v218 op_sel:[1,1,0] op_sel_hi:[1,0,1] neg_lo:[1,0,0]
  v_mfma_f32_16x16x32_f16 v[196:199], v[204:207], a[108:111], 0
  v_pk_fma_f16 v217, v185, v41, v217 op_sel:[1,1,0] op_sel_hi:[1,0,1] neg_lo:[1,0,0]
  v_pk_fma_f16 v211, v171, v43, v211 op_sel:[1,1,0] op_sel_hi:[1,0,1] neg_lo:[1,0,0]
  v_cvt_pk_f16_f32 v169, v169, v173
  v_pk_mul_f16 v209, v169, v41 op_sel:[0,0] op_sel_hi:[0,1]
  v_pk_fma_f16 v209, v169, v41, v209 op_sel:[1,1,0] op_sel_hi:[1,0,1] neg_lo:[1,0,0]
  v_pk_fma_f16 v216, v184, v40, v216 op_sel:[1,1,0] op_sel_hi:[1,0,1] neg_lo:[1,0,0]
  s_nop 0
  v_mfma_f32_16x16x32_f16 v[136:139], a[112:115], v[208:211], 0
  v_cvt_pk_f16_f32 v193, v193, v197
  v_cvt_pk_f16_f32 v178, v178, v182
  v_mfma_f32_16x16x32_f16 v[156:159], a[116:119], v[216:219], 0
  v_cvt_pk_f16_f32 v176, v176, v180
  v_pk_mul_f16 v214, v178, v46 op_sel:[0,0] op_sel_hi:[0,1]
  v_mfma_f32_16x16x32_f16 v[152:155], a[116:119], v[208:211], 0
  v_cvt_pk_f16_f32 v194, v194, v198
  v_cvt_pk_f16_f32 v179, v179, v183
  v_mfma_f32_16x16x32_f16 v[144:147], a[112:115], v[216:219], 0
  v_pk_mul_f16 v222, v194, v46 op_sel:[0,0] op_sel_hi:[0,1]
  v_pk_fma_f16 v222, v194, v46, v222 op_sel:[1,1,0] op_sel_hi:[1,0,1] neg_lo:[1,0,0]
  v_pk_mul_f16 v221, v193, v45 op_sel:[0,0] op_sel_hi:[0,1]
  v_pk_mul_f16 v215, v179, v47 op_sel:[0,0] op_sel_hi:[0,1]
  v_pk_fma_f16 v214, v178, v46, v214 op_sel:[1,1,0] op_sel_hi:[1,0,1] neg_lo:[1,0,0]
  v_cvt_pk_f16_f32 v192, v192, v196
  s_nop 1
  v_cndmask_b32 v145, v145, v157, s[40:41]
  v_cvt_pk_f16_f32 v225, v144, v145
  v_cvt_pk_f16_f32 v177, v177, v181
  v_pk_mul_f16 v213, v177, v45 op_sel:[0,0] op_sel_hi:[0,1]
  v_pk_fma_f16 v213, v177, v45, v213 op_sel:[1,1,0] op_sel_hi:[1,0,1] neg_lo:[1,0,0]
  v_cvt_pk_f16_f32 v227, v146, v147
  v_cndmask_b32 v137, v137, v153, s[40:41]
  v_cvt_pk_f16_f32 v195, v195, v199
  v_pk_mul_f16 v220, v192, v44 op_sel:[0,0] op_sel_hi:[0,1]
  v_pk_fma_f16 v220, v192, v44, v220 op_sel:[1,1,0] op_sel_hi:[1,0,1] neg_lo:[1,0,0]
  v_cvt_pk_f16_f32 v224, v136, v137
  v_pk_mul_f16 v223, v195, v47 op_sel:[0,0] op_sel_hi:[0,1]
  v_pk_fma_f16 v223, v195, v47, v223 op_sel:[1,1,0] op_sel_hi:[1,0,1] neg_lo:[1,0,0]
  v_pk_mul_f16 v212, v176, v44 op_sel:[0,0] op_sel_hi:[0,1]
  v_pk_fma_f16 v215, v179, v47, v215 op_sel:[1,1,0] op_sel_hi:[1,0,1] neg_lo:[1,0,0]
  v_pk_fma_f16 v221, v193, v45, v221 op_sel:[1,1,0] op_sel_hi:[1,0,1] neg_lo:[1,0,0]
  v_pk_fma_f16 v212, v176, v44, v212 op_sel:[1,1,0] op_sel_hi:[1,0,1] neg_lo:[1,0,0]
  s_nop 0
  v_mfma_f32_16x16x32_f16 v[148:151], a[112:115], v[220:223], 0
  ds_write_b64 v11, v[224:225] offset:29696
  v_mfma_f32_16x16x32_f16 v[140:143], a[112:115], v[212:215], 0
  v_cvt_pk_f16_f32 v226, v138, v139
  ds_write_b64 v11, v[226:227] offset:30720
  s_nop 3
  v_cvt_pk_f16_f32 v229, v148, v149
  s_nop 0
  v_cvt_pk_f16_f32 v228, v140, v141
  ds_write_b64 v11, v[228:229] offset:30208
  v_cvt_pk_f16_f32 v230, v142, v143
  v_cvt_pk_f16_f32 v231, v150, v151
  ds_write_b64 v11, v[230:231] offset:31232
  s_waitcnt lgkmcnt(0)
  s_barrier
  ds_read_b128 v[244:247], v98 offset:29696
  s_mul_i32 s30, s24, 8320
  s_add_u32 s30, s30, 0x0
  s_add_u32 s31, s30, 0x1000
  ds_read_b128 v[248:251], v98 offset:33792
  s_lshl_b32 s28, s24, 5
  s_add_u32 s28, s28, 0x0
  s_add_u32 s29, s28, 0x41000
  s_waitcnt lgkmcnt(1)
  v_or_b32 v244, 1, v244
  v_or_b32 v246, 1, v246
  buffer_store_dwordx4 v[244:247], v2, s[8:11], s30 offen sc1
  s_waitcnt lgkmcnt(0)
  v_or_b32 v248, 1, v248
  v_or_b32 v250, 1, v250
  buffer_store_dwordx4 v[248:251], v2, s[8:11], s31 offen sc1
  s_waitcnt vmcnt(0)
  buffer_load_dwordx4 v[244:247], v99, s[8:11], s28 offen sc1
  buffer_load_dwordx4 v[248:251], v99, s[8:11], s29 offen sc1
  s_waitcnt vmcnt(1)
  v_and_b32 v252, v244, v246
  s_waitcnt vmcnt(0)
  v_and_b32 v253, v248, v250
  v_and_b32 v252, v252, v253
  v_and_b32 v252, 1, v252
  v_cmp_eq_u32 vcc, 0, v252
  s_nop 0
  s_cbranch_vccz polldone_28
poll_27:
  s_cmp_eq_u32 s26, 0
  s_cbranch_scc1 polldone_28
  s_sub_u32 s26, s26, 1
  s_mov_b64 exec, vcc
  buffer_load_dwordx4 v[244:247], v99, s[8:11], s28 offen sc1
  buffer_load_dwordx4 v[248:251], v99, s[8:11], s29 offen sc1
  s_waitcnt vmcnt(0)
  v_and_b32 v252, v244, v246
  v_and_b32 v253, v248, v250
  v_and_b32 v252, v252, v253
  v_and_b32 v252, 1, v252
  v_cmp_eq_u32 vcc, 0, v252
  s_nop 0
  s_cbranch_vccnz poll_27
polldone_28:
  s_mov_b64 exec, -1
  s_mov_b32 s65, 1
  s_branch layer_loop
lay1_c_24:
  s_lshl_b32 s28, s24, 5
  s_add_u32 s28, s28, 0x2a0000
  s_add_u32 s29, s28, 0x104000
  s_waitcnt vmcnt(0)
  buffer_load_dwordx4 v[244:247], v1, s[8:11], s28 offen sc1
  buffer_load_dwordx4 v[248:251], v1, s[8:11], s29 offen sc1
  s_waitcnt vmcnt(0)
  v_or3_b32 v252, v244, v246, v248
  v_or_b32 v252, v252, v250
  v_and_b32 v252, 1, v252
  v_cmp_ne_u32 vcc, 0, v252
  s_nop 0
  s_cbranch_vccz polldone_30
poll_29:
  s_cmp_eq_u32 s26, 0
  s_cbranch_scc1 polldone_30
  s_sub_u32 s26, s26, 1
  s_mov_b64 exec, vcc
  buffer_load_dwordx4 v[244:247], v1, s[8:11], s28 offen sc1
  buffer_load_dwordx4 v[248:251], v1, s[8:11], s29 offen sc1
  s_waitcnt vmcnt(0)
  v_or3_b32 v252, v244, v246, v248
  v_or_b32 v252, v252, v250
  v_and_b32 v252, 1, v252
  v_cmp_ne_u32 vcc, 0, v252
  s_nop 0
  s_cbranch_vccnz poll_29
polldone_30:
  s_mov_b64 exec, -1
  v_fma_mix_f32 v104, v244, 1.0, v104 op_sel:[0,0,0] op_sel_hi:[1,0,0]
  v_fma_mix_f32 v108, v246, 1.0, v108 op_sel:[0,0,0] op_sel_hi:[1,0,0]
  v_fma_mix_f32 v112, v248, 1.0, v112 op_sel:[0,0,0] op_sel_hi:[1,0,0]
  v_fma_mix_f32 v116, v250, 1.0, v116 op_sel:[0,0,0] op_sel_hi:[1,0,0]
  v_cvt_pk_bf16_f32 v136, v104, v108
  v_fma_mix_f32 v105, v244, 1.0, v105 op_sel:[1,0,0] op_sel_hi:[1,0,0]
  v_fma_mix_f32 v109, v246, 1.0, v109 op_sel:[1,0,0] op_sel_hi:[1,0,0]
  v_cvt_pk_bf16_f32 v140, v112, v116
  buffer_store_dword v136, v124, s[12:15], s44 offen sc1
  v_fma_mix_f32 v113, v248, 1.0, v113 op_sel:[1,0,0] op_sel_hi:[1,0,0]
  v_fma_mix_f32 v117, v250, 1.0, v117 op_sel:[1,0,0] op_sel_hi:[1,0,0]
  v_cvt_pk_bf16_f32 v137, v105, v109
  buffer_store_dword v140, v124, s[12:15], s45 offen sc1
  v_fma_mix_f32 v106, v245, 1.0, v106 op_sel:[0,0,0] op_sel_hi:[1,0,0]
  v_fma_mix_f32 v110, v247, 1.0, v110 op_sel:[0,0,0] op_sel_hi:[1,0,0]
  v_cvt_pk_bf16_f32 v141, v113, v117
  buffer_store_dword v137, v124, s[12:15], s46 offen sc1
  v_fma_mix_f32 v114, v249, 1.0, v114 op_sel:[0,0,0] op_sel_hi:[1,0,0]
  v_fma_mix_f32 v118, v251, 1.0, v118 op_sel:[0,0,0] op_sel_hi:[1,0,0]
  v_cvt_pk_bf16_f32 v138, v106, v110
  buffer_store_dword v141, v124, s[12:15], s47 offen sc1
  v_fma_mix_f32 v107, v245, 1.0, v107 op_sel:[1,0,0] op_sel_hi:[1,0,0]
  v_fma_mix_f32 v111, v247, 1.0, v111 op_sel:[1,0,0] op_sel_hi:[1,0,0]
  v_cvt_pk_bf16_f32 v142, v114, v118
  buffer_store_dword v138, v124, s[12:15], s48 offen sc1
  v_fma_mix_f32 v115, v249, 1.0, v115 op_sel:[1,0,0] op_sel_hi:[1,0,0]
  v_fma_mix_f32 v119, v251, 1.0, v119 op_sel:[1,0,0] op_sel_hi:[1,0,0]
  v_cvt_pk_bf16_f32 v139, v107, v111
  buffer_store_dword v142, v124, s[12:15], s49 offen sc1
  v_cvt_pk_bf16_f32 v143, v115, v119
  buffer_store_dword v139, v124, s[12:15], s50 offen sc1
  buffer_store_dword v143, v124, s[12:15], s51 offen sc1
  s_endpgm
ca_sp_10:
  s_waitcnt vmcnt(0)
  ds_read_b128 v[136:139], v6 offset:0
  s_mov_b32 s34, 0x7e0000
  ds_read_b128 v[152:155], v6 offset:256
  buffer_load_dwordx4 v[64:67], v21, s[8:11], s34 offen sc1
  ds_read_b128 v[140:143], v6 offset:2048
  buffer_load_dwordx4 v[68:71], v21, s[8:11], s34 offen offset:64 sc1
  ds_read_b128 v[144:147], v6 offset:4096
  s_lshl_b32 s34, s25, 4
  ds_read_b128 v[156:159], v6 offset:2304
  ds_read_b128 v[160:163], v6 offset:4352
  ds_read_b128 v[148:151], v6 offset:6144
  s_waitcnt lgkmcnt(6)
  v_mfma_f32_16x16x32_f16 v[168:171], v[136:139], a[0:3], 0
  ds_read_b128 v[164:167], v6 offset:6400
  v_mfma_f32_16x16x32_f16 v[176:179], v[136:139], a[16:19], 0
  v_and_b32 v232, 15, v0
  s_waitcnt lgkmcnt(6)
  v_mfma_f32_16x16x32_f16 v[180:183], v[152:155], a[16:19], 0
  v_bfe_u32 v233, v0, 4, 2
  s_waitcnt lgkmcnt(5)
  v_mfma_f32_16x16x32_f16 v[168:171], v[140:143], a[4:7], v[168:171]
  v_lshl_add_u32 v232, v233, 8, v232
  v_mfma_f32_16x16x32_f16 v[172:175], v[152:155], a[0:3], 0
  v_add_u32 v232, s34, v232
  v_mfma_f32_16x16x32_f16 v[176:179], v[140:143], a[20:23], v[176:179]
  v_lshlrev_b32 v233, 2, v232
  s_waitcnt lgkmcnt(3)
  v_mfma_f32_16x16x32_f16 v[180:183], v[156:159], a[20:23], v[180:183]
  v_cmp_eq_u32 vcc, 0, v232
  v_mfma_f32_16x16x32_f16 v[168:171], v[144:147], a[8:11], v[168:171]
  v_mov_b32 v235, 8192
  v_mfma_f32_16x16x32_f16 v[172:175], v[156:159], a[4:7], v[172:175]
  v_cndmask_b32 v235, v233, v235, vcc
  v_mfma_f32_16x16x32_f16 v[176:179], v[144:147], a[24:27], v[176:179]
  v_sub_u32 v234, 3328, v233
  s_waitcnt lgkmcnt(2)
  v_mfma_f32_16x16x32_f16 v[180:183], v[160:163], a[24:27], v[180:183]
  s_waitcnt lgkmcnt(1)
  v_mfma_f32_16x16x32_f16 v[176:179], v[148:151], a[28:31], v[176:179]
  v_mfma_f32_16x16x32_f16 v[168:171], v[148:151], a[12:15], v[168:171]
  v_mfma_f32_16x16x32_f16 v[172:175], v[160:163], a[8:11], v[172:175]
  s_waitcnt lgkmcnt(0)
  v_mfma_f32_16x16x32_f16 v[172:175], v[164:167], a[12:15], v[172:175]
  s_nop 4
  v_cvt_pk_f16_f32 v169, v169, v177
  v_mfma_f32_16x16x32_f16 v[180:183], v[164:167], a[28:31], v[180:183]
  v_cvt_pk_f16_f32 v168, v168, v176
  v_pk_mul_f16 v201, v169, v25 op_sel:[0,0] op_sel_hi:[0,1]
  v_pk_mul_f16 v200, v168, v24 op_sel:[0,0] op_sel_hi:[0,1]
  v_cvt_pk_f16_f32 v171, v171, v179
  v_cvt_pk_f16_f32 v170, v170, v178
  v_pk_mul_f16 v202, v170, v26 op_sel:[0,0] op_sel_hi:[0,1]
  v_pk_mul_f16 v203, v171, v27 op_sel:[0,0] op_sel_hi:[0,1]
  v_pk_fma_f16 v202, v170, v26, v202 op_sel:[1,1,0] op_sel_hi:[1,0,1] neg_lo:[1,0,0]
  v_cvt_pk_f16_f32 v174, v174, v182
  v_pk_fma_f16 v201, v169, v25, v201 op_sel:[1,1,0] op_sel_hi:[1,0,1] neg_lo:[1,0,0]
  v_pk_fma_f16 v203, v171, v27, v203 op_sel:[1,1,0] op_sel_hi:[1,0,1] neg_lo:[1,0,0]
  v_cvt_pk_f16_f32 v175, v175, v183
  v_pk_fma_f16 v200, v168, v24, v200 op_sel:[1,1,0] op_sel_hi:[1,0,1] neg_lo:[1,0,0]
  v_cvt_pk_f16_f32 v173, v173, v181
  v_pk_mul_f16 v207, v175, v31 op_sel:[0,0] op_sel_hi:[0,1]
  v_cvt_pk_f16_f32 v172, v172, v180
  v_pk_mul_f16 v204, v172, v28 op_sel:[0,0] op_sel_hi:[0,1]
  v_mfma_f32_16x16x32_f16 v[184:187], a[32:35], v[200:203], 0
  v_pk_mul_f16 v206, v174, v30 op_sel:[0,0] op_sel_hi:[0,1]
  v_pk_fma_f16 v206, v174, v30, v206 op_sel:[1,1,0] op_sel_hi:[1,0,1] neg_lo:[1,0,0]
  v_pk_mul_f16 v205, v173, v29 op_sel:[0,0] op_sel_hi:[0,1]
  v_pk_fma_f16 v204, v172, v28, v204 op_sel:[1,1,0] op_sel_hi:[1,0,1] neg_lo:[1,0,0]
  v_pk_fma_f16 v205, v173, v29, v205 op_sel:[1,1,0] op_sel_hi:[1,0,1] neg_lo:[1,0,0]
  v_pk_fma_f16 v207, v175, v31, v207 op_sel:[1,1,0] op_sel_hi:[1,0,1] neg_lo:[1,0,0]
  s_nop 1
  v_mfma_f32_16x16x32_f16 v[184:187], a[36:39], v[204:207], v[184:187]
  v_mfma_f32_16x16x32_f16 v[188:191], a[40:43], v[200:203], 0
  v_mfma_f32_16x16x32_f16 v[188:191], a[44:47], v[204:207], v[188:191]
  s_nop 5
  v_cvt_pk_f16_f32 v216, v184, v185
  ds_write_b32 v233, v216 offset:29696
  v_mfma_f32_16x16x32_f16 v[192:195], a[48:51], v[200:203], 0
  v_cvt_pk_f16_f32 v217, v186, v187
  ds_write_b32 v233, v217 offset:29952
  v_mfma_f32_16x16x32_f16 v[192:195], a[52:55], v[204:207], v[192:195]
  v_cvt_pk_f16_f32 v218, v188, v189
  ds_write_b32 v233, v218 offset:30208
  v_mfma_f32_16x16x32_f16 v[196:199], a[56:59], v[200:203], 0
  v_cvt_pk_f16_f32 v219, v190, v191
  ds_write_b32 v233, v219 offset:30464
  v_mfma_f32_16x16x32_f16 v[196:199], a[60:63], v[204:207], v[196:199]
  s_nop 1
  v_cvt_pk_f16_f32 v220, v192, v193
  ds_write_b32 v233, v220 offset:33792
  v_cvt_pk_f16_f32 v221, v194, v195
  ds_write_b32 v233, v221 offset:34048
  s_nop 1
  v_cvt_pk_f16_f32 v222, v196, v197
  ds_write_b32 v233, v222 offset:34304
  v_cvt_pk_f16_f32 v223, v198, v199
  ds_write_b32 v233, v223 offset:34560
  ds_write_b32 v235, v216 offset:29696
  s_waitcnt lgkmcnt(0)
  s_barrier
  ds_read_b32 v227, v234 offset:33792
  ds_read_b32 v224, v234 offset:34560
  ds_read_b32 v225, v234 offset:34304
  ds_read_b32 v226, v234 offset:34048
  ds_read_b32 v230, v234 offset:29952
  ds_read_b32 v231, v234 offset:29696
  ds_read_b32 v228, v234 offset:30464
  ds_read_b32 v229, v234 offset:30208
  v_pk_mul_f16 v211, v219, v59 op_sel:[0,0] op_sel_hi:[0,1] neg_hi:[0,1]
  v_pk_mul_f16 v209, v217, v57 op_sel:[0,0] op_sel_hi:[0,1] neg_hi:[0,1]
  v_pk_mul_f16 v210, v218, v58 op_sel:[0,0] op_sel_hi:[0,1] neg_hi:[0,1]
  v_pk_fma_f16 v211, v219, v59, v211 op_sel:[1,1,0] op_sel_hi:[1,0,1] neg_lo:[1,0,0] neg_hi:[1,0,0]
  s_waitcnt vmcnt(1) lgkmcnt(7)
  v_pk_fma_f16 v211, v227, v67, v211 op_sel:[0,0,0] op_sel_hi:[0,1,1] neg_hi:[0,1,0]
  v_pk_mul_f16 v208, v216, v56 op_sel:[0,0] op_sel_hi:[0,1] neg_hi:[0,1]
  v_pk_fma_f16 v210, v218, v58, v210 op_sel:[1,1,0] op_sel_hi:[1,0,1] neg_lo:[1,0,0] neg_hi:[1,0,0]
  v_pk_fma_f16 v208, v216, v56, v208 op_sel:[1,1,0] op_sel_hi:[1,0,1] neg_lo:[1,0,0] neg_hi:[1,0,0]
  s_waitcnt lgkmcnt(6)
  v_pk_fma_f16 v208, v224, v64, v208 op_sel:[0,0,0] op_sel_hi:[0,1,1] neg_hi:[0,1,0]
  s_waitcnt lgkmcnt(4)
  v_pk_fma_f16 v210, v226, v66, v210 op_sel:[0,0,0] op_sel_hi:[0,1,1] neg_hi:[0,1,0]
  v_pk_fma_f16 v208, v224, v64, v208 op_sel:[1,1,0] op_sel_hi:[1,0,1]
  v_pk_fma_f16 v209, v217, v57, v209 op_sel:[1,1,0] op_sel_hi:[1,0,1] neg_lo:[1,0,0] neg_hi:[1,0,0]
  v_pk_mul_f16 v215, v223, v63 op_sel:[0,0] op_sel_hi:[0,1] neg_hi:[0,1]
  v_pk_mul_f16 v214, v222, v62 op_sel:[0,0] op_sel_hi:[0,1] neg_hi:[0,1]
  v_pk_fma_f16 v209, v225, v65, v209 op_sel:[0,0,0] op_sel_hi:[0,1,1] neg_hi:[0,1,0]
  v_pk_fma_f16 v209, v225, v65, v209 op_sel:[1,1,0] op_sel_hi:[1,0,1]
  v_pk_fma_f16 v210, v226, v66, v210 op_sel:[1,1,0] op_sel_hi:[1,0,1]
  v_pk_mul_f16 v213, v221, v61 op_sel:[0,0] op_sel_hi:[0,1] neg_hi:[0,1]
  v_pk_fma_f16 v211, v227, v67, v211 op_sel:[1,1,0] op_sel_hi:[1,0,1]
  v_pk_mul_f16 v212, v220, v60 op_sel:[0,0] op_sel_hi:[0,1] neg_hi:[0,1]
  v_pk_fma_f16 v213, v221, v61, v213 op_sel:[1,1,0] op_sel_hi:[1,0,1] neg_lo:[1,0,0] neg_hi:[1,0,0]
  v_pk_fma_f16 v214, v222, v62, v214 op_sel:[1,1,0] op_sel_hi:[1,0,1] neg_lo:[1,0,0] neg_hi:[1,0,0]
  s_waitcnt vmcnt(0) lgkmcnt(0)
  v_pk_fma_f16 v213, v229, v69, v213 op_sel:[0,0,0] op_sel_hi:[0,1,1] neg_hi:[0,1,0]
  v_mfma_f32_16x16x32_f16 v[168:171], a[32:35], v[208:211], 0
  v_pk_fma_f16 v212, v220, v60, v212 op_sel:[1,1,0] op_sel_hi:[1,0,1] neg_lo:[1,0,0] neg_hi:[1,0,0]
  v_pk_fma_f16 v212, v228, v68, v212 op_sel:[0,0,0] op_sel_hi:[0,1,1] neg_hi:[0,1,0]
  v_pk_fma_f16 v214, v230, v70, v214 op_sel:[0,0,0] op_sel_hi:[0,1,1] neg_hi:[0,1,0]
  v_pk_fma_f16 v212, v228, v68, v212 op_sel:[1,1,0] op_sel_hi:[1,0,1]
  v_pk_fma_f16 v215, v223, v63, v215 op_sel:[1,1,0] op_sel_hi:[1,0,1] neg_lo:[1,0,0] neg_hi:[1,0,0]
  v_pk_fma_f16 v215, v231, v71, v215 op_sel:[0,0,0] op_sel_hi:[0,1,1] neg_hi:[0,1,0]
  v_pk_fma_f16 v214, v230, v70, v214 op_sel:[1,1,0] op_sel_hi:[1,0,1]
  v_pk_fma_f16 v215, v231, v71, v215 op_sel:[1,1,0] op_sel_hi:[1,0,1]
  v_pk_fma_f16 v213, v229, v69, v213 op_sel:[1,1,0] op_sel_hi:[1,0,1]
  s_nop 1
  v_mfma_f32_16x16x32_f16 v[168:171], a[36:39], v[212:215], v[168:171]
  v_mfma_f32_16x16x32_f16 v[172:175], a[40:43], v[208:211], 0
  v_mfma_f32_16x16x32_f16 v[172:175], a[44:47], v[212:215], v[172:175]
  s_nop 5
  v_cvt_pk_f16_f32 v168, v168, v169
  v_pk_mul_f16 v200, v168, v24 op_sel:[0,0] op_sel_hi:[0,1]
  v_pk_fma_f16 v200, v168, v24, v200 op_sel:[1,1,0] op_sel_hi:[1,0,1] neg_lo:[1,0,0]
  ds_write_b32 v7, v200 offset:12288
  v_mfma_f32_16x16x32_f16 v[176:179], a[48:51], v[208:211], 0
  v_cvt_pk_f16_f32 v170, v170, v171
  v_pk_mul_f16 v201, v170, v25 op_sel:[0,0] op_sel_hi:[0,1]
  v_pk_fma_f16 v201, v170, v25, v201 op_sel:[1,1,0] op_sel_hi:[1,0,1] neg_lo:[1,0,0]
  v_cvt_pk_f16_f32 v172, v172, v173
  ds_write_b32 v7, v201 offset:12304
  v_mfma_f32_16x16x32_f16 v[176:179], a[52:55], v[212:215], v[176:179]
  v_pk_mul_f16 v202, v172, v26 op_sel:[0,0] op_sel_hi:[0,1]
  v_pk_fma_f16 v202, v172, v26, v202 op_sel:[1,1,0] op_sel_hi:[1,0,1] neg_lo:[1,0,0]
  ds_write_b32 v96, v202 offset:12288
  v_mfma_f32_16x16x32_f16 v[180:183], a[56:59], v[208:211], 0
  v_cvt_pk_f16_f32 v174, v174, v175
  v_pk_mul_f16 v203, v174, v27 op_sel:[0,0] op_sel_hi:[0,1]
  v_pk_fma_f16 v203, v174, v27, v203 op_sel:[1,1,0] op_sel_hi:[1,0,1] neg_lo:[1,0,0]
  ds_write_b32 v96, v203 offset:12304
  v_mfma_f32_16x16x32_f16 v[180:183], a[60:63], v[212:215], v[180:183]
  v_cvt_pk_f16_f32 v176, v176, v177
  v_pk_mul_f16 v204, v176, v28 op_sel:[0,0] op_sel_hi:[0,1]
  v_pk_fma_f16 v204, v176, v28, v204 op_sel:[1,1,0] op_sel_hi:[1,0,1] neg_lo:[1,0,0]
  ds_write_b32 v7, v204 offset:12544
  v_cvt_pk_f16_f32 v178, v178, v179
  v_pk_mul_f16 v205, v178, v29 op_sel:[0,0] op_sel_hi:[0,1]
  v_pk_fma_f16 v205, v178, v29, v205 op_sel:[1,1,0] op_sel_hi:[1,0,1] neg_lo:[1,0,0]
  ds_write_b32 v7, v205 offset:12560
  v_cvt_pk_f16_f32 v180, v180, v181
  v_pk_mul_f16 v206, v180, v30 op_sel:[0,0] op_sel_hi:[0,1]
  v_pk_fma_f16 v206, v180, v30, v206 op_sel:[1,1,0] op_sel_hi:[1,0,1] neg_lo:[1,0,0]
  v_cvt_pk_f16_f32 v182, v182, v183
  ds_write_b32 v96, v206 offset:12544
  v_pk_mul_f16 v207, v182, v31 op_sel:[0,0] op_sel_hi:[0,1]
  v_pk_fma_f16 v207, v182, v31, v207 op_sel:[1,1,0] op_sel_hi:[1,0,1] neg_lo:[1,0,0]
  ds_write_b32 v96, v207 offset:12560
  s_waitcnt lgkmcnt(0)
  s_barrier
  ds_read_b128 v[136:139], v6 offset:12288
  s_mul_i32 s30, s24, 8320
  ds_read_b128 v[156:159], v6 offset:14592
  s_add_u32 s30, s30, 0x2a0000
  ds_read_b128 v[152:155], v6 offset:12544
  s_add_u32 s31, s30, 0x1000
  ds_read_b128 v[140:143], v6 offset:14336
  ds_read_b128 v[144:147], v6 offset:16384
  ds_read_b128 v[160:163], v6 offset:16640
  ds_read_b128 v[148:151], v6 offset:18432
  s_waitcnt lgkmcnt(6)
  v_mfma_f32_16x16x32_f16 v[192:195], a[16:19], v[136:139], 0
  ds_read_b128 v[164:167], v6 offset:18688
  v_mfma_f32_16x16x32_f16 v[184:187], a[0:3], v[136:139], 0
  s_waitcnt lgkmcnt(5)
  v_mfma_f32_16x16x32_f16 v[188:191], a[0:3], v[152:155], 0
  v_mfma_f32_16x16x32_f16 v[188:191], a[4:7], v[156:159], v[188:191]
  s_waitcnt lgkmcnt(4)
  v_mfma_f32_16x16x32_f16 v[192:195], a[20:23], v[140:143], v[192:195]
  s_waitcnt lgkmcnt(3)
  v_mfma_f32_16x16x32_f16 v[192:195], a[24:27], v[144:147], v[192:195]
  s_waitcnt lgkmcnt(2)
  v_mfma_f32_16x16x32_f16 v[188:191], a[8:11], v[160:163], v[188:191]
  v_mfma_f32_16x16x32_f16 v[196:199], a[16:19], v[152:155], 0
  v_mfma_f32_16x16x32_f16 v[184:187], a[4:7], v[140:143], v[184:187]
  v_mfma_f32_16x16x32_f16 v[184:187], a[8:11], v[144:147], v[184:187]
  s_waitcnt lgkmcnt(1)
  v_mfma_f32_16x16x32_f16 v[184:187], a[12:15], v[148:151], v[184:187]
  v_mfma_f32_16x16x32_f16 v[192:195], a[28:31], v[148:151], v[192:195]
  v_mfma_f32_16x16x32_f16 v[196:199], a[20:23], v[156:159], v[196:199]
  v_mfma_f32_16x16x32_f16 v[196:199], a[24:27], v[160:163], v[196:199]
  s_nop 5
  v_cvt_pk_f16_f32 v235, v187, -v195
  s_waitcnt lgkmcnt(0)
  v_mfma_f32_16x16x32_f16 v[188:191], a[12:15], v[164:167], v[188:191]
  v_cvt_pk_f16_f32 v234, v186, -v194
  v_mfma_f32_16x16x32_f16 v[196:199], a[28:31], v[164:167], v[196:199]
  v_cvt_pk_f16_f32 v233, v185, -v193
  v_or_b32 v234, 1, v234
  v_cvt_pk_f16_f32 v232, v184, -v192
  v_or_b32 v232, 1, v232
  buffer_store_dwordx4 v[232:235], v3, s[8:11], s30 offen sc1
  s_nop 2
  v_cvt_pk_f16_f32 v237, v189, -v197
  v_cvt_pk_f16_f32 v238, v190, -v198
  v_cvt_pk_f16_f32 v239, v191, -v199
  v_cvt_pk_f16_f32 v236, v188, -v196
  v_or_b32 v236, 1, v236
  v_or_b32 v238, 1, v238
  buffer_store_dwordx4 v[236:239], v3, s[8:11], s30 offen offset:1024 sc1
  s_nop 1
  s_branch ca_join_11
main_exit:
  s_endpgm
.p2align 8
.type dft_tables,@object
dft_tables:
.long 0x3000,0x3000,0x3000,0x3000,0x30008000,0x30008000,0x30008000,0x30008000
.long 0x3000,0x263e2fd9,0x2a1f2f64,0x2c722ea7,0x30008000,0x2fd9a63e,0x2f64aa1f,0x2ea7ac72
.long 0x3000,0x2da82da8,0x30000000,0x2da8ada8,0x30008000,0x2da8ada8,0xb000,0xada8ada8
.long 0x3000,0x2ea72c72,0x2f64aa1f,0x263eafd9,0x30008000,0x2c72aea7,0xaa1faf64,0xafd9a63e
.long 0x3000,0x30000000,0xb000,0xb0008000,0x30008000,0xb000,0xb0008000,0x80003000
.long 0x3000,0x2fd9a63e,0xaa1faf64,0xaea72c72,0x30008000,0xa63eafd9,0xaf642a1f,0x2c722ea7
.long 0x3000,0x2da8ada8,0xb0008000,0x2da82da8,0x30008000,0xada8ada8,0x80003000,0x2da8ada8
.long 0x3000,0x2c72aea7,0xaf642a1f,0x2fd9263e,0x30008000,0xaea7ac72,0x2a1f2f64,0x263eafd9
.long 0x3000,0x3000,0x3000,0x3000,0x30008000,0x30008000,0x30008000,0x30008000
.long 0x2da82da8,0x2ea72c72,0x2f642a1f,0x2fd9263e,0x2da8ada8,0x2c72aea7,0x2a1faf64,0x263eafd9
.long 0xb000,0xada8ada8,0xb0008000,0xada82da8,0xb0008000,0xada82da8,0x80003000,0x2da82da8
.long 0xada8ada8,0xafd9263e,0xaa1f2f64,0x2c722ea7,0xada82da8,0x263e2fd9,0x2f642a1f,0x2ea7ac72
.long 0x3000,0x30000000,0xb000,0xb0008000,0x30008000,0xb000,0xb0008000,0x80003000
.long 0x2da82da8,0x2c72aea7,0xaf64aa1f,0xa63e2fd9,0x2da8ada8,0xaea7ac72,0xaa1f2f64,0x2fd9263e
.long 0xb000,0xada82da8,0x30000000,0xada8ada8,0xb0008000,0x2da82da8,0xb000,0xada82da8
.long 0xada8ada8,0x263e2fd9,0x2a1faf64,0xaea72c72,0xada82da8,0x2fd9a63e,0xaf64aa1f,0x2c722ea7
.long 0x3000,0x3000,0x3000,0x3000,0x30008000,0x30008000,0x30008000,0x30008000
.long 0x30000000,0x2fd9a63e,0x2f64aa1f,0x2ea7ac72,0xb000,0xa63eafd9,0xaa1faf64,0xac72aea7
.long 0x3000,0x2da82da8,0x30000000,0x2da8ada8,0x30008000,0x2da8ada8,0xb000,0xada8ada8
.long 0x30000000,0x2c72aea7,0xaa1faf64,0xafd9a63e,0xb000,0xaea7ac72,0xaf642a1f,0xa63e2fd9
.long 0x3000,0x30000000,0xb000,0xb0008000,0x30008000,0xb000,0xb0008000,0x80003000
.long 0x30000000,0xa63eafd9,0xaf642a1f,0x2c722ea7,0xb000,0xafd9263e,0x2a1f2f64,0x2ea7ac72
.long 0x3000,0x2da8ada8,0xb0008000,0x2da82da8,0x30008000,0xada8ada8,0x80003000,0x2da8ada8
.long 0x30000000,0xaea7ac72,0x2a1f2f64,0x263eafd9,0xb000,0xac722ea7,0x2f64aa1f,0xafd9a63e
.long 0x3000,0x3000,0x3000,0x3000,0x30008000,0x30008000,0x30008000,0x30008000
.long 0x2da8ada8,0x2c72aea7,0x2a1faf64,0x263eafd9,0xada8ada8,0xaea7ac72,0xaf64aa1f,0xafd9a63e
.long 0xb000,0xada8ada8,0xb0008000,0xada82da8,0xb0008000,0xada82da8,0x80003000,0x2da82da8
.long 0xada82da8,0x263e2fd9,0x2f642a1f,0x2ea7ac72,0x2da82da8,0x2fd9a63e,0x2a1faf64,0xac72aea7
.long 0x3000,0x30000000,0xb000,0xb0008000,0x30008000,0xb000,0xb0008000,0x80003000
.long 0x2da8ada8,0xaea7ac72,0xaa1f2f64,0x2fd9263e,0xada8ada8,0xac722ea7,0x2f642a1f,0x263eafd9
.long 0xb000,0xada82da8,0x30000000,0xada8ada8,0xb0008000,0x2da82da8,0xb000,0xada82da8
.long 0xada82da8,0x2fd9a63e,0xaf64aa1f,0x2c722ea7,0x2da82da8,0xa63eafd9,0xaa1f2f64,0x2ea7ac72
.long 0x3000,0x3000,0x3000,0x3000,0x30008000,0x30008000,0x30008000,0x30008000
.long 0xb000,0xa63eafd9,0xaa1faf64,0xac72aea7,0xb0008000,0xafd9263e,0xaf642a1f,0xaea72c72
.long 0x3000,0x2da82da8,0x30000000,0x2da8ada8,0x30008000,0x2da8ada8,0xb000,0xada8ada8
.long 0xb000,0xaea7ac72,0xaf642a1f,0xa63e2fd9,0xb0008000,0xac722ea7,0x2a1f2f64,0x2fd9263e
.long 0x3000,0x30000000,0xb000,0xb0008000,0x30008000,0xb000,0xb0008000,0x80003000
.long 0xb000,0xafd9263e,0x2a1f2f64,0x2ea7ac72,0xb0008000,0x263e2fd9,0x2f64aa1f,0xac72aea7
.long 0x3000,0x2da8ada8,0xb0008000,0x2da82da8,0x30008000,0xada8ada8,0x80003000,0x2da8ada8
.long 0xb000,0xac722ea7,0x2f64aa1f,0xafd9a63e,0xb0008000,0x2ea72c72,0xaa1faf64,0xa63e2fd9
.long 0x3000,0x3000,0x3000,0x3000,0x30008000,0x30008000,0x30008000,0x30008000
.long 0xada8ada8,0xaea7ac72,0xaf64aa1f,0xafd9a63e,0xada82da8,0xac722ea7,0xaa1f2f64,0xa63e2fd9
.long 0xb000,0xada8ada8,0xb0008000,0xada82da8,0xb0008000,0xada82da8,0x80003000,0x2da82da8
.long 0x2da82da8,0x2fd9a63e,0x2a1faf64,0xac72aea7,0x2da8ada8,0xa63eafd9,0xaf64aa1f,0xaea72c72
.long 0x3000,0x30000000,0xb000,0xb0008000,0x30008000,0xb000,0xb0008000,0x80003000
.long 0xada8ada8,0xac722ea7,0x2f642a1f,0x263eafd9,0xada82da8,0x2ea72c72,0x2a1faf64,0xafd9a63e
.long 0xb000,0xada82da8,0x30000000,0xada8ada8,0xb0008000,0x2da82da8,0xb000,0xada82da8
.long 0x2da82da8,0xa63eafd9,0xaa1f2f64,0x2ea7ac72,0x2da8ada8,0xafd9263e,0x2f642a1f,0xac72aea7
.long 0x3000,0x3000,0x3000,0x3000,0x30008000,0x30008000,0x30008000,0x30008000
.long 0xb0008000,0xafd9263e,0xaf642a1f,0xaea72c72,0x80003000,0x263e2fd9,0x2a1f2f64,0x2c722ea7
.long 0x3000,0x2da82da8,0x30000000,0x2da8ada8,0x30008000,0x2da8ada8,0xb000,0xada8ada8
.long 0xb0008000,0xac722ea7,0x2a1f2f64,0x2fd9263e,0x80003000,0x2ea72c72,0x2f64aa1f,0x263eafd9
.long 0x3000,0x30000000,0xb000,0xb0008000,0x30008000,0xb000,0xb0008000,0x80003000
.long 0xb0008000,0x263e2fd9,0x2f64aa1f,0xac72aea7,0x80003000,0x2fd9a63e,0xaa1faf64,0xaea72c72
.long 0x3000,0x2da8ada8,0xb0008000,0x2da82da8,0x30008000,0xada8ada8,0x80003000,0x2da8ada8
.long 0xb0008000,0x2ea72c72,0xaa1faf64,0xa63e2fd9,0x80003000,0x2c72aea7,0xaf642a1f,0x2fd9263e
.long 0x3000,0x3000,0x3000,0x3000,0x30008000,0x30008000,0x30008000,0x30008000
.long 0xada82da8,0xac722ea7,0xaa1f2f64,0xa63e2fd9,0x2da82da8,0x2ea72c72,0x2f642a1f,0x2fd9263e
.long 0xb000,0xada8ada8,0xb0008000,0xada82da8,0xb0008000,0xada82da8,0x80003000,0x2da82da8
.long 0x2da8ada8,0xa63eafd9,0xaf64aa1f,0xaea72c72,0xada8ada8,0xafd9263e,0xaa1f2f64,0x2c722ea7
.long 0x3000,0x30000000,0xb000,0xb0008000,0x30008000,0xb000,0xb0008000,0x80003000
.long 0xada82da8,0x2ea72c72,0x2a1faf64,0xafd9a63e,0x2da82da8,0x2c72aea7,0xaf64aa1f,0xa63e2fd9
.long 0xb000,0xada82da8,0x30000000,0xada8ada8,0xb0008000,0x2da82da8,0xb000,0xada82da8
.long 0x2da8ada8,0xafd9263e,0x2f642a1f,0xac72aea7,0xada8ada8,0x263e2fd9,0x2a1faf64,0xaea72c72
.long 0x3000,0x2a1f2f64,0x2da82da8,0x2f642a1f,0x30008000,0x2f64aa1f,0x2da8ada8,0x2a1faf64
.long 0x3000,0x2c722ea7,0x2f642a1f,0x2fd9a63e,0x30008000,0x2ea7ac72,0x2a1faf64,0xa63eafd9
.long 0x3000,0x2f642a1f,0x2da8ada8,0xaa1faf64,0x30008000,0x2a1faf64,0xada8ada8,0xaf642a1f
.long 0x3000,0x2fd9263e,0x2a1faf64,0xaea7ac72,0x30008000,0x263eafd9,0xaf64aa1f,0xac722ea7
.long 0x3000,0x2f64aa1f,0xada8ada8,0xaa1f2f64,0x30008000,0xaa1faf64,0xada82da8,0x2f642a1f
.long 0x3000,0x2ea7ac72,0xaf64aa1f,0x263e2fd9,0x30008000,0xac72aea7,0xaa1f2f64,0x2fd9a63e
.long 0x3000,0x2a1faf64,0xada82da8,0x2f64aa1f,0x30008000,0xaf64aa1f,0x2da82da8,0xaa1faf64
.long 0x3000,0x263eafd9,0xaa1f2f64,0x2c72aea7,0x30008000,0xafd9a63e,0x2f642a1f,0xaea7ac72
.long 0x30000000,0x2f64aa1f,0x2da8ada8,0x2a1faf64,0xb000,0xaa1faf64,0xada8ada8,0xaf64aa1f
.long 0x2da8ada8,0x263eafd9,0xaa1faf64,0xaea7ac72,0xada8ada8,0xafd9a63e,0xaf642a1f,0xac722ea7
.long 0xb0008000,0xaa1f2f64,0x2da82da8,0x2f64aa1f,0x80003000,0x2f642a1f,0x2da8ada8,0xaa1faf64
.long 0xada82da8,0x2c722ea7,0x2f64aa1f,0xa63eafd9,0x2da82da8,0x2ea7ac72,0xaa1faf64,0xafd9263e
.long 0x30000000,0xaa1faf64,0xada82da8,0x2f642a1f,0xb000,0xaf642a1f,0x2da82da8,0x2a1faf64
.long 0x2da8ada8,0xafd9a63e,0x2a1f2f64,0x2c72aea7,0xada8ada8,0xa63e2fd9,0x2f64aa1f,0xaea7ac72
.long 0xb0008000,0x2f642a1f,0xada8ada8,0x2a1f2f64,0x80003000,0x2a1faf64,0xada82da8,0x2f64aa1f
.long 0xada82da8,0x2ea7ac72,0xaf642a1f,0x2fd9a63e,0x2da82da8,0xac72aea7,0x2a1f2f64,0xa63eafd9
.long 0xb000,0xaa1faf64,0xada8ada8,0xaf64aa1f,0xb0008000,0xaf642a1f,0xada82da8,0xaa1f2f64
.long 0xb0008000,0xaea72c72,0xaa1f2f64,0x263e2fd9,0x80003000,0x2c722ea7,0x2f642a1f,0x2fd9a63e
.long 0xb000,0xaf64aa1f,0xada82da8,0x2a1f2f64,0xb0008000,0xaa1f2f64,0x2da82da8,0x2f64aa1f
.long 0xb0008000,0xa63e2fd9,0x2f642a1f,0x2c72aea7,0x80003000,0x2fd9263e,0x2a1faf64,0xaea7ac72
.long 0xb000,0xaf642a1f,0x2da82da8,0x2a1faf64,0xb0008000,0x2a1f2f64,0x2da8ada8,0xaf64aa1f
.long 0xb0008000,0x2c722ea7,0x2a1faf64,0xafd9263e,0x80003000,0x2ea7ac72,0xaf64aa1f,0x263e2fd9
.long 0xb000,0xaa1f2f64,0x2da8ada8,0xaf642a1f,0xb0008000,0x2f642a1f,0xada8ada8,0x2a1f2f64
.long 0xb0008000,0x2fd9263e,0xaf64aa1f,0x2ea72c72,0x80003000,0x263eafd9,0xaa1f2f64,0x2c72aea7
.long 0xb0008000,0xaf642a1f,0xada82da8,0xaa1f2f64,0x80003000,0x2a1f2f64,0x2da82da8,0x2f642a1f
.long 0x2da82da8,0x2fd9263e,0x2f64aa1f,0x2c72aea7,0x2da8ada8,0x263eafd9,0xaa1faf64,0xaea7ac72
.long 0x30000000,0x2a1faf64,0xada8ada8,0xaf642a1f,0xb000,0xaf64aa1f,0xada82da8,0x2a1f2f64
.long 0xada8ada8,0xaea72c72,0x2a1f2f64,0x2fd9a63e,0xada82da8,0x2c722ea7,0x2f64aa1f,0xa63eafd9
.long 0xb0008000,0x2a1f2f64,0x2da8ada8,0xaf64aa1f,0x80003000,0x2f64aa1f,0xada8ada8,0xaa1f2f64
.long 0x2da82da8,0x263eafd9,0xaf642a1f,0x2ea72c72,0x2da8ada8,0xafd9a63e,0x2a1f2f64,0x2c72aea7
.long 0x30000000,0xaf64aa1f,0x2da82da8,0xaa1faf64,0xb000,0xaa1f2f64,0x2da8ada8,0xaf642a1f
.long 0xada8ada8,0x2c722ea7,0xaa1faf64,0x263e2fd9,0xada82da8,0x2ea7ac72,0xaf642a1f,0x2fd9a63e
.long 0x3000,0x2a1f2f64,0x2da82da8,0x2f642a1f,0x30008000,0x2f64aa1f,0x2da8ada8,0x2a1faf64
.long 0xb000,0xac72aea7,0xaf64aa1f,0xafd9263e,0xb0008000,0xaea72c72,0xaa1f2f64,0x263e2fd9
.long 0x3000,0x2f642a1f,0x2da8ada8,0xaa1faf64,0x30008000,0x2a1faf64,0xada8ada8,0xaf642a1f
.long 0xb000,0xafd9a63e,0xaa1f2f64,0x2ea72c72,0xb0008000,0xa63e2fd9,0x2f642a1f,0x2c72aea7
.long 0x3000,0x2f64aa1f,0xada8ada8,0xaa1f2f64,0x30008000,0xaa1faf64,0xada82da8,0x2f642a1f
.long 0xb000,0xaea72c72,0x2f642a1f,0xa63eafd9,0xb0008000,0x2c722ea7,0x2a1faf64,0xafd9263e
.long 0x3000,0x2a1faf64,0xada82da8,0x2f64aa1f,0x30008000,0xaf64aa1f,0x2da82da8,0xaa1faf64
.long 0xb000,0xa63e2fd9,0x2a1faf64,0xac722ea7,0xb0008000,0x2fd9263e,0xaf64aa1f,0x2ea72c72
.long 0x30000000,0x2f64aa1f,0x2da8ada8,0x2a1faf64,0xb000,0xaa1faf64,0xada8ada8,0xaf64aa1f
.long 0xada82da8,0xa63e2fd9,0x2a1f2f64,0x2ea72c72,0x2da82da8,0x2fd9263e,0x2f64aa1f,0x2c72aea7
.long 0xb0008000,0xaa1f2f64,0x2da82da8,0x2f64aa1f,0x80003000,0x2f642a1f,0x2da8ada8,0xaa1faf64
.long 0x2da8ada8,0xac72aea7,0xaf642a1f,0x263e2fd9,0xada8ada8,0xaea72c72,0x2a1f2f64,0x2fd9a63e
.long 0x30000000,0xaa1faf64,0xada82da8,0x2f642a1f,0xb000,0xaf642a1f,0x2da82da8,0x2a1faf64
.long 0xada82da8,0x2fd9263e,0xaa1faf64,0xac722ea7,0x2da82da8,0x263eafd9,0xaf642a1f,0x2ea72c72
.long 0xb0008000,0x2f642a1f,0xada8ada8,0x2a1f2f64,0x80003000,0x2a1faf64,0xada82da8,0x2f64aa1f
.long 0x2da8ada8,0xaea72c72,0x2f64aa1f,0xafd9263e,0xada8ada8,0x2c722ea7,0xaa1faf64,0x263e2fd9
.long 0xb000,0xaa1faf64,0xada8ada8,0xaf64aa1f,0xb0008000,0xaf642a1f,0xada82da8,0xaa1f2f64
.long 0x30000000,0x2ea7ac72,0x2a1faf64,0xa63eafd9,0xb000,0xac72aea7,0xaf64aa1f,0xafd9263e
.long 0xb000,0xaf64aa1f,0xada82da8,0x2a1f2f64,0xb0008000,0xaa1f2f64,0x2da82da8,0x2f64aa1f
.long 0x30000000,0x263eafd9,0xaf64aa1f,0xac722ea7,0xb000,0xafd9a63e,0xaa1f2f64,0x2ea72c72
.long 0xb000,0xaf642a1f,0x2da82da8,0x2a1faf64,0xb0008000,0x2a1f2f64,0x2da8ada8,0xaf64aa1f
.long 0x30000000,0xac72aea7,0xaa1f2f64,0x2fd9a63e,0xb000,0xaea72c72,0x2f642a1f,0xa63eafd9
.long 0xb000,0xaa1f2f64,0x2da8ada8,0xaf642a1f,0xb0008000,0x2f642a1f,0xada8ada8,0x2a1f2f64
.long 0x30000000,0xafd9a63e,0x2f642a1f,0xaea7ac72,0xb000,0xa63e2fd9,0x2a1faf64,0xac722ea7
.long 0xb0008000,0xaf642a1f,0xada82da8,0xaa1f2f64,0x80003000,0x2a1f2f64,0x2da82da8,0x2f642a1f
.long 0xada8ada8,0xafd9a63e,0xaf642a1f,0xac722ea7,0xada82da8,0xa63e2fd9,0x2a1f2f64,0x2ea72c72
.long 0x30000000,0x2a1faf64,0xada8ada8,0xaf642a1f,0xb000,0xaf64aa1f,0xada82da8,0x2a1f2f64
.long 0x2da82da8,0x2ea7ac72,0xaa1faf64,0xafd9263e,0x2da8ada8,0xac72aea7,0xaf642a1f,0x263e2fd9
.long 0xb0008000,0x2a1f2f64,0x2da8ada8,0xaf64aa1f,0x80003000,0x2f64aa1f,0xada8ada8,0xaa1f2f64
.long 0xada8ada8,0xa63e2fd9,0x2f64aa1f,0xaea7ac72,0xada82da8,0x2fd9263e,0xaa1faf64,0xac722ea7
.long 0x30000000,0xaf64aa1f,0x2da82da8,0xaa1faf64,0xb000,0xaa1f2f64,0x2da8ada8,0xaf642a1f
.long 0x2da82da8,0xac72aea7,0x2a1f2f64,0xa63eafd9,0x2da8ada8,0xaea72c72,0x2f64aa1f,0xafd9263e
.long 0x3000,0xb000,0x3000,0xb000,0x30008000,0xb0008000,0x30008000,0xb0008000
.long 0x3000,0xa63eafd9,0x2a1f2f64,0xac72aea7,0x30008000,0xafd9263e,0x2f64aa1f,0xaea72c72
.long 0x3000,0xada8ada8,0x30000000,0xada82da8,0x30008000,0xada82da8,0xb000,0x2da82da8
.long 0x3000,0xaea7ac72,0x2f64aa1f,0xa63e2fd9,0x30008000,0xac722ea7,0xaa1faf64,0x2fd9263e
.long 0x3000,0xb0008000,0xb000,0x30000000,0x30008000,0x80003000,0xb0008000,0xb000
.long 0x3000,0xafd9263e,0xaa1faf64,0x2ea7ac72,0x30008000,0x263e2fd9,0xaf642a1f,0xac72aea7
.long 0x3000,0xada82da8,0xb0008000,0xada8ada8,0x30008000,0x2da82da8,0x80003000,0xada82da8
.long 0x3000,0xac722ea7,0xaf642a1f,0xafd9a63e,0x30008000,0x2ea72c72,0x2a1f2f64,0xa63e2fd9
.long 0x3000,0xb000,0x3000,0xb000,0x30008000,0xb0008000,0x30008000,0xb0008000
.long 0x2da82da8,0xaea7ac72,0x2f642a1f,0xafd9a63e,0x2da8ada8,0xac722ea7,0x2a1faf64,0xa63e2fd9
.long 0xb000,0x2da82da8,0xb0008000,0x2da8ada8,0xb0008000,0x2da8ada8,0x80003000,0xada8ada8
.long 0xada8ada8,0x2fd9a63e,0xaa1f2f64,0xac72aea7,0xada82da8,0xa63eafd9,0x2f642a1f,0xaea72c72
.long 0x3000,0xb0008000,0xb000,0x30000000,0x30008000,0x80003000,0xb0008000,0xb000
.long 0x2da82da8,0xac722ea7,0xaf64aa1f,0x263eafd9,0x2da8ada8,0x2ea72c72,0xaa1f2f64,0xafd9a63e
.long 0xb000,0x2da8ada8,0x30000000,0x2da82da8,0xb0008000,0xada8ada8,0xb000,0x2da8ada8
.long 0xada8ada8,0xa63eafd9,0x2a1faf64,0x2ea7ac72,0xada82da8,0xafd9263e,0xaf64aa1f,0xac72aea7
.long 0x3000,0xb000,0x3000,0xb000,0x30008000,0xb0008000,0x30008000,0xb0008000
.long 0x30000000,0xafd9263e,0x2f64aa1f,0xaea72c72,0xb000,0x263e2fd9,0xaa1faf64,0x2c722ea7
.long 0x3000,0xada8ada8,0x30000000,0xada82da8,0x30008000,0xada82da8,0xb000,0x2da82da8
.long 0x30000000,0xac722ea7,0xaa1faf64,0x2fd9263e,0xb000,0x2ea72c72,0xaf642a1f,0x263eafd9
.long 0x3000,0xb0008000,0xb000,0x30000000,0x30008000,0x80003000,0xb0008000,0xb000
.long 0x30000000,0x263e2fd9,0xaf642a1f,0xac72aea7,0xb000,0x2fd9a63e,0x2a1f2f64,0xaea72c72
.long 0x3000,0xada82da8,0xb0008000,0xada8ada8,0x30008000,0x2da82da8,0x80003000,0xada82da8
.long 0x30000000,0x2ea72c72,0x2a1f2f64,0xa63e2fd9,0xb000,0x2c72aea7,0x2f64aa1f,0x2fd9263e
.long 0x3000,0xb000,0x3000,0xb000,0x30008000,0xb0008000,0x30008000,0xb0008000
.long 0x2da8ada8,0xac722ea7,0x2a1faf64,0xa63e2fd9,0xada8ada8,0x2ea72c72,0xaf64aa1f,0x2fd9263e
.long 0xb000,0x2da82da8,0xb0008000,0x2da8ada8,0xb0008000,0x2da8ada8,0x80003000,0xada8ada8
.long 0xada82da8,0xa63eafd9,0x2f642a1f,0xaea72c72,0x2da82da8,0xafd9263e,0x2a1faf64,0x2c722ea7
.long 0x3000,0xb0008000,0xb000,0x30000000,0x30008000,0x80003000,0xb0008000,0xb000
.long 0x2da8ada8,0x2ea72c72,0xaa1f2f64,0xafd9a63e,0xada8ada8,0x2c72aea7,0x2f642a1f,0xa63e2fd9
.long 0xb000,0x2da8ada8,0x30000000,0x2da82da8,0xb0008000,0xada8ada8,0xb000,0x2da8ada8
.long 0xada82da8,0xafd9263e,0xaf64aa1f,0xac72aea7,0x2da82da8,0x263e2fd9,0xaa1f2f64,0xaea72c72
.long 0x3000,0xb000,0x3000,0xb000,0x30008000,0xb0008000,0x30008000,0xb0008000
.long 0xb000,0x263e2fd9,0xaa1faf64,0x2c722ea7,0xb0008000,0x2fd9a63e,0xaf642a1f,0x2ea7ac72
.long 0x3000,0xada8ada8,0x30000000,0xada82da8,0x30008000,0xada82da8,0xb000,0x2da82da8
.long 0xb000,0x2ea72c72,0xaf642a1f,0x263eafd9,0xb0008000,0x2c72aea7,0x2a1f2f64,0xafd9a63e
.long 0x3000,0xb0008000,0xb000,0x30000000,0x30008000,0x80003000,0xb0008000,0xb000
.long 0xb000,0x2fd9a63e,0x2a1f2f64,0xaea72c72,0xb0008000,0xa63eafd9,0x2f64aa1f,0x2c722ea7
.long 0x3000,0xada82da8,0xb0008000,0xada8ada8,0x30008000,0x2da82da8,0x80003000,0xada82da8
.long 0xb000,0x2c72aea7,0x2f64aa1f,0x2fd9263e,0xb0008000,0xaea7ac72,0xaa1faf64,0x263eafd9
.long 0x3000,0xb000,0x3000,0xb000,0x30008000,0xb0008000,0x30008000,0xb0008000
.long 0xada8ada8,0x2ea72c72,0xaf64aa1f,0x2fd9263e,0xada82da8,0x2c72aea7,0xaa1f2f64,0x263eafd9
.long 0xb000,0x2da82da8,0xb0008000,0x2da8ada8,0xb0008000,0x2da8ada8,0x80003000,0xada8ada8
.long 0x2da82da8,0xafd9263e,0x2a1faf64,0x2c722ea7,0x2da8ada8,0x263e2fd9,0xaf64aa1f,0x2ea7ac72
.long 0x3000,0xb0008000,0xb000,0x30000000,0x30008000,0x80003000,0xb0008000,0xb000
.long 0xada8ada8,0x2c72aea7,0x2f642a1f,0xa63e2fd9,0xada82da8,0xaea7ac72,0x2a1faf64,0x2fd9263e
.long 0xb000,0x2da8ada8,0x30000000,0x2da82da8,0xb0008000,0xada8ada8,0xb000,0x2da8ada8
.long 0x2da82da8,0x263e2fd9,0xaa1f2f64,0xaea72c72,0x2da8ada8,0x2fd9a63e,0x2f642a1f,0x2c722ea7
.long 0x3000,0xb000,0x3000,0xb000,0x30008000,0xb0008000,0x30008000,0xb0008000
.long 0xb0008000,0x2fd9a63e,0xaf642a1f,0x2ea7ac72,0x80003000,0xa63eafd9,0x2a1f2f64,0xac72aea7
.long 0x3000,0xada8ada8,0x30000000,0xada82da8,0x30008000,0xada82da8,0xb000,0x2da82da8
.long 0xb0008000,0x2c72aea7,0x2a1f2f64,0xafd9a63e,0x80003000,0xaea7ac72,0x2f64aa1f,0xa63e2fd9
.long 0x3000,0xb0008000,0xb000,0x30000000,0x30008000,0x80003000,0xb0008000,0xb000
.long 0xb0008000,0xa63eafd9,0x2f64aa1f,0x2c722ea7,0x80003000,0xafd9263e,0xaa1faf64,0x2ea7ac72
.long 0x3000,0xada82da8,0xb0008000,0xada8ada8,0x30008000,0x2da82da8,0x80003000,0xada82da8
.long 0xb0008000,0xaea7ac72,0xaa1faf64,0x263eafd9,0x80003000,0xac722ea7,0xaf642a1f,0xafd9a63e
.long 0x3000,0xb000,0x3000,0xb000,0x30008000,0xb0008000,0x30008000,0xb0008000
.long 0xada82da8,0x2c72aea7,0xaa1f2f64,0x263eafd9,0x2da82da8,0xaea7ac72,0x2f642a1f,0xafd9a63e
.long 0xb000,0x2da82da8,0xb0008000,0x2da8ada8,0xb0008000,0x2da8ada8,0x80003000,0xada8ada8
.long 0x2da8ada8,0x263e2fd9,0xaf64aa1f,0x2ea7ac72,0xada8ada8,0x2fd9a63e,0xaa1f2f64,0xac72aea7
.long 0x3000,0xb0008000,0xb000,0x30000000,0x30008000,0x80003000,0xb0008000,0xb000
.long 0xada82da8,0xaea7ac72,0x2a1faf64,0x2fd9263e,0x2da82da8,0xac722ea7,0xaf64aa1f,0x263eafd9
.long 0xb000,0x2da8ada8,0x30000000,0x2da82da8,0xb0008000,0xada8ada8,0xb000,0x2da8ada8
.long 0x2da8ada8,0x2fd9a63e,0x2f642a1f,0x2c722ea7,0xada8ada8,0xa63eafd9,0x2a1faf64,0x2ea7ac72
.long 0x3000,0xaa1faf64,0x2da82da8,0xaf64aa1f,0x30008000,0xaf642a1f,0x2da8ada8,0xaa1f2f64
.long 0x3000,0xac72aea7,0x2f642a1f,0xafd9263e,0x30008000,0xaea72c72,0x2a1faf64,0x263e2fd9
.long 0x3000,0xaf64aa1f,0x2da8ada8,0x2a1f2f64,0x30008000,0xaa1f2f64,0xada8ada8,0x2f64aa1f
.long 0x3000,0xafd9a63e,0x2a1faf64,0x2ea72c72,0x30008000,0xa63e2fd9,0xaf64aa1f,0x2c72aea7
.long 0x3000,0xaf642a1f,0xada8ada8,0x2a1faf64,0x30008000,0x2a1f2f64,0xada82da8,0xaf64aa1f
.long 0x3000,0xaea72c72,0xaf64aa1f,0xa63eafd9,0x30008000,0x2c722ea7,0xaa1f2f64,0xafd9263e
.long 0x3000,0xaa1f2f64,0xada82da8,0xaf642a1f,0x30008000,0x2f642a1f,0x2da82da8,0x2a1f2f64
.long 0x3000,0xa63e2fd9,0xaa1f2f64,0xac722ea7,0x30008000,0x2fd9263e,0x2f642a1f,0x2ea72c72
.long 0x30000000,0xaf642a1f,0x2da8ada8,0xaa1f2f64,0xb000,0x2a1f2f64,0xada8ada8,0x2f642a1f
.long 0x2da8ada8,0xa63e2fd9,0xaa1faf64,0x2ea72c72,0xada8ada8,0x2fd9263e,0xaf642a1f,0x2c72aea7
.long 0xb0008000,0x2a1faf64,0x2da82da8,0xaf642a1f,0x80003000,0xaf64aa1f,0x2da8ada8,0x2a1f2f64
.long 0xada82da8,0xac72aea7,0x2f64aa1f,0x263e2fd9,0x2da82da8,0xaea72c72,0xaa1faf64,0x2fd9a63e
.long 0x30000000,0x2a1f2f64,0xada82da8,0xaf64aa1f,0xb000,0x2f64aa1f,0x2da82da8,0xaa1f2f64
.long 0x2da8ada8,0x2fd9263e,0x2a1f2f64,0xac722ea7,0xada8ada8,0x263eafd9,0x2f64aa1f,0x2ea72c72
.long 0xb0008000,0xaf64aa1f,0xada8ada8,0xaa1faf64,0x80003000,0xaa1f2f64,0xada82da8,0xaf642a1f
.long 0xada82da8,0xaea72c72,0xaf642a1f,0xafd9263e,0x2da82da8,0x2c722ea7,0x2a1f2f64,0x263e2fd9
.long 0xb000,0x2a1f2f64,0xada8ada8,0x2f642a1f,0xb0008000,0x2f64aa1f,0xada82da8,0x2a1faf64
.long 0xb0008000,0x2ea7ac72,0xaa1f2f64,0xa63eafd9,0x80003000,0xac72aea7,0x2f642a1f,0xafd9263e
.long 0xb000,0x2f642a1f,0xada82da8,0xaa1faf64,0xb0008000,0x2a1faf64,0x2da82da8,0xaf642a1f
.long 0xb0008000,0x263eafd9,0x2f642a1f,0xac722ea7,0x80003000,0xafd9a63e,0x2a1faf64,0x2ea72c72
.long 0xb000,0x2f64aa1f,0x2da82da8,0xaa1f2f64,0xb0008000,0xaa1faf64,0x2da8ada8,0x2f642a1f
.long 0xb0008000,0xac72aea7,0x2a1faf64,0x2fd9a63e,0x80003000,0xaea72c72,0xaf64aa1f,0xa63eafd9
.long 0xb000,0x2a1faf64,0x2da8ada8,0x2f64aa1f,0xb0008000,0xaf64aa1f,0xada8ada8,0xaa1faf64
.long 0xb0008000,0xafd9a63e,0xaf64aa1f,0xaea7ac72,0x80003000,0xa63e2fd9,0xaa1f2f64,0xac722ea7
.long 0xb0008000,0x2f64aa1f,0xada82da8,0x2a1faf64,0x80003000,0xaa1faf64,0x2da82da8,0xaf64aa1f
.long 0x2da82da8,0xafd9a63e,0x2f64aa1f,0xac722ea7,0x2da8ada8,0xa63e2fd9,0xaa1faf64,0x2ea72c72
.long 0x30000000,0xaa1f2f64,0xada8ada8,0x2f64aa1f,0xb000,0x2f642a1f,0xada82da8,0xaa1faf64
.long 0xada8ada8,0x2ea7ac72,0x2a1f2f64,0xafd9263e,0xada82da8,0xac72aea7,0x2f64aa1f,0x263e2fd9
.long 0xb0008000,0xaa1faf64,0x2da8ada8,0x2f642a1f,0x80003000,0xaf642a1f,0xada8ada8,0x2a1faf64
.long 0x2da82da8,0xa63e2fd9,0xaf642a1f,0xaea7ac72,0x2da8ada8,0x2fd9263e,0x2a1f2f64,0xac722ea7
.long 0x30000000,0x2f642a1f,0x2da82da8,0x2a1f2f64,0xb000,0x2a1faf64,0x2da8ada8,0x2f64aa1f
.long 0xada8ada8,0xac72aea7,0xaa1faf64,0xa63eafd9,0xada82da8,0xaea72c72,0xaf642a1f,0xafd9263e
.long 0x3000,0xaa1faf64,0x2da82da8,0xaf64aa1f,0x30008000,0xaf642a1f,0x2da8ada8,0xaa1f2f64
.long 0xb000,0x2c722ea7,0xaf64aa1f,0x2fd9a63e,0xb0008000,0x2ea7ac72,0xaa1f2f64,0xa63eafd9
.long 0x3000,0xaf64aa1f,0x2da8ada8,0x2a1f2f64,0x30008000,0xaa1f2f64,0xada8ada8,0x2f64aa1f
.long 0xb000,0x2fd9263e,0xaa1f2f64,0xaea7ac72,0xb0008000,0x263eafd9,0x2f642a1f,0xac722ea7
.long 0x3000,0xaf642a1f,0xada8ada8,0x2a1faf64,0x30008000,0x2a1f2f64,0xada82da8,0xaf64aa1f
.long 0xb000,0x2ea7ac72,0x2f642a1f,0x263e2fd9,0xb0008000,0xac72aea7,0x2a1faf64,0x2fd9a63e
.long 0x3000,0xaa1f2f64,0xada82da8,0xaf642a1f,0x30008000,0x2f642a1f,0x2da82da8,0x2a1f2f64
.long 0xb000,0x263eafd9,0x2a1faf64,0x2c72aea7,0xb0008000,0xafd9a63e,0xaf64aa1f,0xaea7ac72
.long 0x30000000,0xaf642a1f,0x2da8ada8,0xaa1f2f64,0xb000,0x2a1f2f64,0xada8ada8,0x2f642a1f
.long 0xada82da8,0x263eafd9,0x2a1f2f64,0xaea7ac72,0x2da82da8,0xafd9a63e,0x2f64aa1f,0xac722ea7
.long 0xb0008000,0x2a1faf64,0x2da82da8,0xaf642a1f,0x80003000,0xaf64aa1f,0x2da8ada8,0x2a1f2f64
.long 0x2da8ada8,0x2c722ea7,0xaf642a1f,0xa63eafd9,0xada8ada8,0x2ea7ac72,0x2a1f2f64,0xafd9263e
.long 0x30000000,0x2a1f2f64,0xada82da8,0xaf64aa1f,0xb000,0x2f64aa1f,0x2da82da8,0xaa1f2f64
.long 0xada82da8,0xafd9a63e,0xaa1faf64,0x2c72aea7,0x2da82da8,0xa63e2fd9,0xaf642a1f,0xaea7ac72
.long 0xb0008000,0xaf64aa1f,0xada8ada8,0xaa1faf64,0x80003000,0xaa1f2f64,0xada82da8,0xaf642a1f
.long 0x2da8ada8,0x2ea7ac72,0x2f64aa1f,0x2fd9a63e,0xada8ada8,0xac72aea7,0xaa1faf64,0xa63eafd9
.long 0xb000,0x2a1f2f64,0xada8ada8,0x2f642a1f,0xb0008000,0x2f64aa1f,0xada82da8,0x2a1faf64
.long 0x30000000,0xaea72c72,0x2a1faf64,0x263e2fd9,0xb000,0x2c722ea7,0xaf64aa1f,0x2fd9a63e
.long 0xb000,0x2f642a1f,0xada82da8,0xaa1faf64,0xb0008000,0x2a1faf64,0x2da82da8,0xaf642a1f
.long 0x30000000,0xa63e2fd9,0xaf64aa1f,0x2c72aea7,0xb000,0x2fd9263e,0xaa1f2f64,0xaea7ac72
.long 0xb000,0x2f64aa1f,0x2da82da8,0xaa1f2f64,0xb0008000,0xaa1faf64,0x2da8ada8,0x2f642a1f
.long 0x30000000,0x2c722ea7,0xaa1f2f64,0xafd9263e,0xb000,0x2ea7ac72,0x2f642a1f,0x263e2fd9
.long 0xb000,0x2a1faf64,0x2da8ada8,0x2f64aa1f,0xb0008000,0xaf64aa1f,0xada8ada8,0xaa1faf64
.long 0x30000000,0x2fd9263e,0x2f642a1f,0x2ea72c72,0xb000,0x263eafd9,0x2a1faf64,0x2c72aea7
.long 0xb0008000,0x2f64aa1f,0xada82da8,0x2a1faf64,0x80003000,0xaa1faf64,0x2da82da8,0xaf64aa1f
.long 0xada8ada8,0x2fd9263e,0xaf642a1f,0x2c72aea7,0xada82da8,0x263eafd9,0x2a1f2f64,0xaea7ac72
.long 0x30000000,0xaa1f2f64,0xada8ada8,0x2f64aa1f,0xb000,0x2f642a1f,0xada82da8,0xaa1faf64
.long 0x2da82da8,0xaea72c72,0xaa1faf64,0x2fd9a63e,0x2da8ada8,0x2c722ea7,0xaf642a1f,0xa63eafd9
.long 0xb0008000,0xaa1faf64,0x2da8ada8,0x2f642a1f,0x80003000,0xaf642a1f,0xada8ada8,0x2a1faf64
.long 0xada8ada8,0x263eafd9,0x2f64aa1f,0x2ea72c72,0xada82da8,0xafd9a63e,0xaa1faf64,0x2c72aea7
.long 0x30000000,0x2f642a1f,0x2da82da8,0x2a1f2f64,0xb000,0x2a1faf64,0x2da8ada8,0x2f64aa1f
.long 0x2da82da8,0x2c722ea7,0x2a1f2f64,0x263e2fd9,0x2da8ada8,0x2ea7ac72,0x2f64aa1f,0x2fd9a63e
.long 0x34003400,0x34003400,0x34003400,0x34003400,0x33d93400,0x32a73364,0xb3d9b400,0xb2a7b364
.long 0x33643400,0x2e1f31a8,0x33643400,0x2e1f31a8,0x32a73400,0xaa3e2e1f,0xb2a7b400,0x2a3eae1f
.long 0x31a83400,0xb1a80000,0x31a83400,0xb1a80000,0x30723400,0xb3d9ae1f,0xb072b400,0x33d92e1f
.long 0x2e1f3400,0xb364b1a8,0x2e1f3400,0xb364b1a8,0x2a3e3400,0xb072b364,0xaa3eb400,0x30723364
.long 0x3400,0x8000b400,0x3400,0x8000b400,0xaa3e3400,0x3072b364,0x2a3eb400,0xb0723364
.long 0xae1f3400,0x3364b1a8,0xae1f3400,0x3364b1a8,0xb0723400,0x33d9ae1f,0x3072b400,0xb3d92e1f
.long 0xb1a83400,0x31a88000,0xb1a83400,0x31a88000,0xb2a73400,0x2a3e2e1f,0x32a7b400,0xaa3eae1f
.long 0xb3643400,0xae1f31a8,0xb3643400,0xae1f31a8,0xb3d93400,0xb2a73364,0x33d9b400,0x32a7b364
.long 0x34003400,0x34003400,0x34003400,0x34003400,0x307231a8,0x2a3e2e1f,0xb072b1a8,0xaa3eae1f
.long 0xae1f0000,0xb364b1a8,0xae1f0000,0xb364b1a8,0xb3d9b1a8,0xb072b364,0x33d931a8,0x30723364
.long 0xb1a8b400,0x31a88000,0xb1a8b400,0x31a88000,0x2a3eb1a8,0x32a73364,0xaa3e31a8,0xb2a7b364
.long 0x33648000,0xae1f31a8,0x33648000,0xae1f31a8,0x32a731a8,0xb3d9ae1f,0xb2a7b1a8,0x33d92e1f
.long 0x3400,0x8000b400,0x3400,0x8000b400,0xb2a731a8,0x33d9ae1f,0x32a7b1a8,0xb3d92e1f
.long 0xb3640000,0x2e1f31a8,0xb3640000,0x2e1f31a8,0xaa3eb1a8,0xb2a73364,0x2a3e31a8,0x32a7b364
.long 0x31a8b400,0xb1a80000,0x31a8b400,0xb1a80000,0x33d9b1a8,0x3072b364,0xb3d931a8,0xb0723364
.long 0x2e1f8000,0x3364b1a8,0x2e1f8000,0x3364b1a8,0xb07231a8,0xaa3e2e1f,0x3072b1a8,0x2a3eae1f
.long 0x34003400,0x34003400,0x34003400,0x34003400,0xaa3e0000,0xb072ae1f,0x2a3e8000,0x30722e1f
.long 0xb364b400,0xae1fb1a8,0xb364b400,0xae1fb1a8,0x30728000,0x33d93364,0xb0720000,0xb3d9b364
.long 0x31a83400,0xb1a80000,0x31a83400,0xb1a80000,0xb2a70000,0xaa3eb364,0x32a78000,0x2a3e3364
.long 0xae1fb400,0x336431a8,0xae1fb400,0x336431a8,0x33d98000,0xb2a72e1f,0xb3d90000,0x32a7ae1f
.long 0x3400,0x8000b400,0x3400,0x8000b400,0xb3d90000,0x32a72e1f,0x33d98000,0xb2a7ae1f
.long 0x2e1fb400,0xb36431a8,0x2e1fb400,0xb36431a8,0x32a78000,0x2a3eb364,0xb2a70000,0xaa3e3364
.long 0xb1a83400,0x31a88000,0xb1a83400,0x31a88000,0xb0720000,0xb3d93364,0x30728000,0x33d9b364
.long 0x3364b400,0x2e1fb1a8,0x3364b400,0x2e1fb1a8,0x2a3e8000,0x3072ae1f,0xaa3e0000,0xb0722e1f
.long 0x34003400,0x34003400,0x34003400,0x34003400,0xb2a7b1a8,0xb3d9b364,0x32a731a8,0x33d93364
.long 0x2e1f8000,0x336431a8,0x2e1f8000,0x336431a8,0x2a3e31a8,0xb2a7ae1f,0xaa3eb1a8,0x32a72e1f
.long 0xb1a8b400,0x31a88000,0xb1a8b400,0x31a88000,0x33d931a8,0xb0722e1f,0xb3d9b1a8,0x3072ae1f
.long 0xb3640000,0x2e1fb1a8,0xb3640000,0x2e1fb1a8,0x3072b1a8,0xaa3e3364,0xb07231a8,0x2a3eb364
.long 0x3400,0x8000b400,0x3400,0x8000b400,0xb072b1a8,0x2a3e3364,0x307231a8,0xaa3eb364
.long 0x33648000,0xae1fb1a8,0x33648000,0xae1fb1a8,0xb3d931a8,0x30722e1f,0x33d9b1a8,0xb072ae1f
.long 0x31a8b400,0xb1a80000,0x31a8b400,0xb1a80000,0xaa3e31a8,0x32a7ae1f,0x2a3eb1a8,0xb2a72e1f
.long 0xae1f0000,0xb36431a8,0xae1f0000,0xb36431a8,0x32a7b1a8,0x33d9b364,0xb2a731a8,0xb3d93364
.long 0x80008000,0x80008000,0x80008000,0x80008000,0xaa3e8000,0xb072ae1f,0x2a3e8000,0x30722e1f
.long 0xae1f8000,0xb364b1a8,0xae1f8000,0xb364b1a8,0xb0728000,0xb3d9b364,0x30728000,0x33d93364
.long 0xb1a88000,0xb1a8b400,0xb1a88000,0xb1a8b400,0xb2a78000,0xaa3eb364,0x32a78000,0x2a3e3364
.long 0xb3648000,0x2e1fb1a8,0xb3648000,0x2e1fb1a8,0xb3d98000,0x32a7ae1f,0x33d98000,0xb2a72e1f
.long 0xb4008000,0x34008000,0xb4008000,0x34008000,0xb3d98000,0x32a72e1f,0x33d98000,0xb2a7ae1f
.long 0xb3648000,0x2e1f31a8,0xb3648000,0x2e1f31a8,0xb2a78000,0xaa3e3364,0x32a78000,0x2a3eb364
.long 0xb1a88000,0xb1a83400,0xb1a88000,0xb1a83400,0xb0728000,0xb3d93364,0x30728000,0x33d9b364
.long 0xae1f8000,0xb36431a8,0xae1f8000,0xb36431a8,0xaa3e8000,0xb0722e1f,0x2a3e8000,0x3072ae1f
.long 0x80008000,0x80008000,0x80008000,0x80008000,0xb2a7b1a8,0xb3d9b364,0x32a731a8,0x33d93364
.long 0xb364b400,0xae1fb1a8,0xb364b400,0xae1fb1a8,0xaa3eb1a8,0x32a72e1f,0x2a3e31a8,0xb2a7ae1f
.long 0x31a88000,0x31a83400,0x31a88000,0x31a83400,0x33d931a8,0xb0722e1f,0xb3d9b1a8,0x3072ae1f
.long 0x2e1f3400,0xb364b1a8,0x2e1f3400,0xb364b1a8,0xb07231a8,0x2a3eb364,0x3072b1a8,0xaa3e3364
.long 0xb4008000,0x34008000,0xb4008000,0x34008000,0xb072b1a8,0x2a3e3364,0x307231a8,0xaa3eb364
.long 0x2e1fb400,0xb36431a8,0x2e1fb400,0xb36431a8,0x33d9b1a8,0xb072ae1f,0xb3d931a8,0x30722e1f
.long 0x31a88000,0x31a8b400,0x31a88000,0x31a8b400,0xaa3e31a8,0x32a7ae1f,0x2a3eb1a8,0xb2a72e1f
.long 0xb3643400,0xae1f31a8,0xb3643400,0xae1f31a8,0xb2a731a8,0xb3d93364,0x32a7b1a8,0x33d9b364
.long 0x80008000,0x80008000,0x80008000,0x80008000,0xb3d9b400,0xb2a7b364,0x33d93400,0x32a73364
.long 0x2e1f8000,0x336431a8,0x2e1f8000,0x336431a8,0x32a73400,0xaa3e2e1f,0xb2a7b400,0x2a3eae1f
.long 0xb1a88000,0xb1a8b400,0xb1a88000,0xb1a8b400,0xb072b400,0x33d92e1f,0x30723400,0xb3d9ae1f
.long 0x33648000,0xae1f31a8,0x33648000,0xae1f31a8,0x2a3e3400,0xb072b364,0xaa3eb400,0x30723364
.long 0xb4008000,0x34008000,0xb4008000,0x34008000,0x2a3eb400,0xb0723364,0xaa3e3400,0x3072b364
.long 0x33648000,0xae1fb1a8,0x33648000,0xae1fb1a8,0xb0723400,0x33d9ae1f,0x3072b400,0xb3d92e1f
.long 0xb1a88000,0xb1a83400,0xb1a88000,0xb1a83400,0x32a7b400,0xaa3eae1f,0xb2a73400,0x2a3e2e1f
.long 0x2e1f8000,0x3364b1a8,0x2e1f8000,0x3364b1a8,0xb3d93400,0xb2a73364,0x33d9b400,0x32a7b364
.long 0x80008000,0x80008000,0x80008000,0x80008000,0xb072b1a8,0xaa3eae1f,0x307231a8,0x2a3e2e1f
.long 0x33643400,0x2e1f31a8,0x33643400,0x2e1f31a8,0xb3d9b1a8,0xb072b364,0x33d931a8,0x30723364
.long 0x31a88000,0x31a83400,0x31a88000,0x31a83400,0xaa3e31a8,0xb2a7b364,0x2a3eb1a8,0x32a73364
.long 0xae1fb400,0x336431a8,0xae1fb400,0x336431a8,0x32a731a8,0xb3d9ae1f,0xb2a7b1a8,0x33d92e1f
.long 0xb4008000,0x34008000,0xb4008000,0x34008000,0x32a7b1a8,0xb3d92e1f,0xb2a731a8,0x33d9ae1f
.long 0xae1f3400,0x3364b1a8,0xae1f3400,0x3364b1a8,0xaa3eb1a8,0xb2a73364,0x2a3e31a8,0x32a7b364
.long 0x31a88000,0x31a8b400,0x31a88000,0x31a8b400,0xb3d931a8,0xb0723364,0x33d9b1a8,0x3072b364
.long 0x3364b400,0x2e1fb1a8,0x3364b400,0x2e1fb1a8,0xb07231a8,0xaa3e2e1f,0x3072b1a8,0x2a3eae1f
.long 0xb4003400,0xb4003400,0xb4003400,0xb4003400,0xb3d93400,0xb2a73364,0x33d9b400,0x32a7b364
.long 0xb3643400,0xae1f31a8,0xb3643400,0xae1f31a8,0xb2a73400,0x2a3e2e1f,0x32a7b400,0xaa3eae1f
.long 0xb1a83400,0x31a80000,0xb1a83400,0x31a80000,0xb0723400,0x33d9ae1f,0x3072b400,0xb3d92e1f
.long 0xae1f3400,0x3364b1a8,0xae1f3400,0x3364b1a8,0xaa3e3400,0x3072b364,0x2a3eb400,0xb0723364
.long 0x80003400,0xb400,0x80003400,0xb400,0x2a3e3400,0xb072b364,0xaa3eb400,0x30723364
.long 0x2e1f3400,0xb364b1a8,0x2e1f3400,0xb364b1a8,0x30723400,0xb3d9ae1f,0xb072b400,0x33d92e1f
.long 0x31a83400,0xb1a88000,0x31a83400,0xb1a88000,0x32a73400,0xaa3e2e1f,0xb2a7b400,0x2a3eae1f
.long 0x33643400,0x2e1f31a8,0x33643400,0x2e1f31a8,0x33d93400,0x32a73364,0xb3d9b400,0xb2a7b364
.long 0xb4003400,0xb4003400,0xb4003400,0xb4003400,0xb07231a8,0xaa3e2e1f,0x3072b1a8,0x2a3eae1f
.long 0x2e1f0000,0x3364b1a8,0x2e1f0000,0x3364b1a8,0x33d9b1a8,0x3072b364,0xb3d931a8,0xb0723364
.long 0x31a8b400,0xb1a88000,0x31a8b400,0xb1a88000,0xaa3eb1a8,0xb2a73364,0x2a3e31a8,0x32a7b364
.long 0xb3648000,0x2e1f31a8,0xb3648000,0x2e1f31a8,0xb2a731a8,0x33d9ae1f,0x32a7b1a8,0xb3d92e1f
.long 0x80003400,0xb400,0x80003400,0xb400,0x32a731a8,0xb3d9ae1f,0xb2a7b1a8,0x33d92e1f
.long 0x33640000,0xae1f31a8,0x33640000,0xae1f31a8,0x2a3eb1a8,0x32a73364,0xaa3e31a8,0xb2a7b364
.long 0xb1a8b400,0x31a80000,0xb1a8b400,0x31a80000,0xb3d9b1a8,0xb072b364,0x33d931a8,0x30723364
.long 0xae1f8000,0xb364b1a8,0xae1f8000,0xb364b1a8,0x307231a8,0x2a3e2e1f,0xb072b1a8,0xaa3eae1f
.long 0xb4003400,0xb4003400,0xb4003400,0xb4003400,0x2a3e0000,0x3072ae1f,0xaa3e8000,0xb0722e1f
.long 0x3364b400,0x2e1fb1a8,0x3364b400,0x2e1fb1a8,0xb0728000,0xb3d93364,0x30720000,0x33d9b364
.long 0xb1a83400,0x31a80000,0xb1a83400,0x31a80000,0x32a70000,0x2a3eb364,0xb2a78000,0xaa3e3364
.long 0x2e1fb400,0xb36431a8,0x2e1fb400,0xb36431a8,0xb3d98000,0x32a72e1f,0x33d90000,0xb2a7ae1f
.long 0x80003400,0xb400,0x80003400,0xb400,0x33d90000,0xb2a72e1f,0xb3d98000,0x32a7ae1f
.long 0xae1fb400,0x336431a8,0xae1fb400,0x336431a8,0xb2a78000,0xaa3eb364,0x32a70000,0x2a3e3364
.long 0x31a83400,0xb1a88000,0x31a83400,0xb1a88000,0x30720000,0x33d93364,0xb0728000,0xb3d9b364
.long 0xb364b400,0xae1fb1a8,0xb364b400,0xae1fb1a8,0xaa3e8000,0xb072ae1f,0x2a3e0000,0x30722e1f
.long 0xb4003400,0xb4003400,0xb4003400,0xb4003400,0x32a7b1a8,0x33d9b364,0xb2a731a8,0xb3d93364
.long 0xae1f8000,0xb36431a8,0xae1f8000,0xb36431a8,0xaa3e31a8,0x32a7ae1f,0x2a3eb1a8,0xb2a72e1f
.long 0x31a8b400,0xb1a88000,0x31a8b400,0xb1a88000,0xb3d931a8,0x30722e1f,0x33d9b1a8,0xb072ae1f
.long 0x33640000,0xae1fb1a8,0x33640000,0xae1fb1a8,0xb072b1a8,0x2a3e3364,0x307231a8,0xaa3eb364
.long 0x80003400,0xb400,0x80003400,0xb400,0x3072b1a8,0xaa3e3364,0xb07231a8,0x2a3eb364
.long 0xb3648000,0x2e1fb1a8,0xb3648000,0x2e1fb1a8,0x33d931a8,0xb0722e1f,0xb3d9b1a8,0x3072ae1f
.long 0xb1a8b400,0x31a80000,0xb1a8b400,0x31a80000,0x2a3e31a8,0xb2a7ae1f,0xaa3eb1a8,0x32a72e1f
.long 0x2e1f0000,0x336431a8,0x2e1f0000,0x336431a8,0xb2a7b1a8,0xb3d9b364,0x32a731a8,0x33d93364
.long 0x80008000,0x80008000,0x80008000,0x80008000,0x2a3e8000,0x3072ae1f,0xaa3e8000,0xb0722e1f
.long 0x2e1f8000,0x3364b1a8,0x2e1f8000,0x3364b1a8,0x30728000,0x33d9b364,0xb0728000,0xb3d93364
.long 0x31a88000,0x31a8b400,0x31a88000,0x31a8b400,0x32a78000,0x2a3eb364,0xb2a78000,0xaa3e3364
.long 0x33648000,0xae1fb1a8,0x33648000,0xae1fb1a8,0x33d98000,0xb2a7ae1f,0xb3d98000,0x32a72e1f
.long 0x34008000,0xb4008000,0x34008000,0xb4008000,0x33d98000,0xb2a72e1f,0xb3d98000,0x32a7ae1f
.long 0x33648000,0xae1f31a8,0x33648000,0xae1f31a8,0x32a78000,0x2a3e3364,0xb2a78000,0xaa3eb364
.long 0x31a88000,0x31a83400,0x31a88000,0x31a83400,0x30728000,0x33d93364,0xb0728000,0xb3d9b364
.long 0x2e1f8000,0x336431a8,0x2e1f8000,0x336431a8,0x2a3e8000,0x30722e1f,0xaa3e8000,0xb072ae1f
.long 0x80008000,0x80008000,0x80008000,0x80008000,0x32a7b1a8,0x33d9b364,0xb2a731a8,0xb3d93364
.long 0x3364b400,0x2e1fb1a8,0x3364b400,0x2e1fb1a8,0x2a3eb1a8,0xb2a72e1f,0xaa3e31a8,0x32a7ae1f
.long 0xb1a88000,0xb1a83400,0xb1a88000,0xb1a83400,0xb3d931a8,0x30722e1f,0x33d9b1a8,0xb072ae1f
.long 0xae1f3400,0x3364b1a8,0xae1f3400,0x3364b1a8,0x307231a8,0xaa3eb364,0xb072b1a8,0x2a3e3364
.long 0x34008000,0xb4008000,0x34008000,0xb4008000,0x3072b1a8,0xaa3e3364,0xb07231a8,0x2a3eb364
.long 0xae1fb400,0x336431a8,0xae1fb400,0x336431a8,0xb3d9b1a8,0x3072ae1f,0x33d931a8,0xb0722e1f
.long 0xb1a88000,0xb1a8b400,0xb1a88000,0xb1a8b400,0x2a3e31a8,0xb2a7ae1f,0xaa3eb1a8,0x32a72e1f
.long 0x33643400,0x2e1f31a8,0x33643400,0x2e1f31a8,0x32a731a8,0x33d93364,0xb2a7b1a8,0xb3d9b364
.long 0x80008000,0x80008000,0x80008000,0x80008000,0x33d9b400,0x32a7b364,0xb3d93400,0xb2a73364
.long 0xae1f8000,0xb36431a8,0xae1f8000,0xb36431a8,0xb2a73400,0x2a3e2e1f,0x32a7b400,0xaa3eae1f
.long 0x31a88000,0x31a8b400,0x31a88000,0x31a8b400,0x3072b400,0xb3d92e1f,0xb0723400,0x33d9ae1f
.long 0xb3648000,0x2e1f31a8,0xb3648000,0x2e1f31a8,0xaa3e3400,0x3072b364,0x2a3eb400,0xb0723364
.long 0x34008000,0xb4008000,0x34008000,0xb4008000,0xaa3eb400,0x30723364,0x2a3e3400,0xb072b364
.long 0xb3648000,0x2e1fb1a8,0xb3648000,0x2e1fb1a8,0x30723400,0xb3d9ae1f,0xb072b400,0x33d92e1f
.long 0x31a88000,0x31a83400,0x31a88000,0x31a83400,0xb2a7b400,0x2a3eae1f,0x32a73400,0xaa3e2e1f
.long 0xae1f8000,0xb364b1a8,0xae1f8000,0xb364b1a8,0x33d93400,0x32a73364,0xb3d9b400,0xb2a7b364
.long 0x80008000,0x80008000,0x80008000,0x80008000,0x3072b1a8,0x2a3eae1f,0xb07231a8,0xaa3e2e1f
.long 0xb3643400,0xae1f31a8,0xb3643400,0xae1f31a8,0x33d9b1a8,0x3072b364,0xb3d931a8,0xb0723364
.long 0xb1a88000,0xb1a83400,0xb1a88000,0xb1a83400,0x2a3e31a8,0x32a7b364,0xaa3eb1a8,0xb2a73364
.long 0x2e1fb400,0xb36431a8,0x2e1fb400,0xb36431a8,0xb2a731a8,0x33d9ae1f,0x32a7b1a8,0xb3d92e1f
.long 0x34008000,0xb4008000,0x34008000,0xb4008000,0xb2a7b1a8,0x33d92e1f,0x32a731a8,0xb3d9ae1f
.long 0x2e1f3400,0xb364b1a8,0x2e1f3400,0xb364b1a8,0x2a3eb1a8,0x32a73364,0xaa3e31a8,0xb2a7b364
.long 0xb1a88000,0xb1a8b400,0xb1a88000,0xb1a8b400,0x33d931a8,0x30723364,0xb3d9b1a8,0xb072b364
.long 0xb364b400,0xae1fb1a8,0xb364b400,0xae1fb1a8,0x307231a8,0x2a3e2e1f,0xb072b1a8,0xaa3eae1f
.long 0x3400,0x3400,0x3400,0x3400,0x34008000,0x34008000,0x34008000,0x34008000
.long 0x3400,0x2e1f3364,0x31a831a8,0x33642e1f,0x34008000,0x3364ae1f,0x31a8b1a8,0x2e1fb364
.long 0x3400,0x31a831a8,0x34000000,0x31a8b1a8,0x34008000,0x31a8b1a8,0xb400,0xb1a8b1a8
.long 0x3400,0x33642e1f,0x31a8b1a8,0xae1fb364,0x34008000,0x2e1fb364,0xb1a8b1a8,0xb3642e1f
.long 0x3400,0x34000000,0xb400,0xb4008000,0x34008000,0xb400,0xb4008000,0x80003400
.long 0x3400,0x3364ae1f,0xb1a8b1a8,0xae1f3364,0x34008000,0xae1fb364,0xb1a831a8,0x33642e1f
.long 0x3400,0x31a8b1a8,0xb4008000,0x31a831a8,0x34008000,0xb1a8b1a8,0x80003400,0x31a8b1a8
.long 0x3400,0x2e1fb364,0xb1a831a8,0x3364ae1f,0x34008000,0xb364ae1f,0x31a831a8,0xae1fb364
.long 0x3400,0x3400,0x3400,0x3400,0x34008000,0x34008000,0x34008000,0x34008000
.long 0x34000000,0x3364ae1f,0x31a8b1a8,0x2e1fb364,0xb400,0xae1fb364,0xb1a8b1a8,0xb364ae1f
.long 0xb400,0xb1a8b1a8,0xb4008000,0xb1a831a8,0xb4008000,0xb1a831a8,0x80003400,0x31a831a8
.long 0xb4008000,0xae1f3364,0x31a831a8,0x3364ae1f,0x80003400,0x33642e1f,0x31a8b1a8,0xae1fb364
.long 0x3400,0x34000000,0xb400,0xb4008000,0x34008000,0xb400,0xb4008000,0x80003400
.long 0x34000000,0xae1fb364,0xb1a831a8,0x33642e1f,0xb400,0xb3642e1f,0x31a831a8,0x2e1fb364
.long 0xb400,0xb1a831a8,0x34000000,0xb1a8b1a8,0xb4008000,0x31a831a8,0xb400,0xb1a831a8
.long 0xb4008000,0x33642e1f,0xb1a8b1a8,0x2e1f3364,0x80003400,0x2e1fb364,0xb1a831a8,0x3364ae1f
.long 0x3400,0x3400,0x3400,0x3400,0x34008000,0x34008000,0x34008000,0x34008000
.long 0xb400,0xae1fb364,0xb1a8b1a8,0xb364ae1f,0xb4008000,0xb3642e1f,0xb1a831a8,0xae1f3364
.long 0x3400,0x31a831a8,0x34000000,0x31a8b1a8,0x34008000,0x31a8b1a8,0xb400,0xb1a8b1a8
.long 0xb400,0xb364ae1f,0xb1a831a8,0x2e1f3364,0xb4008000,0xae1f3364,0x31a831a8,0x3364ae1f
.long 0x3400,0x34000000,0xb400,0xb4008000,0x34008000,0xb400,0xb4008000,0x80003400
.long 0xb400,0xb3642e1f,0x31a831a8,0x2e1fb364,0xb4008000,0x2e1f3364,0x31a8b1a8,0xb364ae1f
.long 0x3400,0x31a8b1a8,0xb4008000,0x31a831a8,0x34008000,0xb1a8b1a8,0x80003400,0x31a8b1a8
.long 0xb400,0xae1f3364,0x31a8b1a8,0xb3642e1f,0xb4008000,0x33642e1f,0xb1a8b1a8,0x2e1f3364
.long 0x3400,0x3400,0x3400,0x3400,0x34008000,0x34008000,0x34008000,0x34008000
.long 0xb4008000,0xb3642e1f,0xb1a831a8,0xae1f3364,0x80003400,0x2e1f3364,0x31a831a8,0x33642e1f
.long 0xb400,0xb1a8b1a8,0xb4008000,0xb1a831a8,0xb4008000,0xb1a831a8,0x80003400,0x31a831a8
.long 0x34000000,0x2e1fb364,0xb1a8b1a8,0xb3642e1f,0xb400,0xb364ae1f,0xb1a831a8,0x2e1f3364
.long 0x3400,0x34000000,0xb400,0xb4008000,0x34008000,0xb400,0xb4008000,0x80003400
.long 0xb4008000,0x2e1f3364,0x31a8b1a8,0xb364ae1f,0x80003400,0x3364ae1f,0xb1a8b1a8,0xae1f3364
.long 0xb400,0xb1a831a8,0x34000000,0xb1a8b1a8,0xb4008000,0x31a831a8,0xb400,0xb1a831a8
.long 0x34000000,0xb364ae1f,0x31a831a8,0xae1fb364,0xb400,0xae1f3364,0x31a8b1a8,0xb3642e1f
.long 0x0,0x0,0x0,0x0,0x3400,0x8000b400,0x3400,0x8000b400
.long 0x0,0x0,0x0,0x0,0x0,0x0,0x0,0x0
.long 0x0,0x0,0x0,0x0,0x0,0x0,0x0,0x0
.long 0x0,0x0,0x0,0x0,0x0,0x0,0x0,0x0
.long 0x0,0x0,0x0,0x0,0x0,0x0,0x0,0x0
.long 0x0,0x0,0x0,0x0,0x0,0x0,0x0,0x0
.long 0x0,0x0,0x0,0x0,0x0,0x0,0x0,0x0
.long 0x0,0x0,0x0,0x0,0x0,0x0,0x0,0x0
.long 0x0,0x0,0x0,0x0,0x3400,0x8000b400,0x3400,0x8000b400
.long 0x0,0x0,0x0,0x0,0x0,0x0,0x0,0x0
.long 0x0,0x0,0x0,0x0,0x0,0x0,0x0,0x0
.long 0x0,0x0,0x0,0x0,0x0,0x0,0x0,0x0
.long 0x0,0x0,0x0,0x0,0x0,0x0,0x0,0x0
.long 0x0,0x0,0x0,0x0,0x0,0x0,0x0,0x0
.long 0x0,0x0,0x0,0x0,0x0,0x0,0x0,0x0
.long 0x0,0x0,0x0,0x0,0x0,0x0,0x0,0x0
.long 0x0,0x0,0x0,0x0,0x3400,0x8000b400,0x3400,0x8000b400
.long 0x0,0x0,0x0,0x0,0x0,0x0,0x0,0x0
.long 0x0,0x0,0x0,0x0,0x0,0x0,0x0,0x0
.long 0x0,0x0,0x0,0x0,0x0,0x0,0x0,0x0
.long 0x0,0x0,0x0,0x0,0x0,0x0,0x0,0x0
.long 0x0,0x0,0x0,0x0,0x0,0x0,0x0,0x0
.long 0x0,0x0,0x0,0x0,0x0,0x0,0x0,0x0
.long 0x0,0x0,0x0,0x0,0x0,0x0,0x0,0x0
.long 0x0,0x0,0x0,0x0,0x3400,0x8000b400,0x3400,0x8000b400
.long 0x0,0x0,0x0,0x0,0x0,0x0,0x0,0x0
.long 0x0,0x0,0x0,0x0,0x0,0x0,0x0,0x0
.long 0x0,0x0,0x0,0x0,0x0,0x0,0x0,0x0
.long 0x0,0x0,0x0,0x0,0x0,0x0,0x0,0x0
.long 0x0,0x0,0x0,0x0,0x0,0x0,0x0,0x0
.long 0x0,0x0,0x0,0x0,0x0,0x0,0x0,0x0
.long 0x0,0x0,0x0,0x0,0x0,0x0,0x0,0x0
.long 0x80003c00,0x80003c00,0x80003c00,0x80003c00,0x80003c00,0xa2483c00,0xa6483bff,0xa8b63bff
.long 0x80003c00,0xa6483bff,0xaa483bfe,0xacb53bfa,0x80003c00,0xa8b63bff,0xacb53bfa,0xaf0e3bf4
.long 0x80003c00,0xaa483bfe,0xae463bf6,0xb0b23bea,0x80003c00,0xabd93bfc,0xafd63bf1,0xb1db3bdd
.long 0x80003c00,0xacb53bfa,0xb0b23bea,0xb3033bce,0x80003c00,0xad7e3bf8,0xb1793be2,0xb4143bbc
.long 0x80003c00,0xae463bf6,0xb23e3bd9,0xb4a53ba8,0x80003c00,0xaf0e3bf4,0xb3033bce,0xb5343b91
.long 0x80003c00,0xafd63bf1,0xb3c63bc3,0xb5c23b77,0x80003c00,0xb04e3bed,0xb4443bb6,0xb64e3b5a
.long 0x80003c00,0xb0b23bea,0xb4a53ba8,0xb6d73b3b,0x80003c00,0xb1153be6,0xb5053b99,0xb75e3b1a
.long 0x80003c00,0xb1793be2,0xb5643b88,0xb7e33af6,0x80003c00,0xb1db3bdd,0xb5c23b77,0xb8323ad0
.long 0x80003c00,0x80003c00,0x80003c00,0x80003c00,0xaa483bfe,0xabd93bfc,0xacb53bfa,0xad7e3bf8
.long 0xae463bf6,0xafd63bf1,0xb0b23bea,0xb1793be2,0xb0b23bea,0xb1db3bdd,0xb3033bce,0xb4143bbc
.long 0xb23e3bd9,0xb3c63bc3,0xb4a53ba8,0xb5643b88,0xb3c63bc3,0xb4d53ba0,0xb5c23b77,0xb6aa3b46
.long 0xb4a53ba8,0xb5c23b77,0xb6d73b3b,0xb7e33af6,0xb5643b88,0xb6aa3b46,0xb7e33af6,0xb8873a99
.long 0xb61f3b64,0xb78b3b0e,0xb8723aa7,0xb9133a2f,0xb6d73b3b,0xb8323ad0,0xb8ec3a4f,0xb99639ba
.long 0xb78b3b0e,0xb89b3a8a,0xb95f39ed,0xba0f393a,0xb81d3add,0xb9003a3f,0xb9cb3984,0xba7c38b0
.long 0xb8723aa7,0xb95f39ed,0xba2f3913,0xbadd381d,0xb8c43a6d,0xb9ba3996,0xba8a389b,0xbb303705
.long 0xb9133a2f,0xba0f393a,0xbadd381d,0xbb7735c2,0xb95f39ed,0xba5e38d8,0xbb253732,0xbbaf3475
.long 0x80003c00,0x80003c00,0x80003c00,0x80003c00,0xae463bf6,0xaf0e3bf4,0xafd63bf1,0xb04e3bed
.long 0xb23e3bd9,0xb3033bce,0xb3c63bc3,0xb4443bb6,0xb4a53ba8,0xb5343b91,0xb5c23b77,0xb64e3b5a
.long 0xb61f3b64,0xb6d73b3b,0xb78b3b0e,0xb81d3add,0xb78b3b0e,0xb8323ad0,0xb89b3a8a,0xb9003a3f
.long 0xb8723aa7,0xb8ec3a4f,0xb95f39ed,0xb9cb3984,0xb9133a2f,0xb99639ba,0xba0f393a,0xba7c38b0
.long 0xb9a839a8,0xba2f3913,0xbaa73872,0xbb0e378b,0xba2f3913,0xbab5385d,0xbb253732,0xbb803593
.long 0xbaa73872,0xbb253732,0xbb883564,0xbbce3303,0xbb0e378b,0xbb803593,0xbbce3303,0xbbf82d7e
.long 0xbb64361f,0xbbc333c6,0xbbf62e46,0xbbfeaa48,0xbba834a5,0xbbed304e,0xbbffa648,0xbbddb1db
.long 0xbbd9323e,0xbbff2648,0xbbeab0b2,0xbb99b505,0xbbf62e46,0xbbf8ad7e,0xbbb6b444,0xbb30b705
.long 0x80003c00,0x80003c00,0x80003c00,0x80003c00,0xb0b23bea,0xb1153be6,0xb1793be2,0xb1db3bdd
.long 0xb4a53ba8,0xb5053b99,0xb5643b88,0xb5c23b77,0xb6d73b3b,0xb75e3b1a,0xb7e33af6,0xb8323ad0
.long 0xb8723aa7,0xb8c43a6d,0xb9133a2f,0xb95f39ed,0xb95f39ed,0xb9ba3996,0xba0f393a,0xba5e38d8
.long 0xba2f3913,0xba8a389b,0xbadd381d,0xbb253732,0xbadd381d,0xbb303705,0xbb7735c2,0xbbaf3475
.long 0xbb64361f,0xbba834a5,0xbbd9323e,0xbbf62e46,0xbbc333c6,0xbbed304e,0xbbff2648,0xbbf8ad7e
.long 0xbbf62e46,0xbbffa648,0xbbeab0b2,0xbbb6b444,0xbbfeaa48,0xbbddb1db,0xbb99b505,0xbb30b705
.long 0xbbd9b23e,0xbb88b564,0xbb0eb78b,0xba6db8c4,0xbb88b564,0xbb02b7b7,0xba4fb8ec,0xb972b9dc
.long 0xbb0eb78b,0xba4fb8ec,0xb95fb9ed,0xb848bac2,0xba6db8c4,0xb972b9dc,0xb848bac2,0xb5f1bb6e
.long 0x80003c00,0xb23e3bd9,0xb61f3b64,0xb8723aa7,0x80003c00,0xb2a13bd4,0xb67c3b50,0xb8b03a7c
.long 0x80003c00,0xb3033bce,0xb6d73b3b,0xb8ec3a4f,0x80003c00,0xb3653bc9,0xb7323b25,0xb9273a1f
.long 0x80003c00,0xb3c63bc3,0xb78b3b0e,0xb95f39ed,0x80003c00,0xb4143bbc,0xb7e33af6,0xb99639ba
.long 0x80003c00,0xb4443bb6,0xb81d3add,0xb9cb3984,0x80003c00,0xb4753baf,0xb8483ac2,0xb9fe394d
.long 0x80003c00,0xb4a53ba8,0xb8723aa7,0xba2f3913,0x80003c00,0xb4d53ba0,0xb89b3a8a,0xba5e38d8
.long 0x80003c00,0xb5053b99,0xb8c43a6d,0xba8a389b,0x80003c00,0xb5343b91,0xb8ec3a4f,0xbab5385d
.long 0x80003c00,0xb5643b88,0xb9133a2f,0xbadd381d,0x80003c00,0xb5933b80,0xb93a3a0f,0xbb0237b7
.long 0x80003c00,0xb5c23b77,0xb95f39ed,0xbb253732,0x80003c00,0xb5f13b6e,0xb98439cb,0xbb4636aa
.long 0xb9a839a8,0xbaa73872,0xbb64361f,0xbbd9323e,0xb9ed395f,0xbae93807,0xbb993505,0xbbf42f0e
.long 0xba2f3913,0xbb253732,0xbbc333c6,0xbbff2648,0xba6d38c4,0xbb5a364e,0xbbe23179,0xbbfcabd9
.long 0xbaa73872,0xbb883564,0xbbf62e46,0xbbeab0b2,0xbadd381d,0xbbaf3475,0xbbff2648,0xbbc9b365
.long 0xbb0e378b,0xbbce3303,0xbbfeaa48,0xbb99b505,0xbb3b36d7,0xbbe63115,0xbbf1afd6,0xbb5ab64e
.long 0xbb64361f,0xbbf62e46,0xbbd9b23e,0xbb0eb78b,0xbb883564,0xbbff28b6,0xbbb6b444,0xbab5b85d
.long 0xbba834a5,0xbbffa648,0xbb88b564,0xba4fb8ec,0xbbc333c6,0xbbf8ad7e,0xbb50b67c,0xb9dcb972
.long 0xbbd9323e,0xbbeab0b2,0xbb0eb78b,0xb95fb9ed,0xbbea30b2,0xbbd4b2a1,0xbac2b848,0xb8d8ba5e
.long 0xbbf62e46,0xbbb6b444,0xba6db8c4,0xb848bac2,0xbbfe2a48,0xbb91b534,0xba0fb93a,0xb75ebb1a
.long 0xbc000000,0xbbd9b23e,0xbb64b61f,0xbaa7b872,0xbbf6ae46,0xbba0b4d5,0xbaf6b7e3,0xb9feb94d
.long 0xbbd9b23e,0xbb50b67c,0xba6db8c4,0xb93aba0f,0xbba8b4a5,0xbae9b807,0xb9cbb984,0xb85dbab5
.long 0xbb64b61f,0xba6db8c4,0xb913ba2f,0xb6d7bb3b,0xbb0eb78b,0xb9dcb972,0xb848bac2,0xb4d5bba0
.long 0xbaa7b872,0xb93aba0f,0xb6d7bb3b,0xb179bbe2,0xba2fb913,0xb887ba99,0xb505bb99,0xa8b6bbff
.long 0xb9a8b9a8,0xb78bbb0e,0xb23ebbd9,0x2e46bbf6,0xb913ba2f,0xb5f1bb6e,0xacb5bbfa,0x3365bbc9
.long 0xb872baa7,0xb444bbb6,0x2a48bbfe,0x35c2bb77,0xb78bbb0e,0xb115bbe6,0x3179bbe2,0x37b7bb02
.long 0xb61fbb64,0xaa48bbfe,0x34a5bba8,0x38c4ba6d,0xb4a5bba8,0x2bd9bbfc,0x367cbb50,0x3996b9ba
.long 0xb23ebbd9,0x3179bbe2,0x381dbadd,0x3a4fb8ec,0xae46bbf6,0x3475bbaf,0x38ecba4f,0x3ae9b807
.long 0xb9a8b9a8,0xb872baa7,0xb61fbb64,0xb23ebbd9,0xb8c4ba6d,0xb6aabb46,0xb303bbce,0xa248bc00
.long 0xb78bbb0e,0xb444bbb6,0xaa48bbfe,0x3179bbe2,0xb564bb88,0xaf0ebbf4,0x2fd6bbf1,0x3593bb80
.long 0xb23ebbd9,0x2a48bbfe,0x34a5bba8,0x381dbadd,0xaa48bbfe,0x32a1bbd4,0x3732bb25,0x394db9fe
.long 0x2e46bbf6,0x35c2bb77,0x38c4ba6d,0x3a4fb8ec,0x33c6bbc3,0x3807bae9,0x39cbb984,0x3b1ab75e
.long 0x361fbb64,0x3913ba2f,0x3aa7b872,0x3ba8b4a5,0x381dbadd,0x39feb94d,0x3b50b67c,0x3bf4af0e
.long 0x3913ba2f,0x3ac2b848,0x3bc3b3c6,0x3bfa2cb5,0x39edb95f,0x3b5ab64e,0x3bfaacb5,0x3bbc3414
.long 0x3aa7b872,0x3bc3b3c6,0x3bf62e46,0x3b3b36d7,0x3b3bb6d7,0x3bf8ad7e,0x3bb63444,0x3a7c38b0
.long 0x3ba8b4a5,0x3bfa2cb5,0x3b3b36d7,0x398439cb,0x3beab0b2,0x3bc93365,0x3a8a389b,0x385d3ab5
.long 0x80004000,0x0,0x80004000,0x0,0x80004000,0x0,0xba1f3f64,0x0
.long 0x80004000,0x0,0xbda83da8,0x0,0x80004000,0x0,0xbf643a1f,0x0
.long 0x80004000,0x0,0xc0000000,0x0,0x80004000,0x0,0xbf64ba1f,0x0
.long 0x80004000,0x0,0xbda8bda8,0x0,0x80004000,0x0,0xba1fbf64,0x0
.long 0x80004000,0x0,0x8000c000,0x0,0x80004000,0x0,0x3a1fbf64,0x0
.long 0x80004000,0x0,0x3da8bda8,0x0,0x80004000,0x0,0x3f64ba1f,0x0
.long 0x80004000,0x0,0x40008000,0x0,0x80004000,0x0,0x3f643a1f,0x0
.long 0x80004000,0x0,0x3da83da8,0x0,0x80004000,0x0,0x3a1f3f64,0x0
.long 0x80004000,0x0,0x80004000,0x0,0xbda83da8,0x0,0xbf643a1f,0x0
.long 0xc0000000,0x0,0xbda8bda8,0x0,0xbda8bda8,0x0,0x3a1fbf64,0x0
.long 0x8000c000,0x0,0x40008000,0x0,0x3da8bda8,0x0,0x3a1f3f64,0x0
.long 0x40008000,0x0,0xbda83da8,0x0,0x3da83da8,0x0,0xbf64ba1f,0x0
.long 0x80004000,0x0,0x8000c000,0x0,0xbda83da8,0x0,0x3f64ba1f,0x0
.long 0xc0000000,0x0,0x3da83da8,0x0,0xbda8bda8,0x0,0xba1f3f64,0x0
.long 0x8000c000,0x0,0xc0000000,0x0,0x3da8bda8,0x0,0xba1fbf64,0x0
.long 0x40008000,0x0,0x3da8bda8,0x0,0x3da83da8,0x0,0x3f643a1f,0x0
.long 0x80004000,0x0,0x80004000,0x0,0xc0000000,0x0,0xbf64ba1f,0x0
.long 0x8000c000,0x0,0x3da8bda8,0x0,0x40008000,0x0,0x3a1f3f64,0x0
.long 0x80004000,0x0,0xc0000000,0x0,0xc0000000,0x0,0x3a1fbf64,0x0
.long 0x8000c000,0x0,0x3da83da8,0x0,0x40008000,0x0,0xbf643a1f,0x0
.long 0x80004000,0x0,0x8000c000,0x0,0xc0000000,0x0,0x3f643a1f,0x0
.long 0x8000c000,0x0,0xbda83da8,0x0,0x40008000,0x0,0xba1fbf64,0x0
.long 0x80004000,0x0,0x40008000,0x0,0xc0000000,0x0,0xba1f3f64,0x0
.long 0x8000c000,0x0,0xbda8bda8,0x0,0x40008000,0x0,0x3f64ba1f,0x0
.long 0x80004000,0x0,0x80004000,0x0,0xbda8bda8,0x0,0xba1fbf64,0x0
.long 0x40008000,0x0,0x3da83da8,0x0,0xbda83da8,0x0,0xbf64ba1f,0x0
.long 0x8000c000,0x0,0x40008000,0x0,0x3da83da8,0x0,0xbf643a1f,0x0
.long 0xc0000000,0x0,0x3da8bda8,0x0,0x3da8bda8,0x0,0xba1f3f64,0x0
.long 0x80004000,0x0,0x8000c000,0x0,0xbda8bda8,0x0,0x3a1f3f64,0x0
.long 0x40008000,0x0,0xbda8bda8,0x0,0xbda83da8,0x0,0x3f643a1f,0x0
.long 0x8000c000,0x0,0xc0000000,0x0,0x3da83da8,0x0,0x3f64ba1f,0x0
.long 0xc0000000,0x0,0xbda83da8,0x0,0x3da8bda8,0x0,0x3a1fbf64,0x0
.long 0x40000000,0x0,0x40000000,0x0,0x40000000,0x0,0x3f643a1f,0x0
.long 0x40000000,0x0,0x3da83da8,0x0,0x40000000,0x0,0x3a1f3f64,0x0
.long 0x40000000,0x0,0x4000,0x0,0x40000000,0x0,0xba1f3f64,0x0
.long 0x40000000,0x0,0xbda83da8,0x0,0x40000000,0x0,0xbf643a1f,0x0
.long 0x40000000,0x0,0xc0000000,0x0,0x40000000,0x0,0xbf64ba1f,0x0
.long 0x40000000,0x0,0xbda8bda8,0x0,0x40000000,0x0,0xba1fbf64,0x0
.long 0x40000000,0x0,0x8000c000,0x0,0x40000000,0x0,0x3a1fbf64,0x0
.long 0x40000000,0x0,0x3da8bda8,0x0,0x40000000,0x0,0x3f64ba1f,0x0
.long 0x40000000,0x0,0x40000000,0x0,0x3da83da8,0x0,0x3a1f3f64,0x0
.long 0x4000,0x0,0xbda83da8,0x0,0xbda83da8,0x0,0xbf64ba1f,0x0
.long 0xc0000000,0x0,0x8000c000,0x0,0xbda8bda8,0x0,0x3f64ba1f,0x0
.long 0x8000c000,0x0,0x3da83da8,0x0,0x3da8bda8,0x0,0xba1f3f64,0x0
.long 0x40000000,0x0,0xc0000000,0x0,0x3da83da8,0x0,0xba1fbf64,0x0
.long 0x4000,0x0,0x3da8bda8,0x0,0xbda83da8,0x0,0x3f643a1f,0x0
.long 0xc0000000,0x0,0x4000,0x0,0xbda8bda8,0x0,0xbf643a1f,0x0
.long 0x8000c000,0x0,0xbda8bda8,0x0,0x3da8bda8,0x0,0x3a1fbf64,0x0
.long 0x40000000,0x0,0x40000000,0x0,0x4000,0x0,0xba1f3f64,0x0
.long 0xc0000000,0x0,0xbda8bda8,0x0,0x8000c000,0x0,0x3f64ba1f,0x0
.long 0x40000000,0x0,0x4000,0x0,0x4000,0x0,0xbf64ba1f,0x0
.long 0xc0000000,0x0,0x3da8bda8,0x0,0x8000c000,0x0,0x3a1f3f64,0x0
.long 0x40000000,0x0,0xc0000000,0x0,0x4000,0x0,0x3a1fbf64,0x0
.long 0xc0000000,0x0,0x3da83da8,0x0,0x8000c000,0x0,0xbf643a1f,0x0
.long 0x40000000,0x0,0x8000c000,0x0,0x4000,0x0,0x3f643a1f,0x0
.long 0xc0000000,0x0,0xbda83da8,0x0,0x8000c000,0x0,0xba1fbf64,0x0
.long 0x40000000,0x0,0x40000000,0x0,0xbda83da8,0x0,0xbf643a1f,0x0
.long 0x8000c000,0x0,0x3da8bda8,0x0,0x3da83da8,0x0,0xba1f3f64,0x0
.long 0xc0000000,0x0,0x8000c000,0x0,0x3da8bda8,0x0,0x3a1f3f64,0x0
.long 0x4000,0x0,0xbda8bda8,0x0,0xbda8bda8,0x0,0x3f643a1f,0x0
.long 0x40000000,0x0,0xc0000000,0x0,0xbda83da8,0x0,0x3f64ba1f,0x0
.long 0x8000c000,0x0,0xbda83da8,0x0,0x3da83da8,0x0,0x3a1fbf64,0x0
.long 0xc0000000,0x0,0x4000,0x0,0x3da8bda8,0x0,0xba1fbf64,0x0
.long 0x4000,0x0,0x3da83da8,0x0,0xbda8bda8,0x0,0xbf64ba1f,0x0
.long 0x0,0x80004000,0x0,0x80004000,0x0,0x80004000,0x0,0xba1f3f64
.long 0x0,0x80004000,0x0,0xbda83da8,0x0,0x80004000,0x0,0xbf643a1f
.long 0x0,0x80004000,0x0,0xc0000000,0x0,0x80004000,0x0,0xbf64ba1f
.long 0x0,0x80004000,0x0,0xbda8bda8,0x0,0x80004000,0x0,0xba1fbf64
.long 0x0,0x80004000,0x0,0x8000c000,0x0,0x80004000,0x0,0x3a1fbf64
.long 0x0,0x80004000,0x0,0x3da8bda8,0x0,0x80004000,0x0,0x3f64ba1f
.long 0x0,0x80004000,0x0,0x40008000,0x0,0x80004000,0x0,0x3f643a1f
.long 0x0,0x80004000,0x0,0x3da83da8,0x0,0x80004000,0x0,0x3a1f3f64
.long 0x0,0x80004000,0x0,0x80004000,0x0,0xbda83da8,0x0,0xbf643a1f
.long 0x0,0xc0000000,0x0,0xbda8bda8,0x0,0xbda8bda8,0x0,0x3a1fbf64
.long 0x0,0x8000c000,0x0,0x40008000,0x0,0x3da8bda8,0x0,0x3a1f3f64
.long 0x0,0x40008000,0x0,0xbda83da8,0x0,0x3da83da8,0x0,0xbf64ba1f
.long 0x0,0x80004000,0x0,0x8000c000,0x0,0xbda83da8,0x0,0x3f64ba1f
.long 0x0,0xc0000000,0x0,0x3da83da8,0x0,0xbda8bda8,0x0,0xba1f3f64
.long 0x0,0x8000c000,0x0,0xc0000000,0x0,0x3da8bda8,0x0,0xba1fbf64
.long 0x0,0x40008000,0x0,0x3da8bda8,0x0,0x3da83da8,0x0,0x3f643a1f
.long 0x0,0x80004000,0x0,0x80004000,0x0,0xc0000000,0x0,0xbf64ba1f
.long 0x0,0x8000c000,0x0,0x3da8bda8,0x0,0x40008000,0x0,0x3a1f3f64
.long 0x0,0x80004000,0x0,0xc0000000,0x0,0xc0000000,0x0,0x3a1fbf64
.long 0x0,0x8000c000,0x0,0x3da83da8,0x0,0x40008000,0x0,0xbf643a1f
.long 0x0,0x80004000,0x0,0x8000c000,0x0,0xc0000000,0x0,0x3f643a1f
.long 0x0,0x8000c000,0x0,0xbda83da8,0x0,0x40008000,0x0,0xba1fbf64
.long 0x0,0x80004000,0x0,0x40008000,0x0,0xc0000000,0x0,0xba1f3f64
.long 0x0,0x8000c000,0x0,0xbda8bda8,0x0,0x40008000,0x0,0x3f64ba1f
.long 0x0,0x80004000,0x0,0x80004000,0x0,0xbda8bda8,0x0,0xba1fbf64
.long 0x0,0x40008000,0x0,0x3da83da8,0x0,0xbda83da8,0x0,0xbf64ba1f
.long 0x0,0x8000c000,0x0,0x40008000,0x0,0x3da83da8,0x0,0xbf643a1f
.long 0x0,0xc0000000,0x0,0x3da8bda8,0x0,0x3da8bda8,0x0,0xba1f3f64
.long 0x0,0x80004000,0x0,0x8000c000,0x0,0xbda8bda8,0x0,0x3a1f3f64
.long 0x0,0x40008000,0x0,0xbda8bda8,0x0,0xbda83da8,0x0,0x3f643a1f
.long 0x0,0x8000c000,0x0,0xc0000000,0x0,0x3da83da8,0x0,0x3f64ba1f
.long 0x0,0xc0000000,0x0,0xbda83da8,0x0,0x3da8bda8,0x0,0x3a1fbf64
.long 0x0,0x40000000,0x0,0x40000000,0x0,0x40000000,0x0,0x3f643a1f
.long 0x0,0x40000000,0x0,0x3da83da8,0x0,0x40000000,0x0,0x3a1f3f64
.long 0x0,0x40000000,0x0,0x4000,0x0,0x40000000,0x0,0xba1f3f64
.long 0x0,0x40000000,0x0,0xbda83da8,0x0,0x40000000,0x0,0xbf643a1f
.long 0x0,0x40000000,0x0,0xc0000000,0x0,0x40000000,0x0,0xbf64ba1f
.long 0x0,0x40000000,0x0,0xbda8bda8,0x0,0x40000000,0x0,0xba1fbf64
.long 0x0,0x40000000,0x0,0x8000c000,0x0,0x40000000,0x0,0x3a1fbf64
.long 0x0,0x40000000,0x0,0x3da8bda8,0x0,0x40000000,0x0,0x3f64ba1f
.long 0x0,0x40000000,0x0,0x40000000,0x0,0x3da83da8,0x0,0x3a1f3f64
.long 0x0,0x4000,0x0,0xbda83da8,0x0,0xbda83da8,0x0,0xbf64ba1f
.long 0x0,0xc0000000,0x0,0x8000c000,0x0,0xbda8bda8,0x0,0x3f64ba1f
.long 0x0,0x8000c000,0x0,0x3da83da8,0x0,0x3da8bda8,0x0,0xba1f3f64
.long 0x0,0x40000000,0x0,0xc0000000,0x0,0x3da83da8,0x0,0xba1fbf64
.long 0x0,0x4000,0x0,0x3da8bda8,0x0,0xbda83da8,0x0,0x3f643a1f
.long 0x0,0xc0000000,0x0,0x4000,0x0,0xbda8bda8,0x0,0xbf643a1f
.long 0x0,0x8000c000,0x0,0xbda8bda8,0x0,0x3da8bda8,0x0,0x3a1fbf64
.long 0x0,0x40000000,0x0,0x40000000,0x0,0x4000,0x0,0xba1f3f64
.long 0x0,0xc0000000,0x0,0xbda8bda8,0x0,0x8000c000,0x0,0x3f64ba1f
.long 0x0,0x40000000,0x0,0x4000,0x0,0x4000,0x0,0xbf64ba1f
.long 0x0,0xc0000000,0x0,0x3da8bda8,0x0,0x8000c000,0x0,0x3a1f3f64
.long 0x0,0x40000000,0x0,0xc0000000,0x0,0x4000,0x0,0x3a1fbf64
.long 0x0,0xc0000000,0x0,0x3da83da8,0x0,0x8000c000,0x0,0xbf643a1f
.long 0x0,0x40000000,0x0,0x8000c000,0x0,0x4000,0x0,0x3f643a1f
.long 0x0,0xc0000000,0x0,0xbda83da8,0x0,0x8000c000,0x0,0xba1fbf64
.long 0x0,0x40000000,0x0,0x40000000,0x0,0xbda83da8,0x0,0xbf643a1f
.long 0x0,0x8000c000,0x0,0x3da8bda8,0x0,0x3da83da8,0x0,0xba1f3f64
.long 0x0,0xc0000000,0x0,0x8000c000,0x0,0x3da8bda8,0x0,0x3a1f3f64
.long 0x0,0x4000,0x0,0xbda8bda8,0x0,0xbda8bda8,0x0,0x3f643a1f
.long 0x0,0x40000000,0x0,0xc0000000,0x0,0xbda83da8,0x0,0x3f64ba1f
.long 0x0,0x8000c000,0x0,0xbda83da8,0x0,0x3da83da8,0x0,0x3a1fbf64
.long 0x0,0xc0000000,0x0,0x4000,0x0,0x3da8bda8,0x0,0xba1fbf64
.long 0x0,0x4000,0x0,0x3da83da8,0x0,0xbda8bda8,0x0,0xbf64ba1f
.long 0x30002c00,0x80002c00,0x80002c00,0x80002c00,0x30002c00,0xa23e2bd9,0xa61f2b64,0xa8722aa7
.long 0x30002c00,0xa61f2b64,0xa9a829a8,0xab64261f,0x30002c00,0xa8722aa7,0xab64261f,0xabd9a23e
.long 0x30002c00,0xa9a829a8,0xac000000,0xa9a8a9a8,0x30002c00,0xaaa72872,0xab64a61f,0xa23eabd9
.long 0x30002c00,0xab64261f,0xa9a8a9a8,0x261fab64,0x30002c00,0xabd9223e,0xa61fab64,0x2aa7a872
.long 0x30002c00,0xac000000,0x8000ac00,0x2c008000,0x30002c00,0xabd9a23e,0x261fab64,0x2aa72872
.long 0x30002c00,0xab64a61f,0x29a8a9a8,0x261f2b64,0x30002c00,0xaaa7a872,0x2b64a61f,0xa23e2bd9
.long 0x30002c00,0xa9a8a9a8,0x2c008000,0xa9a829a8,0x30002c00,0xa872aaa7,0x2b64261f,0xabd9223e
.long 0x30002c00,0xa61fab64,0x29a829a8,0xab64a61f,0x30002c00,0xa23eabd9,0x261f2b64,0xa872aaa7
.long 0x80002c00,0x80002c00,0x80002c00,0x80002c00,0xa9a829a8,0xaaa72872,0xab64261f,0xabd9223e
.long 0xac000000,0xab64a61f,0xa9a8a9a8,0xa61fab64,0xa9a8a9a8,0xa23eabd9,0x261fab64,0x2aa7a872
.long 0x8000ac00,0x29a8a9a8,0x2c008000,0x29a829a8,0x29a8a9a8,0x2bd9223e,0x261f2b64,0xa8722aa7
.long 0x2c008000,0x261f2b64,0xa9a829a8,0xab64a61f,0x29a829a8,0xa8722aa7,0xab64a61f,0x223eabd9
.long 0x80002c00,0xac000000,0x8000ac00,0x2c008000,0xa9a829a8,0xa872aaa7,0x2b64a61f,0x223e2bd9
.long 0xac000000,0x261fab64,0x29a829a8,0xab64261f,0xa9a8a9a8,0x2bd9a23e,0xa61f2b64,0xa872aaa7
.long 0x8000ac00,0x29a829a8,0xac000000,0x29a8a9a8,0x29a8a9a8,0xa23e2bd9,0xa61fab64,0x2aa72872
.long 0x2c008000,0xab64261f,0x29a8a9a8,0xa61f2b64,0x29a829a8,0xaaa7a872,0x2b64261f,0xabd9a23e
.long 0x80002c00,0x80002c00,0x80002c00,0x80002c00,0xac000000,0xabd9a23e,0xab64a61f,0xaaa7a872
.long 0x8000ac00,0x261fab64,0x29a8a9a8,0x2b64a61f,0x2c008000,0x2aa72872,0x261f2b64,0xa23e2bd9
.long 0x80002c00,0xa9a829a8,0xac000000,0xa9a8a9a8,0xac000000,0xa872aaa7,0x261fab64,0x2bd9a23e
.long 0x8000ac00,0x2b64a61f,0x29a829a8,0xa61f2b64,0x2c008000,0x223e2bd9,0xab64261f,0xa872aaa7
.long 0x80002c00,0xac000000,0x8000ac00,0x2c008000,0xac000000,0x223eabd9,0x2b64261f,0xa8722aa7
.long 0x8000ac00,0x2b64261f,0xa9a829a8,0xa61fab64,0x2c008000,0xa8722aa7,0xa61fab64,0x2bd9223e
.long 0x80002c00,0xa9a8a9a8,0x2c008000,0xa9a829a8,0xac000000,0x2aa7a872,0xa61f2b64,0xa23eabd9
.long 0x8000ac00,0x261f2b64,0xa9a8a9a8,0x2b64261f,0x2c008000,0xabd9223e,0x2b64a61f,0xaaa72872
.long 0x80002c00,0x80002c00,0x80002c00,0x80002c00,0xa9a8a9a8,0xa872aaa7,0xa61fab64,0xa23eabd9
.long 0x2c008000,0x2b64261f,0x29a829a8,0x261f2b64,0xa9a829a8,0xabd9223e,0xab64a61f,0xa872aaa7
.long 0x8000ac00,0x29a8a9a8,0x2c008000,0x29a829a8,0x29a829a8,0xa23e2bd9,0xab64261f,0xaaa7a872
.long 0xac000000,0xa61fab64,0x29a8a9a8,0x2b64261f,0x29a8a9a8,0x2aa72872,0xa61f2b64,0xabd9a23e
.long 0x80002c00,0xac000000,0x8000ac00,0x2c008000,0xa9a8a9a8,0x2aa7a872,0x261f2b64,0xabd9223e
.long 0x2c008000,0xa61f2b64,0xa9a8a9a8,0x2b64a61f,0xa9a829a8,0xa23eabd9,0x2b64261f,0xaaa72872
.long 0x8000ac00,0x29a829a8,0xac000000,0x29a8a9a8,0x29a829a8,0xabd9a23e,0x2b64a61f,0xa8722aa7
.long 0xac000000,0x2b64a61f,0xa9a829a8,0x261fab64,0x29a8a9a8,0xa8722aa7,0x261fab64,0xa23e2bd9
.long 0x80002c00,0x80002c00,0x80002c00,0x80002c00,0x8000ac00,0x223eabd9,0x261fab64,0x2872aaa7
.long 0x80002c00,0xa61f2b64,0xa9a829a8,0xab64261f,0x8000ac00,0x2872aaa7,0x2b64a61f,0x2bd9223e
.long 0x80002c00,0xa9a829a8,0xac000000,0xa9a8a9a8,0x8000ac00,0x2aa7a872,0x2b64261f,0x223e2bd9
.long 0x80002c00,0xab64261f,0xa9a8a9a8,0x261fab64,0x8000ac00,0x2bd9a23e,0x261f2b64,0xaaa72872
.long 0x80002c00,0xac000000,0x8000ac00,0x2c008000,0x8000ac00,0x2bd9223e,0xa61f2b64,0xaaa7a872
.long 0x80002c00,0xab64a61f,0x29a8a9a8,0x261f2b64,0x8000ac00,0x2aa72872,0xab64261f,0x223eabd9
.long 0x80002c00,0xa9a8a9a8,0x2c008000,0xa9a829a8,0x8000ac00,0x28722aa7,0xab64a61f,0x2bd9a23e
.long 0x80002c00,0xa61fab64,0x29a829a8,0xab64a61f,0x8000ac00,0x223e2bd9,0xa61fab64,0x28722aa7
.long 0x80002c00,0x80002c00,0x80002c00,0x80002c00,0x29a8a9a8,0x2aa7a872,0x2b64a61f,0x2bd9a23e
.long 0xac000000,0xab64a61f,0xa9a8a9a8,0xa61fab64,0x29a829a8,0x223e2bd9,0xa61f2b64,0xaaa72872
.long 0x8000ac00,0x29a8a9a8,0x2c008000,0x29a829a8,0xa9a829a8,0xabd9a23e,0xa61fab64,0x2872aaa7
.long 0x2c008000,0x261f2b64,0xa9a829a8,0xab64a61f,0xa9a8a9a8,0x2872aaa7,0x2b64261f,0xa23e2bd9
.long 0x80002c00,0xac000000,0x8000ac00,0x2c008000,0x29a8a9a8,0x28722aa7,0xab64261f,0xa23eabd9
.long 0xac000000,0x261fab64,0x29a829a8,0xab64261f,0x29a829a8,0xabd9223e,0x261fab64,0x28722aa7
.long 0x8000ac00,0x29a829a8,0xac000000,0x29a8a9a8,0xa9a829a8,0x223eabd9,0x261f2b64,0xaaa7a872
.long 0x2c008000,0xab64261f,0x29a8a9a8,0xa61f2b64,0xa9a8a9a8,0x2aa72872,0xab64a61f,0x2bd9223e
.long 0x80002c00,0x80002c00,0x80002c00,0x80002c00,0x2c008000,0x2bd9223e,0x2b64261f,0x2aa72872
.long 0x8000ac00,0x261fab64,0x29a8a9a8,0x2b64a61f,0xac000000,0xaaa7a872,0xa61fab64,0x223eabd9
.long 0x80002c00,0xa9a829a8,0xac000000,0xa9a8a9a8,0x2c008000,0x28722aa7,0xa61f2b64,0xabd9223e
.long 0x8000ac00,0x2b64a61f,0x29a829a8,0xa61f2b64,0xac000000,0xa23eabd9,0x2b64a61f,0x28722aa7
.long 0x80002c00,0xac000000,0x8000ac00,0x2c008000,0x2c008000,0xa23e2bd9,0xab64a61f,0x2872aaa7
.long 0x8000ac00,0x2b64261f,0xa9a829a8,0xa61fab64,0xac000000,0x2872aaa7,0x261f2b64,0xabd9a23e
.long 0x80002c00,0xa9a8a9a8,0x2c008000,0xa9a829a8,0x2c008000,0xaaa72872,0x261fab64,0x223e2bd9
.long 0x8000ac00,0x261f2b64,0xa9a8a9a8,0x2b64261f,0xac000000,0x2bd9a23e,0xab64261f,0x2aa7a872
.long 0x80002c00,0x80002c00,0x80002c00,0x80002c00,0x29a829a8,0x28722aa7,0x261f2b64,0x223e2bd9
.long 0x2c008000,0x2b64261f,0x29a829a8,0x261f2b64,0x29a8a9a8,0x2bd9a23e,0x2b64261f,0x28722aa7
.long 0x8000ac00,0x29a8a9a8,0x2c008000,0x29a829a8,0xa9a8a9a8,0x223eabd9,0x2b64a61f,0x2aa72872
.long 0xac000000,0xa61fab64,0x29a8a9a8,0x2b64261f,0xa9a829a8,0xaaa7a872,0x261fab64,0x2bd9223e
.long 0x80002c00,0xac000000,0x8000ac00,0x2c008000,0x29a829a8,0xaaa72872,0xa61fab64,0x2bd9a23e
.long 0x2c008000,0xa61f2b64,0xa9a8a9a8,0x2b64a61f,0x29a8a9a8,0x223e2bd9,0xab64a61f,0x2aa7a872
.long 0x8000ac00,0x29a829a8,0xac000000,0x29a8a9a8,0xa9a8a9a8,0x2bd9223e,0xab64261f,0x2872aaa7
.long 0xac000000,0x2b64a61f,0xa9a829a8,0x261fab64,0xa9a829a8,0x2872aaa7,0xa61f2b64,0x223eabd9
.long 0x30002c00,0x8000ac00,0x80002c00,0x8000ac00,0x30002c00,0x223eabd9,0xa61f2b64,0x2872aaa7
.long 0x30002c00,0x261fab64,0xa9a829a8,0x2b64a61f,0x30002c00,0x2872aaa7,0xab64261f,0x2bd9223e
.long 0x30002c00,0x29a8a9a8,0xac000000,0x29a829a8,0x30002c00,0x2aa7a872,0xab64a61f,0x223e2bd9
.long 0x30002c00,0x2b64a61f,0xa9a8a9a8,0xa61f2b64,0x30002c00,0x2bd9a23e,0xa61fab64,0xaaa72872
.long 0x30002c00,0x2c008000,0x8000ac00,0xac000000,0x30002c00,0x2bd9223e,0x261fab64,0xaaa7a872
.long 0x30002c00,0x2b64261f,0x29a8a9a8,0xa61fab64,0x30002c00,0x2aa72872,0x2b64a61f,0x223eabd9
.long 0x30002c00,0x29a829a8,0x2c008000,0x29a8a9a8,0x30002c00,0x28722aa7,0x2b64261f,0x2bd9a23e
.long 0x30002c00,0x261f2b64,0x29a829a8,0x2b64261f,0x30002c00,0x223e2bd9,0x261f2b64,0x28722aa7
.long 0x80002c00,0x8000ac00,0x80002c00,0x8000ac00,0xa9a829a8,0x2aa7a872,0xab64261f,0x2bd9a23e
.long 0xac000000,0x2b64261f,0xa9a8a9a8,0x261f2b64,0xa9a8a9a8,0x223e2bd9,0x261fab64,0xaaa72872
.long 0x8000ac00,0xa9a829a8,0x2c008000,0xa9a8a9a8,0x29a8a9a8,0xabd9a23e,0x261f2b64,0x2872aaa7
.long 0x2c008000,0xa61fab64,0xa9a829a8,0x2b64261f,0x29a829a8,0x2872aaa7,0xab64a61f,0xa23e2bd9
.long 0x80002c00,0x2c008000,0x8000ac00,0xac000000,0xa9a829a8,0x28722aa7,0x2b64a61f,0xa23eabd9
.long 0xac000000,0xa61f2b64,0x29a829a8,0x2b64a61f,0xa9a8a9a8,0xabd9223e,0xa61f2b64,0x28722aa7
.long 0x8000ac00,0xa9a8a9a8,0xac000000,0xa9a829a8,0x29a8a9a8,0x223eabd9,0xa61fab64,0xaaa7a872
.long 0x2c008000,0x2b64a61f,0x29a8a9a8,0x261fab64,0x29a829a8,0x2aa72872,0x2b64261f,0x2bd9223e
.long 0x80002c00,0x8000ac00,0x80002c00,0x8000ac00,0xac000000,0x2bd9223e,0xab64a61f,0x2aa72872
.long 0x8000ac00,0xa61f2b64,0x29a8a9a8,0xab64261f,0x2c008000,0xaaa7a872,0x261f2b64,0x223eabd9
.long 0x80002c00,0x29a8a9a8,0xac000000,0x29a829a8,0xac000000,0x28722aa7,0x261fab64,0xabd9223e
.long 0x8000ac00,0xab64261f,0x29a829a8,0x261fab64,0x2c008000,0xa23eabd9,0xab64261f,0x28722aa7
.long 0x80002c00,0x2c008000,0x8000ac00,0xac000000,0xac000000,0xa23e2bd9,0x2b64261f,0x2872aaa7
.long 0x8000ac00,0xab64a61f,0xa9a829a8,0x261f2b64,0x2c008000,0x2872aaa7,0xa61fab64,0xabd9a23e
.long 0x80002c00,0x29a829a8,0x2c008000,0x29a8a9a8,0xac000000,0xaaa72872,0xa61f2b64,0x223e2bd9
.long 0x8000ac00,0xa61fab64,0xa9a8a9a8,0xab64a61f,0x2c008000,0x2bd9a23e,0x2b64a61f,0x2aa7a872
.long 0x80002c00,0x8000ac00,0x80002c00,0x8000ac00,0xa9a8a9a8,0x28722aa7,0xa61fab64,0x223e2bd9
.long 0x2c008000,0xab64a61f,0x29a829a8,0xa61fab64,0xa9a829a8,0x2bd9a23e,0xab64a61f,0x28722aa7
.long 0x8000ac00,0xa9a829a8,0x2c008000,0xa9a8a9a8,0x29a829a8,0x223eabd9,0xab64261f,0x2aa72872
.long 0xac000000,0x261f2b64,0x29a8a9a8,0xab64a61f,0x29a8a9a8,0xaaa7a872,0xa61f2b64,0x2bd9223e
.long 0x80002c00,0x2c008000,0x8000ac00,0xac000000,0xa9a8a9a8,0xaaa72872,0x261f2b64,0x2bd9a23e
.long 0x2c008000,0x261fab64,0xa9a8a9a8,0xab64261f,0xa9a829a8,0x223e2bd9,0x2b64261f,0x2aa7a872
.long 0x8000ac00,0xa9a8a9a8,0xac000000,0xa9a829a8,0x29a829a8,0x2bd9223e,0x2b64a61f,0x2872aaa7
.long 0xac000000,0xab64261f,0xa9a829a8,0xa61f2b64,0x29a8a9a8,0x2872aaa7,0x261fab64,0x223eabd9
.long 0x80002c00,0x8000ac00,0x80002c00,0x8000ac00,0x8000ac00,0xa23e2bd9,0x261fab64,0xa8722aa7
.long 0x80002c00,0x261fab64,0xa9a829a8,0x2b64a61f,0x8000ac00,0xa8722aa7,0x2b64a61f,0xabd9a23e
.long 0x80002c00,0x29a8a9a8,0xac000000,0x29a829a8,0x8000ac00,0xaaa72872,0x2b64261f,0xa23eabd9
.long 0x80002c00,0x2b64a61f,0xa9a8a9a8,0xa61f2b64,0x8000ac00,0xabd9223e,0x261f2b64,0x2aa7a872
.long 0x80002c00,0x2c008000,0x8000ac00,0xac000000,0x8000ac00,0xabd9a23e,0xa61f2b64,0x2aa72872
.long 0x80002c00,0x2b64261f,0x29a8a9a8,0xa61fab64,0x8000ac00,0xaaa7a872,0xab64261f,0xa23e2bd9
.long 0x80002c00,0x29a829a8,0x2c008000,0x29a8a9a8,0x8000ac00,0xa872aaa7,0xab64a61f,0xabd9223e
.long 0x80002c00,0x261f2b64,0x29a829a8,0x2b64261f,0x8000ac00,0xa23eabd9,0xa61fab64,0xa872aaa7
.long 0x80002c00,0x8000ac00,0x80002c00,0x8000ac00,0x29a8a9a8,0xaaa72872,0x2b64a61f,0xabd9223e
.long 0xac000000,0x2b64261f,0xa9a8a9a8,0x261f2b64,0x29a829a8,0xa23eabd9,0xa61f2b64,0x2aa7a872
.long 0x8000ac00,0xa9a829a8,0x2c008000,0xa9a8a9a8,0xa9a829a8,0x2bd9223e,0xa61fab64,0xa8722aa7
.long 0x2c008000,0xa61fab64,0xa9a829a8,0x2b64261f,0xa9a8a9a8,0xa8722aa7,0x2b64261f,0x223eabd9
.long 0x80002c00,0x2c008000,0x8000ac00,0xac000000,0x29a8a9a8,0xa872aaa7,0xab64261f,0x223e2bd9
.long 0xac000000,0xa61f2b64,0x29a829a8,0x2b64a61f,0x29a829a8,0x2bd9a23e,0x261fab64,0xa872aaa7
.long 0x8000ac00,0xa9a8a9a8,0xac000000,0xa9a829a8,0xa9a829a8,0xa23e2bd9,0x261f2b64,0x2aa72872
.long 0x2c008000,0x2b64a61f,0x29a8a9a8,0x261fab64,0xa9a8a9a8,0xaaa7a872,0xab64a61f,0xabd9a23e
.long 0x80002c00,0x8000ac00,0x80002c00,0x8000ac00,0x2c008000,0xabd9a23e,0x2b64261f,0xaaa7a872
.long 0x8000ac00,0xa61f2b64,0x29a8a9a8,0xab64261f,0xac000000,0x2aa72872,0xa61fab64,0xa23e2bd9
.long 0x80002c00,0x29a8a9a8,0xac000000,0x29a829a8,0x2c008000,0xa872aaa7,0xa61f2b64,0x2bd9a23e
.long 0x8000ac00,0xab64261f,0x29a829a8,0x261fab64,0xac000000,0x223e2bd9,0x2b64a61f,0xa872aaa7
.long 0x80002c00,0x2c008000,0x8000ac00,0xac000000,0x2c008000,0x223eabd9,0xab64a61f,0xa8722aa7
.long 0x8000ac00,0xab64a61f,0xa9a829a8,0x261f2b64,0xac000000,0xa8722aa7,0x261f2b64,0x2bd9223e
.long 0x80002c00,0x29a829a8,0x2c008000,0x29a8a9a8,0x2c008000,0x2aa7a872,0x261fab64,0xa23eabd9
.long 0x8000ac00,0xa61fab64,0xa9a8a9a8,0xab64a61f,0xac000000,0xabd9223e,0xab64261f,0xaaa72872
.long 0x80002c00,0x8000ac00,0x80002c00,0x8000ac00,0x29a829a8,0xa872aaa7,0x261f2b64,0xa23eabd9
.long 0x2c008000,0xab64a61f,0x29a829a8,0xa61fab64,0x29a8a9a8,0xabd9223e,0x2b64261f,0xa872aaa7
.long 0x8000ac00,0xa9a829a8,0x2c008000,0xa9a8a9a8,0xa9a8a9a8,0xa23e2bd9,0x2b64a61f,0xaaa7a872
.long 0xac000000,0x261f2b64,0x29a8a9a8,0xab64a61f,0xa9a829a8,0x2aa72872,0x261fab64,0xabd9a23e
.long 0x80002c00,0x2c008000,0x8000ac00,0xac000000,0x29a829a8,0x2aa7a872,0xa61fab64,0xabd9223e
.long 0x2c008000,0x261fab64,0xa9a8a9a8,0xab64261f,0x29a8a9a8,0xa23eabd9,0xab64a61f,0xaaa72872
.long 0x8000ac00,0xa9a8a9a8,0xac000000,0xa9a829a8,0xa9a8a9a8,0xabd9a23e,0xab64261f,0xa8722aa7
.long 0xac000000,0xab64261f,0xa9a829a8,0xa61f2b64,0xa9a829a8,0xa8722aa7,0xa61f2b64,0xa23e2bd9
.long 0x3c00,0x3c00,0x3c00,0x3c00,0x3c00,0x22483c00,0x26483bff,0x28b63bff
.long 0x3c00,0x26483bff,0x2a483bfe,0x2cb53bfa,0x3c00,0x28b63bff,0x2cb53bfa,0x2f0e3bf4
.long 0x3c00,0x2a483bfe,0x2e463bf6,0x30b23bea,0x3c00,0x2bd93bfc,0x2fd63bf1,0x31db3bdd
.long 0x3c00,0x2cb53bfa,0x30b23bea,0x33033bce,0x3c00,0x2d7e3bf8,0x31793be2,0x34143bbc
.long 0x3c00,0x2e463bf6,0x323e3bd9,0x34a53ba8,0x3c00,0x2f0e3bf4,0x33033bce,0x35343b91
.long 0x3c00,0x2fd63bf1,0x33c63bc3,0x35c23b77,0x3c00,0x304e3bed,0x34443bb6,0x364e3b5a
.long 0x3c00,0x30b23bea,0x34a53ba8,0x36d73b3b,0x3c00,0x31153be6,0x35053b99,0x375e3b1a
.long 0x3c00,0x31793be2,0x35643b88,0x37e33af6,0x3c00,0x31db3bdd,0x35c23b77,0x38323ad0
.long 0x3c00,0x3c00,0x3c00,0x3c00,0x2a483bfe,0x2bd93bfc,0x2cb53bfa,0x2d7e3bf8
.long 0x2e463bf6,0x2fd63bf1,0x30b23bea,0x31793be2,0x30b23bea,0x31db3bdd,0x33033bce,0x34143bbc
.long 0x323e3bd9,0x33c63bc3,0x34a53ba8,0x35643b88,0x33c63bc3,0x34d53ba0,0x35c23b77,0x36aa3b46
.long 0x34a53ba8,0x35c23b77,0x36d73b3b,0x37e33af6,0x35643b88,0x36aa3b46,0x37e33af6,0x38873a99
.long 0x361f3b64,0x378b3b0e,0x38723aa7,0x39133a2f,0x36d73b3b,0x38323ad0,0x38ec3a4f,0x399639ba
.long 0x378b3b0e,0x389b3a8a,0x395f39ed,0x3a0f393a,0x381d3add,0x39003a3f,0x39cb3984,0x3a7c38b0
.long 0x38723aa7,0x395f39ed,0x3a2f3913,0x3add381d,0x38c43a6d,0x39ba3996,0x3a8a389b,0x3b303705
.long 0x39133a2f,0x3a0f393a,0x3add381d,0x3b7735c2,0x395f39ed,0x3a5e38d8,0x3b253732,0x3baf3475
.long 0x3c00,0x3c00,0x3c00,0x3c00,0x2e463bf6,0x2f0e3bf4,0x2fd63bf1,0x304e3bed
.long 0x323e3bd9,0x33033bce,0x33c63bc3,0x34443bb6,0x34a53ba8,0x35343b91,0x35c23b77,0x364e3b5a
.long 0x361f3b64,0x36d73b3b,0x378b3b0e,0x381d3add,0x378b3b0e,0x38323ad0,0x389b3a8a,0x39003a3f
.long 0x38723aa7,0x38ec3a4f,0x395f39ed,0x39cb3984,0x39133a2f,0x399639ba,0x3a0f393a,0x3a7c38b0
.long 0x39a839a8,0x3a2f3913,0x3aa73872,0x3b0e378b,0x3a2f3913,0x3ab5385d,0x3b253732,0x3b803593
.long 0x3aa73872,0x3b253732,0x3b883564,0x3bce3303,0x3b0e378b,0x3b803593,0x3bce3303,0x3bf82d7e
.long 0x3b64361f,0x3bc333c6,0x3bf62e46,0x3bfeaa48,0x3ba834a5,0x3bed304e,0x3bffa648,0x3bddb1db
.long 0x3bd9323e,0x3bff2648,0x3beab0b2,0x3b99b505,0x3bf62e46,0x3bf8ad7e,0x3bb6b444,0x3b30b705
.long 0x3c00,0x3c00,0x3c00,0x3c00,0x30b23bea,0x31153be6,0x31793be2,0x31db3bdd
.long 0x34a53ba8,0x35053b99,0x35643b88,0x35c23b77,0x36d73b3b,0x375e3b1a,0x37e33af6,0x38323ad0
.long 0x38723aa7,0x38c43a6d,0x39133a2f,0x395f39ed,0x395f39ed,0x39ba3996,0x3a0f393a,0x3a5e38d8
.long 0x3a2f3913,0x3a8a389b,0x3add381d,0x3b253732,0x3add381d,0x3b303705,0x3b7735c2,0x3baf3475
.long 0x3b64361f,0x3ba834a5,0x3bd9323e,0x3bf62e46,0x3bc333c6,0x3bed304e,0x3bff2648,0x3bf8ad7e
.long 0x3bf62e46,0x3bffa648,0x3beab0b2,0x3bb6b444,0x3bfeaa48,0x3bddb1db,0x3b99b505,0x3b30b705
.long 0x3bd9b23e,0x3b88b564,0x3b0eb78b,0x3a6db8c4,0x3b88b564,0x3b02b7b7,0x3a4fb8ec,0x3972b9dc
.long 0x3b0eb78b,0x3a4fb8ec,0x395fb9ed,0x3848bac2,0x3a6db8c4,0x3972b9dc,0x3848bac2,0x35f1bb6e
.long 0x3c00,0x3c00,0x3c00,0x3c00,0x323e3bd9,0x32a13bd4,0x33033bce,0x33653bc9
.long 0x361f3b64,0x367c3b50,0x36d73b3b,0x37323b25,0x38723aa7,0x38b03a7c,0x38ec3a4f,0x39273a1f
.long 0x39a839a8,0x39ed395f,0x3a2f3913,0x3a6d38c4,0x3aa73872,0x3ae93807,0x3b253732,0x3b5a364e
.long 0x3b64361f,0x3b993505,0x3bc333c6,0x3be23179,0x3bd9323e,0x3bf42f0e,0x3bff2648,0x3bfcabd9
.long 0x3c000000,0x3bf6ae46,0x3bd9b23e,0x3ba8b4a5,0x3bd9b23e,0x3ba0b4d5,0x3b50b67c,0x3ae9b807
.long 0x3b64b61f,0x3af6b7e3,0x3a6db8c4,0x39cbb984,0x3aa7b872,0x39feb94d,0x393aba0f,0x385dbab5
.long 0x39a8b9a8,0x38c4ba6d,0x378bbb0e,0x3564bb88,0x3872baa7,0x36aabb46,0x3444bbb6,0x2f0ebbf4
.long 0x361fbb64,0x3303bbce,0x2a48bbfe,0xafd6bbf1,0x323ebbd9,0x2248bc00,0xb179bbe2,0xb593bb80
.long 0x3c00,0x3c00,0x3c00,0x3c00,0x33c63bc3,0x34143bbc,0x34443bb6,0x34753baf
.long 0x378b3b0e,0x37e33af6,0x381d3add,0x38483ac2,0x395f39ed,0x399639ba,0x39cb3984,0x39fe394d
.long 0x3aa73872,0x3add381d,0x3b0e378b,0x3b3b36d7,0x3b883564,0x3baf3475,0x3bce3303,0x3be63115
.long 0x3bf62e46,0x3bff2648,0x3bfeaa48,0x3bf1afd6,0x3beab0b2,0x3bc9b365,0x3b99b505,0x3b5ab64e
.long 0x3b64b61f,0x3b0eb78b,0x3aa7b872,0x3a2fb913,0x3a6db8c4,0x39dcb972,0x393aba0f,0x3887ba99
.long 0x3913ba2f,0x3848bac2,0x36d7bb3b,0x3505bb99,0x36d7bb3b,0x34d5bba0,0x3179bbe2,0x28b6bbff
.long 0x323ebbd9,0x2a48bbfe,0xae46bbf6,0xb3c6bbc3,0xaa48bbfe,0xb2a1bbd4,0xb5c2bb77,0xb807bae9
.long 0xb4a5bba8,0xb732bb25,0xb8c4ba6d,0xb9cbb984,0xb81dbadd,0xb94db9fe,0xba4fb8ec,0xbb1ab75e
.long 0x3c00,0x3c00,0x3c00,0x3c00,0x34a53ba8,0x34d53ba0,0x35053b99,0x35343b91
.long 0x38723aa7,0x389b3a8a,0x38c43a6d,0x38ec3a4f,0x3a2f3913,0x3a5e38d8,0x3a8a389b,0x3ab5385d
.long 0x3b64361f,0x3b883564,0x3ba834a5,0x3bc333c6,0x3bf62e46,0x3bff28b6,0x3bffa648,0x3bf8ad7e
.long 0x3bd9b23e,0x3bb6b444,0x3b88b564,0x3b50b67c,0x3b0eb78b,0x3ab5b85d,0x3a4fb8ec,0x39dcb972
.long 0x39a8b9a8,0x3913ba2f,0x3872baa7,0x378bbb0e,0x378bbb0e,0x35f1bb6e,0x3444bbb6,0x3115bbe6
.long 0x323ebbd9,0x2cb5bbfa,0xaa48bbfe,0xb179bbe2,0xae46bbf6,0xb365bbc9,0xb5c2bb77,0xb7b7bb02
.long 0xb61fbb64,0xb81dbadd,0xb913ba2f,0xb9edb95f,0xb913ba2f,0xb9feb94d,0xbac2b848,0xbb5ab64e
.long 0xbaa7b872,0xbb50b67c,0xbbc3b3c6,0xbbfaacb5,0xbba8b4a5,0xbbf4af0e,0xbbfa2cb5,0xbbbc3414
.long 0x3c00,0x3c00,0x3c00,0x3c00,0x35643b88,0x35933b80,0x35c23b77,0x35f13b6e
.long 0x39133a2f,0x393a3a0f,0x395f39ed,0x398439cb,0x3add381d,0x3b0237b7,0x3b253732,0x3b4636aa
.long 0x3bd9323e,0x3bea30b2,0x3bf62e46,0x3bfe2a48,0x3beab0b2,0x3bd4b2a1,0x3bb6b444,0x3b91b534
.long 0x3b0eb78b,0x3ac2b848,0x3a6db8c4,0x3a0fb93a,0x395fb9ed,0x38d8ba5e,0x3848bac2,0x375ebb1a
.long 0x361fbb64,0x34a5bba8,0x323ebbd9,0x2e46bbf6,0x2a48bbfe,0xabd9bbfc,0xb179bbe2,0xb475bbaf
.long 0xb4a5bba8,0xb67cbb50,0xb81dbadd,0xb8ecba4f,0xb8c4ba6d,0xb996b9ba,0xba4fb8ec,0xbae9b807
.long 0xbaa7b872,0xbb3bb6d7,0xbba8b4a5,0xbbeab0b2,0xbbc3b3c6,0xbbf8ad7e,0xbbfa2cb5,0xbbc93365
.long 0xbbf62e46,0xbbb63444,0xbb3b36d7,0xba8a389b,0xbb3b36d7,0xba7c38b0,0xb98439cb,0xb85d3ab5
.long 0x3000,0x3000,0x3000,0x3000,0x3000,0x22462ff6,0x263e2fd9,0x28a52fa8
.long 0x3000,0x263e2fd9,0x2a1f2f64,0x2c722ea7,0x3000,0x28a52fa8,0x2c722ea7,0x2e2f2d13
.long 0x3000,0x2a1f2f64,0x2da82da8,0x2f642a1f,0x3000,0x2b8b2f0e,0x2ea72c72,0x2ff62246
.long 0x3000,0x2c722ea7,0x2f642a1f,0x2fd9a63e,0x3000,0x2d132e2f,0x2fd9263e,0x2f0eab8b
.long 0x3000,0x2da82da8,0x30000000,0x2da8ada8,0x3000,0x2e2f2d13,0x2fd9a63e,0x2b8baf0e
.long 0x3000,0x2ea72c72,0x2f64aa1f,0x263eafd9,0x3000,0x2f0e2b8b,0x2ea7ac72,0xa246aff6
.long 0x3000,0x2f642a1f,0x2da8ada8,0xaa1faf64,0x3000,0x2fa828a5,0x2c72aea7,0xad13ae2f
.long 0x3000,0x2fd9263e,0x2a1faf64,0xaea7ac72,0x3000,0x2ff62246,0x263eafd9,0xafa8a8a5
.long 0x3000,0x3000,0x3000,0x3000,0x2a1f2f64,0x2b8b2f0e,0x2c722ea7,0x2d132e2f
.long 0x2da82da8,0x2ea72c72,0x2f642a1f,0x2fd9263e,0x2f642a1f,0x2ff62246,0x2fd9a63e,0x2f0eab8b
.long 0x30000000,0x2f64aa1f,0x2da8ada8,0x2a1faf64,0x2f64aa1f,0x2d13ae2f,0x263eafd9,0xa8a5afa8
.long 0x2da8ada8,0x263eafd9,0xaa1faf64,0xaea7ac72,0x2a1faf64,0xa8a5afa8,0xaea7ac72,0xaff62246
.long 0xb000,0xada8ada8,0xb0008000,0xada82da8,0xaa1faf64,0xafa8a8a5,0xaea72c72,0xa2462ff6
.long 0xada8ada8,0xafd9263e,0xaa1f2f64,0x2c722ea7,0xaf64aa1f,0xae2f2d13,0x263e2fd9,0x2fa828a5
.long 0xb0008000,0xaa1f2f64,0x2da82da8,0x2f64aa1f,0xaf642a1f,0x22462ff6,0x2fd9263e,0x2b8baf0e
.long 0xada82da8,0x2c722ea7,0x2f64aa1f,0xa63eafd9,0xaa1f2f64,0x2f0e2b8b,0x2c72aea7,0xae2fad13
.long 0x3000,0x3000,0x3000,0x3000,0x2da82da8,0x2e2f2d13,0x2ea72c72,0x2f0e2b8b
.long 0x30000000,0x2fd9a63e,0x2f64aa1f,0x2ea7ac72,0x2da8ada8,0x2b8baf0e,0x263eafd9,0xa246aff6
.long 0xb000,0xaa1faf64,0xada8ada8,0xaf64aa1f,0xada8ada8,0xafa8a8a5,0xafd9263e,0xae2f2d13
.long 0xb0008000,0xaea72c72,0xaa1f2f64,0x263e2fd9,0xada82da8,0xa2462ff6,0x2c722ea7,0x2fa828a5
.long 0x3000,0x2da82da8,0x30000000,0x2da8ada8,0x2da82da8,0x2ff6a246,0x2c72aea7,0xa8a5afa8
.long 0x30000000,0x2c72aea7,0xaa1faf64,0xafd9a63e,0x2da8ada8,0xa8a5afa8,0xafd9a63e,0xad132e2f
.long 0xb000,0xaf64aa1f,0xada82da8,0x2a1f2f64,0xada8ada8,0xaf0e2b8b,0x263e2fd9,0x2ff62246
.long 0xb0008000,0xa63e2fd9,0x2f642a1f,0x2c72aea7,0xada82da8,0x2d132e2f,0x2ea7ac72,0xab8baf0e
.long 0x3000,0x3000,0x3000,0x3000,0x2f642a1f,0x2fa828a5,0x2fd9263e,0x2ff62246
.long 0x2da8ada8,0x2c72aea7,0x2a1faf64,0x263eafd9,0xaa1faf64,0xad13ae2f,0xaea7ac72,0xafa8a8a5
.long 0xb0008000,0xaf642a1f,0xada82da8,0xaa1f2f64,0xaa1f2f64,0x22462ff6,0x2c722ea7,0x2f0e2b8b
.long 0x2da82da8,0x2fd9263e,0x2f64aa1f,0x2c72aea7,0x2f64aa1f,0x2b8baf0e,0xa63eafd9,0xae2fad13
.long 0xb000,0xada8ada8,0xb0008000,0xada82da8,0xaf64aa1f,0xaf0e2b8b,0xa63e2fd9,0x2d132e2f
.long 0xada82da8,0x263e2fd9,0x2f642a1f,0x2ea7ac72,0x2a1f2f64,0x2ff62246,0x2c72aea7,0xab8baf0e
.long 0x30000000,0x2a1faf64,0xada8ada8,0xaf642a1f,0x2a1faf64,0xae2fad13,0xaea72c72,0x28a52fa8
.long 0xada8ada8,0xaea72c72,0x2a1f2f64,0x2fd9a63e,0xaf642a1f,0x28a52fa8,0x2fd9a63e,0xa246aff6
.long 0x3000,0x3000,0x3000,0x3000,0x30000000,0x2ff6a246,0x2fd9a63e,0x2fa8a8a5
.long 0xb000,0xa63eafd9,0xaa1faf64,0xac72aea7,0xb0008000,0xafa828a5,0xaea72c72,0xad132e2f
.long 0x3000,0x2a1f2f64,0x2da82da8,0x2f642a1f,0x30000000,0x2f0eab8b,0x2c72aea7,0x2246aff6
.long 0xb000,0xac72aea7,0xaf64aa1f,0xafd9263e,0xb0008000,0xae2f2d13,0xa63e2fd9,0x2b8b2f0e
.long 0x3000,0x2da82da8,0x30000000,0x2da8ada8,0x30000000,0x2d13ae2f,0xa63eafd9,0xaf0eab8b
.long 0xb000,0xaea7ac72,0xaf642a1f,0xa63e2fd9,0xb0008000,0xab8b2f0e,0x2c722ea7,0x2ff6a246
.long 0x3000,0x2f642a1f,0x2da8ada8,0xaa1faf64,0x30000000,0x28a5afa8,0xaea7ac72,0xae2f2d13
.long 0xb000,0xafd9a63e,0xaa1f2f64,0x2ea72c72,0xb0008000,0xa2462ff6,0x2fd9263e,0x28a5afa8
.long 0x3000,0x3000,0x3000,0x3000,0x2f64aa1f,0x2f0eab8b,0x2ea7ac72,0x2e2fad13
.long 0xada8ada8,0xaea7ac72,0xaf64aa1f,0xafd9a63e,0xaa1f2f64,0xa2462ff6,0x263e2fd9,0x2b8b2f0e
.long 0x30000000,0x2f64aa1f,0x2da8ada8,0x2a1faf64,0xaa1faf64,0xae2fad13,0xafd9a63e,0xafa828a5
.long 0xada82da8,0xa63e2fd9,0x2a1f2f64,0x2ea72c72,0x2f642a1f,0x2fa8a8a5,0x2c72aea7,0xa246aff6
.long 0xb000,0xada8ada8,0xb0008000,0xada82da8,0xaf642a1f,0xa8a52fa8,0x2c722ea7,0x2ff62246
.long 0x2da82da8,0x2fd9a63e,0x2a1faf64,0xac72aea7,0x2a1faf64,0xad13ae2f,0xafd9263e,0xa8a52fa8
.long 0xb0008000,0xaa1f2f64,0x2da82da8,0x2f64aa1f,0x2a1f2f64,0x2ff6a246,0x263eafd9,0xaf0eab8b
.long 0x2da8ada8,0xac72aea7,0xaf642a1f,0x263e2fd9,0xaf64aa1f,0xab8b2f0e,0x2ea72c72,0x2d13ae2f
.long 0x3000,0x3000,0x3000,0x3000,0x2da8ada8,0x2d13ae2f,0x2c72aea7,0x2b8baf0e
.long 0xb0008000,0xafd9263e,0xaf642a1f,0xaea72c72,0x2da82da8,0x2f0e2b8b,0x2fd9263e,0x2ff6a246
.long 0xb000,0xaa1faf64,0xada8ada8,0xaf64aa1f,0xada82da8,0xa8a52fa8,0x263e2fd9,0x2d132e2f
.long 0x30000000,0x2ea7ac72,0x2a1faf64,0xa63eafd9,0xada8ada8,0xaff6a246,0xaea72c72,0xa8a52fa8
.long 0x3000,0x2da82da8,0x30000000,0x2da8ada8,0x2da8ada8,0xa246aff6,0xaea7ac72,0xafa828a5
.long 0xb0008000,0xac722ea7,0x2a1f2f64,0x2fd9263e,0x2da82da8,0x2fa8a8a5,0x263eafd9,0xae2fad13
.long 0xb000,0xaf64aa1f,0xada82da8,0x2a1f2f64,0xada82da8,0x2b8b2f0e,0x2fd9a63e,0x2246aff6
.long 0x30000000,0x263eafd9,0xaf64aa1f,0xac722ea7,0xada8ada8,0xae2f2d13,0x2c722ea7,0x2f0eab8b
.long 0x3000,0x3000,0x3000,0x3000,0x2a1faf64,0x28a5afa8,0x263eafd9,0x2246aff6
.long 0xada82da8,0xac722ea7,0xaa1f2f64,0xa63e2fd9,0x2f64aa1f,0x2e2fad13,0x2c72aea7,0x28a5afa8
.long 0xb0008000,0xaf642a1f,0xada82da8,0xaa1f2f64,0x2f642a1f,0x2ff6a246,0x2ea7ac72,0x2b8baf0e
.long 0xada8ada8,0xafd9a63e,0xaf642a1f,0xac722ea7,0x2a1f2f64,0x2f0e2b8b,0x2fd9a63e,0x2d13ae2f
.long 0xb000,0xada8ada8,0xb0008000,0xada82da8,0xaa1f2f64,0x2b8b2f0e,0x2fd9263e,0x2e2fad13
.long 0x2da8ada8,0xa63eafd9,0xaf64aa1f,0xaea72c72,0xaf642a1f,0xa2462ff6,0x2ea72c72,0x2f0eab8b
.long 0x30000000,0x2a1faf64,0xada8ada8,0xaf642a1f,0xaf64aa1f,0xad132e2f,0x2c722ea7,0x2fa8a8a5
.long 0x2da82da8,0x2ea7ac72,0xaa1faf64,0xafd9263e,0xaa1faf64,0xafa828a5,0x263e2fd9,0x2ff6a246
.long 0x3000,0x3000,0x3000,0x3000,0xb000,0xa246aff6,0xa63eafd9,0xa8a5afa8
.long 0x3000,0x263e2fd9,0x2a1f2f64,0x2c722ea7,0xb000,0xa8a5afa8,0xac72aea7,0xae2fad13
.long 0x3000,0x2a1f2f64,0x2da82da8,0x2f642a1f,0xb000,0xab8baf0e,0xaea7ac72,0xaff6a246
.long 0x3000,0x2c722ea7,0x2f642a1f,0x2fd9a63e,0xb000,0xad13ae2f,0xafd9a63e,0xaf0e2b8b
.long 0x3000,0x2da82da8,0x30000000,0x2da8ada8,0xb000,0xae2fad13,0xafd9263e,0xab8b2f0e
.long 0x3000,0x2ea72c72,0x2f64aa1f,0x263eafd9,0xb000,0xaf0eab8b,0xaea72c72,0x22462ff6
.long 0x3000,0x2f642a1f,0x2da8ada8,0xaa1faf64,0xb000,0xafa8a8a5,0xac722ea7,0x2d132e2f
.long 0x3000,0x2fd9263e,0x2a1faf64,0xaea7ac72,0xb000,0xaff6a246,0xa63e2fd9,0x2fa828a5
.long 0x3000,0x3000,0x3000,0x3000,0xaa1faf64,0xab8baf0e,0xac72aea7,0xad13ae2f
.long 0x2da82da8,0x2ea72c72,0x2f642a1f,0x2fd9263e,0xaf64aa1f,0xaff6a246,0xafd9263e,0xaf0e2b8b
.long 0x30000000,0x2f64aa1f,0x2da8ada8,0x2a1faf64,0xaf642a1f,0xad132e2f,0xa63e2fd9,0x28a52fa8
.long 0x2da8ada8,0x263eafd9,0xaa1faf64,0xaea7ac72,0xaa1f2f64,0x28a52fa8,0x2ea72c72,0x2ff6a246
.long 0xb000,0xada8ada8,0xb0008000,0xada82da8,0x2a1f2f64,0x2fa828a5,0x2ea7ac72,0x2246aff6
.long 0xada8ada8,0xafd9263e,0xaa1f2f64,0x2c722ea7,0x2f642a1f,0x2e2fad13,0xa63eafd9,0xafa8a8a5
.long 0xb0008000,0xaa1f2f64,0x2da82da8,0x2f64aa1f,0x2f64aa1f,0xa246aff6,0xafd9a63e,0xab8b2f0e
.long 0xada82da8,0x2c722ea7,0x2f64aa1f,0xa63eafd9,0x2a1faf64,0xaf0eab8b,0xac722ea7,0x2e2f2d13
.long 0x3000,0x3000,0x3000,0x3000,0xada8ada8,0xae2fad13,0xaea7ac72,0xaf0eab8b
.long 0x30000000,0x2fd9a63e,0x2f64aa1f,0x2ea7ac72,0xada82da8,0xab8b2f0e,0xa63e2fd9,0x22462ff6
.long 0xb000,0xaa1faf64,0xada8ada8,0xaf64aa1f,0x2da82da8,0x2fa828a5,0x2fd9a63e,0x2e2fad13
.long 0xb0008000,0xaea72c72,0xaa1f2f64,0x263e2fd9,0x2da8ada8,0x2246aff6,0xac72aea7,0xafa8a8a5
.long 0x3000,0x2da82da8,0x30000000,0x2da8ada8,0xada8ada8,0xaff62246,0xac722ea7,0x28a52fa8
.long 0x30000000,0x2c72aea7,0xaa1faf64,0xafd9a63e,0xada82da8,0x28a52fa8,0x2fd9263e,0x2d13ae2f
.long 0xb000,0xaf64aa1f,0xada82da8,0x2a1f2f64,0x2da82da8,0x2f0eab8b,0xa63eafd9,0xaff6a246
.long 0xb0008000,0xa63e2fd9,0x2f642a1f,0x2c72aea7,0x2da8ada8,0xad13ae2f,0xaea72c72,0x2b8b2f0e
.long 0x3000,0x3000,0x3000,0x3000,0xaf64aa1f,0xafa8a8a5,0xafd9a63e,0xaff6a246
.long 0x2da8ada8,0x2c72aea7,0x2a1faf64,0x263eafd9,0x2a1f2f64,0x2d132e2f,0x2ea72c72,0x2fa828a5
.long 0xb0008000,0xaf642a1f,0xada82da8,0xaa1f2f64,0x2a1faf64,0xa246aff6,0xac72aea7,0xaf0eab8b
.long 0x2da82da8,0x2fd9263e,0x2f64aa1f,0x2c72aea7,0xaf642a1f,0xab8b2f0e,0x263e2fd9,0x2e2f2d13
.long 0xb000,0xada8ada8,0xb0008000,0xada82da8,0x2f642a1f,0x2f0eab8b,0x263eafd9,0xad13ae2f
.long 0xada82da8,0x263e2fd9,0x2f642a1f,0x2ea7ac72,0xaa1faf64,0xaff6a246,0xac722ea7,0x2b8b2f0e
.long 0x30000000,0x2a1faf64,0xada8ada8,0xaf642a1f,0xaa1f2f64,0x2e2f2d13,0x2ea7ac72,0xa8a5afa8
.long 0xada8ada8,0xaea72c72,0x2a1f2f64,0x2fd9a63e,0x2f64aa1f,0xa8a5afa8,0xafd9263e,0x22462ff6
.long 0x3000,0x3000,0x3000,0x3000,0xb0008000,0xaff62246,0xafd9263e,0xafa828a5
.long 0xb000,0xa63eafd9,0xaa1faf64,0xac72aea7,0x30000000,0x2fa8a8a5,0x2ea7ac72,0x2d13ae2f
.long 0x3000,0x2a1f2f64,0x2da82da8,0x2f642a1f,0xb0008000,0xaf0e2b8b,0xac722ea7,0xa2462ff6
.long 0xb000,0xac72aea7,0xaf64aa1f,0xafd9263e,0x30000000,0x2e2fad13,0x263eafd9,0xab8baf0e
.long 0x3000,0x2da82da8,0x30000000,0x2da8ada8,0xb0008000,0xad132e2f,0x263e2fd9,0x2f0e2b8b
.long 0xb000,0xaea7ac72,0xaf642a1f,0xa63e2fd9,0x30000000,0x2b8baf0e,0xac72aea7,0xaff62246
.long 0x3000,0x2f642a1f,0x2da8ada8,0xaa1faf64,0xb0008000,0xa8a52fa8,0x2ea72c72,0x2e2fad13
.long 0xb000,0xafd9a63e,0xaa1f2f64,0x2ea72c72,0x30000000,0x2246aff6,0xafd9a63e,0xa8a52fa8
.long 0x3000,0x3000,0x3000,0x3000,0xaf642a1f,0xaf0e2b8b,0xaea72c72,0xae2f2d13
.long 0xada8ada8,0xaea7ac72,0xaf64aa1f,0xafd9a63e,0x2a1faf64,0x2246aff6,0xa63eafd9,0xab8baf0e
.long 0x30000000,0x2f64aa1f,0x2da8ada8,0x2a1faf64,0x2a1f2f64,0x2e2f2d13,0x2fd9263e,0x2fa8a8a5
.long 0xada82da8,0xa63e2fd9,0x2a1f2f64,0x2ea72c72,0xaf64aa1f,0xafa828a5,0xac722ea7,0x22462ff6
.long 0xb000,0xada8ada8,0xb0008000,0xada82da8,0x2f64aa1f,0x28a5afa8,0xac72aea7,0xaff6a246
.long 0x2da82da8,0x2fd9a63e,0x2a1faf64,0xac72aea7,0xaa1f2f64,0x2d132e2f,0x2fd9a63e,0x28a5afa8
.long 0xb0008000,0xaa1f2f64,0x2da82da8,0x2f64aa1f,0xaa1faf64,0xaff62246,0xa63e2fd9,0x2f0e2b8b
.long 0x2da8ada8,0xac72aea7,0xaf642a1f,0x263e2fd9,0x2f642a1f,0x2b8baf0e,0xaea7ac72,0xad132e2f
.long 0x3000,0x3000,0x3000,0x3000,0xada82da8,0xad132e2f,0xac722ea7,0xab8b2f0e
.long 0xb0008000,0xafd9263e,0xaf642a1f,0xaea72c72,0xada8ada8,0xaf0eab8b,0xafd9a63e,0xaff62246
.long 0xb000,0xaa1faf64,0xada8ada8,0xaf64aa1f,0x2da8ada8,0x28a5afa8,0xa63eafd9,0xad13ae2f
.long 0x30000000,0x2ea7ac72,0x2a1faf64,0xa63eafd9,0x2da82da8,0x2ff62246,0x2ea7ac72,0x28a5afa8
.long 0x3000,0x2da82da8,0x30000000,0x2da8ada8,0xada82da8,0x22462ff6,0x2ea72c72,0x2fa8a8a5
.long 0xb0008000,0xac722ea7,0x2a1f2f64,0x2fd9263e,0xada8ada8,0xafa828a5,0xa63e2fd9,0x2e2f2d13
.long 0xb000,0xaf64aa1f,0xada82da8,0x2a1f2f64,0x2da8ada8,0xab8baf0e,0xafd9263e,0xa2462ff6
.long 0x30000000,0x263eafd9,0xaf64aa1f,0xac722ea7,0x2da82da8,0x2e2fad13,0xac72aea7,0xaf0e2b8b
.long 0x3000,0x3000,0x3000,0x3000,0xaa1f2f64,0xa8a52fa8,0xa63e2fd9,0xa2462ff6
.long 0xada82da8,0xac722ea7,0xaa1f2f64,0xa63e2fd9,0xaf642a1f,0xae2f2d13,0xac722ea7,0xa8a52fa8
.long 0xb0008000,0xaf642a1f,0xada82da8,0xaa1f2f64,0xaf64aa1f,0xaff62246,0xaea72c72,0xab8b2f0e
.long 0xada8ada8,0xafd9a63e,0xaf642a1f,0xac722ea7,0xaa1faf64,0xaf0eab8b,0xafd9263e,0xad132e2f
.long 0xb000,0xada8ada8,0xb0008000,0xada82da8,0x2a1faf64,0xab8baf0e,0xafd9a63e,0xae2f2d13
.long 0x2da8ada8,0xa63eafd9,0xaf64aa1f,0xaea72c72,0x2f64aa1f,0x2246aff6,0xaea7ac72,0xaf0e2b8b
.long 0x30000000,0x2a1faf64,0xada8ada8,0xaf642a1f,0x2f642a1f,0x2d13ae2f,0xac72aea7,0xafa828a5
.long 0x2da82da8,0x2ea7ac72,0xaa1faf64,0xafd9263e,0x2a1f2f64,0x2fa8a8a5,0xa63eafd9,0xaff62246
.long 0x30008000,0x30008000,0x30008000,0x30008000,0x30008000,0x2ff6a246,0x2fd9a63e,0x2fa8a8a5
.long 0x30008000,0x2fd9a63e,0x2f64aa1f,0x2ea7ac72,0x30008000,0x2fa8a8a5,0x2ea7ac72,0x2d13ae2f
.long 0x30008000,0x2f64aa1f,0x2da8ada8,0x2a1faf64,0x30008000,0x2f0eab8b,0x2c72aea7,0x2246aff6
.long 0x30008000,0x2ea7ac72,0x2a1faf64,0xa63eafd9,0x30008000,0x2e2fad13,0x263eafd9,0xab8baf0e
.long 0x30008000,0x2da8ada8,0xb000,0xada8ada8,0x30008000,0x2d13ae2f,0xa63eafd9,0xaf0eab8b
.long 0x30008000,0x2c72aea7,0xaa1faf64,0xafd9a63e,0x30008000,0x2b8baf0e,0xac72aea7,0xaff62246
.long 0x30008000,0x2a1faf64,0xada8ada8,0xaf642a1f,0x30008000,0x28a5afa8,0xaea7ac72,0xae2f2d13
.long 0x30008000,0x263eafd9,0xaf64aa1f,0xac722ea7,0x30008000,0x2246aff6,0xafd9a63e,0xa8a52fa8
.long 0x30008000,0x30008000,0x30008000,0x30008000,0x2f64aa1f,0x2f0eab8b,0x2ea7ac72,0x2e2fad13
.long 0x2da8ada8,0x2c72aea7,0x2a1faf64,0x263eafd9,0x2a1faf64,0x2246aff6,0xa63eafd9,0xab8baf0e
.long 0xb000,0xaa1faf64,0xada8ada8,0xaf64aa1f,0xaa1faf64,0xae2fad13,0xafd9a63e,0xafa828a5
.long 0xada8ada8,0xafd9a63e,0xaf642a1f,0xac722ea7,0xaf64aa1f,0xafa828a5,0xac722ea7,0x22462ff6
.long 0xb0008000,0xada82da8,0x80003000,0x2da82da8,0xaf642a1f,0xa8a52fa8,0x2c722ea7,0x2ff62246
.long 0xada82da8,0x263e2fd9,0x2f642a1f,0x2ea7ac72,0xaa1f2f64,0x2d132e2f,0x2fd9a63e,0x28a5afa8
.long 0x80003000,0x2f642a1f,0x2da8ada8,0xaa1faf64,0x2a1f2f64,0x2ff6a246,0x263eafd9,0xaf0eab8b
.long 0x2da82da8,0x2ea7ac72,0xaa1faf64,0xafd9263e,0x2f642a1f,0x2b8baf0e,0xaea7ac72,0xad132e2f
.long 0x30008000,0x30008000,0x30008000,0x30008000,0x2da8ada8,0x2d13ae2f,0x2c72aea7,0x2b8baf0e
.long 0xb000,0xa63eafd9,0xaa1faf64,0xac72aea7,0xada8ada8,0xaf0eab8b,0xafd9a63e,0xaff62246
.long 0xb0008000,0xaf642a1f,0xada82da8,0xaa1f2f64,0xada82da8,0xa8a52fa8,0x263e2fd9,0x2d132e2f
.long 0x80003000,0x2c722ea7,0x2f642a1f,0x2fd9a63e,0x2da82da8,0x2ff62246,0x2ea7ac72,0x28a5afa8
.long 0x30008000,0x2da8ada8,0xb000,0xada8ada8,0x2da8ada8,0xa246aff6,0xaea7ac72,0xafa828a5
.long 0xb000,0xaea7ac72,0xaf642a1f,0xa63e2fd9,0xada8ada8,0xafa828a5,0xa63e2fd9,0x2e2f2d13
.long 0xb0008000,0xaa1f2f64,0x2da82da8,0x2f64aa1f,0xada82da8,0x2b8b2f0e,0x2fd9a63e,0x2246aff6
.long 0x80003000,0x2fd9263e,0x2a1faf64,0xaea7ac72,0x2da82da8,0x2e2fad13,0xac72aea7,0xaf0e2b8b
.long 0x30008000,0x30008000,0x30008000,0x30008000,0x2a1faf64,0x28a5afa8,0x263eafd9,0x2246aff6
.long 0xada8ada8,0xaea7ac72,0xaf64aa1f,0xafd9a63e,0xaf642a1f,0xae2f2d13,0xac722ea7,0xa8a52fa8
.long 0x80003000,0x2a1f2f64,0x2da82da8,0x2f642a1f,0x2f642a1f,0x2ff6a246,0x2ea7ac72,0x2b8baf0e
.long 0x2da8ada8,0x263eafd9,0xaa1faf64,0xaea7ac72,0xaa1faf64,0xaf0eab8b,0xafd9263e,0xad132e2f
.long 0xb0008000,0xada82da8,0x80003000,0x2da82da8,0xaa1f2f64,0x2b8b2f0e,0x2fd9263e,0x2e2fad13
.long 0x2da82da8,0x2fd9a63e,0x2a1faf64,0xac72aea7,0x2f64aa1f,0x2246aff6,0xaea7ac72,0xaf0e2b8b
.long 0xb000,0xaf64aa1f,0xada82da8,0x2a1f2f64,0xaf64aa1f,0xad132e2f,0x2c722ea7,0x2fa8a8a5
.long 0xada82da8,0x2c722ea7,0x2f64aa1f,0xa63eafd9,0x2a1f2f64,0x2fa8a8a5,0xa63eafd9,0xaff62246
.long 0x30008000,0x30008000,0x30008000,0x30008000,0xb000,0xa246aff6,0xa63eafd9,0xa8a5afa8
.long 0xb0008000,0xafd9263e,0xaf642a1f,0xaea72c72,0x80003000,0x28a52fa8,0x2c722ea7,0x2e2f2d13
.long 0x30008000,0x2f64aa1f,0x2da8ada8,0x2a1faf64,0xb000,0xab8baf0e,0xaea7ac72,0xaff6a246
.long 0xb0008000,0xaea72c72,0xaa1f2f64,0x263e2fd9,0x80003000,0x2d132e2f,0x2fd9263e,0x2f0eab8b
.long 0x30008000,0x2da8ada8,0xb000,0xada8ada8,0xb000,0xae2fad13,0xafd9263e,0xab8b2f0e
.long 0xb0008000,0xac722ea7,0x2a1f2f64,0x2fd9263e,0x80003000,0x2f0e2b8b,0x2ea7ac72,0xa246aff6
.long 0x30008000,0x2a1faf64,0xada8ada8,0xaf642a1f,0xb000,0xafa8a8a5,0xac722ea7,0x2d132e2f
.long 0xb0008000,0xa63e2fd9,0x2f642a1f,0x2c72aea7,0x80003000,0x2ff62246,0x263eafd9,0xafa8a8a5
.long 0x30008000,0x30008000,0x30008000,0x30008000,0xaa1faf64,0xab8baf0e,0xac72aea7,0xad13ae2f
.long 0xada82da8,0xac722ea7,0xaa1f2f64,0xa63e2fd9,0x2f642a1f,0x2ff62246,0x2fd9a63e,0x2f0eab8b
.long 0xb000,0xaa1faf64,0xada8ada8,0xaf64aa1f,0xaf642a1f,0xad132e2f,0xa63e2fd9,0x28a52fa8
.long 0x2da82da8,0x2fd9263e,0x2f64aa1f,0x2c72aea7,0x2a1faf64,0xa8a5afa8,0xaea7ac72,0xaff62246
.long 0xb0008000,0xada82da8,0x80003000,0x2da82da8,0x2a1f2f64,0x2fa828a5,0x2ea7ac72,0x2246aff6
.long 0x2da8ada8,0xa63eafd9,0xaf64aa1f,0xaea72c72,0xaf64aa1f,0xae2f2d13,0x263e2fd9,0x2fa828a5
.long 0x80003000,0x2f642a1f,0x2da8ada8,0xaa1faf64,0x2f64aa1f,0xa246aff6,0xafd9a63e,0xab8b2f0e
.long 0xada8ada8,0xaea72c72,0x2a1f2f64,0x2fd9a63e,0xaa1f2f64,0x2f0e2b8b,0x2c72aea7,0xae2fad13
.long 0x30008000,0x30008000,0x30008000,0x30008000,0xada8ada8,0xae2fad13,0xaea7ac72,0xaf0eab8b
.long 0x80003000,0x263e2fd9,0x2a1f2f64,0x2c722ea7,0x2da8ada8,0x2b8baf0e,0x263eafd9,0xa246aff6
.long 0xb0008000,0xaf642a1f,0xada82da8,0xaa1f2f64,0x2da82da8,0x2fa828a5,0x2fd9a63e,0x2e2fad13
.long 0xb000,0xac72aea7,0xaf64aa1f,0xafd9263e,0xada82da8,0xa2462ff6,0x2c722ea7,0x2fa828a5
.long 0x30008000,0x2da8ada8,0xb000,0xada8ada8,0xada8ada8,0xaff62246,0xac722ea7,0x28a52fa8
.long 0x80003000,0x2ea72c72,0x2f64aa1f,0x263eafd9,0x2da8ada8,0xa8a5afa8,0xafd9a63e,0xad132e2f
.long 0xb0008000,0xaa1f2f64,0x2da82da8,0x2f64aa1f,0x2da82da8,0x2f0eab8b,0xa63eafd9,0xaff6a246
.long 0xb000,0xafd9a63e,0xaa1f2f64,0x2ea72c72,0xada82da8,0x2d132e2f,0x2ea7ac72,0xab8baf0e
.long 0x30008000,0x30008000,0x30008000,0x30008000,0xaf64aa1f,0xafa8a8a5,0xafd9a63e,0xaff6a246
.long 0x2da82da8,0x2ea72c72,0x2f642a1f,0x2fd9263e,0xaa1faf64,0xad13ae2f,0xaea7ac72,0xafa8a8a5
.long 0x80003000,0x2a1f2f64,0x2da82da8,0x2f642a1f,0x2a1faf64,0xa246aff6,0xac72aea7,0xaf0eab8b
.long 0xada82da8,0xa63e2fd9,0x2a1f2f64,0x2ea72c72,0x2f64aa1f,0x2b8baf0e,0xa63eafd9,0xae2fad13
.long 0xb0008000,0xada82da8,0x80003000,0x2da82da8,0x2f642a1f,0x2f0eab8b,0x263eafd9,0xad13ae2f
.long 0xada8ada8,0xafd9263e,0xaa1f2f64,0x2c722ea7,0x2a1f2f64,0x2ff62246,0x2c72aea7,0xab8baf0e
.long 0xb000,0xaf64aa1f,0xada82da8,0x2a1f2f64,0xaa1f2f64,0x2e2f2d13,0x2ea7ac72,0xa8a5afa8
.long 0x2da8ada8,0xac72aea7,0xaf642a1f,0x263e2fd9,0xaf642a1f,0x28a52fa8,0x2fd9a63e,0xa246aff6
.long 0x30008000,0x30008000,0x30008000,0x30008000,0xb0008000,0xaff62246,0xafd9263e,0xafa828a5
.long 0x30008000,0x2fd9a63e,0x2f64aa1f,0x2ea7ac72,0xb0008000,0xafa828a5,0xaea72c72,0xad132e2f
.long 0x30008000,0x2f64aa1f,0x2da8ada8,0x2a1faf64,0xb0008000,0xaf0e2b8b,0xac722ea7,0xa2462ff6
.long 0x30008000,0x2ea7ac72,0x2a1faf64,0xa63eafd9,0xb0008000,0xae2f2d13,0xa63e2fd9,0x2b8b2f0e
.long 0x30008000,0x2da8ada8,0xb000,0xada8ada8,0xb0008000,0xad132e2f,0x263e2fd9,0x2f0e2b8b
.long 0x30008000,0x2c72aea7,0xaa1faf64,0xafd9a63e,0xb0008000,0xab8b2f0e,0x2c722ea7,0x2ff6a246
.long 0x30008000,0x2a1faf64,0xada8ada8,0xaf642a1f,0xb0008000,0xa8a52fa8,0x2ea72c72,0x2e2fad13
.long 0x30008000,0x263eafd9,0xaf64aa1f,0xac722ea7,0xb0008000,0xa2462ff6,0x2fd9263e,0x28a5afa8
.long 0x30008000,0x30008000,0x30008000,0x30008000,0xaf642a1f,0xaf0e2b8b,0xaea72c72,0xae2f2d13
.long 0x2da8ada8,0x2c72aea7,0x2a1faf64,0x263eafd9,0xaa1f2f64,0xa2462ff6,0x263e2fd9,0x2b8b2f0e
.long 0xb000,0xaa1faf64,0xada8ada8,0xaf64aa1f,0x2a1f2f64,0x2e2f2d13,0x2fd9263e,0x2fa8a8a5
.long 0xada8ada8,0xafd9a63e,0xaf642a1f,0xac722ea7,0x2f642a1f,0x2fa8a8a5,0x2c72aea7,0xa246aff6
.long 0xb0008000,0xada82da8,0x80003000,0x2da82da8,0x2f64aa1f,0x28a5afa8,0xac72aea7,0xaff6a246
.long 0xada82da8,0x263e2fd9,0x2f642a1f,0x2ea7ac72,0x2a1faf64,0xad13ae2f,0xafd9263e,0xa8a52fa8
.long 0x80003000,0x2f642a1f,0x2da8ada8,0xaa1faf64,0xaa1faf64,0xaff62246,0xa63e2fd9,0x2f0e2b8b
.long 0x2da82da8,0x2ea7ac72,0xaa1faf64,0xafd9263e,0xaf64aa1f,0xab8b2f0e,0x2ea72c72,0x2d13ae2f
.long 0x30008000,0x30008000,0x30008000,0x30008000,0xada82da8,0xad132e2f,0xac722ea7,0xab8b2f0e
.long 0xb000,0xa63eafd9,0xaa1faf64,0xac72aea7,0x2da82da8,0x2f0e2b8b,0x2fd9263e,0x2ff6a246
.long 0xb0008000,0xaf642a1f,0xada82da8,0xaa1f2f64,0x2da8ada8,0x28a5afa8,0xa63eafd9,0xad13ae2f
.long 0x80003000,0x2c722ea7,0x2f642a1f,0x2fd9a63e,0xada8ada8,0xaff6a246,0xaea72c72,0xa8a52fa8
.long 0x30008000,0x2da8ada8,0xb000,0xada8ada8,0xada82da8,0x22462ff6,0x2ea72c72,0x2fa8a8a5
.long 0xb000,0xaea7ac72,0xaf642a1f,0xa63e2fd9,0x2da82da8,0x2fa8a8a5,0x263eafd9,0xae2fad13
.long 0xb0008000,0xaa1f2f64,0x2da82da8,0x2f64aa1f,0x2da8ada8,0xab8baf0e,0xafd9263e,0xa2462ff6
.long 0x80003000,0x2fd9263e,0x2a1faf64,0xaea7ac72,0xada8ada8,0xae2f2d13,0x2c722ea7,0x2f0eab8b
.long 0x30008000,0x30008000,0x30008000,0x30008000,0xaa1f2f64,0xa8a52fa8,0xa63e2fd9,0xa2462ff6
.long 0xada8ada8,0xaea7ac72,0xaf64aa1f,0xafd9a63e,0x2f64aa1f,0x2e2fad13,0x2c72aea7,0x28a5afa8
.long 0x80003000,0x2a1f2f64,0x2da82da8,0x2f642a1f,0xaf64aa1f,0xaff62246,0xaea72c72,0xab8b2f0e
.long 0x2da8ada8,0x263eafd9,0xaa1faf64,0xaea7ac72,0x2a1f2f64,0x2f0e2b8b,0x2fd9a63e,0x2d13ae2f
.long 0xb0008000,0xada82da8,0x80003000,0x2da82da8,0x2a1faf64,0xab8baf0e,0xafd9a63e,0xae2f2d13
.long 0x2da82da8,0x2fd9a63e,0x2a1faf64,0xac72aea7,0xaf642a1f,0xa2462ff6,0x2ea72c72,0x2f0eab8b
.long 0xb000,0xaf64aa1f,0xada82da8,0x2a1f2f64,0x2f642a1f,0x2d13ae2f,0xac72aea7,0xafa828a5
.long 0xada82da8,0x2c722ea7,0x2f64aa1f,0xa63eafd9,0xaa1faf64,0xafa828a5,0x263e2fd9,0x2ff6a246
.long 0x30008000,0x30008000,0x30008000,0x30008000,0x80003000,0x22462ff6,0x263e2fd9,0x28a52fa8
.long 0xb0008000,0xafd9263e,0xaf642a1f,0xaea72c72,0xb000,0xa8a5afa8,0xac72aea7,0xae2fad13
.long 0x30008000,0x2f64aa1f,0x2da8ada8,0x2a1faf64,0x80003000,0x2b8b2f0e,0x2ea72c72,0x2ff62246
.long 0xb0008000,0xaea72c72,0xaa1f2f64,0x263e2fd9,0xb000,0xad13ae2f,0xafd9a63e,0xaf0e2b8b
.long 0x30008000,0x2da8ada8,0xb000,0xada8ada8,0x80003000,0x2e2f2d13,0x2fd9a63e,0x2b8baf0e
.long 0xb0008000,0xac722ea7,0x2a1f2f64,0x2fd9263e,0xb000,0xaf0eab8b,0xaea72c72,0x22462ff6
.long 0x30008000,0x2a1faf64,0xada8ada8,0xaf642a1f,0x80003000,0x2fa828a5,0x2c72aea7,0xad13ae2f
.long 0xb0008000,0xa63e2fd9,0x2f642a1f,0x2c72aea7,0xb000,0xaff6a246,0xa63e2fd9,0x2fa828a5
.long 0x30008000,0x30008000,0x30008000,0x30008000,0x2a1f2f64,0x2b8b2f0e,0x2c722ea7,0x2d132e2f
.long 0xada82da8,0xac722ea7,0xaa1f2f64,0xa63e2fd9,0xaf64aa1f,0xaff6a246,0xafd9263e,0xaf0e2b8b
.long 0xb000,0xaa1faf64,0xada8ada8,0xaf64aa1f,0x2f64aa1f,0x2d13ae2f,0x263eafd9,0xa8a5afa8
.long 0x2da82da8,0x2fd9263e,0x2f64aa1f,0x2c72aea7,0xaa1f2f64,0x28a52fa8,0x2ea72c72,0x2ff6a246
.long 0xb0008000,0xada82da8,0x80003000,0x2da82da8,0xaa1faf64,0xafa8a8a5,0xaea72c72,0xa2462ff6
.long 0x2da8ada8,0xa63eafd9,0xaf64aa1f,0xaea72c72,0x2f642a1f,0x2e2fad13,0xa63eafd9,0xafa8a8a5
.long 0x80003000,0x2f642a1f,0x2da8ada8,0xaa1faf64,0xaf642a1f,0x22462ff6,0x2fd9263e,0x2b8baf0e
.long 0xada8ada8,0xaea72c72,0x2a1f2f64,0x2fd9a63e,0x2a1faf64,0xaf0eab8b,0xac722ea7,0x2e2f2d13
.long 0x30008000,0x30008000,0x30008000,0x30008000,0x2da82da8,0x2e2f2d13,0x2ea72c72,0x2f0e2b8b
.long 0x80003000,0x263e2fd9,0x2a1f2f64,0x2c722ea7,0xada82da8,0xab8b2f0e,0xa63e2fd9,0x22462ff6
.long 0xb0008000,0xaf642a1f,0xada82da8,0xaa1f2f64,0xada8ada8,0xafa8a8a5,0xafd9263e,0xae2f2d13
.long 0xb000,0xac72aea7,0xaf64aa1f,0xafd9263e,0x2da8ada8,0x2246aff6,0xac72aea7,0xafa8a8a5
.long 0x30008000,0x2da8ada8,0xb000,0xada8ada8,0x2da82da8,0x2ff6a246,0x2c72aea7,0xa8a5afa8
.long 0x80003000,0x2ea72c72,0x2f64aa1f,0x263eafd9,0xada82da8,0x28a52fa8,0x2fd9263e,0x2d13ae2f
.long 0xb0008000,0xaa1f2f64,0x2da82da8,0x2f64aa1f,0xada8ada8,0xaf0e2b8b,0x263e2fd9,0x2ff62246
.long 0xb000,0xafd9a63e,0xaa1f2f64,0x2ea72c72,0x2da8ada8,0xad13ae2f,0xaea72c72,0x2b8b2f0e
.long 0x30008000,0x30008000,0x30008000,0x30008000,0x2f642a1f,0x2fa828a5,0x2fd9263e,0x2ff62246
.long 0x2da82da8,0x2ea72c72,0x2f642a1f,0x2fd9263e,0x2a1f2f64,0x2d132e2f,0x2ea72c72,0x2fa828a5
.long 0x80003000,0x2a1f2f64,0x2da82da8,0x2f642a1f,0xaa1f2f64,0x22462ff6,0x2c722ea7,0x2f0e2b8b
.long 0xada82da8,0xa63e2fd9,0x2a1f2f64,0x2ea72c72,0xaf642a1f,0xab8b2f0e,0x263e2fd9,0x2e2f2d13
.long 0xb0008000,0xada82da8,0x80003000,0x2da82da8,0xaf64aa1f,0xaf0e2b8b,0xa63e2fd9,0x2d132e2f
.long 0xada8ada8,0xafd9263e,0xaa1f2f64,0x2c722ea7,0xaa1faf64,0xaff6a246,0xac722ea7,0x2b8b2f0e
.long 0xb000,0xaf64aa1f,0xada82da8,0x2a1f2f64,0x2a1faf64,0xae2fad13,0xaea72c72,0x28a52fa8
.long 0x2da8ada8,0xac72aea7,0xaf642a1f,0x263e2fd9,0x2f64aa1f,0xa8a5afa8,0xafd9263e,0x22462ff6
.long 0x80003c00,0x80003c00,0x80003c00,0x80003c00,0x80003c00,0x9a483c00,0x9e483c00,0xa0b63c00
.long 0x80003c00,0x9e483c00,0xa2483c00,0xa4b63c00,0x80003c00,0xa0b63c00,0xa4b63c00,0xa7113bff
.long 0x80003c00,0xa2483c00,0xa6483bff,0xa8b63bff,0x80003c00,0xa3db3c00,0xa7da3bff,0xa9e33bfe
.long 0x80003c00,0xa4b63c00,0xa8b63bff,0xab113bfd,0x80003c00,0xa57f3c00,0xa97f3bfe,0xac1f3bfc
.long 0x80003c00,0xa6483bff,0xaa483bfe,0xacb53bfa,0x80003c00,0xa7113bff,0xab113bfd,0xad4c3bf9
.long 0x80003c00,0xa7da3bff,0xabd93bfc,0xade23bf7,0x80003c00,0xa8523bff,0xac513bfb,0xae783bf6
.long 0x80003c00,0xa8b63bff,0xacb53bfa,0xaf0e3bf4,0x80003c00,0xa91b3bfe,0xad1a3bf9,0xafa43bf1
.long 0x80003c00,0xa97f3bfe,0xad7e3bf8,0xb01d3bef,0x80003c00,0xa9e33bfe,0xade23bf7,0xb0673bed
.long 0x80003c00,0x80003c00,0x80003c00,0x80003c00,0xa2483c00,0xa3db3c00,0xa4b63c00,0xa57f3c00
.long 0xa6483bff,0xa7da3bff,0xa8b63bff,0xa97f3bfe,0xa8b63bff,0xa9e33bfe,0xab113bfd,0xac1f3bfc
.long 0xaa483bfe,0xabd93bfc,0xacb53bfa,0xad7e3bf8,0xabd93bfc,0xace73bfa,0xade23bf7,0xaedc3bf4
.long 0xacb53bfa,0xade23bf7,0xaf0e3bf4,0xb01d3bef,0xad7e3bf8,0xaedc3bf4,0xb01d3bef,0xb0cb3be9
.long 0xae463bf6,0xafd63bf1,0xb0b23bea,0xb1793be2,0xaf0e3bf4,0xb0673bed,0xb1473be4,0xb2263bda
.long 0xafd63bf1,0xb0e43be8,0xb1db3bdd,0xb2d23bd1,0xb04e3bed,0xb1603be3,0xb26f3bd6,0xb37d3bc7
.long 0xb0b23bea,0xb1db3bdd,0xb3033bce,0xb4143bbc,0xb1153be6,0xb2573bd7,0xb3963bc6,0xb4693bb1
.long 0xb1793be2,0xb2d23bd1,0xb4143bbc,0xb4bd3ba4,0xb1db3bdd,0xb34c3bca,0xb45d3bb2,0xb5113b97
.long 0x80003c00,0x80003c00,0x80003c00,0x80003c00,0xa6483bff,0xa7113bff,0xa7da3bff,0xa8523bff
.long 0xaa483bfe,0xab113bfd,0xabd93bfc,0xac513bfb,0xacb53bfa,0xad4c3bf9,0xade23bf7,0xae783bf6
.long 0xae463bf6,0xaf0e3bf4,0xafd63bf1,0xb04e3bed,0xafd63bf1,0xb0673bed,0xb0e43be8,0xb1603be3
.long 0xb0b23bea,0xb1473be4,0xb1db3bdd,0xb26f3bd6,0xb1793be2,0xb2263bda,0xb2d23bd1,0xb37d3bc7
.long 0xb23e3bd9,0xb3033bce,0xb3c63bc3,0xb4443bb6,0xb3033bce,0xb3df3bc1,0xb45d3bb2,0xb4c93ba2
.long 0xb3c63bc3,0xb45d3bb2,0xb4d53ba0,0xb54c3b8c,0xb4443bb6,0xb4c93ba2,0xb54c3b8c,0xb5ce3b74
.long 0xb4a53ba8,0xb5343b91,0xb5c23b77,0xb64e3b5a,0xb5053b99,0xb59f3b7d,0xb6373b5f,0xb6cc3b3e
.long 0xb5643b88,0xb6083b69,0xb6aa3b46,0xb7483b20,0xb5c23b77,0xb6703b53,0xb71b3b2b,0xb7c23aff
.long 0x80003c00,0x80003c00,0x80003c00,0x80003c00,0xa8b63bff,0xa91b3bfe,0xa97f3bfe,0xa9e33bfe
.long 0xacb53bfa,0xad1a3bf9,0xad7e3bf8,0xade23bf7,0xaf0e3bf4,0xafa43bf1,0xb01d3bef,0xb0673bed
.long 0xb0b23bea,0xb1153be6,0xb1793be2,0xb1db3bdd,0xb1db3bdd,0xb2573bd7,0xb2d23bd1,0xb34c3bca
.long 0xb3033bce,0xb3963bc6,0xb4143bbc,0xb45d3bb2,0xb4143bbc,0xb4693bb1,0xb4bd3ba4,0xb5113b97
.long 0xb4a53ba8,0xb5053b99,0xb5643b88,0xb5c23b77,0xb5343b91,0xb59f3b7d,0xb6083b69,0xb6703b53
.long 0xb5c23b77,0xb6373b5f,0xb6aa3b46,0xb71b3b2b,0xb64e3b5a,0xb6cc3b3e,0xb7483b20,0xb7c23aff
.long 0xb6d73b3b,0xb75e3b1a,0xb7e33af6,0xb8323ad0,0xb75e3b1a,0xb7ee3af3,0xb83d3ac9,0xb8813a9c
.long 0xb7e33af6,0xb83d3ac9,0xb8873a99,0xb8ce3a65,0xb8323ad0,0xb8813a9c,0xb8ce3a65,0xb9183a2b
.long 0x80003c00,0x80003c00,0x80003c00,0x80003c00,0xaa483bfe,0xaaac3bfd,0xab113bfd,0xab753bfd
.long 0xae463bf6,0xaeaa3bf5,0xaf0e3bf4,0xaf723bf2,0xb0b23bea,0xb0fd3be7,0xb1473be4,0xb1913be1
.long 0xb23e3bd9,0xb2a13bd4,0xb3033bce,0xb3653bc9,0xb3c63bc3,0xb4203bbb,0xb45d3bb2,0xb4993baa
.long 0xb4a53ba8,0xb4ed3b9d,0xb5343b91,0xb57c3b84,0xb5643b88,0xb5b63b79,0xb6083b69,0xb6593b58
.long 0xb61f3b64,0xb67c3b50,0xb6d73b3b,0xb7323b25,0xb6d73b3b,0xb73d3b22,0xb7a13b08,0xb8023aed
.long 0xb78b3b0e,0xb7f93af0,0xb8323ad0,0xb8673aae,0xb81d3add,0xb8583ab8,0xb8913a92,0xb8c93a69
.long 0xb8723aa7,0xb8b03a7c,0xb8ec3a4f,0xb9273a1f,0xb8c43a6d,0xb9053a3b,0xb9433a07,0xb98039d0
.long 0xb9133a2f,0xb95639f6,0xb99639ba,0xb9d4397b,0xb95f39ed,0xb9a439ad,0xb9e53969,0xba233922
.long 0x80003c00,0x80003c00,0x80003c00,0x80003c00,0xabd93bfc,0xac1f3bfc,0xac513bfb,0xac833bfb
.long 0xafd63bf1,0xb01d3bef,0xb04e3bed,0xb0803bec,0xb1db3bdd,0xb2263bda,0xb26f3bd6,0xb2b93bd2
.long 0xb3c63bc3,0xb4143bbc,0xb4443bb6,0xb4753baf,0xb4d53ba0,0xb5113b97,0xb54c3b8c,0xb5873b82
.long 0xb5c23b77,0xb6083b69,0xb64e3b5a,0xb6933b4b,0xb6aa3b46,0xb6f93b33,0xb7483b20,0xb7963b0b
.long 0xb78b3b0e,0xb7e33af6,0xb81d3add,0xb8483ac2,0xb8323ad0,0xb8623ab1,0xb8913a92,0xb8bf3a71
.long 0xb89b3a8a,0xb8ce3a65,0xb9003a3f,0xb9303a17,0xb9003a3f,0xb9353a13,0xb96939e5,0xb99b39b5
.long 0xb95f39ed,0xb99639ba,0xb9cb3984,0xb9fe394d,0xb9ba3996,0xb9f2395b,0xba27391d,0xba5a38dd
.long 0xba0f393a,0xba4738f6,0xba7c38b0,0xbaae3867,0xba5e38d8,0xba95388c,0xbac9383d,0xbaf937d8
.long 0x80003c00,0x80003c00,0x80003c00,0x80003c00,0xacb53bfa,0xace73bfa,0xad1a3bf9,0xad4c3bf9
.long 0xb0b23bea,0xb0e43be8,0xb1153be6,0xb1473be4,0xb3033bce,0xb34c3bca,0xb3963bc6,0xb3df3bc1
.long 0xb4a53ba8,0xb4d53ba0,0xb5053b99,0xb5343b91,0xb5c23b77,0xb5fd3b6b,0xb6373b5f,0xb6703b53
.long 0xb6d73b3b,0xb71b3b2b,0xb75e3b1a,0xb7a13b08,0xb7e33af6,0xb8173ae0,0xb83d3ac9,0xb8623ab1
.long 0xb8723aa7,0xb89b3a8a,0xb8c43a6d,0xb8ec3a4f,0xb8ec3a4f,0xb9183a2b,0xb9433a07,0xb96d39e1
.long 0xb95f39ed,0xb98d39c3,0xb9ba3996,0xb9e53969,0xb9cb3984,0xb9fa3951,0xba27391d,0xba5238e7
.long 0xba2f3913,0xba5e38d8,0xba8a389b,0xbab5385d,0xba8a389b,0xbab83858,0xbae33812,0xbb0b3796
.long 0xbadd381d,0xbb0837a1,0xbb303705,0xbb553665,0xbb253732,0xbb4e3687,0xbb7235da,0xbb933529
.long 0x80003c00,0x80003c00,0x80003c00,0x80003c00,0xad7e3bf8,0xadb03bf8,0xade23bf7,0xae143bf7
.long 0xb1793be2,0xb1aa3be0,0xb1db3bdd,0xb20d3bdb,0xb4143bbc,0xb4383bb7,0xb45d3bb2,0xb4813bad
.long 0xb5643b88,0xb5933b80,0xb5c23b77,0xb5f13b6e,0xb6aa3b46,0xb6e33b39,0xb71b3b2b,0xb7533b1d
.long 0xb7e33af6,0xb8123ae3,0xb8323ad0,0xb8523abc,0xb8873a99,0xb8ab3a7f,0xb8ce3a65,0xb8f13a4b
.long 0xb9133a2f,0xb93a3a0f,0xb95f39ed,0xb98439cb,0xb99639ba,0xb9be3992,0xb9e53969,0xba0b393e
.long 0xba0f393a,0xba373909,0xba5e38d8,0xba8338a6,0xba7c38b0,0xbaa33877,0xbac9383d,0xbaed3802
.long 0xbadd381d,0xbb0237b7,0xbb253732,0xbb4636aa,0xbb303705,0xbb533670,0xbb7235da,0xbb8f3540
.long 0xbb7735c2,0xbb95351d,0xbbaf3475,0xbbc63396,0xbbaf3475,0xbbc7337d,0xbbdb320d,0xbbeb3099
.long 0x2fff3000,0x2ffa2ffe,0x2ff12ff6,0x2fe22fea,0x2ff13000,0x2f772fc3,0x2e8a2f0e,0x2d3a2ded
.long 0x2fce3000,0x2e4f2f3b,0x2b322d13,0x1a4827c6,0x2f993000,0x2c9b2e6d,0x9a4828a5,0xaceca964
.long 0x2f503000,0x29052d5f,0xabe3a246,0xafceae6d,0x2ef63000,0x1a482c1d,0xaec2ab8b,0xaf25affe
.long 0x2e8a3000,0xa8442964,0xaffaae2f,0xaa7caedd,0x2e0f3000,0xac4824b2,0xaf50afa8,0x2844aad7
.long 0x2d843000,0xae0f9e48,0xacecaff6,0x2e8a24b2,0x2cec3000,0xaf50a7c6,0xa579af0e,0x2ffa2d5f
.long 0x2c483000,0xaff1aad7,0x2905ad13,0x2dcb2fc3,0x2b323000,0xafe2acc4,0x2dcba8a5,0x23d62f88
.long 0x29c23000,0xaf25aded,0x2fb62246,0xac482cc4,0x28443000,0xadcbaedd,0x2fce2b8b,0xaf991e48
.long 0x25793000,0xabe3af88,0x2e0f2e2f,0xaf77ac1d,0x20b53000,0xa703afea,0x29c22fa8,0xabe3af3b
.long 0x2fce2fd9,0x2fb62fc3,0x2f992fa8,0x2f772f88,0x2b322c72,0x27032964,0x9a482246,0xa844a4b2
.long 0xaa7ca63e,0xae0facc4,0xafb6af0e,0xafe2affe,0xafb6aea7,0xaf77affe,0xac48ae2f,0x20b5a7c6
.long 0xae8aafd9,0xa3d6ac1d,0x2d3a28a5,0x2fff2f3b,0xa0b5ac72,0x2e8a2ad7,0x2f502ff6,0x23d62cc4
.long 0x2dcb263e,0x2f252fea,0xa3d62b8b,0xafcead5f,0x2ff12ea7,0x1a482d5f,0xafe2ad13,0xa905aedd
.long 0x2c482fd9,0xaef6a7c6,0xab32afa8,0x2f502964,0xa9052c72,0xaec2af88,0x2dcba246,0x2be32fea
.long 0xaf77a63e,0x20b5ae6d,0x2ef62f0e,0xae8a1e48,0xaef6aea7,0x2f501e48,0xa7032e2f,0xad3aafc3
.long 0xa579afd9,0x2e4f2edd,0xaffaa8a5,0x2d84aad7,0x2d3aac72,0xa5792f3b,0xa9c2aff6,0x2e4f2e6d
.long 0x2fff263e,0xaf9924b2,0x2e4fab8b,0xac482ded,0x2cec2ea7,0xadcbaded,0x2e8a2d13,0xaf25ac1d
.long 0x2f502f64,0x2f252f3b,0x2ef62f0e,0x2ec22edd,0xabe3aa1f,0xad84acc4,0xaec2ae2f,0xaf99af3b
.long 0xae8aaf64,0xabe3ad5f,0xa0b5a8a5,0x29c224b2,0x2d3a2a1f,0x2fce2edd,0x2f502ff6,0x2be32ded
.long 0x2d842f64,0xa0b52964,0xae4fab8b,0xafe2afc3,0xae4faa1f,0xaf77afea,0xa579ad13,0x2e0f2964
.long 0xac48af64,0x2cec1e48,0x2f992fa8,0x1a482cc4,0x2f252a1f,0x2c9b2fc3,0xadcba246,0xae4faffe
.long 0x29c22f64,0xaf99aad7,0xa844af0e,0x2fce2c1d,0xafb6aa1f,0x9a48ae6d,0x2fce2e2f,0xab322ad7
.long 0xa579af64,0x2fb62ded,0xad3a28a5,0xaa7cafea,0x2ffa2a1f,0xac482c1d,0xa9c2aff6,0x2fb62d5f
.long 0x9a482f64,0xad3aaf88,0x2ff12b8b,0xae8a27c6,0xaff1aa1f,0x2f50a4b2,0xac9b2d13,0x20b5af88
.long 0x2703af64,0x23d62ffe,0xab32afa8,0x2dcb2e6d,0x2f992a1f,0xafe2a7c6,0x2fff2246,0xaff11e48
.long 0x2e8a2ea7,0x2e4f2e6d,0x2e0f2e2f,0x2dcb2ded,0xaffaafd9,0xafe2affe,0xaf50afa8,0xae4faedd
.long 0x2dcb2c72,0x2f992edd,0x2ff12ff6,0x2ec22f88,0xa3d6263e,0xad84aad7,0xafe2af0e,0xaf25afea
.long 0xac48aea7,0x2844a4b2,0x2f252d13,0x2f772ffe,0x2f992fd9,0x27032d5f,0xadcba8a5,0xafb6afc3
.long 0xaf77ac72,0xad3aafc3,0x2be3a246,0x2fe22f3b,0x2be3a63e,0x2f772f88,0xa7032b8b,0xaffaae6d
.long 0x25792ea7,0xaff1acc4,0xa0b5ae2f,0x2fff2d5f,0xae0fafd9,0x2e8a1e48,0x29c22fa8,0xaff1ac1d
.long 0x2fff2c72,0xab322c1d,0xacecaff6,0x2fce2964,0xae4f263e,0x9a48af3b,0x2e8a2f0e,0xaf99a4b2
.long 0x2703aea7,0x2be32fea,0xaf99ad13,0x2f509e48,0x2b322fd9,0xaec2aded,0x2fff28a5,0xaef627c6
.long 0xaf50ac72,0x2ffa27c6,0xafb62246,0x2e8aaad7,0x2fb6a63e,0xaf502964,0x2ec2ab8b,0xae0f2cc4
.long 0x2d842da8,0x2d3a2d5f,0x2cec2d13,0x2c9b2cc4,0xacecada8,0xaa7cac1d,0xa579a8a5,0x20b59e48
.long 0x2c482da8,0x23d62964,0xa905a246,0xad84ac1d,0xab32ada8,0x2579a4b2,0x2dcb2b8b,0x2ff12f3b
.long 0x29c22da8,0xab329e48,0xafb6ae2f,0xaec2afea,0xa844ada8,0x2d8427c6,0x2fce2fa8,0x29052ded
.long 0x25792da8,0xaef6aad7,0xae0faff6,0x29c2a7c6,0xa0b5ada8,0x2fce2cc4,0x29c22f0e,0xaef6a964
.long 0x9a482da8,0xaffaaded,0x23d6ad13,0x2fe22e6d,0x23d6ada8,0x2f772edd,0xac9b28a5,0xad3aaffe
.long 0xa7032da8,0xae4faf88,0x2f252246,0x1a482edd,0x2905ada8,0x2c9b2fea,0xafffab8b,0x2cecaad7
.long 0xaa7c2da8,0xa905affe,0x2ef62e2f,0xafcea4b2,0x2be3ada8,0x1a482fc3,0xac48afa8,0x2f252d5f
.long 0xac9b2da8,0x2844af3b,0x20b52ff6,0xaa7cafc3,0x2d3aada8,0xac482e6d,0x2a7caf0e,0xa8442f88
.long 0x2c482c72,0x2be32c1d,0x2b322b8b,0x2a7c2ad7,0x2905263e,0x2c482ad7,0x2dcb2d13,0x2ef62e6d
.long 0xaf77aea7,0xaffaafea,0xaef6afa8,0xac9baded,0x2ef62fd9,0x2a7c2d5f,0xa7032246,0xae0fac1d
.long 0xa579ac72,0x2cec27c6,0x2ffa2f0e,0x2dcb2f88,0xad3aa63e,0xafe2af88,0xa9c2ae2f,0x2cec24b2
.long 0x2fff2ea7,0x29052e6d,0xae4fa8a5,0xaec2affe,0xacecafd9,0x2d841e48,0x2e8a2ff6,0xab3227c6
.long 0xa7032c72,0xafb6aedd,0x2905ab8b,0x2f772f3b,0x2f25263e,0x27032f3b,0xafffad13,0x2844acc4
.long 0xaf50aea7,0x2e0fa4b2,0x28442fa8,0xafe2ad5f,0x28442fd9,0xaf77aded,0x2ec2a246,0xa0b52edd
.long 0x2c9bac72,0x23d62fc3,0xae0faf0e,0x2fff2964,0xaffaa63e,0x2e8aa964,0xaa7c2e2f,0xa3d6afea
.long 0x2d842ea7,0xaf25acc4,0x2ff128a5,0xafce1e48,0x23d6afd9,0x1a482ffe,0xa579aff6,0x29052fc3
.long 0x29c22a1f,0x29052964,0x284428a5,0x270327c6,0x2fb62f64,0x2fff2fea,0x2fce2ff6,0x2f252f88
.long 0xa579aa1f,0x28441e48,0x2d3a2b8b,0x2f502e6d,0xaffaaf64,0xaec2afc3,0xa9c2ad13,0x28449e48
.long 0x9a482a1f,0xae0faad7,0xaff1afa8,0xac9baedd,0x2ff12f64,0x2a7c2e6d,0xac9ba246,0xaffaaf3b
.long 0x2703aa1f,0x2ff12ded,0x2b322f0e,0xad84a4b2,0xaf99af64,0x2579ac1d,0x2fff2e2f,0x23d62ded
.long 0xaa7c2a1f,0xaf25af88,0x2be3a8a5,0x2ec22fc3,0x2ef62f64,0xad8424b2,0xac48aff6,0x2f992964
.long 0x2c9baa1f,0x2be32ffe,0xaffaab8b,0x29c2acc4,0xae0faf64,0x2fce27c6,0xaa7c2d13,0xabe3affe
.long 0xadcb2a1f,0x20b5af3b,0x2cec2fa8,0xafe2ac1d,0x2cec2f64,0xaf77acc4,0x2fe22246,0xae0f2ad7
.long 0x2ec2aa1f,0xacec2d5f,0x2905af0e,0x1a482fea,0xab32af64,0x2c9b2edd,0xad84ae2f,0x2e4f2d5f
.long 0x2579263e,0x23d624b2,0x20b52246,0x1a481e48,0x2e0f2ea7,0x2c9b2d5f,0x29c22b8b,0x23d627c6
.long 0x2fff2fd9,0x2f252fc3,0x2cec2e2f,0x27032ad7,0x2e4f2c72,0x2fff2f88,0x2e8a2fa8,0x29052cc4
.long 0x2703a63e,0x2ef62cc4,0x2f992ff6,0x2a7c2ded,0xab32aea7,0x2c481e48,0x2fff2f0e,0x2be32edd
.long 0xaf50afd9,0x20b5ac1d,0x2fb62d13,0x2c9b2f88,0xafb6ac72,0xaa7caf3b,0x2ec228a5,0x2d3a2fea
.long 0xac9b263e,0xae4fafea,0x2d3aa246,0x2dcb2ffe,0x20b52ea7,0xafe2aded,0x2a7cab8b,0x2e4f2fc3
.long 0x2d842fd9,0xaf99a7c6,0x23d6ae2f,0x2ec22f3b,0x2ff12c72,0xad842964,0xa579afa8,0x2f252e6d
.long 0x2ec2a63e,0xa8442e6d,0xab32aff6,0x2f772d5f,0x2905aea7,0x27032ffe,0xad84af0e,0x2fb62c1d
.long 0xa9c2afd9,0x2d3a2edd,0xaef6ad13,0x2fe22964,0xaef6ac72,0x2f772ad7,0xafcea8a5,0x2ffa24b2
.long 0x9a488000,0xa0b59e48,0xa3d6a246,0xa579a4b2,0xa3d68000,0xa9c2a7c6,0xac9bab8b,0xae0fad5f
.long 0xa7038000,0xacecaad7,0xaf25ae2f,0xafffafc3,0xa9058000,0xae8aacc4,0xafffafa8,0xae4faf88
.long 0xaa7c8000,0xaf99aded,0xaef6aff6,0xa703acc4,0xabe38000,0xafffaedd,0xac48af0e,0x2b329e48
.long 0xac9b8000,0xafb6af88,0xa0b5ad13,0x2f502c1d,0xad3a8000,0xaec2afea,0x2a7ca8a5,0x2fb62f3b
.long 0xadcb8000,0xad3aaffe,0x2e4f2246,0x2c9b2fea,0xae4f8000,0xaa7cafc3,0x2fe22b8b,0xa0b52ded
.long 0xaec28000,0xa3d6af3b,0x2f992e2f,0xad8427c6,0xaf258000,0x2579ae6d,0x2d842fa8,0xaff1a964
.long 0xaf778000,0x2b32ad5f,0x28442ff6,0xaec2ae6d,0xafb68000,0x2d84ac1d,0xa7032f0e,0xa905affe
.long 0xafe28000,0x2ef6a964,0xad3a2d13,0x29c2aedd,0xaffa8000,0x2fcea4b2,0xaf7728a5,0x2ef6aad7
.long 0xa703a63e,0xa844a7c6,0xa905a8a5,0xa9c2a964,0xaf25aea7,0xafceaf88,0xafffaff6,0xafb6afea
.long 0xaf50afd9,0xad3aae6d,0xa844ab8b,0x25799e48,0xa844ac72,0x29c21e48,0x2ec22d13,0x2ffa2fc3
.long 0x2c9b263e,0x2ff12edd,0x2e0f2fa8,0x1a482ad7,0x2ffa2ea7,0x2c9b2f3b,0xaa7c2246,0xaff1ae6d
.long 0x2d842fd9,0xab3224b2,0xaff1af0e,0xa703aded,0xa3d62c72,0xafffaded,0xa579ae2f,0x2f992c1d
.long 0xaec2a63e,0xabe3afc3,0x2f2528a5,0x2a7c2f88,0xaf99aea7,0x2c48a964,0x2d842ff6,0xaef6a4b2
.long 0xa9c2afd9,0x2ffa2cc4,0xabe32b8b,0xac9baffe,0x2be3ac72,0x2a7c2ffe,0xafcead13,0x2e0fa7c6
.long 0x2fe2263e,0xacec2c1d,0xa0b5afa8,0x2dcb2f3b,0x2e0f2ea7,0xafe2aad7,0x2f77a246,0xacec2cc4
.long 0x9a482fd9,0xa905afea,0x2cec2f0e,0xaec2ad5f,0xae4f2c72,0x2d84ad5f,0xac9b2e2f,0x2b32aedd
.long 0xaa7caa1f,0xab32aad7,0xabe3ab8b,0xac48ac1d,0xaef6af64,0xadcbae6d,0xac48ad13,0xa905aad7
.long 0x2c9b2a1f,0x2ef62ded,0x2ffa2fa8,0x2f772fea,0x2e0f2f64,0x27032c1d,0xaa7ca246,0xaef6ad5f
.long 0xadcbaa1f,0xaffaaf88,0xacecaf0e,0x2579a7c6,0xacecaf64,0x29c2a4b2,0x2fe22e2f,0x2d3a2f88
.long 0x2ec22a1f,0x2e4f2ffe,0xa90528a5,0xafffae6d,0x2b322f64,0xae8aa7c6,0xad84aff6,0x2cec9e48
.long 0xaf77aa1f,0xa905af3b,0x2fb62b8b,0x27032edd,0xa844af64,0x2fff2cc4,0xa7032d13,0xaf25af3b
.long 0x2fe22a1f,0xa8442d5f,0xae0fafa8,0x2f5024b2,0x20b52f64,0xaec2aedd,0x2f772246,0xa8442ded
.long 0xafffaa1f,0x2e0fa964,0xa3d62f0e,0xac9bafc3,0x23d6af64,0x2a7c2fea,0xae8aae2f,0x2ffa2964
.long 0x2fce2a1f,0xaff19e48,0x2f25a8a5,0xad842cc4,0xa9052f64,0x2579afc3,0x9a482ff6,0xa3d6affe
.long 0xac9bac72,0xacecacc4,0xad3aad13,0xad84ad5f,0xa0b5a63e,0x25791e48,0x2a7c28a5,0x2cec2c1d
.long 0x2d842ea7,0x29052c1d,0xa3d62246,0xac48a964,0xaff1afd9,0xadcbaf3b,0xa579ab8b,0x2b3224b2
.long 0x2ec22c72,0x2fb62fea,0x2b322e2f,0xa9c21e48,0xa905263e,0xafceaded,0xad84afa8,0x2844a7c6
.long 0xa9c2aea7,0x2e0f27c6,0x2ef62ff6,0xa5792ad7,0x2ef62fd9,0xa9c22964,0xafceaf0e,0x20b5acc4
.long 0xafe2ac72,0xa3d6ae6d,0x2ffa2d13,0x1a482ded,0x2d3aa63e,0x2c9b2ffe,0xaf77a8a5,0xa3d6aedd
.long 0x9a482ea7,0xaf25aedd,0x2e4fa246,0x27032f88,0xacecafd9,0x2fff2ad7,0xac9b2b8b,0xa905afea
.long 0x2fce2c72,0xaef624b2,0x2905ae2f,0x2a7c2ffe,0xaf25263e,0x2c48ad5f,0x9a482fa8,0xabe3afc3
.long 0x2a7caea7,0xa0b52fc3,0xa844aff6,0x2c9b2f3b,0x28442fd9,0xaa7caf88,0x2c482f0e,0xad3aae6d
.long 0xadcbada8,0xae0faded,0xae4fae2f,0xae8aae6d,0x2e4f2da8,0x2f502edd,0x2fe22fa8,0x2ffa2ffe
.long 0xaec2ada8,0xaff1af88,0xaf99aff6,0xadcbaedd,0x2f252da8,0x2fe22fea,0x2d842f0e,0x23d62ad7
.long 0xaf77ada8,0xaf25affe,0xa844ad13,0x2c4824b2,0x2fb62da8,0x2dcb2fc3,0xa70328a5,0xaf99ad5f
.long 0xafe2ada8,0xabe3af3b,0x2d3a2246,0x2f772fc3,0x2ffa2da8,0x27032e6d,0xaf77ab8b,0xabe3af88
.long 0xafffada8,0x20b5ad5f,0x2ff12e2f,0xa5792cc4,0x2ff12da8,0xa9c22c1d,0xae8aafa8,0x2e0f9e48
.long 0xafceada8,0x2ceca964,0x2b322ff6,0xafffac1d,0x2f992da8,0xae8a24b2,0x1a48af0e,0x2e4f2f3b
.long 0xaf50ada8,0x2f991e48,0xabe32d13,0xa703afea,0x2ef62da8,0xafffa7c6,0x2ec2a8a5,0xab322ded
.long 0xae8aada8,0x2fb62ad7,0xaffaa246,0x2f50a7c6,0x2e0f2da8,0xaec2acc4,0x2f502b8b,0xafb6a964
.long 0xaec2aea7,0xaef6aedd,0xaf25af0e,0xaf50af3b,0x2f992fd9,0x2ec22f3b,0x2d842e2f,0x2be32cc4
.long 0xa9c2ac72,0x20b5a4b2,0x2be328a5,0x2e8a2d5f,0xabe3a63e,0xaf50aded,0xafceaff6,0xad3aaedd
.long 0x2fe22ea7,0x2e4f2fc3,0x20b52b8b,0xad84a964,0xae0fafd9,0x2579a964,0x2f772d13,0x2e4f2fea
.long 0x9a482c72,0xaf99acc4,0xacecafa8,0x2c489e48,0x2e4f263e,0x2dcb2ffe,0xac9b2246,0xaf25afc3
.long 0xafceaea7,0x2844ac1d,0x2f992f0e,0xa9c22ad7,0x2b322fd9,0xafceaad7,0x1a48ae2f,0x2fb62e6d
.long 0x2a7cac72,0x2d3a2fea,0xafb6a8a5,0x2579aded,0xafb6a63e,0x29c2ad5f,0x2c482ff6,0xaffaac1d
.long 0x2e8a2ea7,0xaff1a7c6,0x2d3aab8b,0x1a482f88,0xa0b5afd9,0x2c9b2f88,0xaf50ad13,0x2ff124b2
.long 0xadcb2c72,0x2b32ae6d,0xa3d62fa8,0xa703affe,0x2ff1263e,0xafff9e48,0x2fe2a246,0xaf9927c6
.long 0xaf77af64,0xaf99af88,0xafb6afa8,0xafceafc3,0x28442a1f,0x1a4824b2,0xa703a246,0xab32a964
.long 0x2fe22f64,0x2fb62ffe,0x2e0f2f0e,0x2a7c2cc4,0xa0b5aa1f,0x2c4827c6,0x2f772e2f,0x2fb62ffe
.long 0xafffaf64,0xad3aaf3b,0x23d6a8a5,0x2e8a2c1d,0xa3d62a1f,0xaf50acc4,0xae8aaff6,0x20b5aad7
.long 0x2fce2f64,0x23d62d5f,0xaf25ab8b,0xadcbafea,0x2905aa1f,0x2fe22edd,0x9a482d13,0xaff1ad5f
.long 0xaf50af64,0x2b32a964,0x2ef62fa8,0xac4827c6,0xabe32a1f,0xadcbafea,0x2ec22246,0x29052f88
.long 0x2e8a2f64,0xaef69e48,0xa0b5af0e,0x2f772e6d,0x2d3aaa1f,0x27032fc3,0xaf50ae2f,0x2ef69e48
.long 0xad84af64,0x2ffa2ad7,0xae4f28a5,0x2579aedd,0xae4f2a1f,0x29c2ae6d,0x25792ff6,0xad3aaf3b
.long 0x2c482f64,0xae4faded,0x2f992b8b,0xafffa4b2,0x2f25aa1f,0xae8a2c1d,0x2dcbad13,0xacec2ded
.long 0xafe2afd9,0xaff1afea,0xaffaaff6,0xafffaffe,0xad3aac72,0xae8aaded,0xaf77af0e,0xaff1afc3
.long 0x9a48263e,0xab32a7c6,0xae4fad13,0xafceaf3b,0x2cec2ea7,0x1a482964,0xac9ba8a5,0xaf99ae6d
.long 0x2fce2fd9,0x2be32e6d,0xa9052246,0xaf50ad5f,0x2f252c72,0x2ec22ffe,0x9a482b8b,0xaef6ac1d
.long 0x2a7ca63e,0x2ffa2edd,0x28442e2f,0xae8aa964,0xa844aea7,0x2f502ad7,0x2c482fa8,0xae0fa4b2
.long 0xae8aafd9,0x2ceca4b2,0x2e0f2ff6,0xad841e48,0xaffaac72,0x2579ad5f,0x2f502f0e,0xacec27c6
.long 0xadcb263e,0xa905afc3,0x2ff12d13,0xac482ad7,0xa3d62ea7,0xadcbaf88,0x2fe228a5,0xab322cc4
.long 0x2c482fd9,0xafb6acc4,0x2f25a246,0xa9c22ded,0x2f992c72,0xafce9e48,0x2dcbab8b,0xa8442edd
.long 0x2f77a63e,0xae0f2c1d,0x2be3ae2f,0xa5792f88,0x2be3aea7,0xa9c22f3b,0x2703afa8,0xa0b52fea
.long 0x3c00,0x3c00,0x3c00,0x3c00,0x26483bff,0x2fd63bf1,0x33033bce,0x35053b99
.long 0x2a483bfe,0x33c63bc3,0x36d73b3b,0x38c43a6d,0x2cb53bfa,0x35c23b77,0x38ec3a4f,0x3a8a389b
.long 0x2e463bf6,0x378b3b0e,0x3a2f3913,0x3ba834a5,0x2fd63bf1,0x389b3a8a,0x3b253732,0x3bffa648
.long 0x30b23bea,0x395f39ed,0x3bc333c6,0x3b88b564,0x31793be2,0x3a0f393a,0x3bff2648,0x3a4fb8ec
.long 0x323e3bd9,0x3aa73872,0x3bd9b23e,0x3872baa7,0x33033bce,0x3b253732,0x3b50b67c,0x3444bbb6
.long 0x33c63bc3,0x3b883564,0x3a6db8c4,0xaa48bbfe,0x34443bb6,0x3bce3303,0x393aba0f,0xb5c2bb77
.long 0x34a53ba8,0x3bf62e46,0x378bbb0e,0xb913ba2f,0x35053b99,0x3bffa648,0x3444bbb6,0xbac2b848
.long 0x35643b88,0x3beab0b2,0x2a48bbfe,0xbbc3b3c6,0x35c23b77,0x3bb6b444,0xb179bbe2,0xbbfa2cb5
.long 0x3c00,0x3c00,0x3c00,0x3c00,0x367c3b50,0x37e33af6,0x389b3a8a,0x393a3a0f
.long 0x39ed395f,0x3add381d,0x3b883564,0x3bea30b2,0x3b993505,0x3bff2648,0x3bb6b444,0x3ac2b848
.long 0x3bf6ae46,0x3b0eb78b,0x3913ba2f,0x34a5bba8,0x3af6b7e3,0x3848bac2,0x2cb5bbfa,0xb67cbb50
.long 0x38c4ba6d,0x2a48bbfe,0xb81dbadd,0xbb3bb6d7,0x3303bbce,0xb732bb25,0xbb50b67c,0xbbb63444
.long 0xb23ebbd9,0xbaa7b872,0xbbd9323e,0xb8723aa7,0xb89bba8a,0xbbfaacb5,0xb98439cb,0x2fd63bf1
.long 0xbaddb81d,0xbb3b36d7,0xb0b23bea,0x39ed395f,0xbbf1afd6,0xb89b3a8a,0x37323b25,0x3bff2648
.long 0xbba834a5,0xae463bf6,0x3b0e378b,0x3a2fb913,0xba0f393a,0x367c3b50,0x3bf1afd6,0x3179bbe2
.long 0xb6d73b3b,0x3a6d38c4,0x39edb95f,0xb81dbadd,0xa6483bff,0x3bf12fd6,0x3303bbce,0xbb99b505
.long 0x3c00,0x3c00,0x3c00,0x3c00,0x39cb3984,0x3a4f38ec,0x3ac23848,0x3b253732
.long 0x3bfeaa48,0x3bc3b3c6,0x3b3bb6d7,0x3a6db8c4,0x393aba0f,0x367cbb50,0x2fd6bbf1,0xb179bbe2
.long 0xae46bbf6,0xb78bbb0e,0xba2fb913,0xbba8b4a5,0xba4fb8ec,0xbbe2b179,0xbb993505,0xb98439cb
.long 0xbbea30b2,0xb9ed395f,0xb3c63bc3,0x35643b88,0xb89b3a8a,0x2cb53bfa,0x398439cb,0x3bf12fd6
.long 0x323e3bd9,0x3aa73872,0x3bd9b23e,0x3872baa7,0x3ac23848,0x3b99b505,0x35c2bb77,0xb7e3baf6
.long 0x3bc3b3c6,0x3564bb88,0xb8c4ba6d,0xbbfe2a48,0x37e3baf6,0xb848bac2,0xbbfa2cb5,0xb67c3b50
.long 0xb4a5bba8,0xbbf6ae46,0xb78b3b0e,0x39133a2f,0xbb25b732,0xb98439cb,0x37e33af6,0x3bceb303
.long 0xbb883564,0x30b23bea,0x3bfe2a48,0x33c6bbc3,0xb67c3b50,0x3af637e3,0x389bba8a,0xba0fb93a
.long 0x3c00,0x3c00,0x3c00,0x3c00,0x3b7735c2,0x3bb63444,0x3be23179,0x3bfa2cb5
.long 0x395fb9ed,0x381dbadd,0x3564bb88,0x30b2bbea,0xb732bb25,0xb984b9cb,0xbaf6b7e3,0xbbceb303
.long 0xbbf62e46,0xbb0e378b,0xb9133a2f,0xb4a53ba8,0xb4443bb6,0x33033bce,0x393a3a0f,0x3b7735c2
.long 0x3a6d38c4,0x3bfe2a48,0x3addb81d,0x36d7bb3b,0x3ac2b848,0x3505bb99,0xb5c2bb77,0xbaf6b7e3
.long 0xb23ebbd9,0xbaa7b872,0xbbd9323e,0xb8723aa7,0xbbe2b179,0xba0f393a,0x26483bff,0x3a4f38ec
.long 0xb81d3add,0x36d73b3b,0x3bea30b2,0x395fb9ed,0x38ec3a4f,0x3be2b179,0x3505bb99,0xb984b9cb
.long 0x3ba8b4a5,0x2e46bbf6,0xbb0eb78b,0xba2f3913,0x2cb5bbfa,0xbb77b5c2,0xb8ec3a4f,0x389b3a8a
.long 0xbb3bb6d7,0xb8c43a6d,0x395f39ed,0x3addb81d,0xb9cb3984,0x38ec3a4f,0x3ac2b848,0xb732bb25
.long 0x3c00,0x3c00,0x3c00,0x3c00,0x3bffa648,0x3bf1afd6,0x3bceb303,0x3b99b505
.long 0xaa48bbfe,0xb3c6bbc3,0xb6d7bb3b,0xb8c4ba6d,0xbbfa2cb5,0xbb7735c2,0xba4f38ec,0xb89b3a8a
.long 0x2e463bf6,0x378b3b0e,0x3a2f3913,0x3ba834a5,0x3bf1afd6,0x3a8ab89b,0x3732bb25,0xa648bbff
.long 0xb0b2bbea,0xb95fb9ed,0xbbc3b3c6,0xbb883564,0xbbe23179,0xb93a3a0f,0xa6483bff,0x38ec3a4f
.long 0x323e3bd9,0x3aa73872,0x3bd9b23e,0x3872baa7,0x3bceb303,0x3732bb25,0xb67cbb50,0xbbb6b444
.long 0xb3c6bbc3,0xbb88b564,0xba6d38c4,0x2a483bfe,0xbbb63444,0xb3033bce,0x3a0f393a,0x3b77b5c2
.long 0x34a53ba8,0x3bf62e46,0x378bbb0e,0xb913ba2f,0x3b99b505,0xa648bbff,0xbbb6b444,0xb8483ac2
.long 0xb564bb88,0xbbea30b2,0xaa483bfe,0x3bc333c6,0xbb7735c2,0x34443bb6,0x3be2b179,0xacb5bbfa
.long 0x3c00,0x3c00,0x3c00,0x3c00,0x3b50b67c,0x3af6b7e3,0x3a8ab89b,0x3a0fb93a
.long 0xb9edb95f,0xbaddb81d,0xbb88b564,0xbbeab0b2,0xb5053b99,0xa6483bff,0x34443bb6,0x38483ac2
.long 0x3bf6ae46,0x3b0eb78b,0x3913ba2f,0x34a5bba8,0xb7e3baf6,0xbac2b848,0xbbfaacb5,0xbb50367c
.long 0xb8c43a6d,0xaa483bfe,0x381d3add,0x3b3b36d7,0x3bce3303,0x3b25b732,0x367cbb50,0xb444bbb6
.long 0xb23ebbd9,0xbaa7b872,0xbbd9323e,0xb8723aa7,0xba8a389b,0xacb53bfa,0x39cb3984,0x3bf1afd6
.long 0x3add381d,0x3b3bb6d7,0x30b2bbea,0xb9edb95f,0x2fd6bbf1,0xba8ab89b,0xbb253732,0xa6483bff
.long 0xbba834a5,0xae463bf6,0x3b0e378b,0x3a2fb913,0x393a3a0f,0x3b50b67c,0xafd6bbf1,0xbbe2b179
.long 0x36d7bb3b,0xba6db8c4,0xb9ed395f,0x381d3add,0xbbffa648,0xafd63bf1,0x3bce3303,0x3505bb99
.long 0x3c00,0x3c00,0x3c00,0x3c00,0x3984b9cb,0x38ecba4f,0x3848bac2,0x3732bb25
.long 0xbbfe2a48,0xbbc333c6,0xbb3b36d7,0xba6d38c4,0x3a0f393a,0x3b50367c,0x3bf12fd6,0x3be2b179
.long 0xae46bbf6,0xb78bbb0e,0xba2fb913,0xbba8b4a5,0xb8ec3a4f,0xb1793be2,0x35053b99,0x39cb3984
.long 0x3beab0b2,0x39edb95f,0x33c6bbc3,0xb564bb88,0xba8ab89b,0xbbfa2cb5,0xb9cb3984,0xafd63bf1
.long 0x323e3bd9,0x3aa73872,0x3bd9b23e,0x3872baa7,0x3848bac2,0xb505bb99,0xbb77b5c2,0xbaf637e3
.long 0xbbc333c6,0xb5643b88,0x38c43a6d,0x3bfeaa48,0x3af637e3,0x3ac2b848,0xacb5bbfa,0xbb50b67c
.long 0xb4a5bba8,0xbbf6ae46,0xb78b3b0e,0x39133a2f,0xb7323b25,0x39cb3984,0x3af6b7e3,0xb303bbce
.long 0x3b88b564,0xb0b2bbea,0xbbfeaa48,0xb3c63bc3,0xbb50b67c,0xb7e33af6,0x3a8a389b,0x393aba0f
.long 0x3c00,0x3c00,0x3c00,0x3c00,0x35c2bb77,0x3444bbb6,0x3179bbe2,0x2cb5bbfa
.long 0xb95f39ed,0xb81d3add,0xb5643b88,0xb0b23bea,0x3b25b732,0x39cbb984,0x37e3baf6,0x3303bbce
.long 0xbbf62e46,0xbb0e378b,0xb9133a2f,0xb4a53ba8,0x3bb63444,0x3bceb303,0x3a0fb93a,0x35c2bb77
.long 0xba6db8c4,0xbbfeaa48,0xbadd381d,0xb6d73b3b,0x38483ac2,0x3b993505,0x3b77b5c2,0x37e3baf6
.long 0xb23ebbd9,0xbaa7b872,0xbbd9323e,0xb8723aa7,0xb1793be2,0x393a3a0f,0x3bffa648,0x38ecba4f
.long 0x381dbadd,0xb6d7bb3b,0xbbeab0b2,0xb95f39ed,0xba4f38ec,0x31793be2,0x3b993505,0x39cbb984
.long 0x3ba8b4a5,0x2e46bbf6,0xbb0eb78b,0xba2f3913,0xbbfaacb5,0xb5c23b77,0x3a4f38ec,0x3a8ab89b
.long 0x3b3b36d7,0x38c4ba6d,0xb95fb9ed,0xbadd381d,0xb984b9cb,0xba4f38ec,0x38483ac2,0x3b25b732
.long 0x3c00,0x3c00,0x3c00,0x3c00,0xa648bbff,0xafd6bbf1,0xb303bbce,0xb505bb99
.long 0x2a483bfe,0x33c63bc3,0x36d73b3b,0x38c43a6d,0xacb5bbfa,0xb5c2bb77,0xb8ecba4f,0xba8ab89b
.long 0x2e463bf6,0x378b3b0e,0x3a2f3913,0x3ba834a5,0xafd6bbf1,0xb89bba8a,0xbb25b732,0xbbff2648
.long 0x30b23bea,0x395f39ed,0x3bc333c6,0x3b88b564,0xb179bbe2,0xba0fb93a,0xbbffa648,0xba4f38ec
.long 0x323e3bd9,0x3aa73872,0x3bd9b23e,0x3872baa7,0xb303bbce,0xbb25b732,0xbb50367c,0xb4443bb6
.long 0x33c63bc3,0x3b883564,0x3a6db8c4,0xaa48bbfe,0xb444bbb6,0xbbceb303,0xb93a3a0f,0x35c23b77
.long 0x34a53ba8,0x3bf62e46,0x378bbb0e,0xb913ba2f,0xb505bb99,0xbbff2648,0xb4443bb6,0x3ac23848
.long 0x35643b88,0x3beab0b2,0x2a48bbfe,0xbbc3b3c6,0xb5c2bb77,0xbbb63444,0x31793be2,0x3bfaacb5
.long 0x3c00,0x3c00,0x3c00,0x3c00,0xb67cbb50,0xb7e3baf6,0xb89bba8a,0xb93aba0f
.long 0x39ed395f,0x3add381d,0x3b883564,0x3bea30b2,0xbb99b505,0xbbffa648,0xbbb63444,0xbac23848
.long 0x3bf6ae46,0x3b0eb78b,0x3913ba2f,0x34a5bba8,0xbaf637e3,0xb8483ac2,0xacb53bfa,0x367c3b50
.long 0x38c4ba6d,0x2a48bbfe,0xb81dbadd,0xbb3bb6d7,0xb3033bce,0x37323b25,0x3b50367c,0x3bb6b444
.long 0xb23ebbd9,0xbaa7b872,0xbbd9323e,0xb8723aa7,0x389b3a8a,0x3bfa2cb5,0x3984b9cb,0xafd6bbf1
.long 0xbaddb81d,0xbb3b36d7,0xb0b23bea,0x39ed395f,0x3bf12fd6,0x389bba8a,0xb732bb25,0xbbffa648
.long 0xbba834a5,0xae463bf6,0x3b0e378b,0x3a2fb913,0x3a0fb93a,0xb67cbb50,0xbbf12fd6,0xb1793be2
.long 0xb6d73b3b,0x3a6d38c4,0x39edb95f,0xb81dbadd,0x2648bbff,0xbbf1afd6,0xb3033bce,0x3b993505
.long 0x3c00,0x3c00,0x3c00,0x3c00,0xb9cbb984,0xba4fb8ec,0xbac2b848,0xbb25b732
.long 0x3bfeaa48,0x3bc3b3c6,0x3b3bb6d7,0x3a6db8c4,0xb93a3a0f,0xb67c3b50,0xafd63bf1,0x31793be2
.long 0xae46bbf6,0xb78bbb0e,0xba2fb913,0xbba8b4a5,0x3a4f38ec,0x3be23179,0x3b99b505,0x3984b9cb
.long 0xbbea30b2,0xb9ed395f,0xb3c63bc3,0x35643b88,0x389bba8a,0xacb5bbfa,0xb984b9cb,0xbbf1afd6
.long 0x323e3bd9,0x3aa73872,0x3bd9b23e,0x3872baa7,0xbac2b848,0xbb993505,0xb5c23b77,0x37e33af6
.long 0x3bc3b3c6,0x3564bb88,0xb8c4ba6d,0xbbfe2a48,0xb7e33af6,0x38483ac2,0x3bfaacb5,0x367cbb50
.long 0xb4a5bba8,0xbbf6ae46,0xb78b3b0e,0x39133a2f,0x3b253732,0x3984b9cb,0xb7e3baf6,0xbbce3303
.long 0xbb883564,0x30b23bea,0x3bfe2a48,0x33c6bbc3,0x367cbb50,0xbaf6b7e3,0xb89b3a8a,0x3a0f393a
.long 0x3c00,0x3c00,0x3c00,0x3c00,0xbb77b5c2,0xbbb6b444,0xbbe2b179,0xbbfaacb5
.long 0x395fb9ed,0x381dbadd,0x3564bb88,0x30b2bbea,0x37323b25,0x398439cb,0x3af637e3,0x3bce3303
.long 0xbbf62e46,0xbb0e378b,0xb9133a2f,0xb4a53ba8,0x3444bbb6,0xb303bbce,0xb93aba0f,0xbb77b5c2
.long 0x3a6d38c4,0x3bfe2a48,0x3addb81d,0x36d7bb3b,0xbac23848,0xb5053b99,0x35c23b77,0x3af637e3
.long 0xb23ebbd9,0xbaa7b872,0xbbd9323e,0xb8723aa7,0x3be23179,0x3a0fb93a,0xa648bbff,0xba4fb8ec
.long 0xb81d3add,0x36d73b3b,0x3bea30b2,0x395fb9ed,0xb8ecba4f,0xbbe23179,0xb5053b99,0x398439cb
.long 0x3ba8b4a5,0x2e46bbf6,0xbb0eb78b,0xba2f3913,0xacb53bfa,0x3b7735c2,0x38ecba4f,0xb89bba8a
.long 0xbb3bb6d7,0xb8c43a6d,0x395f39ed,0x3addb81d,0x39cbb984,0xb8ecba4f,0xbac23848,0x37323b25
.long 0x3c00,0x3c00,0x3c00,0x3c00,0xbbff2648,0xbbf12fd6,0xbbce3303,0xbb993505
.long 0xaa48bbfe,0xb3c6bbc3,0xb6d7bb3b,0xb8c4ba6d,0x3bfaacb5,0x3b77b5c2,0x3a4fb8ec,0x389bba8a
.long 0x2e463bf6,0x378b3b0e,0x3a2f3913,0x3ba834a5,0xbbf12fd6,0xba8a389b,0xb7323b25,0x26483bff
.long 0xb0b2bbea,0xb95fb9ed,0xbbc3b3c6,0xbb883564,0x3be2b179,0x393aba0f,0x2648bbff,0xb8ecba4f
.long 0x323e3bd9,0x3aa73872,0x3bd9b23e,0x3872baa7,0xbbce3303,0xb7323b25,0x367c3b50,0x3bb63444
.long 0xb3c6bbc3,0xbb88b564,0xba6d38c4,0x2a483bfe,0x3bb6b444,0x3303bbce,0xba0fb93a,0xbb7735c2
.long 0x34a53ba8,0x3bf62e46,0x378bbb0e,0xb913ba2f,0xbb993505,0x26483bff,0x3bb63444,0x3848bac2
.long 0xb564bb88,0xbbea30b2,0xaa483bfe,0x3bc333c6,0x3b77b5c2,0xb444bbb6,0xbbe23179,0x2cb53bfa
.long 0x3c00,0x3c00,0x3c00,0x3c00,0xbb50367c,0xbaf637e3,0xba8a389b,0xba0f393a
.long 0xb9edb95f,0xbaddb81d,0xbb88b564,0xbbeab0b2,0x3505bb99,0x2648bbff,0xb444bbb6,0xb848bac2
.long 0x3bf6ae46,0x3b0eb78b,0x3913ba2f,0x34a5bba8,0x37e33af6,0x3ac23848,0x3bfa2cb5,0x3b50b67c
.long 0xb8c43a6d,0xaa483bfe,0x381d3add,0x3b3b36d7,0xbbceb303,0xbb253732,0xb67c3b50,0x34443bb6
.long 0xb23ebbd9,0xbaa7b872,0xbbd9323e,0xb8723aa7,0x3a8ab89b,0x2cb5bbfa,0xb9cbb984,0xbbf12fd6
.long 0x3add381d,0x3b3bb6d7,0x30b2bbea,0xb9edb95f,0xafd63bf1,0x3a8a389b,0x3b25b732,0x2648bbff
.long 0xbba834a5,0xae463bf6,0x3b0e378b,0x3a2fb913,0xb93aba0f,0xbb50367c,0x2fd63bf1,0x3be23179
.long 0x36d7bb3b,0xba6db8c4,0xb9ed395f,0x381d3add,0x3bff2648,0x2fd6bbf1,0xbbceb303,0xb5053b99
.long 0x3c00,0x3c00,0x3c00,0x3c00,0xb98439cb,0xb8ec3a4f,0xb8483ac2,0xb7323b25
.long 0xbbfe2a48,0xbbc333c6,0xbb3b36d7,0xba6d38c4,0xba0fb93a,0xbb50b67c,0xbbf1afd6,0xbbe23179
.long 0xae46bbf6,0xb78bbb0e,0xba2fb913,0xbba8b4a5,0x38ecba4f,0x3179bbe2,0xb505bb99,0xb9cbb984
.long 0x3beab0b2,0x39edb95f,0x33c6bbc3,0xb564bb88,0x3a8a389b,0x3bfaacb5,0x39cbb984,0x2fd6bbf1
.long 0x323e3bd9,0x3aa73872,0x3bd9b23e,0x3872baa7,0xb8483ac2,0x35053b99,0x3b7735c2,0x3af6b7e3
.long 0xbbc333c6,0xb5643b88,0x38c43a6d,0x3bfeaa48,0xbaf6b7e3,0xbac23848,0x2cb53bfa,0x3b50367c
.long 0xb4a5bba8,0xbbf6ae46,0xb78b3b0e,0x39133a2f,0x3732bb25,0xb9cbb984,0xbaf637e3,0x33033bce
.long 0x3b88b564,0xb0b2bbea,0xbbfeaa48,0xb3c63bc3,0x3b50367c,0x37e3baf6,0xba8ab89b,0xb93a3a0f
.long 0x3c00,0x3c00,0x3c00,0x3c00,0xb5c23b77,0xb4443bb6,0xb1793be2,0xacb53bfa
.long 0xb95f39ed,0xb81d3add,0xb5643b88,0xb0b23bea,0xbb253732,0xb9cb3984,0xb7e33af6,0xb3033bce
.long 0xbbf62e46,0xbb0e378b,0xb9133a2f,0xb4a53ba8,0xbbb6b444,0xbbce3303,0xba0f393a,0xb5c23b77
.long 0xba6db8c4,0xbbfeaa48,0xbadd381d,0xb6d73b3b,0xb848bac2,0xbb99b505,0xbb7735c2,0xb7e33af6
.long 0xb23ebbd9,0xbaa7b872,0xbbd9323e,0xb8723aa7,0x3179bbe2,0xb93aba0f,0xbbff2648,0xb8ec3a4f
.long 0x381dbadd,0xb6d7bb3b,0xbbeab0b2,0xb95f39ed,0x3a4fb8ec,0xb179bbe2,0xbb99b505,0xb9cb3984
.long 0x3ba8b4a5,0x2e46bbf6,0xbb0eb78b,0xba2f3913,0x3bfa2cb5,0x35c2bb77,0xba4fb8ec,0xba8a389b
.long 0x3b3b36d7,0x38c4ba6d,0xb95fb9ed,0xbadd381d,0x398439cb,0x3a4fb8ec,0xb848bac2,0xbb253732
.long 0x80003c00,0x92483c00,0x96483c00,0x98b63c00,0x80003c00,0x9bdb3c00,0x9fdb3c00,0xa1e43c00
.long 0x80003c00,0x9f123c00,0xa3113c00,0xa54d3c00,0x80003c00,0xa11b3c00,0xa51b3c00,0xa7a83bff
.long 0x80003c00,0xa2ad3c00,0xa6ad3bff,0xa9013bfe,0x80003c00,0xa4203c00,0xa81f3bff,0xaa2f3bfe
.long 0x80003c00,0xa4e93c00,0xa8e83bfe,0xab5c3bfd,0x80003c00,0xa5b23bff,0xa9b13bfe,0xac443bfb
.long 0x80003c00,0xa67b3bff,0xaa7a3bfd,0xacdb3bfa,0x80003c00,0xa7443bff,0xab433bfd,0xad713bf9
.long 0x80003c00,0xa8063bff,0xac063bfc,0xae073bf7,0x80003c00,0xa86b3bff,0xac6a3bfb,0xae9d3bf5
.long 0x80003c00,0xa8cf3bff,0xacce3bfa,0xaf333bf3,0x80003c00,0xa9343bfe,0xad333bf9,0xafc93bf1
.long 0x80003c00,0xa9983bfe,0xad973bf8,0xb02f3bee,0x80003c00,0xa9fd3bfe,0xadfb3bf7,0xb07a3bec
.long 0x9a483c00,0x9bdb3c00,0x9cb63c00,0x9d7f3c00,0xa3db3c00,0xa4e93c00,0xa5e43bff,0xa6df3bff
.long 0xa7113bff,0xa86b3bff,0xa94d3bfe,0xaa2f3bfe,0xa91b3bfe,0xaa613bfd,0xaba73bfc,0xac773bfb
.long 0xaaac3bfd,0xac2b3bfc,0xad003bfa,0xadd53bf7,0xac1f3bfc,0xad263bf9,0xae2d3bf6,0xaf333bf3
.long 0xace73bfa,0xae203bf7,0xaf593bf2,0xb0483bee,0xadb03bf8,0xaf1a3bf3,0xb0423bee,0xb0f63be7
.long 0xae783bf6,0xb00a3bf0,0xb0d73be8,0xb1a43be0,0xaf403bf3,0xb0863beb,0xb16c3be2,0xb2513bd8
.long 0xb0043bf0,0xb1033be7,0xb2013bdc,0xb2fd3bcf,0xb0673bed,0xb17f3be2,0xb2943bd4,0xb3a83bc5
.long 0xb0cb3be9,0xb1fa3bdc,0xb3283bcc,0xb4293bba,0xb12e3be5,0xb2763bd6,0xb3ba3bc3,0xb47e3bae
.long 0xb1913be1,0xb2f03bcf,0xb4263bba,0xb4d23ba1,0xb1f43bdc,0xb36b3bc8,0xb46f3bb0,0xb5263b93
.long 0x9e483c00,0x9f123c00,0x9fdb3c00,0xa0523c00,0xa7da3bff,0xa86b3bff,0xa8e83bfe,0xa9663bfe
.long 0xab113bfd,0xabf23bfc,0xac6a3bfb,0xacdb3bfa,0xad1a3bf9,0xadbc3bf8,0xae5f3bf6,0xaf013bf4
.long 0xaeaa3bf5,0xaf7e3bf2,0xb0293bef,0xb0933beb,0xb01d3bef,0xb09f3beb,0xb1223be5,0xb1a43be0
.long 0xb0e43be8,0xb17f3be2,0xb2193bda,0xb2b33bd3,0xb1aa3be0,0xb25d3bd7,0xb30f3bce,0xb3c03bc3
.long 0xb26f3bd6,0xb33a3bcb,0xb4023bbf,0xb4663bb1,0xb3343bcb,0xb40b3bbe,0xb47b3bae,0xb4ea3b9d
.long 0xb3f73bc0,0xb4783baf,0xb4f33b9c,0xb56d3b87,0xb45d3bb2,0xb4e43b9e,0xb56a3b87,0xb5ee3b6e
.long 0xb4bd3ba4,0xb54f3b8c,0xb5df3b71,0xb66d3b53,0xb51d3b95,0xb5b93b78,0xb6543b59,0xb6eb3b37
.long 0xb57c3b84,0xb6223b64,0xb6c63b3f,0xb7673b18,0xb5da3b72,0xb68a3b4d,0xb7373b24,0xb7e03af7
.long 0xa0b63c00,0xa11b3c00,0xa17f3c00,0xa1e43c00,0xa9e33bfe,0xaa613bfd,0xaade3bfd,0xab5c3bfd
.long 0xad4c3bf9,0xadbc3bf8,0xae2d3bf6,0xae9d3bf5,0xafa43bf1,0xb0233bef,0xb0743bec,0xb0c53be9
.long 0xb0fd3be7,0xb1663be3,0xb1cf3bde,0xb2383bd9,0xb2263bda,0xb2a73bd3,0xb3283bcc,0xb3a83bc5
.long 0xb34c3bca,0xb3e53bc1,0xb43e3bb7,0xb48a3bac,0xb4383bb7,0xb4903bab,0xb4e73b9e,0xb53d3b8f
.long 0xb4c93ba2,0xb52c3b92,0xb58d3b81,0xb5ee3b6e,0xb5583b8a,0xb5c53b76,0xb6313b60,0xb69b3b49
.long 0xb5e53b70,0xb65c3b57,0xb6d23b3d,0xb7453b20,0xb6703b53,0xb6f13b35,0xb76f3b16,0xb7eb3af4
.long 0xb6f93b33,0xb7833b10,0xb8053aeb,0xb8463ac3,0xb7803b11,0xb8093ae9,0xb8503abd,0xb8953a8f
.long 0xb8023aed,0xb84e3abe,0xb8993a8c,0xb8e13a57,0xb8423ac6,0xb8923a91,0xb8e03a58,0xb92a3a1c
.long 0xa2483c00,0xa2ad3c00,0xa3113c00,0xa3763c00,0xabd93bfc,0xac2b3bfc,0xac6a3bfb,0xaca93bfb
.long 0xaf0e3bf4,0xaf7e3bf2,0xafef3bf0,0xb02f3bee,0xb1153be6,0xb1663be3,0xb1b63bdf,0xb2073bdb
.long 0xb2a13bd4,0xb3093bce,0xb3713bc8,0xb3d93bc1,0xb4143bbc,0xb4543bb4,0xb4933bab,0xb4d23ba1
.long 0xb4d53ba0,0xb5203b94,0xb56a3b87,0xb5b33b7a,0xb5933b80,0xb5e83b6f,0xb63c3b5e,0xb6903b4c
.long 0xb64e3b5a,0xb6ad3b45,0xb70a3b2f,0xb7673b18,0xb7053b30,0xb76c3b16,0xb7d23afb,0xb81c3add
.long 0xb7b73b02,0xb8133ae2,0xb84a3ac1,0xb8803a9d,0xb8323ad0,0xb86e3aa9,0xb8a83a81,0xb8e13a57
.long 0xb8873a99,0xb8c53a6c,0xb9023a3d,0xb93d3a0c,0xb8d83a5e,0xb9193a2a,0xb95839f4,0xb99539bb
.long 0xb9273a1f,0xb96a39e4,0xb9aa39a6,0xb9e83965,0xb97239dc,0xb9b7399a,0xb9f83954,0xba36390b
.long 0xa3db3c00,0xa4203c00,0xa4523c00,0xa4843c00,0xace73bfa,0xad263bf9,0xad653bf9,0xada33bf8
.long 0xb0673bed,0xb09f3beb,0xb0d73be8,0xb10f3be6,0xb2573bd7,0xb2a73bd3,0xb2f73bcf,0xb3463bca
.long 0xb4203bbb,0xb4543bb4,0xb4873bac,0xb4ba3ba5,0xb5113b97,0xb54f3b8c,0xb58d3b81,0xb5cb3b75
.long 0xb5fd3b6b,0xb6453b5c,0xb68d3b4c,0xb6d43b3c,0xb6e33b39,0xb7343b25,0xb7853b10,0xb7d53afa
.long 0xb7c23aff,0xb80e3ae5,0xb83a3acb,0xb8663aaf,0xb84d3abf,0xb87e3a9f,0xb8ad3a7e,0xb8dc3a5b
.long 0xb8b53a78,0xb8e83a51,0xb91b3a29,0xb94b39ff,0xb9183a2b,0xb94e39fd,0xb98239cd,0xb9b4399c
.long 0xb97639d8,0xb9ae39a3,0xb9e3396b,0xba163931,0xb9d03980,0xba083942,0xba3d3902,0xba7038c0
.long 0xba233922,0xba5b38dc,0xba903894,0xbac13849,0xba7138bf,0xbaa83871,0xbadb3820,0xbb0a3799
.long 0xa4b63c00,0xa4e93c00,0xa51b3c00,0xa54d3c00,0xade23bf7,0xae203bf7,0xae5f3bf6,0xae9d3bf5
.long 0xb1473be4,0xb17f3be2,0xb1b63bdf,0xb1ee3bdd,0xb3963bc6,0xb3e53bc1,0xb41a3bbc,0xb4413bb6
.long 0xb4ed3b9d,0xb5203b94,0xb5523b8b,0xb5843b82,0xb6083b69,0xb6453b5c,0xb6823b4f,0xb6be3b41
.long 0xb71b3b2b,0xb7613b19,0xb7a63b07,0xb7eb3af4,0xb8123ae3,0xb8393acb,0xb85f3ab3,0xb8853a9a
.long 0xb8913a92,0xb8bb3a73,0xb8e53a54,0xb90d3a34,0xb9093a37,0xb9363a12,0xb96239eb,0xb98c39c4
.long 0xb97b39d4,0xb9a939a7,0xb9d63979,0xba013949,0xb9e53969,0xba143934,0xba4138fd,0xba6c38c5
.long 0xba4738f6,0xba7538b9,0xbaa2387a,0xbacb3839,0xbaa0387c,0xbacd3836,0xbaf737dd,0xbb1f374b
.long 0xbaf037f9,0xbb1b375c,0xbb4236bb,0xbb663617,0xbb3636ee,0xbb5d363f,0xbb81358d,0xbba034d8
.long 0xa57f3c00,0xa5b23bff,0xa5e43bff,0xa6163bff,0xaedc3bf4,0xaf1a3bf3,0xaf593bf2,0xaf973bf2
.long 0xb2263bda,0xb25d3bd7,0xb2943bd4,0xb2cc3bd1,0xb4693bb1,0xb4903bab,0xb4b73ba5,0xb4de3b9f
.long 0xb5b63b79,0xb5e83b6f,0xb61a3b65,0xb64b3b5b,0xb6f93b33,0xb7343b25,0xb76f3b16,0xb7a93b06
.long 0xb8173ae0,0xb8393acb,0xb85a3ab6,0xb87b3aa1,0xb8ab3a7f,0xb8cf3a65,0xb8f33a49,0xb9173a2c
.long 0xb9353a13,0xb95c39f1,0xb98239cd,0xb9a739a9,0xb9b5399b,0xb9de3971,0xba043946,0xba2a3919
.long 0xba2b3918,0xba5338e6,0xba7a38b2,0xba9f387e,0xba95388c,0xbabc3851,0xbae13815,0xbb0437af
.long 0xbaf337ee,0xbb183767,0xbb3a36dd,0xbb5a3651,0xbb4336b5,0xbb65361d,0xbb833581,0xbb9e34e4
.long 0xbb863570,0xbba334c6,0xbbbc341a,0xbbd132d8,0xbbbb3420,0xbbd132cc,0xbbe33153,0xbbf12fb0
.long 0x3000,0x30000000,0xb000,0xb0008000,0x3000,0x2ff6a246,0xa63eafd9,0xafa828a5
.long 0x3000,0x2fd9a63e,0xaa1faf64,0xaea72c72,0x3000,0x2fa8a8a5,0xac72aea7,0xad132e2f
.long 0x3000,0x2f64aa1f,0xada8ada8,0xaa1f2f64,0x3000,0x2f0eab8b,0xaea7ac72,0xa2462ff6
.long 0x3000,0x2ea7ac72,0xaf64aa1f,0x263e2fd9,0x3000,0x2e2fad13,0xafd9a63e,0x2b8b2f0e
.long 0x3000,0x2da8ada8,0xb0008000,0x2da82da8,0x3000,0x2d13ae2f,0xafd9263e,0x2f0e2b8b
.long 0x3000,0x2c72aea7,0xaf642a1f,0x2fd9263e,0x3000,0x2b8baf0e,0xaea72c72,0x2ff6a246
.long 0x3000,0x2a1faf64,0xada82da8,0x2f64aa1f,0x3000,0x28a5afa8,0xac722ea7,0x2e2fad13
.long 0x3000,0x263eafd9,0xaa1f2f64,0x2c72aea7,0x3000,0x2246aff6,0xa63e2fd9,0x28a5afa8
.long 0x3000,0x30000000,0xb000,0xb0008000,0x2a1f2f64,0x2f0eab8b,0xac72aea7,0xae2f2d13
.long 0x2da82da8,0x2c72aea7,0xaf64aa1f,0xa63e2fd9,0x2f642a1f,0x2246aff6,0xafd9263e,0x2b8b2f0e
.long 0x30000000,0xaa1faf64,0xada82da8,0x2f642a1f,0x2f64aa1f,0xae2fad13,0xa63e2fd9,0x2fa8a8a5
.long 0x2da8ada8,0xafd9a63e,0x2a1f2f64,0x2c72aea7,0x2a1faf64,0xafa828a5,0x2ea72c72,0xa246aff6
.long 0xb000,0xada82da8,0x30000000,0xada8ada8,0xaa1faf64,0xa8a52fa8,0x2ea7ac72,0xaff6a246
.long 0xada8ada8,0x263e2fd9,0x2a1faf64,0xaea72c72,0xaf64aa1f,0x2d132e2f,0xa63eafd9,0xa8a52fa8
.long 0xb0008000,0x2f642a1f,0xada8ada8,0x2a1f2f64,0xaf642a1f,0x2ff6a246,0xafd9a63e,0x2f0e2b8b
.long 0xada82da8,0x2ea7ac72,0xaf642a1f,0x2fd9a63e,0xaa1f2f64,0x2b8baf0e,0xac722ea7,0x2d13ae2f
.long 0x3000,0x30000000,0xb000,0xb0008000,0x2da82da8,0x2d13ae2f,0xaea7ac72,0xab8b2f0e
.long 0x30000000,0xa63eafd9,0xaf642a1f,0x2c722ea7,0x2da8ada8,0xaf0eab8b,0xa63e2fd9,0x2ff6a246
.long 0xb000,0xaf642a1f,0x2da82da8,0x2a1faf64,0xada8ada8,0xa8a52fa8,0x2fd9a63e,0xad13ae2f
.long 0xb0008000,0x2c722ea7,0x2a1faf64,0xafd9263e,0xada82da8,0x2ff62246,0xac72aea7,0xa8a52fa8
.long 0x3000,0x2da8ada8,0xb0008000,0x2da82da8,0x2da82da8,0xa246aff6,0xac722ea7,0x2fa8a8a5
.long 0x30000000,0xaea7ac72,0x2a1f2f64,0x263eafd9,0x2da8ada8,0xafa828a5,0x2fd9263e,0xae2fad13
.long 0xb000,0xaa1f2f64,0x2da8ada8,0xaf642a1f,0xada8ada8,0x2b8b2f0e,0xa63eafd9,0xa2462ff6
.long 0xb0008000,0x2fd9263e,0xaf64aa1f,0x2ea72c72,0xada82da8,0x2e2fad13,0xaea72c72,0x2f0eab8b
.long 0x3000,0x30000000,0xb000,0xb0008000,0x2f642a1f,0x28a5afa8,0xafd9a63e,0xa2462ff6
.long 0x2da8ada8,0xaea7ac72,0xaa1f2f64,0x2fd9263e,0xaa1faf64,0xae2f2d13,0x2ea72c72,0x28a5afa8
.long 0xb0008000,0x2a1f2f64,0x2da8ada8,0xaf64aa1f,0xaa1f2f64,0x2ff6a246,0xac72aea7,0xab8b2f0e
.long 0x2da82da8,0x263eafd9,0xaf642a1f,0x2ea72c72,0x2f64aa1f,0xaf0eab8b,0x263e2fd9,0x2d13ae2f
.long 0xb000,0xada82da8,0x30000000,0xada8ada8,0xaf64aa1f,0x2b8b2f0e,0x263eafd9,0xae2f2d13
.long 0xada82da8,0x2fd9a63e,0xaf64aa1f,0x2c722ea7,0x2a1f2f64,0x2246aff6,0xac722ea7,0x2f0eab8b
.long 0x30000000,0xaf64aa1f,0x2da82da8,0xaa1faf64,0x2a1faf64,0xad132e2f,0x2ea7ac72,0xafa828a5
.long 0xada8ada8,0x2c722ea7,0xaa1faf64,0x263e2fd9,0xaf642a1f,0x2fa8a8a5,0xafd9263e,0x2ff6a246
.long 0x3000,0x30000000,0xb000,0xb0008000,0x30000000,0xa246aff6,0xafd9263e,0x28a52fa8
.long 0xb000,0xafd9263e,0x2a1f2f64,0x2ea7ac72,0xb0008000,0x28a52fa8,0x2ea7ac72,0xae2fad13
.long 0x3000,0x2f64aa1f,0xada8ada8,0xaa1f2f64,0x30000000,0xab8baf0e,0xac722ea7,0x2ff62246
.long 0xb000,0xaea72c72,0x2f642a1f,0xa63eafd9,0xb0008000,0x2d132e2f,0x263eafd9,0xaf0e2b8b
.long 0x3000,0x2da8ada8,0xb0008000,0x2da82da8,0x30000000,0xae2fad13,0x263e2fd9,0x2b8baf0e
.long 0xb000,0xac722ea7,0x2f64aa1f,0xafd9a63e,0xb0008000,0x2f0e2b8b,0xac72aea7,0x22462ff6
.long 0x3000,0x2a1faf64,0xada82da8,0x2f64aa1f,0x30000000,0xafa8a8a5,0x2ea72c72,0xad13ae2f
.long 0xb000,0xa63e2fd9,0x2a1faf64,0xac722ea7,0xb0008000,0x2ff62246,0xafd9a63e,0x2fa828a5
.long 0x3000,0x30000000,0xb000,0xb0008000,0x2f64aa1f,0xab8baf0e,0xaea72c72,0x2d132e2f
.long 0xada8ada8,0xac722ea7,0x2f642a1f,0x263eafd9,0xaa1f2f64,0x2ff62246,0xa63eafd9,0xaf0e2b8b
.long 0x30000000,0xaa1faf64,0xada82da8,0x2f642a1f,0xaa1faf64,0xad132e2f,0x2fd9263e,0xa8a5afa8
.long 0xada82da8,0x2fd9263e,0xaa1faf64,0xac722ea7,0x2f642a1f,0xa8a5afa8,0xac722ea7,0x2ff6a246
.long 0xb000,0xada82da8,0x30000000,0xada8ada8,0xaf642a1f,0x2fa828a5,0xac72aea7,0xa2462ff6
.long 0x2da82da8,0xa63eafd9,0xaa1f2f64,0x2ea7ac72,0x2a1faf64,0xae2f2d13,0x2fd9a63e,0xafa8a8a5
.long 0xb0008000,0x2f642a1f,0xada8ada8,0x2a1f2f64,0x2a1f2f64,0xa246aff6,0xa63e2fd9,0x2b8baf0e
.long 0x2da8ada8,0xaea72c72,0x2f64aa1f,0xafd9263e,0xaf64aa1f,0x2f0e2b8b,0xaea7ac72,0x2e2f2d13
.long 0x3000,0x30000000,0xb000,0xb0008000,0x2da8ada8,0xae2fad13,0xac722ea7,0x2f0e2b8b
.long 0xb0008000,0x263e2fd9,0x2f64aa1f,0xac72aea7,0x2da82da8,0x2b8baf0e,0xafd9a63e,0x22462ff6
.long 0xb000,0xaf642a1f,0x2da82da8,0x2a1faf64,0xada82da8,0x2fa828a5,0xa63eafd9,0xae2f2d13
.long 0x30000000,0xac72aea7,0xaa1f2f64,0x2fd9a63e,0xada8ada8,0xa2462ff6,0x2ea7ac72,0xafa8a8a5
.long 0x3000,0x2da8ada8,0xb0008000,0x2da82da8,0x2da8ada8,0xaff62246,0x2ea72c72,0xa8a5afa8
.long 0xb0008000,0x2ea72c72,0xaa1faf64,0xa63e2fd9,0x2da82da8,0xa8a5afa8,0xa63e2fd9,0x2d13ae2f
.long 0xb000,0xaa1f2f64,0x2da8ada8,0xaf642a1f,0xada82da8,0x2f0eab8b,0xafd9263e,0x2ff62246
.long 0x30000000,0xafd9a63e,0x2f642a1f,0xaea7ac72,0xada8ada8,0x2d132e2f,0xac72aea7,0x2b8b2f0e
.long 0x3000,0x30000000,0xb000,0xb0008000,0x2a1faf64,0xafa8a8a5,0xa63e2fd9,0x2ff62246
.long 0xada82da8,0x2ea72c72,0x2a1faf64,0xafd9a63e,0x2f64aa1f,0xad13ae2f,0xac722ea7,0x2fa828a5
.long 0xb0008000,0x2a1f2f64,0x2da8ada8,0xaf64aa1f,0x2f642a1f,0xa246aff6,0xaea72c72,0x2f0e2b8b
.long 0xada8ada8,0xa63e2fd9,0x2f64aa1f,0xaea7ac72,0x2a1f2f64,0x2b8baf0e,0xafd9263e,0x2e2f2d13
.long 0xb000,0xada82da8,0x30000000,0xada8ada8,0xaa1f2f64,0x2f0eab8b,0xafd9a63e,0x2d132e2f
.long 0x2da8ada8,0xafd9263e,0x2f642a1f,0xac72aea7,0xaf642a1f,0x2ff62246,0xaea7ac72,0x2b8b2f0e
.long 0x30000000,0xaf64aa1f,0x2da82da8,0xaa1faf64,0xaf64aa1f,0x2e2f2d13,0xac72aea7,0x28a52fa8
.long 0x2da82da8,0xac72aea7,0x2a1f2f64,0xa63eafd9,0xaa1faf64,0x28a52fa8,0xa63eafd9,0x22462ff6
.long 0x3000,0x30000000,0xb000,0xb0008000,0xb000,0xaff62246,0x263e2fd9,0x2fa8a8a5
.long 0x3000,0x2fd9a63e,0xaa1faf64,0xaea72c72,0xb000,0xafa828a5,0x2c722ea7,0x2d13ae2f
.long 0x3000,0x2f64aa1f,0xada8ada8,0xaa1f2f64,0xb000,0xaf0e2b8b,0x2ea72c72,0x2246aff6
.long 0x3000,0x2ea7ac72,0xaf64aa1f,0x263e2fd9,0xb000,0xae2f2d13,0x2fd9263e,0xab8baf0e
.long 0x3000,0x2da8ada8,0xb0008000,0x2da82da8,0xb000,0xad132e2f,0x2fd9a63e,0xaf0eab8b
.long 0x3000,0x2c72aea7,0xaf642a1f,0x2fd9263e,0xb000,0xab8b2f0e,0x2ea7ac72,0xaff62246
.long 0x3000,0x2a1faf64,0xada82da8,0x2f64aa1f,0xb000,0xa8a52fa8,0x2c72aea7,0xae2f2d13
.long 0x3000,0x263eafd9,0xaa1f2f64,0x2c72aea7,0xb000,0xa2462ff6,0x263eafd9,0xa8a52fa8
.long 0x3000,0x30000000,0xb000,0xb0008000,0xaa1faf64,0xaf0e2b8b,0x2c722ea7,0x2e2fad13
.long 0x2da82da8,0x2c72aea7,0xaf64aa1f,0xa63e2fd9,0xaf64aa1f,0xa2462ff6,0x2fd9a63e,0xab8baf0e
.long 0x30000000,0xaa1faf64,0xada82da8,0x2f642a1f,0xaf642a1f,0x2e2f2d13,0x263eafd9,0xafa828a5
.long 0x2da8ada8,0xafd9a63e,0x2a1f2f64,0x2c72aea7,0xaa1f2f64,0x2fa8a8a5,0xaea7ac72,0x22462ff6
.long 0xb000,0xada82da8,0x30000000,0xada8ada8,0x2a1f2f64,0x28a5afa8,0xaea72c72,0x2ff62246
.long 0xada8ada8,0x263e2fd9,0x2a1faf64,0xaea72c72,0x2f642a1f,0xad13ae2f,0x263e2fd9,0x28a5afa8
.long 0xb0008000,0x2f642a1f,0xada8ada8,0x2a1f2f64,0x2f64aa1f,0xaff62246,0x2fd9263e,0xaf0eab8b
.long 0xada82da8,0x2ea7ac72,0xaf642a1f,0x2fd9a63e,0x2a1faf64,0xab8b2f0e,0x2c72aea7,0xad132e2f
.long 0x3000,0x30000000,0xb000,0xb0008000,0xada8ada8,0xad132e2f,0x2ea72c72,0x2b8baf0e
.long 0x30000000,0xa63eafd9,0xaf642a1f,0x2c722ea7,0xada82da8,0x2f0e2b8b,0x263eafd9,0xaff62246
.long 0xb000,0xaf642a1f,0x2da82da8,0x2a1faf64,0x2da82da8,0x28a5afa8,0xafd9263e,0x2d132e2f
.long 0xb0008000,0x2c722ea7,0x2a1faf64,0xafd9263e,0x2da8ada8,0xaff6a246,0x2c722ea7,0x28a5afa8
.long 0x3000,0x2da8ada8,0xb0008000,0x2da82da8,0xada8ada8,0x22462ff6,0x2c72aea7,0xafa828a5
.long 0x30000000,0xaea7ac72,0x2a1f2f64,0x263eafd9,0xada82da8,0x2fa8a8a5,0xafd9a63e,0x2e2f2d13
.long 0xb000,0xaa1f2f64,0x2da8ada8,0xaf642a1f,0x2da82da8,0xab8baf0e,0x263e2fd9,0x2246aff6
.long 0xb0008000,0x2fd9263e,0xaf64aa1f,0x2ea72c72,0x2da8ada8,0xae2f2d13,0x2ea7ac72,0xaf0e2b8b
.long 0x3000,0x30000000,0xb000,0xb0008000,0xaf64aa1f,0xa8a52fa8,0x2fd9263e,0x2246aff6
.long 0x2da8ada8,0xaea7ac72,0xaa1f2f64,0x2fd9263e,0x2a1f2f64,0x2e2fad13,0xaea7ac72,0xa8a52fa8
.long 0xb0008000,0x2a1f2f64,0x2da8ada8,0xaf64aa1f,0x2a1faf64,0xaff62246,0x2c722ea7,0x2b8baf0e
.long 0x2da82da8,0x263eafd9,0xaf642a1f,0x2ea72c72,0xaf642a1f,0x2f0e2b8b,0xa63eafd9,0xad132e2f
.long 0xb000,0xada82da8,0x30000000,0xada8ada8,0x2f642a1f,0xab8baf0e,0xa63e2fd9,0x2e2fad13
.long 0xada82da8,0x2fd9a63e,0xaf64aa1f,0x2c722ea7,0xaa1faf64,0xa2462ff6,0x2c72aea7,0xaf0e2b8b
.long 0x30000000,0xaf64aa1f,0x2da82da8,0xaa1faf64,0xaa1f2f64,0x2d13ae2f,0xaea72c72,0x2fa8a8a5
.long 0xada8ada8,0x2c722ea7,0xaa1faf64,0x263e2fd9,0x2f64aa1f,0xafa828a5,0x2fd9a63e,0xaff62246
.long 0x3000,0x30000000,0xb000,0xb0008000,0xb0008000,0x22462ff6,0x2fd9a63e,0xa8a5afa8
.long 0xb000,0xafd9263e,0x2a1f2f64,0x2ea7ac72,0x30000000,0xa8a5afa8,0xaea72c72,0x2e2f2d13
.long 0x3000,0x2f64aa1f,0xada8ada8,0xaa1f2f64,0xb0008000,0x2b8b2f0e,0x2c72aea7,0xaff6a246
.long 0xb000,0xaea72c72,0x2f642a1f,0xa63eafd9,0x30000000,0xad13ae2f,0xa63e2fd9,0x2f0eab8b
.long 0x3000,0x2da8ada8,0xb0008000,0x2da82da8,0xb0008000,0x2e2f2d13,0xa63eafd9,0xab8b2f0e
.long 0xb000,0xac722ea7,0x2f64aa1f,0xafd9a63e,0x30000000,0xaf0eab8b,0x2c722ea7,0xa246aff6
.long 0x3000,0x2a1faf64,0xada82da8,0x2f64aa1f,0xb0008000,0x2fa828a5,0xaea7ac72,0x2d132e2f
.long 0xb000,0xa63e2fd9,0x2a1faf64,0xac722ea7,0x30000000,0xaff6a246,0x2fd9263e,0xafa8a8a5
.long 0x3000,0x30000000,0xb000,0xb0008000,0xaf642a1f,0x2b8b2f0e,0x2ea7ac72,0xad13ae2f
.long 0xada8ada8,0xac722ea7,0x2f642a1f,0x263eafd9,0x2a1faf64,0xaff6a246,0x263e2fd9,0x2f0eab8b
.long 0x30000000,0xaa1faf64,0xada82da8,0x2f642a1f,0x2a1f2f64,0x2d13ae2f,0xafd9a63e,0x28a52fa8
.long 0xada82da8,0x2fd9263e,0xaa1faf64,0xac722ea7,0xaf64aa1f,0x28a52fa8,0x2c72aea7,0xaff62246
.long 0xb000,0xada82da8,0x30000000,0xada8ada8,0x2f64aa1f,0xafa8a8a5,0x2c722ea7,0x2246aff6
.long 0x2da82da8,0xa63eafd9,0xaa1f2f64,0x2ea7ac72,0xaa1f2f64,0x2e2fad13,0xafd9263e,0x2fa828a5
.long 0xb0008000,0x2f642a1f,0xada8ada8,0x2a1f2f64,0xaa1faf64,0x22462ff6,0x263eafd9,0xab8b2f0e
.long 0x2da8ada8,0xaea72c72,0x2f64aa1f,0xafd9263e,0x2f642a1f,0xaf0eab8b,0x2ea72c72,0xae2fad13
.long 0x3000,0x30000000,0xb000,0xb0008000,0xada82da8,0x2e2f2d13,0x2c72aea7,0xaf0eab8b
.long 0xb0008000,0x263e2fd9,0x2f64aa1f,0xac72aea7,0xada8ada8,0xab8b2f0e,0x2fd9263e,0xa246aff6
.long 0xb000,0xaf642a1f,0x2da82da8,0x2a1faf64,0x2da8ada8,0xafa8a8a5,0x263e2fd9,0x2e2fad13
.long 0x30000000,0xac72aea7,0xaa1f2f64,0x2fd9a63e,0x2da82da8,0x2246aff6,0xaea72c72,0x2fa828a5
.long 0x3000,0x2da8ada8,0xb0008000,0x2da82da8,0xada82da8,0x2ff6a246,0xaea7ac72,0x28a52fa8
.long 0xb0008000,0x2ea72c72,0xaa1faf64,0xa63e2fd9,0xada8ada8,0x28a52fa8,0x263eafd9,0xad132e2f
.long 0xb000,0xaa1f2f64,0x2da8ada8,0xaf642a1f,0x2da8ada8,0xaf0e2b8b,0x2fd9a63e,0xaff6a246
.long 0x30000000,0xafd9a63e,0x2f642a1f,0xaea7ac72,0x2da82da8,0xad13ae2f,0x2c722ea7,0xab8baf0e
.long 0x3000,0x30000000,0xb000,0xb0008000,0xaa1f2f64,0x2fa828a5,0x263eafd9,0xaff6a246
.long 0xada82da8,0x2ea72c72,0x2a1faf64,0xafd9a63e,0xaf642a1f,0x2d132e2f,0x2c72aea7,0xafa8a8a5
.long 0xb0008000,0x2a1f2f64,0x2da8ada8,0xaf64aa1f,0xaf64aa1f,0x22462ff6,0x2ea7ac72,0xaf0eab8b
.long 0xada8ada8,0xa63e2fd9,0x2f64aa1f,0xaea7ac72,0xaa1faf64,0xab8b2f0e,0x2fd9a63e,0xae2fad13
.long 0xb000,0xada82da8,0x30000000,0xada8ada8,0x2a1faf64,0xaf0e2b8b,0x2fd9263e,0xad13ae2f
.long 0x2da8ada8,0xafd9263e,0x2f642a1f,0xac72aea7,0x2f64aa1f,0xaff6a246,0x2ea72c72,0xab8baf0e
.long 0x30000000,0xaf64aa1f,0x2da82da8,0xaa1faf64,0x2f642a1f,0xae2fad13,0x2c722ea7,0xa8a5afa8
.long 0x2da82da8,0xac72aea7,0x2a1f2f64,0xa63eafd9,0x2a1f2f64,0xa8a5afa8,0x263e2fd9,0xa246aff6
.long 0x30008000,0xb000,0xb0008000,0x80003000,0x30008000,0xa246aff6,0xafd9263e,0x28a52fa8
.long 0x30008000,0xa63eafd9,0xaf642a1f,0x2c722ea7,0x30008000,0xa8a5afa8,0xaea72c72,0x2e2f2d13
.long 0x30008000,0xaa1faf64,0xada82da8,0x2f642a1f,0x30008000,0xab8baf0e,0xac722ea7,0x2ff62246
.long 0x30008000,0xac72aea7,0xaa1f2f64,0x2fd9a63e,0x30008000,0xad13ae2f,0xa63e2fd9,0x2f0eab8b
.long 0x30008000,0xada8ada8,0x80003000,0x2da8ada8,0x30008000,0xae2fad13,0x263e2fd9,0x2b8baf0e
.long 0x30008000,0xaea7ac72,0x2a1f2f64,0x263eafd9,0x30008000,0xaf0eab8b,0x2c722ea7,0xa246aff6
.long 0x30008000,0xaf64aa1f,0x2da82da8,0xaa1faf64,0x30008000,0xafa8a8a5,0x2ea72c72,0xad13ae2f
.long 0x30008000,0xafd9a63e,0x2f642a1f,0xaea7ac72,0x30008000,0xaff6a246,0x2fd9263e,0xafa8a8a5
.long 0x30008000,0xb000,0xb0008000,0x80003000,0x2f64aa1f,0xab8baf0e,0xaea72c72,0x2d132e2f
.long 0x2da8ada8,0xaea7ac72,0xaa1f2f64,0x2fd9263e,0x2a1faf64,0xaff6a246,0x263e2fd9,0x2f0eab8b
.long 0xb000,0xaf642a1f,0x2da82da8,0x2a1faf64,0xaa1faf64,0xad132e2f,0x2fd9263e,0xa8a5afa8
.long 0xada8ada8,0xa63e2fd9,0x2f64aa1f,0xaea7ac72,0xaf64aa1f,0x28a52fa8,0x2c72aea7,0xaff62246
.long 0xb0008000,0x2da82da8,0xb000,0xada82da8,0xaf642a1f,0x2fa828a5,0xac72aea7,0xa2462ff6
.long 0xada82da8,0x2fd9a63e,0xaf64aa1f,0x2c722ea7,0xaa1f2f64,0x2e2fad13,0xafd9263e,0x2fa828a5
.long 0x80003000,0x2a1faf64,0xada82da8,0x2f64aa1f,0x2a1f2f64,0xa246aff6,0xa63e2fd9,0x2b8baf0e
.long 0x2da82da8,0xac72aea7,0x2a1f2f64,0xa63eafd9,0x2f642a1f,0xaf0eab8b,0x2ea72c72,0xae2fad13
.long 0x30008000,0xb000,0xb0008000,0x80003000,0x2da8ada8,0xae2fad13,0xac722ea7,0x2f0e2b8b
.long 0xb000,0xafd9263e,0x2a1f2f64,0x2ea7ac72,0xada8ada8,0xab8b2f0e,0x2fd9263e,0xa246aff6
.long 0xb0008000,0x2a1f2f64,0x2da8ada8,0xaf64aa1f,0xada82da8,0x2fa828a5,0xa63eafd9,0xae2f2d13
.long 0x80003000,0x2ea7ac72,0xaf64aa1f,0x263e2fd9,0x2da82da8,0x2246aff6,0xaea72c72,0x2fa828a5
.long 0x30008000,0xada8ada8,0x80003000,0x2da8ada8,0x2da8ada8,0xaff62246,0x2ea72c72,0xa8a5afa8
.long 0xb000,0xac722ea7,0x2f64aa1f,0xafd9a63e,0xada8ada8,0x28a52fa8,0x263eafd9,0xad132e2f
.long 0xb0008000,0x2f642a1f,0xada8ada8,0x2a1f2f64,0xada82da8,0x2f0eab8b,0xafd9263e,0x2ff62246
.long 0x80003000,0x263eafd9,0xaa1f2f64,0x2c72aea7,0x2da82da8,0xad13ae2f,0x2c722ea7,0xab8baf0e
.long 0x30008000,0xb000,0xb0008000,0x80003000,0x2a1faf64,0xafa8a8a5,0xa63e2fd9,0x2ff62246
.long 0xada8ada8,0xac722ea7,0x2f642a1f,0x263eafd9,0xaf642a1f,0x2d132e2f,0x2c72aea7,0xafa8a8a5
.long 0x80003000,0x2f64aa1f,0xada8ada8,0xaa1f2f64,0x2f642a1f,0xa246aff6,0xaea72c72,0x2f0e2b8b
.long 0x2da8ada8,0xafd9a63e,0x2a1f2f64,0x2c72aea7,0xaa1faf64,0xab8b2f0e,0x2fd9a63e,0xae2fad13
.long 0xb0008000,0x2da82da8,0xb000,0xada82da8,0xaa1f2f64,0x2f0eab8b,0xafd9a63e,0x2d132e2f
.long 0x2da82da8,0xa63eafd9,0xaa1f2f64,0x2ea7ac72,0x2f64aa1f,0xaff6a246,0x2ea72c72,0xab8baf0e
.long 0xb000,0xaa1f2f64,0x2da8ada8,0xaf642a1f,0xaf64aa1f,0x2e2f2d13,0xac72aea7,0x28a52fa8
.long 0xada82da8,0x2ea7ac72,0xaf642a1f,0x2fd9a63e,0x2a1f2f64,0xa8a5afa8,0x263e2fd9,0xa246aff6
.long 0x30008000,0xb000,0xb0008000,0x80003000,0xb000,0xaff62246,0x263e2fd9,0x2fa8a8a5
.long 0xb0008000,0x263e2fd9,0x2f64aa1f,0xac72aea7,0x80003000,0x2fa8a8a5,0xac72aea7,0xad132e2f
.long 0x30008000,0xaa1faf64,0xada82da8,0x2f642a1f,0xb000,0xaf0e2b8b,0x2ea72c72,0x2246aff6
.long 0xb0008000,0x2c722ea7,0x2a1faf64,0xafd9263e,0x80003000,0x2e2fad13,0xafd9a63e,0x2b8b2f0e
.long 0x30008000,0xada8ada8,0x80003000,0x2da8ada8,0xb000,0xad132e2f,0x2fd9a63e,0xaf0eab8b
.long 0xb0008000,0x2ea72c72,0xaa1faf64,0xa63e2fd9,0x80003000,0x2b8baf0e,0xaea72c72,0x2ff6a246
.long 0x30008000,0xaf64aa1f,0x2da82da8,0xaa1faf64,0xb000,0xa8a52fa8,0x2c72aea7,0xae2f2d13
.long 0xb0008000,0x2fd9263e,0xaf64aa1f,0x2ea72c72,0x80003000,0x2246aff6,0xa63e2fd9,0x28a5afa8
.long 0x30008000,0xb000,0xb0008000,0x80003000,0xaa1faf64,0xaf0e2b8b,0x2c722ea7,0x2e2fad13
.long 0xada82da8,0x2ea72c72,0x2a1faf64,0xafd9a63e,0x2f642a1f,0x2246aff6,0xafd9263e,0x2b8b2f0e
.long 0xb000,0xaf642a1f,0x2da82da8,0x2a1faf64,0xaf642a1f,0x2e2f2d13,0x263eafd9,0xafa828a5
.long 0x2da82da8,0x263eafd9,0xaf642a1f,0x2ea72c72,0x2a1faf64,0xafa828a5,0x2ea72c72,0xa246aff6
.long 0xb0008000,0x2da82da8,0xb000,0xada82da8,0x2a1f2f64,0x28a5afa8,0xaea72c72,0x2ff62246
.long 0x2da8ada8,0xafd9263e,0x2f642a1f,0xac72aea7,0xaf64aa1f,0x2d132e2f,0xa63eafd9,0xa8a52fa8
.long 0x80003000,0x2a1faf64,0xada82da8,0x2f64aa1f,0x2f64aa1f,0xaff62246,0x2fd9263e,0xaf0eab8b
.long 0xada8ada8,0x2c722ea7,0xaa1faf64,0x263e2fd9,0xaa1f2f64,0x2b8baf0e,0xac722ea7,0x2d13ae2f
.long 0x30008000,0xb000,0xb0008000,0x80003000,0xada8ada8,0xad132e2f,0x2ea72c72,0x2b8baf0e
.long 0x80003000,0x2fd9a63e,0xaa1faf64,0xaea72c72,0x2da8ada8,0xaf0eab8b,0xa63e2fd9,0x2ff6a246
.long 0xb0008000,0x2a1f2f64,0x2da8ada8,0xaf64aa1f,0x2da82da8,0x28a5afa8,0xafd9263e,0x2d132e2f
.long 0xb000,0xaea72c72,0x2f642a1f,0xa63eafd9,0xada82da8,0x2ff62246,0xac72aea7,0xa8a52fa8
.long 0x30008000,0xada8ada8,0x80003000,0x2da8ada8,0xada8ada8,0x22462ff6,0x2c72aea7,0xafa828a5
.long 0x80003000,0x2c72aea7,0xaf642a1f,0x2fd9263e,0x2da8ada8,0xafa828a5,0x2fd9263e,0xae2fad13
.long 0xb0008000,0x2f642a1f,0xada8ada8,0x2a1f2f64,0x2da82da8,0xab8baf0e,0x263e2fd9,0x2246aff6
.long 0xb000,0xa63e2fd9,0x2a1faf64,0xac722ea7,0xada82da8,0x2e2fad13,0xaea72c72,0x2f0eab8b
.long 0x30008000,0xb000,0xb0008000,0x80003000,0xaf64aa1f,0xa8a52fa8,0x2fd9263e,0x2246aff6
.long 0x2da82da8,0x2c72aea7,0xaf64aa1f,0xa63e2fd9,0xaa1faf64,0xae2f2d13,0x2ea72c72,0x28a5afa8
.long 0x80003000,0x2f64aa1f,0xada8ada8,0xaa1f2f64,0x2a1faf64,0xaff62246,0x2c722ea7,0x2b8baf0e
.long 0xada82da8,0x2fd9263e,0xaa1faf64,0xac722ea7,0x2f64aa1f,0xaf0eab8b,0x263e2fd9,0x2d13ae2f
.long 0xb0008000,0x2da82da8,0xb000,0xada82da8,0x2f642a1f,0xab8baf0e,0xa63e2fd9,0x2e2fad13
.long 0xada8ada8,0x263e2fd9,0x2a1faf64,0xaea72c72,0x2a1f2f64,0x2246aff6,0xac722ea7,0x2f0eab8b
.long 0xb000,0xaa1f2f64,0x2da8ada8,0xaf642a1f,0xaa1f2f64,0x2d13ae2f,0xaea72c72,0x2fa8a8a5
.long 0x2da8ada8,0xaea72c72,0x2f64aa1f,0xafd9263e,0xaf642a1f,0x2fa8a8a5,0xafd9263e,0x2ff6a246
.long 0x30008000,0xb000,0xb0008000,0x80003000,0xb0008000,0x22462ff6,0x2fd9a63e,0xa8a5afa8
.long 0x30008000,0xa63eafd9,0xaf642a1f,0x2c722ea7,0xb0008000,0x28a52fa8,0x2ea7ac72,0xae2fad13
.long 0x30008000,0xaa1faf64,0xada82da8,0x2f642a1f,0xb0008000,0x2b8b2f0e,0x2c72aea7,0xaff6a246
.long 0x30008000,0xac72aea7,0xaa1f2f64,0x2fd9a63e,0xb0008000,0x2d132e2f,0x263eafd9,0xaf0e2b8b
.long 0x30008000,0xada8ada8,0x80003000,0x2da8ada8,0xb0008000,0x2e2f2d13,0xa63eafd9,0xab8b2f0e
.long 0x30008000,0xaea7ac72,0x2a1f2f64,0x263eafd9,0xb0008000,0x2f0e2b8b,0xac72aea7,0x22462ff6
.long 0x30008000,0xaf64aa1f,0x2da82da8,0xaa1faf64,0xb0008000,0x2fa828a5,0xaea7ac72,0x2d132e2f
.long 0x30008000,0xafd9a63e,0x2f642a1f,0xaea7ac72,0xb0008000,0x2ff62246,0xafd9a63e,0x2fa828a5
.long 0x30008000,0xb000,0xb0008000,0x80003000,0xaf642a1f,0x2b8b2f0e,0x2ea7ac72,0xad13ae2f
.long 0x2da8ada8,0xaea7ac72,0xaa1f2f64,0x2fd9263e,0xaa1f2f64,0x2ff62246,0xa63eafd9,0xaf0e2b8b
.long 0xb000,0xaf642a1f,0x2da82da8,0x2a1faf64,0x2a1f2f64,0x2d13ae2f,0xafd9a63e,0x28a52fa8
.long 0xada8ada8,0xa63e2fd9,0x2f64aa1f,0xaea7ac72,0x2f642a1f,0xa8a5afa8,0xac722ea7,0x2ff6a246
.long 0xb0008000,0x2da82da8,0xb000,0xada82da8,0x2f64aa1f,0xafa8a8a5,0x2c722ea7,0x2246aff6
.long 0xada82da8,0x2fd9a63e,0xaf64aa1f,0x2c722ea7,0x2a1faf64,0xae2f2d13,0x2fd9a63e,0xafa8a8a5
.long 0x80003000,0x2a1faf64,0xada82da8,0x2f64aa1f,0xaa1faf64,0x22462ff6,0x263eafd9,0xab8b2f0e
.long 0x2da82da8,0xac72aea7,0x2a1f2f64,0xa63eafd9,0xaf64aa1f,0x2f0e2b8b,0xaea7ac72,0x2e2f2d13
.long 0x30008000,0xb000,0xb0008000,0x80003000,0xada82da8,0x2e2f2d13,0x2c72aea7,0xaf0eab8b
.long 0xb000,0xafd9263e,0x2a1f2f64,0x2ea7ac72,0x2da82da8,0x2b8baf0e,0xafd9a63e,0x22462ff6
.long 0xb0008000,0x2a1f2f64,0x2da8ada8,0xaf64aa1f,0x2da8ada8,0xafa8a8a5,0x263e2fd9,0x2e2fad13
.long 0x80003000,0x2ea7ac72,0xaf64aa1f,0x263e2fd9,0xada8ada8,0xa2462ff6,0x2ea7ac72,0xafa8a8a5
.long 0x30008000,0xada8ada8,0x80003000,0x2da8ada8,0xada82da8,0x2ff6a246,0xaea7ac72,0x28a52fa8
.long 0xb000,0xac722ea7,0x2f64aa1f,0xafd9a63e,0x2da82da8,0xa8a5afa8,0xa63e2fd9,0x2d13ae2f
.long 0xb0008000,0x2f642a1f,0xada8ada8,0x2a1f2f64,0x2da8ada8,0xaf0e2b8b,0x2fd9a63e,0xaff6a246
.long 0x80003000,0x263eafd9,0xaa1f2f64,0x2c72aea7,0xada8ada8,0x2d132e2f,0xac72aea7,0x2b8b2f0e
.long 0x30008000,0xb000,0xb0008000,0x80003000,0xaa1f2f64,0x2fa828a5,0x263eafd9,0xaff6a246
.long 0xada8ada8,0xac722ea7,0x2f642a1f,0x263eafd9,0x2f64aa1f,0xad13ae2f,0xac722ea7,0x2fa828a5
.long 0x80003000,0x2f64aa1f,0xada8ada8,0xaa1f2f64,0xaf64aa1f,0x22462ff6,0x2ea7ac72,0xaf0eab8b
.long 0x2da8ada8,0xafd9a63e,0x2a1f2f64,0x2c72aea7,0x2a1f2f64,0x2b8baf0e,0xafd9263e,0x2e2f2d13
.long 0xb0008000,0x2da82da8,0xb000,0xada82da8,0x2a1faf64,0xaf0e2b8b,0x2fd9263e,0xad13ae2f
.long 0x2da82da8,0xa63eafd9,0xaa1f2f64,0x2ea7ac72,0xaf642a1f,0x2ff62246,0xaea7ac72,0x2b8b2f0e
.long 0xb000,0xaa1f2f64,0x2da8ada8,0xaf642a1f,0x2f642a1f,0xae2fad13,0x2c722ea7,0xa8a5afa8
.long 0xada82da8,0x2ea7ac72,0xaf642a1f,0x2fd9a63e,0xaa1faf64,0x28a52fa8,0xa63eafd9,0x22462ff6
.long 0x30008000,0xb000,0xb0008000,0x80003000,0x80003000,0x2ff6a246,0xa63eafd9,0xafa828a5
.long 0xb0008000,0x263e2fd9,0x2f64aa1f,0xac72aea7,0xb000,0xafa828a5,0x2c722ea7,0x2d13ae2f
.long 0x30008000,0xaa1faf64,0xada82da8,0x2f642a1f,0x80003000,0x2f0eab8b,0xaea7ac72,0xa2462ff6
.long 0xb0008000,0x2c722ea7,0x2a1faf64,0xafd9263e,0xb000,0xae2f2d13,0x2fd9263e,0xab8baf0e
.long 0x30008000,0xada8ada8,0x80003000,0x2da8ada8,0x80003000,0x2d13ae2f,0xafd9263e,0x2f0e2b8b
.long 0xb0008000,0x2ea72c72,0xaa1faf64,0xa63e2fd9,0xb000,0xab8b2f0e,0x2ea7ac72,0xaff62246
.long 0x30008000,0xaf64aa1f,0x2da82da8,0xaa1faf64,0x80003000,0x28a5afa8,0xac722ea7,0x2e2fad13
.long 0xb0008000,0x2fd9263e,0xaf64aa1f,0x2ea72c72,0xb000,0xa2462ff6,0x263eafd9,0xa8a52fa8
.long 0x30008000,0xb000,0xb0008000,0x80003000,0x2a1f2f64,0x2f0eab8b,0xac72aea7,0xae2f2d13
.long 0xada82da8,0x2ea72c72,0x2a1faf64,0xafd9a63e,0xaf64aa1f,0xa2462ff6,0x2fd9a63e,0xab8baf0e
.long 0xb000,0xaf642a1f,0x2da82da8,0x2a1faf64,0x2f64aa1f,0xae2fad13,0xa63e2fd9,0x2fa8a8a5
.long 0x2da82da8,0x263eafd9,0xaf642a1f,0x2ea72c72,0xaa1f2f64,0x2fa8a8a5,0xaea7ac72,0x22462ff6
.long 0xb0008000,0x2da82da8,0xb000,0xada82da8,0xaa1faf64,0xa8a52fa8,0x2ea7ac72,0xaff6a246
.long 0x2da8ada8,0xafd9263e,0x2f642a1f,0xac72aea7,0x2f642a1f,0xad13ae2f,0x263e2fd9,0x28a5afa8
.long 0x80003000,0x2a1faf64,0xada82da8,0x2f64aa1f,0xaf642a1f,0x2ff6a246,0xafd9a63e,0x2f0e2b8b
.long 0xada8ada8,0x2c722ea7,0xaa1faf64,0x263e2fd9,0x2a1faf64,0xab8b2f0e,0x2c72aea7,0xad132e2f
.long 0x30008000,0xb000,0xb0008000,0x80003000,0x2da82da8,0x2d13ae2f,0xaea7ac72,0xab8b2f0e
.long 0x80003000,0x2fd9a63e,0xaa1faf64,0xaea72c72,0xada82da8,0x2f0e2b8b,0x263eafd9,0xaff62246
.long 0xb0008000,0x2a1f2f64,0x2da8ada8,0xaf64aa1f,0xada8ada8,0xa8a52fa8,0x2fd9a63e,0xad13ae2f
.long 0xb000,0xaea72c72,0x2f642a1f,0xa63eafd9,0x2da8ada8,0xaff6a246,0x2c722ea7,0x28a5afa8
.long 0x30008000,0xada8ada8,0x80003000,0x2da8ada8,0x2da82da8,0xa246aff6,0xac722ea7,0x2fa8a8a5
.long 0x80003000,0x2c72aea7,0xaf642a1f,0x2fd9263e,0xada82da8,0x2fa8a8a5,0xafd9a63e,0x2e2f2d13
.long 0xb0008000,0x2f642a1f,0xada8ada8,0x2a1f2f64,0xada8ada8,0x2b8b2f0e,0xa63eafd9,0xa2462ff6
.long 0xb000,0xa63e2fd9,0x2a1faf64,0xac722ea7,0x2da8ada8,0xae2f2d13,0x2ea7ac72,0xaf0e2b8b
.long 0x30008000,0xb000,0xb0008000,0x80003000,0x2f642a1f,0x28a5afa8,0xafd9a63e,0xa2462ff6
.long 0x2da82da8,0x2c72aea7,0xaf64aa1f,0xa63e2fd9,0x2a1f2f64,0x2e2fad13,0xaea7ac72,0xa8a52fa8
.long 0x80003000,0x2f64aa1f,0xada8ada8,0xaa1f2f64,0xaa1f2f64,0x2ff6a246,0xac72aea7,0xab8b2f0e
.long 0xada82da8,0x2fd9263e,0xaa1faf64,0xac722ea7,0xaf642a1f,0x2f0e2b8b,0xa63eafd9,0xad132e2f
.long 0xb0008000,0x2da82da8,0xb000,0xada82da8,0xaf64aa1f,0x2b8b2f0e,0x263eafd9,0xae2f2d13
.long 0xada8ada8,0x263e2fd9,0x2a1faf64,0xaea72c72,0xaa1faf64,0xa2462ff6,0x2c72aea7,0xaf0e2b8b
.long 0xb000,0xaa1f2f64,0x2da8ada8,0xaf642a1f,0x2a1faf64,0xad132e2f,0x2ea7ac72,0xafa828a5
.long 0x2da8ada8,0xaea72c72,0x2f64aa1f,0xafd9263e,0x2f64aa1f,0xafa828a5,0x2fd9a63e,0xaff62246
.long 0x80003c00,0xaa483bfe,0xae463bf6,0xb0b23bea,0x80003c00,0xaaac3bfd,0xaeaa3bf5,0xb0fd3be7
.long 0x80003c00,0xab113bfd,0xaf0e3bf4,0xb1473be4,0x80003c00,0xab753bfd,0xaf723bf2,0xb1913be1
.long 0x80003c00,0xabd93bfc,0xafd63bf1,0xb1db3bdd,0x80003c00,0xac1f3bfc,0xb01d3bef,0xb2263bda
.long 0x80003c00,0xac513bfb,0xb04e3bed,0xb26f3bd6,0x80003c00,0xac833bfb,0xb0803bec,0xb2b93bd2
.long 0x80003c00,0xacb53bfa,0xb0b23bea,0xb3033bce,0x80003c00,0xace73bfa,0xb0e43be8,0xb34c3bca
.long 0x80003c00,0xad1a3bf9,0xb1153be6,0xb3963bc6,0x80003c00,0xad4c3bf9,0xb1473be4,0xb3df3bc1
.long 0x80003c00,0xad7e3bf8,0xb1793be2,0xb4143bbc,0x80003c00,0xadb03bf8,0xb1aa3be0,0xb4383bb7
.long 0x80003c00,0xade23bf7,0xb1db3bdd,0xb45d3bb2,0x80003c00,0xae143bf7,0xb20d3bdb,0xb4813bad
.long 0xb23e3bd9,0xb3c63bc3,0xb4a53ba8,0xb5643b88,0xb2a13bd4,0xb4203bbb,0xb4ed3b9d,0xb5b63b79
.long 0xb3033bce,0xb45d3bb2,0xb5343b91,0xb6083b69,0xb3653bc9,0xb4993baa,0xb57c3b84,0xb6593b58
.long 0xb3c63bc3,0xb4d53ba0,0xb5c23b77,0xb6aa3b46,0xb4143bbc,0xb5113b97,0xb6083b69,0xb6f93b33
.long 0xb4443bb6,0xb54c3b8c,0xb64e3b5a,0xb7483b20,0xb4753baf,0xb5873b82,0xb6933b4b,0xb7963b0b
.long 0xb4a53ba8,0xb5c23b77,0xb6d73b3b,0xb7e33af6,0xb4d53ba0,0xb5fd3b6b,0xb71b3b2b,0xb8173ae0
.long 0xb5053b99,0xb6373b5f,0xb75e3b1a,0xb83d3ac9,0xb5343b91,0xb6703b53,0xb7a13b08,0xb8623ab1
.long 0xb5643b88,0xb6aa3b46,0xb7e33af6,0xb8873a99,0xb5933b80,0xb6e33b39,0xb8123ae3,0xb8ab3a7f
.long 0xb5c23b77,0xb71b3b2b,0xb8323ad0,0xb8ce3a65,0xb5f13b6e,0xb7533b1d,0xb8523abc,0xb8f13a4b
.long 0xb61f3b64,0xb6d73b3b,0xb78b3b0e,0xb81d3add,0xb67c3b50,0xb73d3b22,0xb7f93af0,0xb8583ab8
.long 0xb6d73b3b,0xb7a13b08,0xb8323ad0,0xb8913a92,0xb7323b25,0xb8023aed,0xb8673aae,0xb8c93a69
.long 0xb78b3b0e,0xb8323ad0,0xb89b3a8a,0xb9003a3f,0xb7e33af6,0xb8623ab1,0xb8ce3a65,0xb9353a13
.long 0xb81d3add,0xb8913a92,0xb9003a3f,0xb96939e5,0xb8483ac2,0xb8bf3a71,0xb9303a17,0xb99b39b5
.long 0xb8723aa7,0xb8ec3a4f,0xb95f39ed,0xb9cb3984,0xb89b3a8a,0xb9183a2b,0xb98d39c3,0xb9fa3951
.long 0xb8c43a6d,0xb9433a07,0xb9ba3996,0xba27391d,0xb8ec3a4f,0xb96d39e1,0xb9e53969,0xba5238e7
.long 0xb9133a2f,0xb99639ba,0xba0f393a,0xba7c38b0,0xb93a3a0f,0xb9be3992,0xba373909,0xbaa33877
.long 0xb95f39ed,0xb9e53969,0xba5e38d8,0xbac9383d,0xb98439cb,0xba0b393e,0xba8338a6,0xbaed3802
.long 0xb8723aa7,0xb8c43a6d,0xb9133a2f,0xb95f39ed,0xb8b03a7c,0xb9053a3b,0xb95639f6,0xb9a439ad
.long 0xb8ec3a4f,0xb9433a07,0xb99639ba,0xb9e53969,0xb9273a1f,0xb98039d0,0xb9d4397b,0xba233922
.long 0xb95f39ed,0xb9ba3996,0xba0f393a,0xba5e38d8,0xb99639ba,0xb9f2395b,0xba4738f6,0xba95388c
.long 0xb9cb3984,0xba27391d,0xba7c38b0,0xbac9383d,0xb9fe394d,0xba5a38dd,0xbaae3867,0xbaf937d8
.long 0xba2f3913,0xba8a389b,0xbadd381d,0xbb253732,0xba5e38d8,0xbab83858,0xbb0837a1,0xbb4e3687
.long 0xba8a389b,0xbae33812,0xbb303705,0xbb7235da,0xbab5385d,0xbb0b3796,0xbb553665,0xbb933529
.long 0xbadd381d,0xbb303705,0xbb7735c2,0xbbaf3475,0xbb0237b7,0xbb533670,0xbb95351d,0xbbc7337d
.long 0xbb253732,0xbb7235da,0xbbaf3475,0xbbdb320d,0xbb4636aa,0xbb8f3540,0xbbc63396,0xbbeb3099
.long 0xb9a839a8,0xb9ed395f,0xba2f3913,0xba6d38c4,0xb9ed395f,0xba33390e,0xba7438ba,0xbab13862
.long 0xba2f3913,0xba7438ba,0xbab5385d,0xbaf037f9,0xba6d38c4,0xbab13862,0xbaf037f9,0xbb283726
.long 0xbaa73872,0xbae93807,0xbb253732,0xbb5a364e,0xbadd381d,0xbb1d3753,0xbb553665,0xbb863570
.long 0xbb0e378b,0xbb4b3693,0xbb803593,0xbbab348d,0xbb3b36d7,0xbb7435ce,0xbba434bd,0xbbca334c
.long 0xbb64361f,0xbb993505,0xbbc333c6,0xbbe23179,0xbb883564,0xbbb73438,0xbbdb320d,0xbbf32f40
.long 0xbba834a5,0xbbd132d2,0xbbed304e,0xbbfd2b11,0xbbc333c6,0xbbe5312e,0xbbf92d1a,0xbc009a48
.long 0xbbd9323e,0xbbf42f0e,0xbbff2648,0xbbfcabd9,0xbbea30b2,0xbbfd2b75,0xbbffa7da,0xbbf1afa4
.long 0xbbf62e46,0xbc001e48,0xbbf8ad7e,0xbbe0b1aa,0xbbfe2a48,0xbbfea9e3,0xbbecb080,0xbbc7b37d
.long 0xbaa73872,0xbadd381d,0xbb0e378b,0xbb3b36d7,0xbae93807,0xbb1d3753,0xbb4b3693,0xbb7435ce
.long 0xbb253732,0xbb553665,0xbb803593,0xbba434bd,0xbb5a364e,0xbb863570,0xbbab348d,0xbbca334c
.long 0xbb883564,0xbbaf3475,0xbbce3303,0xbbe63115,0xbbaf3475,0xbbd032ea,0xbbe830e4,0xbbf82db0
.long 0xbbce3303,0xbbe830e4,0xbbf82d7e,0xbc0024b6,0xbbe63115,0xbbf82db0,0xbc0024b6,0xbbfdaaac
.long 0xbbf62e46,0xbbff2648,0xbbfeaa48,0xbbf1afd6,0xbbff28b6,0xbbfea91b,0xbbf2af72,0xbbdab226
.long 0xbbffa648,0xbbf5aeaa,0xbbddb1db,0xbbb9b42c,0xbbf8ad7e,0xbbe3b160,0xbbc0b3f7,0xbb8fb540
.long 0xbbeab0b2,0xbbc9b365,0xbb99b505,0xbb5ab64e,0xbbd4b2a1,0xbba6b4b1,0xbb69b608,0xbb1db753
.long 0xbbb6b444,0xbb7bb5ab,0xbb30b705,0xbad6b828,0xbb91b534,0xbb49b69e,0xbaf0b7f9,0xba87b8a0
.long 0xbb64361f,0xbb883564,0xbba834a5,0xbbc333c6,0xbb993505,0xbbb73438,0xbbd132d2,0xbbe5312e
.long 0xbbc333c6,0xbbdb320d,0xbbed304e,0xbbf92d1a,0xbbe23179,0xbbf32f40,0xbbfd2b11,0xbc009a48
.long 0xbbf62e46,0xbbff28b6,0xbbffa648,0xbbf8ad7e,0xbbff2648,0xbbfea91b,0xbbf5aeaa,0xbbe3b160
.long 0xbbfeaa48,0xbbf2af72,0xbbddb1db,0xbbc0b3f7,0xbbf1afd6,0xbbdab226,0xbbb9b42c,0xbb8fb540
.long 0xbbd9b23e,0xbbb6b444,0xbb88b564,0xbb50b67c,0xbbb6b444,0xbb86b570,0xbb4bb693,0xbb05b7ac
.long 0xbb88b564,0xbb4bb693,0xbb02b7b7,0xbaaeb867,0xbb50b67c,0xbb05b7ac,0xbaaeb867,0xba4bb8f1
.long 0xbb0eb78b,0xbab5b85d,0xba4fb8ec,0xb9dcb972,0xbac2b848,0xba5ab8dd,0xb9e5b969,0xb964b9e9
.long 0xba6db8c4,0xb9f6b956,0xb972b9dc,0xb8e2ba56,0xba0fb93a,0xb989b9c7,0xb8f6ba47,0xb858bab8
.long 0xbbd9323e,0xbbea30b2,0xbbf62e46,0xbbfe2a48,0xbbf42f0e,0xbbfd2b75,0xbc001e48,0xbbfea9e3
.long 0xbbff2648,0xbbffa7da,0xbbf8ad7e,0xbbecb080,0xbbfcabd9,0xbbf1afa4,0xbbe0b1aa,0xbbc7b37d
.long 0xbbeab0b2,0xbbd4b2a1,0xbbb6b444,0xbb91b534,0xbbc9b365,0xbba6b4b1,0xbb7bb5ab,0xbb49b69e
.long 0xbb99b505,0xbb69b608,0xbb30b705,0xbaf0b7f9,0xbb5ab64e,0xbb1db753,0xbad6b828,0xba87b8a0
.long 0xbb0eb78b,0xbac2b848,0xba6db8c4,0xba0fb93a,0xbab5b85d,0xba5ab8dd,0xb9f6b956,0xb989b9c7
.long 0xba4fb8ec,0xb9e5b969,0xb972b9dc,0xb8f6ba47,0xb9dcb972,0xb964b9e9,0xb8e2ba56,0xb858bab8
.long 0xb95fb9ed,0xb8d8ba5e,0xb848bac2,0xb75ebb1a,0xb8d8ba5e,0xb842bac6,0xb748bb20,0xb5fdbb6b
.long 0xb848bac2,0xb748bb20,0xb5f1bb6e,0xb48dbbab,0xb75ebb1a,0xb5fdbb6b,0xb48dbbab,0xb226bbda
.long 0x9a483000,0x20b5affe,0xa3d62ff6,0x2579afea,0xa3d63000,0x29c2afc3,0xac9b2f0e,0x2e0faded
.long 0xa7033000,0x2cecaf3b,0xaf252d13,0x2fffa7c6,0xa9053000,0x2e8aae6d,0xafff28a5,0x2e4f2964
.long 0xaa7c3000,0x2f99ad5f,0xaef6a246,0x27032e6d,0xabe33000,0x2fffac1d,0xac48ab8b,0xab322ffe
.long 0xac9b3000,0x2fb6a964,0xa0b5ae2f,0xaf502edd,0xad3a3000,0x2ec2a4b2,0x2a7cafa8,0xafb62ad7
.long 0xadcb3000,0x2d3a1e48,0x2e4faff6,0xac9ba4b2,0xae4f3000,0x2a7c27c6,0x2fe2af0e,0x20b5ad5f
.long 0xaec23000,0x23d62ad7,0x2f99ad13,0x2d84afc3,0xaf253000,0xa5792cc4,0x2d84a8a5,0x2ff1af88
.long 0xaf773000,0xab322ded,0x28442246,0x2ec2acc4,0xafb63000,0xad842edd,0xa7032b8b,0x29059e48
.long 0xafe23000,0xaef62f88,0xad3a2e2f,0xa9c22c1d,0xaffa3000,0xafce2fea,0xaf772fa8,0xaef62f3b
.long 0xa7032fd9,0x2844afc3,0xa9052fa8,0x29c2af88,0xaf252c72,0x2fcea964,0xafff2246,0x2fb624b2
.long 0xaf50a63e,0x2d3a2cc4,0xa844af0e,0xa5792ffe,0xa844aea7,0xa9c22ffe,0x2ec2ae2f,0xaffa27c6
.long 0x2c9bafd9,0xaff12c1d,0x2e0f28a5,0x9a48af3b,0x2ffaac72,0xac9baad7,0xaa7c2ff6,0x2ff1acc4
.long 0x2d84263e,0x2b32afea,0xaff12b8b,0x27032d5f,0xa3d62ea7,0x2fffad5f,0xa579ad13,0xaf992edd
.long 0xaec22fd9,0x2be327c6,0x2f25afa8,0xaa7ca964,0xaf992c72,0xac482f88,0x2d84a246,0x2ef6afea
.long 0xa9c2a63e,0xaffa2e6d,0xabe32f0e,0x2c9b9e48,0x2be3aea7,0xaa7c9e48,0xafce2e2f,0xae0f2fc3
.long 0x2fe2afd9,0x2cecaedd,0xa0b5a8a5,0xadcb2ad7,0x2e0fac72,0x2fe2af3b,0x2f77aff6,0x2cecae6d
.long 0x9a48263e,0x2905a4b2,0x2cecab8b,0x2ec2aded,0xae4f2ea7,0xad842ded,0xac9b2d13,0xab322c1d
.long 0xaa7c2f64,0x2b32af3b,0xabe32f0e,0x2c48aedd,0xaef6aa1f,0x2dcb2cc4,0xac48ae2f,0x29052f3b
.long 0x2c9baf64,0xaef62d5f,0x2ffaa8a5,0xaf77a4b2,0x2e0f2a1f,0xa703aedd,0xaa7c2ff6,0x2ef6aded
.long 0xadcb2f64,0x2ffaa964,0xacecab8b,0xa5792fc3,0xacecaa1f,0xa9c22fea,0x2fe2ad13,0xad3aa964
.long 0x2ec2af64,0xae4f9e48,0xa9052fa8,0x2fffacc4,0x2b322a1f,0x2e8aafc3,0xad84a246,0xacec2ffe
.long 0xaf772f64,0x29052ad7,0x2fb6af0e,0xa703ac1d,0xa844aa1f,0xafff2e6d,0xa7032e2f,0x2f25aad7
.long 0x2fe2af64,0x2844aded,0xae0f28a5,0xaf502fea,0x20b52a1f,0x2ec2ac1d,0x2f77aff6,0x2844ad5f
.long 0xafff2f64,0xae0f2f88,0xa3d62b8b,0x2c9ba7c6,0x23d6aa1f,0xaa7c24b2,0xae8a2d13,0xaffa2f88
.long 0x2fceaf64,0x2ff1affe,0x2f25afa8,0x2d84ae6d,0xa9052a1f,0xa57927c6,0x9a482246,0x23d69e48
.long 0xac9b2ea7,0x2cecae6d,0xad3a2e2f,0x2d84aded,0xa0b5afd9,0xa5792ffe,0x2a7cafa8,0xacec2edd
.long 0x2d842c72,0xa905aedd,0xa3d62ff6,0x2c48af88,0xaff1263e,0x2dcb2ad7,0xa579af0e,0xab322fea
.long 0x2ec2aea7,0xafb624b2,0x2b322d13,0x29c2affe,0xa9052fd9,0x2fcead5f,0xad84a8a5,0xa8442fc3
.long 0xa9c2ac72,0xae0f2fc3,0x2ef6a246,0x2579af3b,0x2ef6a63e,0x29c2af88,0xafce2b8b,0xa0b52e6d
.long 0xafe22ea7,0x23d62cc4,0x2ffaae2f,0x9a48ad5f,0x2d3aafd9,0xac9b9e48,0xaf772fa8,0x23d62c1d
.long 0x9a482c72,0x2f25ac1d,0x2e4faff6,0xa703a964,0xacec263e,0xafff2f3b,0xac9b2f0e,0x290524b2
.long 0x2fceaea7,0x2ef6afea,0x2905ad13,0xaa7c1e48,0xaf252fd9,0xac482ded,0x9a4828a5,0x2be3a7c6
.long 0x2a7cac72,0x20b5a7c6,0xa8442246,0xac9b2ad7,0x2844a63e,0x2a7ca964,0x2c48ab8b,0x2d3aacc4
.long 0xadcb2da8,0x2e0fad5f,0xae4f2d13,0x2e8aacc4,0x2e4fada8,0xaf502c1d,0x2fe2a8a5,0xaffa1e48
.long 0xaec22da8,0x2ff1a964,0xaf99a246,0x2dcb2c1d,0x2f25ada8,0xafe224b2,0x2d842b8b,0xa3d6af3b
.long 0xaf772da8,0x2f251e48,0xa844ae2f,0xac482fea,0x2fb6ada8,0xadcba7c6,0xa7032fa8,0x2f99aded
.long 0xafe22da8,0x2be32ad7,0x2d3aaff6,0xaf7727c6,0x2ffaada8,0xa703acc4,0xaf772f0e,0x2be32964
.long 0xafff2da8,0xa0b52ded,0x2ff1ad13,0x2579ae6d,0x2ff1ada8,0x29c2aedd,0xae8a28a5,0xae0f2ffe
.long 0xafce2da8,0xacec2f88,0x2b322246,0x2fffaedd,0x2f99ada8,0x2e8aafea,0x1a48ab8b,0xae4f2ad7
.long 0xaf502da8,0xaf992ffe,0xabe32e2f,0x270324b2,0x2ef6ada8,0x2fffafc3,0x2ec2afa8,0x2b32ad5f
.long 0xae8a2da8,0xafb62f3b,0xaffa2ff6,0xaf502fc3,0x2e0fada8,0x2ec2ae6d,0x2f50af0e,0x2fb6af88
.long 0xaec22c72,0x2ef6ac1d,0xaf252b8b,0x2f50aad7,0x2f99263e,0xaec2aad7,0x2d842d13,0xabe3ae6d
.long 0xa9c2aea7,0xa0b52fea,0x2be3afa8,0xae8a2ded,0xabe32fd9,0x2f50ad5f,0xafce2246,0x2d3a2c1d
.long 0x2fe2ac72,0xae4fa7c6,0x20b52f0e,0x2d84af88,0xae0fa63e,0xa5792f88,0x2f77ae2f,0xae4fa4b2
.long 0x9a482ea7,0x2f99ae6d,0xaceca8a5,0xac482ffe,0x2e4fafd9,0xadcb9e48,0xac9b2ff6,0x2f25a7c6
.long 0xafce2c72,0xa8442edd,0x2f99ab8b,0x29c2af3b,0x2b32263e,0x2fceaf3b,0x1a48ad13,0xafb62cc4
.long 0x2a7caea7,0xad3a24b2,0xafb62fa8,0xa5792d5f,0xafb62fd9,0xa9c22ded,0x2c48a246,0x2ffaaedd
.long 0x2e8aac72,0x2ff1afc3,0x2d3aaf0e,0x9a48a964,0xa0b5a63e,0xac9b2964,0xaf502e2f,0xaff12fea
.long 0xadcb2ea7,0xab322cc4,0xa3d628a5,0x27039e48,0x2ff1afd9,0x2fffaffe,0x2fe2aff6,0x2f99afc3
.long 0xaf772a1f,0x2f99a964,0xafb628a5,0x2fcea7c6,0x28442f64,0x9a48afea,0xa7032ff6,0x2b32af88
.long 0x2fe2aa1f,0xafb69e48,0x2e0f2b8b,0xaa7cae6d,0xa0b5af64,0xac482fc3,0x2f77ad13,0xafb61e48
.long 0xafff2a1f,0x2d3a2ad7,0x23d6afa8,0xae8a2edd,0xa3d62f64,0x2f50ae6d,0xae8aa246,0xa0b52f3b
.long 0x2fceaa1f,0xa3d6aded,0xaf252f0e,0x2dcb24b2,0x2905af64,0xafe22c1d,0x9a482e2f,0x2ff1aded
.long 0xaf502a1f,0xab322f88,0x2ef6a8a5,0x2c48afc3,0xabe32f64,0x2dcba4b2,0x2ec2aff6,0xa905a964
.long 0x2e8aaa1f,0x2ef6affe,0xa0b5ab8b,0xaf772cc4,0x2d3aaf64,0xa703a7c6,0xaf502d13,0xaef62ffe
.long 0xad842a1f,0xaffa2f3b,0xae4f2fa8,0xa5792c1d,0xae4f2f64,0xa9c22cc4,0x25792246,0x2d3aaad7
.long 0x2c48aa1f,0x2e4fad5f,0x2f99af0e,0x2fffafea,0x2f25af64,0x2e8aaedd,0x2dcbae2f,0x2cecad5f
.long 0xafe2263e,0x2ff1a4b2,0xaffa2246,0x2fff9e48,0xad3a2ea7,0x2e8aad5f,0xaf772b8b,0x2ff1a7c6
.long 0x9a482fd9,0x2b32afc3,0xae4f2e2f,0x2fceaad7,0x2cec2c72,0x9a48af88,0xac9b2fa8,0x2f99acc4
.long 0x2fcea63e,0xabe3acc4,0xa9052ff6,0x2f50aded,0x2f25aea7,0xaec29e48,0x9a482f0e,0x2ef6aedd
.long 0x2a7cafd9,0xaffa2c1d,0x28442d13,0x2e8aaf88,0xa844ac72,0xaf502f3b,0x2c4828a5,0x2e0fafea
.long 0xae8a263e,0xacec2fea,0x2e0fa246,0x2d84affe,0xaffa2ea7,0xa5792ded,0x2f50ab8b,0x2cecafc3
.long 0xadcb2fd9,0x290527c6,0x2ff1ae2f,0x2c48af3b,0xa3d62c72,0x2dcba964,0x2fe2afa8,0x2b32ae6d
.long 0x2c48a63e,0x2fb6ae6d,0x2f25aff6,0x29c2ad5f,0x2f99aea7,0x2fceaffe,0x2dcbaf0e,0x2844ac1d
.long 0x2f77afd9,0x2e0faedd,0x2be3ad13,0x2579a964,0x2be3ac72,0x29c2aad7,0x2703a8a5,0x20b5a4b2
.long 0xafff8000,0x2ffa1e48,0xaff1a246,0x2fe224b2,0xaff18000,0x2f7727c6,0xae8aab8b,0x2d3a2d5f
.long 0xafce8000,0x2e4f2ad7,0xab32ae2f,0x1a482fc3,0xaf998000,0x2c9b2cc4,0x1a48afa8,0xacec2f88
.long 0xaf508000,0x29052ded,0x2be3aff6,0xafce2cc4,0xaef68000,0x1a482edd,0x2ec2af0e,0xaf251e48
.long 0xae8a8000,0xa8442f88,0x2ffaad13,0xaa7cac1d,0xae0f8000,0xac482fea,0x2f50a8a5,0x2844af3b
.long 0xad848000,0xae0f2ffe,0x2cec2246,0x2e8aafea,0xacec8000,0xaf502fc3,0x25792b8b,0x2ffaaded
.long 0xac488000,0xaff12f3b,0xa9052e2f,0x2dcba7c6,0xab328000,0xafe22e6d,0xadcb2fa8,0x23d62964
.long 0xa9c28000,0xaf252d5f,0xafb62ff6,0xac482e6d,0xa8448000,0xadcb2c1d,0xafce2f0e,0xaf992ffe
.long 0xa5798000,0xabe32964,0xae0f2d13,0xaf772edd,0xa0b58000,0xa70324b2,0xa9c228a5,0xabe32ad7
.long 0xafcea63e,0x2fb627c6,0xaf99a8a5,0x2f772964,0xab32aea7,0x27032f88,0x1a48aff6,0xa8442fea
.long 0x2a7cafd9,0xae0f2e6d,0x2fb6ab8b,0xafe21e48,0x2fb6ac72,0xaf779e48,0x2c482d13,0x20b5afc3
.long 0x2e8a263e,0xa3d6aedd,0xad3a2fa8,0x2fffaad7,0x20b52ea7,0x2e8aaf3b,0xaf502246,0x23d62e6d
.long 0xadcb2fd9,0x2f25a4b2,0x23d6af0e,0xafce2ded,0xaff12c72,0x1a482ded,0x2fe2ae2f,0xa905ac1d
.long 0xac48a63e,0xaef62fc3,0x2b3228a5,0x2f50af88,0x2905aea7,0xaec22964,0xadcb2ff6,0x2be324b2
.long 0x2f77afd9,0x20b5acc4,0xaef62b8b,0xae8a2ffe,0x2ef6ac72,0x2f50affe,0x2703ad13,0xad3a27c6
.long 0x2579263e,0x2e4fac1d,0x2ffaafa8,0x2d84af3b,0xad3a2ea7,0xa5792ad7,0x29c2a246,0x2e4facc4
.long 0xafff2fd9,0xaf992fea,0xae4f2f0e,0xac482d5f,0xacec2c72,0xadcb2d5f,0xae8a2e2f,0xaf252edd
.long 0xaf50aa1f,0x2f252ad7,0xaef6ab8b,0x2ec22c1d,0x2be3af64,0xad842e6d,0x2ec2ad13,0xaf992ad7
.long 0x2e8a2a1f,0xabe3aded,0x20b52fa8,0x29c2afea,0xad3a2f64,0x2fceac1d,0xaf50a246,0x2be32d5f
.long 0xad84aa1f,0xa0b52f88,0x2e4faf0e,0xafe227c6,0x2e4faf64,0xaf7724b2,0x25792e2f,0x2e0faf88
.long 0x2c482a1f,0x2cecaffe,0xaf9928a5,0x1a482e6d,0xaf252f64,0x2c9b27c6,0x2dcbaff6,0xae4f1e48
.long 0xa9c2aa1f,0xaf992f3b,0x28442b8b,0x2fceaedd,0x2fb6af64,0x9a48acc4,0xafce2d13,0xab322f3b
.long 0x25792a1f,0x2fb6ad5f,0x2d3aafa8,0xaa7ca4b2,0xaffa2f64,0xac482edd,0x29c22246,0x2fb6aded
.long 0x1a48aa1f,0xad3a2964,0xaff12f0e,0xae8a2fc3,0x2ff1af64,0x2f50afea,0x2c9bae2f,0x20b5a964
.long 0xa7032a1f,0x23d61e48,0x2b32a8a5,0x2dcbacc4,0xaf992f64,0xafe22fc3,0xafff2ff6,0xaff12ffe
.long 0xae8aac72,0x2e4f2cc4,0xae0fad13,0x2dcb2d5f,0x2ffaa63e,0xafe29e48,0x2f5028a5,0xae4fac1d
.long 0xadcb2ea7,0x2f99ac1d,0xaff12246,0x2ec22964,0x23d6afd9,0xad842f3b,0x2fe2ab8b,0xaf25a4b2
.long 0x2c482c72,0x2844afea,0xaf252e2f,0x2f779e48,0xaf99263e,0x27032ded,0x2dcbafa8,0xafb627c6
.long 0x2f77aea7,0xad3aa7c6,0xabe32ff6,0x2fe2aad7,0xabe32fd9,0x2f77a964,0x2703af0e,0xaffa2cc4
.long 0xa579ac72,0xaff12e6d,0x20b52d13,0x2fffaded,0x2e0fa63e,0x2e8aaffe,0xa9c2a8a5,0xaff12edd
.long 0xafff2ea7,0xab322edd,0x2ceca246,0x2fceaf88,0x2e4fafd9,0x9a48aad7,0xae8a2b8b,0xaf992fea
.long 0xa7032c72,0x2be3a4b2,0x2f99ae2f,0x2f50affe,0xab32263e,0xaec22d5f,0xafff2fa8,0xaef62fc3
.long 0x2f50aea7,0x2ffaafc3,0x2fb6aff6,0x2e8aaf3b,0xafb62fd9,0xaf502f88,0xaec22f0e,0xae0f2e6d
.long 0xad84ada8,0x2d3a2ded,0xacecae2f,0x2c9b2e6d,0x2cec2da8,0xaa7caedd,0x25792fa8,0x20b5affe
.long 0xac48ada8,0x23d62f88,0x2905aff6,0xad842edd,0x2b322da8,0x2579afea,0xadcb2f0e,0x2ff1aad7
.long 0xa9c2ada8,0xab322ffe,0x2fb6ad13,0xaec2a4b2,0x28442da8,0x2d84afc3,0xafce28a5,0x29052d5f
.long 0xa579ada8,0xaef62f3b,0x2e0f2246,0x29c2afc3,0x20b52da8,0x2fceae6d,0xa9c2ab8b,0xaef62f88
.long 0x1a48ada8,0xaffa2d5f,0xa3d62e2f,0x2fe2acc4,0xa3d62da8,0x2f77ac1d,0x2c9bafa8,0xad3a1e48
.long 0x2703ada8,0xae4f2964,0xaf252ff6,0x1a482c1d,0xa9052da8,0x2c9ba4b2,0x2fffaf0e,0x2cecaf3b
.long 0x2a7cada8,0xa9059e48,0xaef62d13,0xafce2fea,0xabe32da8,0x1a4827c6,0x2c48a8a5,0x2f25aded
.long 0x2c9bada8,0x2844aad7,0xa0b5a246,0xaa7c27c6,0xad3a2da8,0xac482cc4,0xaa7c2b8b,0xa8442964
.long 0xac48aea7,0x2be32edd,0xab32af0e,0x2a7c2f3b,0xa9052fd9,0x2c48af3b,0xadcb2e2f,0x2ef6acc4
.long 0x2f77ac72,0xaffa24b2,0x2ef628a5,0xac9bad5f,0xaef6a63e,0x2a7c2ded,0x2703aff6,0xae0f2edd
.long 0x25792ea7,0x2cecafc3,0xaffa2b8b,0x2dcb2964,0x2d3aafd9,0xafe22964,0x29c22d13,0x2cecafea
.long 0xafff2c72,0x29052cc4,0x2e4fafa8,0xaec21e48,0x2cec263e,0x2d84affe,0xae8a2246,0xab322fc3
.long 0x2703aea7,0xafb62c1d,0xa9052f0e,0x2f77aad7,0xaf252fd9,0x27032ad7,0x2fffae2f,0x2844ae6d
.long 0x2f50ac72,0x2e0fafea,0xa844a8a5,0xafe22ded,0xa844a63e,0xaf772d5f,0xaec22ff6,0xa0b52c1d
.long 0xac9b2ea7,0x23d627c6,0x2e0fab8b,0x2fffaf88,0x2ffaafd9,0x2e8aaf88,0x2a7cad13,0xa3d6a4b2
.long 0xad842c72,0xaf252e6d,0xaff12fa8,0xafce2ffe,0xa3d6263e,0x1a481e48,0x2579a246,0x2905a7c6
.long 0xa9c2af64,0x29052f88,0xa844afa8,0x27032fc3,0xafb62a1f,0x2fffa4b2,0xafcea246,0x2f252964
.long 0x25792f64,0x2844affe,0xad3a2f0e,0x2f50acc4,0x2ffaaa1f,0xaec2a7c6,0x29c22e2f,0x2844affe
.long 0x1a48af64,0xae0f2f3b,0x2ff1a8a5,0xac9bac1d,0xaff12a1f,0x2a7c2cc4,0x2c9baff6,0xaffa2ad7
.long 0xa7032f64,0x2ff1ad5f,0xab32ab8b,0xad842fea,0x2f99aa1f,0x2579aedd,0xafff2d13,0x23d62d5f
.long 0x2a7caf64,0xaf252964,0xabe32fa8,0x2ec2a7c6,0xaef62a1f,0xad842fea,0x2c482246,0x2f99af88
.long 0xac9b2f64,0x2be31e48,0x2ffaaf0e,0x29c2ae6d,0x2e0faa1f,0x2fceafc3,0x2a7cae2f,0xabe31e48
.long 0x2dcbaf64,0x20b5aad7,0xacec28a5,0xafe22edd,0xacec2a1f,0xaf772e6d,0xafe22ff6,0xae0f2f3b
.long 0xaec22f64,0xacec2ded,0xa9052b8b,0x1a4824b2,0x2b32aa1f,0x2c9bac1d,0x2d84ad13,0x2e4faded
.long 0xa579afd9,0x23d62fea,0xa0b5aff6,0x1a482ffe,0xae0fac72,0x2c9b2ded,0xa9c2af0e,0x23d62fc3
.long 0xafff263e,0x2f2527c6,0xacecad13,0x27032f3b,0xae4f2ea7,0x2fffa964,0xae8aa8a5,0x29052e6d
.long 0xa7032fd9,0x2ef6ae6d,0xaf992246,0x2a7c2d5f,0x2b322c72,0x2c48affe,0xafff2b8b,0x2be32c1d
.long 0x2f50a63e,0x20b5aedd,0xafb62e2f,0x2c9b2964,0x2fb6aea7,0xaa7caad7,0xaec22fa8,0x2d3a24b2
.long 0x2c9bafd9,0xae4f24b2,0xad3a2ff6,0x2dcb9e48,0xa0b5ac72,0xafe22d5f,0xaa7c2f0e,0x2e4fa7c6
.long 0xad84263e,0xaf992fc3,0xa3d62d13,0x2ec2aad7,0xaff12ea7,0xad842f88,0x257928a5,0x2f25acc4
.long 0xaec22fd9,0xa8442cc4,0x2b32a246,0x2f77aded,0xa9052c72,0x27031e48,0x2d84ab8b,0x2fb6aedd
.long 0x29c2a63e,0x2d3aac1d,0x2ef6ae2f,0x2fe2af88,0x2ef6aea7,0x2f77af3b,0x2fceafa8,0x2ffaafea
.long 0x361f3b64,0x3b64b61f,0xb61fbb64,0xbb64361f,0x367c3b50,0x3af6b7e3,0xb89bba8a,0xba0f393a
.long 0x36d73b3b,0x3a6db8c4,0xb9edb95f,0xb81d3add,0x37323b25,0x39cbb984,0xbaf6b7e3,0xb3033bce
.long 0x378b3b0e,0x3913ba2f,0xbba8b4a5,0x2e463bf6,0x37e33af6,0x3848bac2,0xbbfaacb5,0x367c3b50
.long 0x381d3add,0x36d7bb3b,0xbbea30b2,0x395f39ed,0x38483ac2,0x3505bb99,0xbb7735c2,0x3af637e3
.long 0x38723aa7,0x323ebbd9,0xbaa73872,0x3bd9323e,0x389b3a8a,0x2cb5bbfa,0xb98439cb,0x3bf1afd6
.long 0x38c43a6d,0xaa48bbfe,0xb81d3add,0x3b3bb6d7,0x38ec3a4f,0xb179bbe2,0xb5053b99,0x39cbb984
.long 0x39133a2f,0xb4a5bba8,0xae463bf6,0x378bbb0e,0x393a3a0f,0xb67cbb50,0x2fd63bf1,0x3179bbe2
.long 0x395f39ed,0xb81dbadd,0x35643b88,0xb0b2bbea,0x398439cb,0xb8ecba4f,0x38483ac2,0xb732bb25
.long 0x361f3b64,0x3b64b61f,0xb61fbb64,0xbb64361f,0x39cb3984,0x38ecba4f,0xbac2b848,0xb7323b25
.long 0x3b883564,0x30b2bbea,0xbbfe2a48,0x33c63bc3,0x3bfaacb5,0xb5c2bb77,0xba4f38ec,0x3a8a389b
.long 0x3b0eb78b,0xba2fb913,0xb4a53ba8,0x3bf6ae46,0x38ecba4f,0xbbe2b179,0x35053b99,0x3984b9cb
.long 0x33c6bbc3,0xbb883564,0x3a6d38c4,0x2a48bbfe,0xb179bbe2,0xb93a3a0f,0x3bff2648,0xb8ecba4f
.long 0xb872baa7,0xb23e3bd9,0x3aa7b872,0xbbd9b23e,0xbac2b848,0x35053b99,0x35c2bb77,0xbaf637e3
.long 0xbbeab0b2,0x39ed395f,0xb3c6bbc3,0xb5643b88,0xbbb63444,0x3bce3303,0xba0fb93a,0x35c23b77
.long 0xba2f3913,0x3ba8b4a5,0xbbf6ae46,0x3b0e378b,0xb7323b25,0x3984b9cb,0xbaf637e3,0x3bceb303
.long 0xaa483bfe,0x33c6bbc3,0xb6d73b3b,0x38c4ba6d,0x35c23b77,0xb444bbb6,0x31793be2,0xacb5bbfa
.long 0x361f3b64,0x3b64b61f,0xb61fbb64,0xbb64361f,0x3b7735c2,0x3444bbb6,0xbbe2b179,0xacb53bfa
.long 0x3b3bb6d7,0xb8c4ba6d,0xb95f39ed,0x3add381d,0x3505bb99,0xbbffa648,0x34443bb6,0x3ac2b848
.long 0xb78bbb0e,0xb9133a2f,0x3ba834a5,0xae46bbf6,0xbbb6b444,0x33033bce,0x3a0fb93a,0xbb77b5c2
.long 0xbadd381d,0x3b3b36d7,0xb0b2bbea,0xb9ed395f,0xb3033bce,0x3b25b732,0xbb50b67c,0x34443bb6
.long 0x38723aa7,0x323ebbd9,0xbaa73872,0x3bd9323e,0x3be23179,0xb93aba0f,0x26483bff,0x38ecba4f
.long 0x3a6db8c4,0xbbfe2a48,0x3add381d,0xb6d7bb3b,0x2fd6bbf1,0xb89b3a8a,0x3b25b732,0xbbffa648
.long 0xb913ba2f,0x34a53ba8,0x2e46bbf6,0xb78b3b0e,0xbbfaacb5,0x3b7735c2,0xba4fb8ec,0x389b3a8a
.long 0xb9ed395f,0x3addb81d,0xbb883564,0x3beab0b2,0xa6483bff,0x2fd6bbf1,0xb3033bce,0x3505bb99
.long 0x361f3b64,0x3b64b61f,0xb61fbb64,0xbb64361f,0x3bffa648,0xafd6bbf1,0xbbce3303,0x35053b99
.long 0x3564bb88,0xbbeab0b2,0x2a483bfe,0x3bc3b3c6,0xba0fb93a,0xb67c3b50,0x3bf12fd6,0xb179bbe2
.long 0xbb0e378b,0x3a2f3913,0x34a5bba8,0xbbf62e46,0x2fd63bf1,0x3a8ab89b,0xbb25b732,0x26483bff
.long 0x3bc333c6,0xb564bb88,0xb8c43a6d,0x3bfe2a48,0x389bba8a,0xbbfa2cb5,0x398439cb,0x2fd6bbf1
.long 0xb872baa7,0xb23e3bd9,0x3aa7b872,0xbbd9b23e,0xbbce3303,0x3b253732,0xb67cbb50,0xb4443bb6
.long 0xb0b23bea,0x395fb9ed,0xbbc333c6,0x3b883564,0x3af637e3,0xb848bac2,0x2cb53bfa,0x367cbb50
.long 0x3a2fb913,0xbba834a5,0x3bf62e46,0xbb0eb78b,0xb505bb99,0x26483bff,0x3444bbb6,0xb8483ac2
.long 0xbbfeaa48,0x3bc333c6,0xbb3bb6d7,0x3a6d38c4,0xb67c3b50,0x37e3baf6,0xb89b3a8a,0x393aba0f
.long 0x361f3b64,0x3b64b61f,0xb61fbb64,0xbb64361f,0x3b50b67c,0xb7e3baf6,0xba8a389b,0x393a3a0f
.long 0xb6d7bb3b,0xba6d38c4,0x39ed395f,0x381dbadd,0xbb253732,0x398439cb,0x37e3baf6,0xbbceb303
.long 0x378b3b0e,0x3913ba2f,0xbba8b4a5,0x2e463bf6,0x3af6b7e3,0xbac2b848,0xacb53bfa,0x3b50b67c
.long 0xb81dbadd,0xb6d73b3b,0x3beab0b2,0xb95fb9ed,0xbac23848,0x3b993505,0xb5c2bb77,0xb7e33af6
.long 0x38723aa7,0x323ebbd9,0xbaa73872,0x3bd9323e,0x3a8ab89b,0xbbfaacb5,0x39cb3984,0xafd6bbf1
.long 0xb8c4ba6d,0x2a483bfe,0x381dbadd,0xbb3b36d7,0xba4f38ec,0x3be2b179,0xbb99b505,0x398439cb
.long 0x39133a2f,0xb4a5bba8,0xae463bf6,0x378bbb0e,0x3a0fb93a,0xbb50367c,0x3bf1afd6,0xbbe2b179
.long 0xb95fb9ed,0x381d3add,0xb564bb88,0x30b23bea,0xb9cb3984,0x3a4fb8ec,0xbac23848,0x3b25b732
.long 0x361f3b64,0x3b64b61f,0xb61fbb64,0xbb64361f,0x3984b9cb,0xba4fb8ec,0xb8483ac2,0x3b253732
.long 0xbb88b564,0xb0b23bea,0x3bfeaa48,0xb3c6bbc3,0x2cb53bfa,0x3b77b5c2,0xb8ecba4f,0xb89b3a8a
.long 0x3b0eb78b,0xba2fb913,0xb4a53ba8,0x3bf6ae46,0xba4fb8ec,0xb1793be2,0x3b99b505,0xb9cbb984
.long 0xb3c63bc3,0x3b88b564,0xba6db8c4,0xaa483bfe,0x3be2b179,0xba0fb93a,0xa6483bff,0x3a4fb8ec
.long 0xb872baa7,0xb23e3bd9,0x3aa7b872,0xbbd9b23e,0xb8483ac2,0x3b99b505,0xbb77b5c2,0x37e33af6
.long 0x3bea30b2,0xb9edb95f,0x33c63bc3,0x3564bb88,0xb444bbb6,0xb3033bce,0x393aba0f,0xbb7735c2
.long 0xba2f3913,0x3ba8b4a5,0xbbf6ae46,0x3b0e378b,0x3b253732,0xb9cbb984,0x37e33af6,0xb303bbce
.long 0x2a48bbfe,0xb3c63bc3,0x36d7bb3b,0xb8c43a6d,0xbb7735c2,0x3bb6b444,0xbbe23179,0x3bfaacb5
.long 0x361f3b64,0x3b64b61f,0xb61fbb64,0xbb64361f,0x35c2bb77,0xbbb6b444,0xb1793be2,0x3bfa2cb5
.long 0xbb3b36d7,0x38c43a6d,0x395fb9ed,0xbaddb81d,0x3b993505,0x2648bbff,0xbbb63444,0x38483ac2
.long 0xb78bbb0e,0xb9133a2f,0x3ba834a5,0xae46bbf6,0xb4443bb6,0x3bceb303,0xb93aba0f,0xb5c23b77
.long 0x3addb81d,0xbb3bb6d7,0x30b23bea,0x39edb95f,0xbbceb303,0x37323b25,0x367cbb50,0xbbb63444
.long 0x38723aa7,0x323ebbd9,0xbaa73872,0x3bd9323e,0x3179bbe2,0xba0f393a,0x3bffa648,0xba4fb8ec
.long 0xba6d38c4,0x3bfeaa48,0xbaddb81d,0x36d73b3b,0x3bf12fd6,0xba8ab89b,0x37323b25,0x2648bbff
.long 0xb913ba2f,0x34a53ba8,0x2e46bbf6,0xb78b3b0e,0xacb53bfa,0x35c2bb77,0xb8ec3a4f,0x3a8ab89b
.long 0x39edb95f,0xbadd381d,0x3b88b564,0xbbea30b2,0xbbffa648,0x3bf12fd6,0xbbceb303,0x3b993505
.long 0x361f3b64,0x3b64b61f,0xb61fbb64,0xbb64361f,0xa648bbff,0xbbf12fd6,0x33033bce,0x3b99b505
.long 0xb5643b88,0x3bea30b2,0xaa48bbfe,0xbbc333c6,0x393aba0f,0xbb50b67c,0xafd63bf1,0x3be2b179
.long 0xbb0e378b,0x3a2f3913,0x34a5bba8,0xbbf62e46,0x3bf1afd6,0xb89bba8a,0xb7323b25,0x3bffa648
.long 0xbbc3b3c6,0x35643b88,0x38c4ba6d,0xbbfeaa48,0x3a8a389b,0xacb5bbfa,0xb9cb3984,0x3bf12fd6
.long 0xb872baa7,0xb23e3bd9,0x3aa7b872,0xbbd9b23e,0x33033bce,0x3732bb25,0xbb50367c,0x3bb63444
.long 0x30b2bbea,0xb95f39ed,0x3bc3b3c6,0xbb88b564,0xb7e33af6,0x3ac2b848,0xbbfa2cb5,0x3b50367c
.long 0x3a2fb913,0xbba834a5,0x3bf62e46,0xbb0eb78b,0xbb993505,0x3bffa648,0xbbb6b444,0x3ac23848
.long 0x3bfe2a48,0xbbc3b3c6,0x3b3b36d7,0xba6db8c4,0xbb50b67c,0x3af637e3,0xba8ab89b,0x3a0f393a
.long 0x361f3b64,0x3b64b61f,0xb61fbb64,0xbb64361f,0xb67cbb50,0xbaf637e3,0x389b3a8a,0x3a0fb93a
.long 0x36d73b3b,0x3a6db8c4,0xb9edb95f,0xb81d3add,0xb732bb25,0xb9cb3984,0x3af637e3,0x3303bbce
.long 0x378b3b0e,0x3913ba2f,0xbba8b4a5,0x2e463bf6,0xb7e3baf6,0xb8483ac2,0x3bfa2cb5,0xb67cbb50
.long 0x381d3add,0x36d7bb3b,0xbbea30b2,0x395f39ed,0xb848bac2,0xb5053b99,0x3b77b5c2,0xbaf6b7e3
.long 0x38723aa7,0x323ebbd9,0xbaa73872,0x3bd9323e,0xb89bba8a,0xacb53bfa,0x3984b9cb,0xbbf12fd6
.long 0x38c43a6d,0xaa48bbfe,0xb81d3add,0x3b3bb6d7,0xb8ecba4f,0x31793be2,0x3505bb99,0xb9cb3984
.long 0x39133a2f,0xb4a5bba8,0xae463bf6,0x378bbb0e,0xb93aba0f,0x367c3b50,0xafd6bbf1,0xb1793be2
.long 0x395f39ed,0xb81dbadd,0x35643b88,0xb0b2bbea,0xb984b9cb,0x38ec3a4f,0xb848bac2,0x37323b25
.long 0x361f3b64,0x3b64b61f,0xb61fbb64,0xbb64361f,0xb9cbb984,0xb8ec3a4f,0x3ac23848,0x3732bb25
.long 0x3b883564,0x30b2bbea,0xbbfe2a48,0x33c63bc3,0xbbfa2cb5,0x35c23b77,0x3a4fb8ec,0xba8ab89b
.long 0x3b0eb78b,0xba2fb913,0xb4a53ba8,0x3bf6ae46,0xb8ec3a4f,0x3be23179,0xb505bb99,0xb98439cb
.long 0x33c6bbc3,0xbb883564,0x3a6d38c4,0x2a48bbfe,0x31793be2,0x393aba0f,0xbbffa648,0x38ec3a4f
.long 0xb872baa7,0xb23e3bd9,0x3aa7b872,0xbbd9b23e,0x3ac23848,0xb505bb99,0xb5c23b77,0x3af6b7e3
.long 0xbbeab0b2,0x39ed395f,0xb3c6bbc3,0xb5643b88,0x3bb6b444,0xbbceb303,0x3a0f393a,0xb5c2bb77
.long 0xba2f3913,0x3ba8b4a5,0xbbf6ae46,0x3b0e378b,0x3732bb25,0xb98439cb,0x3af6b7e3,0xbbce3303
.long 0xaa483bfe,0x33c6bbc3,0xb6d73b3b,0x38c4ba6d,0xb5c2bb77,0x34443bb6,0xb179bbe2,0x2cb53bfa
.long 0x361f3b64,0x3b64b61f,0xb61fbb64,0xbb64361f,0xbb77b5c2,0xb4443bb6,0x3be23179,0x2cb5bbfa
.long 0x3b3bb6d7,0xb8c4ba6d,0xb95f39ed,0x3add381d,0xb5053b99,0x3bff2648,0xb444bbb6,0xbac23848
.long 0xb78bbb0e,0xb9133a2f,0x3ba834a5,0xae46bbf6,0x3bb63444,0xb303bbce,0xba0f393a,0x3b7735c2
.long 0xbadd381d,0x3b3b36d7,0xb0b2bbea,0xb9ed395f,0x3303bbce,0xbb253732,0x3b50367c,0xb444bbb6
.long 0x38723aa7,0x323ebbd9,0xbaa73872,0x3bd9323e,0xbbe2b179,0x393a3a0f,0xa648bbff,0xb8ec3a4f
.long 0x3a6db8c4,0xbbfe2a48,0x3add381d,0xb6d7bb3b,0xafd63bf1,0x389bba8a,0xbb253732,0x3bff2648
.long 0xb913ba2f,0x34a53ba8,0x2e46bbf6,0xb78b3b0e,0x3bfa2cb5,0xbb77b5c2,0x3a4f38ec,0xb89bba8a
.long 0xb9ed395f,0x3addb81d,0xbb883564,0x3beab0b2,0x2648bbff,0xafd63bf1,0x3303bbce,0xb5053b99
.long 0x361f3b64,0x3b64b61f,0xb61fbb64,0xbb64361f,0xbbff2648,0x2fd63bf1,0x3bceb303,0xb505bb99
.long 0x3564bb88,0xbbeab0b2,0x2a483bfe,0x3bc3b3c6,0x3a0f393a,0x367cbb50,0xbbf1afd6,0x31793be2
.long 0xbb0e378b,0x3a2f3913,0x34a5bba8,0xbbf62e46,0xafd6bbf1,0xba8a389b,0x3b253732,0xa648bbff
.long 0x3bc333c6,0xb564bb88,0xb8c43a6d,0x3bfe2a48,0xb89b3a8a,0x3bfaacb5,0xb984b9cb,0xafd63bf1
.long 0xb872baa7,0xb23e3bd9,0x3aa7b872,0xbbd9b23e,0x3bceb303,0xbb25b732,0x367c3b50,0x3444bbb6
.long 0xb0b23bea,0x395fb9ed,0xbbc333c6,0x3b883564,0xbaf6b7e3,0x38483ac2,0xacb5bbfa,0xb67c3b50
.long 0x3a2fb913,0xbba834a5,0x3bf62e46,0xbb0eb78b,0x35053b99,0xa648bbff,0xb4443bb6,0x3848bac2
.long 0xbbfeaa48,0x3bc333c6,0xbb3bb6d7,0x3a6d38c4,0x367cbb50,0xb7e33af6,0x389bba8a,0xb93a3a0f
.long 0x361f3b64,0x3b64b61f,0xb61fbb64,0xbb64361f,0xbb50367c,0x37e33af6,0x3a8ab89b,0xb93aba0f
.long 0xb6d7bb3b,0xba6d38c4,0x39ed395f,0x381dbadd,0x3b25b732,0xb984b9cb,0xb7e33af6,0x3bce3303
.long 0x378b3b0e,0x3913ba2f,0xbba8b4a5,0x2e463bf6,0xbaf637e3,0x3ac23848,0x2cb5bbfa,0xbb50367c
.long 0xb81dbadd,0xb6d73b3b,0x3beab0b2,0xb95fb9ed,0x3ac2b848,0xbb99b505,0x35c23b77,0x37e3baf6
.long 0x38723aa7,0x323ebbd9,0xbaa73872,0x3bd9323e,0xba8a389b,0x3bfa2cb5,0xb9cbb984,0x2fd63bf1
.long 0xb8c4ba6d,0x2a483bfe,0x381dbadd,0xbb3b36d7,0x3a4fb8ec,0xbbe23179,0x3b993505,0xb984b9cb
.long 0x39133a2f,0xb4a5bba8,0xae463bf6,0x378bbb0e,0xba0f393a,0x3b50b67c,0xbbf12fd6,0x3be23179
.long 0xb95fb9ed,0x381d3add,0xb564bb88,0x30b23bea,0x39cbb984,0xba4f38ec,0x3ac2b848,0xbb253732
.long 0x361f3b64,0x3b64b61f,0xb61fbb64,0xbb64361f,0xb98439cb,0x3a4f38ec,0x3848bac2,0xbb25b732
.long 0xbb88b564,0xb0b23bea,0x3bfeaa48,0xb3c6bbc3,0xacb5bbfa,0xbb7735c2,0x38ec3a4f,0x389bba8a
.long 0x3b0eb78b,0xba2fb913,0xb4a53ba8,0x3bf6ae46,0x3a4f38ec,0x3179bbe2,0xbb993505,0x39cb3984
.long 0xb3c63bc3,0x3b88b564,0xba6db8c4,0xaa483bfe,0xbbe23179,0x3a0f393a,0x2648bbff,0xba4f38ec
.long 0xb872baa7,0xb23e3bd9,0x3aa7b872,0xbbd9b23e,0x3848bac2,0xbb993505,0x3b7735c2,0xb7e3baf6
.long 0x3bea30b2,0xb9edb95f,0x33c63bc3,0x3564bb88,0x34443bb6,0x3303bbce,0xb93a3a0f,0x3b77b5c2
.long 0xba2f3913,0x3ba8b4a5,0xbbf6ae46,0x3b0e378b,0xbb25b732,0x39cb3984,0xb7e3baf6,0x33033bce
.long 0x2a48bbfe,0xb3c63bc3,0x36d7bb3b,0xb8c43a6d,0x3b77b5c2,0xbbb63444,0x3be2b179,0xbbfa2cb5
.long 0x361f3b64,0x3b64b61f,0xb61fbb64,0xbb64361f,0xb5c23b77,0x3bb63444,0x3179bbe2,0xbbfaacb5
.long 0xbb3b36d7,0x38c43a6d,0x395fb9ed,0xbaddb81d,0xbb99b505,0xa6483bff,0x3bb6b444,0xb848bac2
.long 0xb78bbb0e,0xb9133a2f,0x3ba834a5,0xae46bbf6,0x3444bbb6,0xbbce3303,0x393a3a0f,0x35c2bb77
.long 0x3addb81d,0xbb3bb6d7,0x30b23bea,0x39edb95f,0x3bce3303,0xb732bb25,0xb67c3b50,0x3bb6b444
.long 0x38723aa7,0x323ebbd9,0xbaa73872,0x3bd9323e,0xb1793be2,0x3a0fb93a,0xbbff2648,0x3a4f38ec
.long 0xba6d38c4,0x3bfeaa48,0xbaddb81d,0x36d73b3b,0xbbf1afd6,0x3a8a389b,0xb732bb25,0xa6483bff
.long 0xb913ba2f,0x34a53ba8,0x2e46bbf6,0xb78b3b0e,0x2cb5bbfa,0xb5c23b77,0x38ecba4f,0xba8a389b
.long 0x39edb95f,0xbadd381d,0x3b88b564,0xbbea30b2,0x3bff2648,0xbbf1afd6,0x3bce3303,0xbb99b505
.long 0x361f3b64,0x3b64b61f,0xb61fbb64,0xbb64361f,0x26483bff,0x3bf1afd6,0xb303bbce,0xbb993505
.long 0xb5643b88,0x3bea30b2,0xaa48bbfe,0xbbc333c6,0xb93a3a0f,0x3b50367c,0x2fd6bbf1,0xbbe23179
.long 0xbb0e378b,0x3a2f3913,0x34a5bba8,0xbbf62e46,0xbbf12fd6,0x389b3a8a,0x3732bb25,0xbbff2648
.long 0xbbc3b3c6,0x35643b88,0x38c4ba6d,0xbbfeaa48,0xba8ab89b,0x2cb53bfa,0x39cbb984,0xbbf1afd6
.long 0xb872baa7,0xb23e3bd9,0x3aa7b872,0xbbd9b23e,0xb303bbce,0xb7323b25,0x3b50b67c,0xbbb6b444
.long 0x30b2bbea,0xb95f39ed,0x3bc3b3c6,0xbb88b564,0x37e3baf6,0xbac23848,0x3bfaacb5,0xbb50b67c
.long 0x3a2fb913,0xbba834a5,0x3bf62e46,0xbb0eb78b,0x3b99b505,0xbbff2648,0x3bb63444,0xbac2b848
.long 0x3bfe2a48,0xbbc3b3c6,0x3b3b36d7,0xba6db8c4,0x3b50367c,0xbaf6b7e3,0x3a8a389b,0xba0fb93a
.long 0x80003c00,0xaa613bfd,0xae5f3bf6,0xb0c53be9,0x80003c00,0xaac53bfd,0xaec33bf5,0xb10f3be6
.long 0x80003c00,0xab2a3bfd,0xaf273bf3,0xb15a3be3,0x80003c00,0xab8e3bfc,0xaf8b3bf2,0xb1a43be0
.long 0x80003c00,0xabf23bfc,0xafef3bf0,0xb1ee3bdd,0x80003c00,0xac2b3bfc,0xb0293bef,0xb2383bd9
.long 0x80003c00,0xac5e3bfb,0xb05b3bed,0xb2823bd5,0x80003c00,0xac903bfb,0xb08d3beb,0xb2cc3bd1
.long 0x80003c00,0xacc23bfa,0xb0be3be9,0xb3153bcd,0x80003c00,0xacf43bfa,0xb0f03be7,0xb35f3bc9
.long 0x80003c00,0xad263bf9,0xb1223be5,0xb3a83bc5,0x80003c00,0xad583bf9,0xb1533be3,0xb3f13bc0
.long 0x80003c00,0xad8a3bf8,0xb1853be1,0xb41d3bbb,0x80003c00,0xadbc3bf8,0xb1b63bdf,0xb4413bb6
.long 0x80003c00,0xadee3bf7,0xb1e83bdd,0xb4663bb1,0x80003c00,0xae203bf7,0xb2193bda,0xb48a3bac
.long 0xb2573bd7,0xb3e53bc1,0xb4b73ba5,0xb5793b85,0xb2b93bd2,0xb42f3bb9,0xb4ff3b9a,0xb5cb3b75
.long 0xb31b3bcd,0xb46c3bb0,0xb5463b8e,0xb61d3b65,0xb37d3bc7,0xb4a83ba7,0xb58d3b81,0xb66d3b53
.long 0xb3df3bc1,0xb4e43b9e,0xb5d43b73,0xb6be3b41,0xb4203bbb,0xb5203b94,0xb61a3b65,0xb70d3b2e
.long 0xb4513bb4,0xb55b3b8a,0xb65f3b57,0xb75c3b1b,0xb4813bad,0xb5963b7f,0xb6a43b47,0xb7a93b06
.long 0xb4b13ba6,0xb5d13b74,0xb6e83b37,0xb7f63af0,0xb4e13b9e,0xb60b3b68,0xb72c3b27,0xb8213ada
.long 0xb5113b97,0xb6453b5c,0xb76f3b16,0xb8463ac3,0xb5403b8f,0xb67f3b50,0xb7b23b04,0xb86b3aab
.long 0xb5703b86,0xb6b83b43,0xb7f33af1,0xb8903a93,0xb59f3b7d,0xb6f13b35,0xb81a3ade,0xb8b43a79
.long 0xb5ce3b74,0xb7293b27,0xb83a3acb,0xb8d73a5f,0xb5fd3b6b,0xb7613b19,0xb85a3ab6,0xb8fa3a44
.long 0xb6373b5f,0xb6f13b35,0xb7a63b07,0xb82c3ad4,0xb6933b4b,0xb7563b1c,0xb80a3ae8,0xb8663aaf
.long 0xb6ee3b36,0xb7ba3b01,0xb8403ac7,0xb89f3a88,0xb7483b20,0xb80e3ae5,0xb8743aa5,0xb8d73a5f
.long 0xb7a13b08,0xb83e3ac8,0xb8a83a81,0xb90d3a34,0xb7f93af0,0xb86e3aa9,0xb8db3a5c,0xb9423a08
.long 0xb8283ad6,0xb89d3a8a,0xb90c3a35,0xb97539d9,0xb8523abc,0xb8ca3a68,0xb93c3a0d,0xb9a739a9
.long 0xb87c3aa0,0xb8f73a46,0xb96b39e3,0xb9d73978,0xb8a63a83,0xb9233a22,0xb99939b8,0xba053944
.long 0xb8ce3a65,0xb94e39fd,0xb9c5398b,0xba323910,0xb8f63a47,0xb97839d7,0xb9f0395d,0xba5d38d9
.long 0xb91d3a27,0xb9a039b0,0xba19392e,0xba8638a2,0xb9433a07,0xb9c83988,0xba4138fd,0xbaad3869
.long 0xb96939e5,0xb9ef395e,0xba6738cc,0xbad2382e,0xb98d39c3,0xba143934,0xba8c3899,0xbaf537e6
.long 0xb8813a9c,0xb8d43a61,0xb9243a21,0xb97139de,0xb8bf3a71,0xb9143a2e,0xb96639e7,0xb9b4399c
.long 0xb8fb3a43,0xb95339f9,0xb9a639aa,0xb9f53957,0xb9353a13,0xb98e39c1,0xb9e3396b,0xba323910
.long 0xb96d39e1,0xb9c83988,0xba1d3929,0xba6c38c5,0xb9a439ad,0xb9ff394b,0xba5438e5,0xbaa23878
.long 0xb9d83976,0xba34390d,0xba89389e,0xbad53829,0xba0b393e,0xba6638cd,0xbaba3855,0xbb0437af
.long 0xba3b3905,0xba96388b,0xbae8380a,0xbb303707,0xba6938c9,0xbac33846,0xbb13377a,0xbb57365c
.long 0xba95388c,0xbaed3800,0xbb3a36dd,0xbb7b35ae,0xbabf384d,0xbb153772,0xbb5e363c,0xbb9a34fc
.long 0xbae6380d,0xbb3936e0,0xbb7f3599,0xbbb53447,0xbb0b3796,0xbb5b364b,0xbb9c34f3,0xbbcd3322
.long 0xbb2e3710,0xbb7a35b3,0xbbb5344b,0xbbdf31b0,0xbb4e3687,0xbb95351a,0xbbcb3340,0xbbee303c
.long 0xb9ba3996,0xb9ff394b,0xba4138fd,0xba7f38ac,0xb9fe394d,0xba4438fa,0xba8538a3,0xbac13849
.long 0xba3f3900,0xba8438a4,0xbac43845,0xbafe37c5,0xba7c38b0,0xbac0384c,0xbafe37c8,0xbb3536f1
.long 0xbab5385d,0xbaf737e0,0xbb3236ff,0xbb663617,0xbae93807,0xbb293724,0xbb603631,0xbb903537
.long 0xbb1a375e,0xbb563662,0xbb89355e,0xbbb43454,0xbb4636aa,0xbb7e359c,0xbbac3487,0xbbd132d8
.long 0xbb6e35f1,0xbba134d2,0xbbc93359,0xbbe73103,0xbb913534,0xbbbe3405,0xbbe0319e,0xbbf62e52
.long 0xbbaf3475,0xbbd63269,0xbbf12fbd,0xbbfe2934,0xbbc93365,0xbbe930c5,0xbbfc2c38,0xbc00a484
.long 0xbbdd31db,0xbbf62e39,0xbc00217f,0xbbfaacdb,0xbbed304e,0xbbfe29ca,0xbbfea9b1,0xbbeeb048
.long 0xbbf82d7e,0xbc009f12,0xbbf6ae5f,0xbbdab21f,0xbbff28b6,0xbbfcab8e,0xbbe7b0f0,0xbbc0b3f1
.long 0xbab83858,0xbaed3800,0xbb1e374e,0xbb4b3696,0xbaf937d8,0xbb2c3718,0xbb593654,0xbb81358a
.long 0xbb3336f9,0xbb623628,0xbb8b3552,0xbbaf3478,0xbb673614,0xbb913531,0xbbb5344b,0xbbd232bf
.long 0xbb933529,0xbbb83435,0xbbd6327c,0xbbeb3086,0xbbb73438,0xbbd63269,0xbbed305b,0xbbfb2c90
.long 0xbbd53288,0xbbed3061,0xbbfb2c6a,0xbc001248,0xbbeb3099,0xbbfb2ca9,0xbc001648,0xbbfbac77
.long 0xbbf92d4c,0xbc002052,0xbbfcac38,0xbbecb07a,0xbc00257f,0xbbfdab2a,0xbbeeb042,0xbbd3b2b3
.long 0xbbfea91b,0xbbf1afb0,0xbbd7b263,0xbbafb472,0xbbf6ae78,0xbbddb1e2,0xbbb7b43e,0xbb82b584
.long 0xbbe5b12e,0xbbc1b3e5,0xbb8eb546,0xbb4cb690,0xbbcdb31b,0xbb9cb4f0,0xbb5cb648,0xbb0cb793
.long 0xbbadb481,0xbb6fb5e8,0xbb21b742,0xbac3b846,0xbb86b570,0xbb3bb6da,0xbadeb81a,0xba72b8be
.long 0xbb7235da,0xbb95351a,0xbbb33457,0xbbcd3322,0xbba434bd,0xbbc133d9,0xbbd93232,0xbbeb3086
.long 0xbbcb3334,0xbbe23172,0xbbf22f59,0xbbfc2b8e,0xbbe830e4,0xbbf72e07,0xbbff2884,0xbbffa616
.long 0xbbf92d1a,0xbc002484,0xbbfea9b1,0xbbf4aecf,0xbc001e48,0xbbfcab8e,0xbbf0afef,0xbbdbb207
.long 0xbbfbac51,0xbbedb055,0xbbd6b27c,0xbbb5b44e,0xbbecb080,0xbbd2b2bf,0xbbaeb47b,0xbb80b590
.long 0xbbd1b2d2,0xbbabb490,0xbb7ab5b1,0xbb3fb6c9,0xbbabb48d,0xbb78b5b9,0xbb3ab6dd,0xbaf0b7f6
.long 0xbb7bb5ab,0xbb3bb6da,0xbaeeb7fe,0xba96b88b,0xbb41b6c1,0xbaf2b7f1,0xba97b889,0xba30b912
.long 0xbafcb7cd,0xba9fb87e,0xba35b90c,0xb9bfb991,0xbaaeb867,0xba42b8fc,0xb9c9b986,0xb944ba05
.long 0xba56b8e2,0xb9dbb973,0xb954b9f8,0xb8c0ba70,0xb9f6b956,0xb96cb9e2,0xb8d6ba60,0xb834bacf
.long 0xbbe13191,0xbbf02ffb,0xbbfa2cce,0xbbff267b,0xbbf82db0,0xbbff289d,0xbc00a452,0xbbfbac77
.long 0xbc001a48,0xbbfdaac5,0xbbf4aef5,0xbbe4b141,0xbbf9ad4c,0xbbebb086,0xbbd7b263,0xbbbbb41d
.long 0xbbe3b160,0xbbcab352,0xbba9b49f,0xbb80b590,0xbbbeb408,0xbb98b508,0xbb6ab602,0xbb34b6f6
.long 0xbb8ab558,0xbb57b65c,0xbb1bb759,0xbad7b826,0xbb49b69e,0xbb07b7a4,0xbabdb850,0xba6ab8c8
.long 0xbaf9b7d8,0xbaa9b86e,0xba50b8ea,0xb9efb95e,0xba9cb881,0xba3eb901,0xb9d6b979,0xb965b9e8
.long 0xba33b90e,0xb9c6b98a,0xb94fb9fc,0xb8cfba65,0xb9beb992,0xb942ba08,0xb8bcba73,0xb82ebad2
.long 0xb93eba0b,0xb8b4ba79,0xb820badb,0xb707bb30,0xb8b5ba78,0xb81cbadd,0xb6f4bb35,0xb5a2bb7d
.long 0xb822bad9,0xb6f6bb34,0xb599bb7f,0xb42fbbb9,0xb710bb2e,0xb5a8bb7c,0xb432bbb8,0xb166bbe3
.long 0x3000,0xb000,0x3000,0xb000,0x3000,0xa246aff6,0x263e2fd9,0xa8a5afa8
.long 0x3000,0xa63eafd9,0x2a1f2f64,0xac72aea7,0x3000,0xa8a5afa8,0x2c722ea7,0xae2fad13
.long 0x3000,0xaa1faf64,0x2da82da8,0xaf64aa1f,0x3000,0xab8baf0e,0x2ea72c72,0xaff6a246
.long 0x3000,0xac72aea7,0x2f642a1f,0xafd9263e,0x3000,0xad13ae2f,0x2fd9263e,0xaf0e2b8b
.long 0x3000,0xada8ada8,0x30000000,0xada82da8,0x3000,0xae2fad13,0x2fd9a63e,0xab8b2f0e
.long 0x3000,0xaea7ac72,0x2f64aa1f,0xa63e2fd9,0x3000,0xaf0eab8b,0x2ea7ac72,0x22462ff6
.long 0x3000,0xaf64aa1f,0x2da8ada8,0x2a1f2f64,0x3000,0xafa8a8a5,0x2c72aea7,0x2d132e2f
.long 0x3000,0xafd9a63e,0x2a1faf64,0x2ea72c72,0x3000,0xaff6a246,0x263eafd9,0x2fa828a5
.long 0x3000,0xb000,0x3000,0xb000,0x2a1f2f64,0xab8baf0e,0x2c722ea7,0xad13ae2f
.long 0x2da82da8,0xaea7ac72,0x2f642a1f,0xafd9a63e,0x2f642a1f,0xaff6a246,0x2fd9a63e,0xaf0e2b8b
.long 0x30000000,0xaf642a1f,0x2da8ada8,0xaa1f2f64,0x2f64aa1f,0xad132e2f,0x263eafd9,0x28a52fa8
.long 0x2da8ada8,0xa63e2fd9,0xaa1faf64,0x2ea72c72,0x2a1faf64,0x28a52fa8,0xaea7ac72,0x2ff6a246
.long 0xb000,0x2da82da8,0xb0008000,0x2da8ada8,0xaa1faf64,0x2fa828a5,0xaea72c72,0x2246aff6
.long 0xada8ada8,0x2fd9a63e,0xaa1f2f64,0xac72aea7,0xaf64aa1f,0x2e2fad13,0x263e2fd9,0xafa8a8a5
.long 0xb0008000,0x2a1faf64,0x2da82da8,0xaf642a1f,0xaf642a1f,0xa246aff6,0x2fd9263e,0xab8b2f0e
.long 0xada82da8,0xac72aea7,0x2f64aa1f,0x263e2fd9,0xaa1f2f64,0xaf0eab8b,0x2c72aea7,0x2e2f2d13
.long 0x3000,0xb000,0x3000,0xb000,0x2da82da8,0xae2fad13,0x2ea72c72,0xaf0eab8b
.long 0x30000000,0xafd9263e,0x2f64aa1f,0xaea72c72,0x2da8ada8,0xab8b2f0e,0x263eafd9,0x22462ff6
.long 0xb000,0x2a1f2f64,0xada8ada8,0x2f642a1f,0xada8ada8,0x2fa828a5,0xafd9263e,0x2e2fad13
.long 0xb0008000,0x2ea7ac72,0xaa1f2f64,0xa63eafd9,0xada82da8,0x2246aff6,0x2c722ea7,0xafa8a8a5
.long 0x3000,0xada8ada8,0x30000000,0xada82da8,0x2da82da8,0xaff62246,0x2c72aea7,0x28a52fa8
.long 0x30000000,0xac722ea7,0xaa1faf64,0x2fd9263e,0x2da8ada8,0x28a52fa8,0xafd9a63e,0x2d13ae2f
.long 0xb000,0x2f642a1f,0xada82da8,0xaa1faf64,0xada8ada8,0x2f0eab8b,0x263e2fd9,0xaff6a246
.long 0xb0008000,0x263eafd9,0x2f642a1f,0xac722ea7,0xada82da8,0xad13ae2f,0x2ea7ac72,0x2b8b2f0e
.long 0x3000,0xb000,0x3000,0xb000,0x2f642a1f,0xafa8a8a5,0x2fd9263e,0xaff6a246
.long 0x2da8ada8,0xac722ea7,0x2a1faf64,0xa63e2fd9,0xaa1faf64,0x2d132e2f,0xaea7ac72,0x2fa828a5
.long 0xb0008000,0x2f64aa1f,0xada82da8,0x2a1faf64,0xaa1f2f64,0xa246aff6,0x2c722ea7,0xaf0eab8b
.long 0x2da82da8,0xafd9a63e,0x2f64aa1f,0xac722ea7,0x2f64aa1f,0xab8b2f0e,0xa63eafd9,0x2e2f2d13
.long 0xb000,0x2da82da8,0xb0008000,0x2da8ada8,0xaf64aa1f,0x2f0eab8b,0xa63e2fd9,0xad13ae2f
.long 0xada82da8,0xa63eafd9,0x2f642a1f,0xaea72c72,0x2a1f2f64,0xaff6a246,0x2c72aea7,0x2b8b2f0e
.long 0x30000000,0xaa1f2f64,0xada8ada8,0x2f64aa1f,0x2a1faf64,0x2e2f2d13,0xaea72c72,0xa8a5afa8
.long 0xada8ada8,0x2ea7ac72,0x2a1f2f64,0xafd9263e,0xaf642a1f,0xa8a5afa8,0x2fd9a63e,0x22462ff6
.long 0x3000,0xb000,0x3000,0xb000,0x30000000,0xaff62246,0x2fd9a63e,0xafa828a5
.long 0xb000,0x263e2fd9,0xaa1faf64,0x2c722ea7,0xb0008000,0x2fa8a8a5,0xaea72c72,0x2d13ae2f
.long 0x3000,0xaa1faf64,0x2da82da8,0xaf64aa1f,0x30000000,0xaf0e2b8b,0x2c72aea7,0xa2462ff6
.long 0xb000,0x2c722ea7,0xaf64aa1f,0x2fd9a63e,0xb0008000,0x2e2fad13,0xa63e2fd9,0xab8baf0e
.long 0x3000,0xada8ada8,0x30000000,0xada82da8,0x30000000,0xad132e2f,0xa63eafd9,0x2f0e2b8b
.long 0xb000,0x2ea72c72,0xaf642a1f,0x263eafd9,0xb0008000,0x2b8baf0e,0x2c722ea7,0xaff62246
.long 0x3000,0xaf64aa1f,0x2da8ada8,0x2a1f2f64,0x30000000,0xa8a52fa8,0xaea7ac72,0x2e2fad13
.long 0xb000,0x2fd9263e,0xaa1f2f64,0xaea7ac72,0xb0008000,0x2246aff6,0x2fd9263e,0xa8a52fa8
.long 0x3000,0xb000,0x3000,0xb000,0x2f64aa1f,0xaf0e2b8b,0x2ea7ac72,0xae2f2d13
.long 0xada8ada8,0x2ea72c72,0xaf64aa1f,0x2fd9263e,0xaa1f2f64,0x2246aff6,0x263e2fd9,0xab8baf0e
.long 0x30000000,0xaf642a1f,0x2da8ada8,0xaa1f2f64,0xaa1faf64,0x2e2f2d13,0xafd9a63e,0x2fa8a8a5
.long 0xada82da8,0x263eafd9,0x2a1f2f64,0xaea7ac72,0x2f642a1f,0xafa828a5,0x2c72aea7,0x22462ff6
.long 0xb000,0x2da82da8,0xb0008000,0x2da8ada8,0xaf642a1f,0x28a5afa8,0x2c722ea7,0xaff6a246
.long 0x2da82da8,0xafd9263e,0x2a1faf64,0x2c722ea7,0x2a1faf64,0x2d132e2f,0xafd9263e,0x28a5afa8
.long 0xb0008000,0x2a1faf64,0x2da82da8,0xaf642a1f,0x2a1f2f64,0xaff62246,0x263eafd9,0x2f0e2b8b
.long 0x2da8ada8,0x2c722ea7,0xaf642a1f,0xa63eafd9,0xaf64aa1f,0x2b8baf0e,0x2ea72c72,0xad132e2f
.long 0x3000,0xb000,0x3000,0xb000,0x2da8ada8,0xad132e2f,0x2c72aea7,0xab8b2f0e
.long 0xb0008000,0x2fd9a63e,0xaf642a1f,0x2ea7ac72,0x2da82da8,0xaf0eab8b,0x2fd9263e,0xaff62246
.long 0xb000,0x2a1f2f64,0xada8ada8,0x2f642a1f,0xada82da8,0x28a5afa8,0x263e2fd9,0xad13ae2f
.long 0x30000000,0xaea72c72,0x2a1faf64,0x263e2fd9,0xada8ada8,0x2ff62246,0xaea72c72,0x28a5afa8
.long 0x3000,0xada8ada8,0x30000000,0xada82da8,0x2da8ada8,0x22462ff6,0xaea7ac72,0x2fa8a8a5
.long 0xb0008000,0x2c72aea7,0x2a1f2f64,0xafd9a63e,0x2da82da8,0xafa828a5,0x263eafd9,0x2e2f2d13
.long 0xb000,0x2f642a1f,0xada82da8,0xaa1faf64,0xada82da8,0xab8baf0e,0x2fd9a63e,0xa2462ff6
.long 0x30000000,0xa63e2fd9,0xaf64aa1f,0x2c72aea7,0xada8ada8,0x2e2fad13,0x2c722ea7,0xaf0e2b8b
.long 0x3000,0xb000,0x3000,0xb000,0x2a1faf64,0xa8a52fa8,0x263eafd9,0xa2462ff6
.long 0xada82da8,0x2c72aea7,0xaa1f2f64,0x263eafd9,0x2f64aa1f,0xae2f2d13,0x2c72aea7,0xa8a52fa8
.long 0xb0008000,0x2f64aa1f,0xada82da8,0x2a1faf64,0x2f642a1f,0xaff62246,0x2ea7ac72,0xab8b2f0e
.long 0xada8ada8,0x2fd9263e,0xaf642a1f,0x2c72aea7,0x2a1f2f64,0xaf0eab8b,0x2fd9a63e,0xad132e2f
.long 0xb000,0x2da82da8,0xb0008000,0x2da8ada8,0xaa1f2f64,0xab8baf0e,0x2fd9263e,0xae2f2d13
.long 0x2da8ada8,0x263e2fd9,0xaf64aa1f,0x2ea7ac72,0xaf642a1f,0x2246aff6,0x2ea72c72,0xaf0e2b8b
.long 0x30000000,0xaa1f2f64,0xada8ada8,0x2f64aa1f,0xaf64aa1f,0x2d13ae2f,0x2c722ea7,0xafa828a5
.long 0x2da82da8,0xaea72c72,0xaa1faf64,0x2fd9a63e,0xaa1faf64,0x2fa8a8a5,0x263e2fd9,0xaff62246
.long 0x3000,0xb000,0x3000,0xb000,0xb000,0x22462ff6,0xa63eafd9,0x28a52fa8
.long 0x3000,0xa63eafd9,0x2a1f2f64,0xac72aea7,0xb000,0x28a52fa8,0xac72aea7,0x2e2f2d13
.long 0x3000,0xaa1faf64,0x2da82da8,0xaf64aa1f,0xb000,0x2b8b2f0e,0xaea7ac72,0x2ff62246
.long 0x3000,0xac72aea7,0x2f642a1f,0xafd9263e,0xb000,0x2d132e2f,0xafd9a63e,0x2f0eab8b
.long 0x3000,0xada8ada8,0x30000000,0xada82da8,0xb000,0x2e2f2d13,0xafd9263e,0x2b8baf0e
.long 0x3000,0xaea7ac72,0x2f64aa1f,0xa63e2fd9,0xb000,0x2f0e2b8b,0xaea72c72,0xa246aff6
.long 0x3000,0xaf64aa1f,0x2da8ada8,0x2a1f2f64,0xb000,0x2fa828a5,0xac722ea7,0xad13ae2f
.long 0x3000,0xafd9a63e,0x2a1faf64,0x2ea72c72,0xb000,0x2ff62246,0xa63e2fd9,0xafa8a8a5
.long 0x3000,0xb000,0x3000,0xb000,0xaa1faf64,0x2b8b2f0e,0xac72aea7,0x2d132e2f
.long 0x2da82da8,0xaea7ac72,0x2f642a1f,0xafd9a63e,0xaf64aa1f,0x2ff62246,0xafd9263e,0x2f0eab8b
.long 0x30000000,0xaf642a1f,0x2da8ada8,0xaa1f2f64,0xaf642a1f,0x2d13ae2f,0xa63e2fd9,0xa8a5afa8
.long 0x2da8ada8,0xa63e2fd9,0xaa1faf64,0x2ea72c72,0xaa1f2f64,0xa8a5afa8,0x2ea72c72,0xaff62246
.long 0xb000,0x2da82da8,0xb0008000,0x2da8ada8,0x2a1f2f64,0xafa8a8a5,0x2ea7ac72,0xa2462ff6
.long 0xada8ada8,0x2fd9a63e,0xaa1f2f64,0xac72aea7,0x2f642a1f,0xae2f2d13,0xa63eafd9,0x2fa828a5
.long 0xb0008000,0x2a1faf64,0x2da82da8,0xaf642a1f,0x2f64aa1f,0x22462ff6,0xafd9a63e,0x2b8baf0e
.long 0xada82da8,0xac72aea7,0x2f64aa1f,0x263e2fd9,0x2a1faf64,0x2f0e2b8b,0xac722ea7,0xae2fad13
.long 0x3000,0xb000,0x3000,0xb000,0xada8ada8,0x2e2f2d13,0xaea7ac72,0x2f0e2b8b
.long 0x30000000,0xafd9263e,0x2f64aa1f,0xaea72c72,0xada82da8,0x2b8baf0e,0xa63e2fd9,0xa246aff6
.long 0xb000,0x2a1f2f64,0xada8ada8,0x2f642a1f,0x2da82da8,0xafa8a8a5,0x2fd9a63e,0xae2f2d13
.long 0xb0008000,0x2ea7ac72,0xaa1f2f64,0xa63eafd9,0x2da8ada8,0xa2462ff6,0xac72aea7,0x2fa828a5
.long 0x3000,0xada8ada8,0x30000000,0xada82da8,0xada8ada8,0x2ff6a246,0xac722ea7,0xa8a5afa8
.long 0x30000000,0xac722ea7,0xaa1faf64,0x2fd9263e,0xada82da8,0xa8a5afa8,0x2fd9263e,0xad132e2f
.long 0xb000,0x2f642a1f,0xada82da8,0xaa1faf64,0x2da82da8,0xaf0e2b8b,0xa63eafd9,0x2ff62246
.long 0xb0008000,0x263eafd9,0x2f642a1f,0xac722ea7,0x2da8ada8,0x2d132e2f,0xaea72c72,0xab8baf0e
.long 0x3000,0xb000,0x3000,0xb000,0xaf64aa1f,0x2fa828a5,0xafd9a63e,0x2ff62246
.long 0x2da8ada8,0xac722ea7,0x2a1faf64,0xa63e2fd9,0x2a1f2f64,0xad13ae2f,0x2ea72c72,0xafa8a8a5
.long 0xb0008000,0x2f64aa1f,0xada82da8,0x2a1faf64,0x2a1faf64,0x22462ff6,0xac72aea7,0x2f0e2b8b
.long 0x2da82da8,0xafd9a63e,0x2f64aa1f,0xac722ea7,0xaf642a1f,0x2b8baf0e,0x263e2fd9,0xae2fad13
.long 0xb000,0x2da82da8,0xb0008000,0x2da8ada8,0x2f642a1f,0xaf0e2b8b,0x263eafd9,0x2d132e2f
.long 0xada82da8,0xa63eafd9,0x2f642a1f,0xaea72c72,0xaa1faf64,0x2ff62246,0xac722ea7,0xab8baf0e
.long 0x30000000,0xaa1f2f64,0xada8ada8,0x2f64aa1f,0xaa1f2f64,0xae2fad13,0x2ea7ac72,0x28a52fa8
.long 0xada8ada8,0x2ea7ac72,0x2a1f2f64,0xafd9263e,0x2f64aa1f,0x28a52fa8,0xafd9263e,0xa246aff6
.long 0x3000,0xb000,0x3000,0xb000,0xb0008000,0x2ff6a246,0xafd9263e,0x2fa8a8a5
.long 0xb000,0x263e2fd9,0xaa1faf64,0x2c722ea7,0x30000000,0xafa828a5,0x2ea7ac72,0xad132e2f
.long 0x3000,0xaa1faf64,0x2da82da8,0xaf64aa1f,0xb0008000,0x2f0eab8b,0xac722ea7,0x2246aff6
.long 0xb000,0x2c722ea7,0xaf64aa1f,0x2fd9a63e,0x30000000,0xae2f2d13,0x263eafd9,0x2b8b2f0e
.long 0x3000,0xada8ada8,0x30000000,0xada82da8,0xb0008000,0x2d13ae2f,0x263e2fd9,0xaf0eab8b
.long 0xb000,0x2ea72c72,0xaf642a1f,0x263eafd9,0x30000000,0xab8b2f0e,0xac72aea7,0x2ff6a246
.long 0x3000,0xaf64aa1f,0x2da8ada8,0x2a1f2f64,0xb0008000,0x28a5afa8,0x2ea72c72,0xae2f2d13
.long 0xb000,0x2fd9263e,0xaa1f2f64,0xaea7ac72,0x30000000,0xa2462ff6,0xafd9a63e,0x28a5afa8
.long 0x3000,0xb000,0x3000,0xb000,0xaf642a1f,0x2f0eab8b,0xaea72c72,0x2e2fad13
.long 0xada8ada8,0x2ea72c72,0xaf64aa1f,0x2fd9263e,0x2a1faf64,0xa2462ff6,0xa63eafd9,0x2b8b2f0e
.long 0x30000000,0xaf642a1f,0x2da8ada8,0xaa1f2f64,0x2a1f2f64,0xae2fad13,0x2fd9263e,0xafa828a5
.long 0xada82da8,0x263eafd9,0x2a1f2f64,0xaea7ac72,0xaf64aa1f,0x2fa8a8a5,0xac722ea7,0xa246aff6
.long 0xb000,0x2da82da8,0xb0008000,0x2da8ada8,0x2f64aa1f,0xa8a52fa8,0xac72aea7,0x2ff62246
.long 0x2da82da8,0xafd9263e,0x2a1faf64,0x2c722ea7,0xaa1f2f64,0xad13ae2f,0x2fd9a63e,0xa8a52fa8
.long 0xb0008000,0x2a1faf64,0x2da82da8,0xaf642a1f,0xaa1faf64,0x2ff6a246,0xa63e2fd9,0xaf0eab8b
.long 0x2da8ada8,0x2c722ea7,0xaf642a1f,0xa63eafd9,0x2f642a1f,0xab8b2f0e,0xaea7ac72,0x2d13ae2f
.long 0x3000,0xb000,0x3000,0xb000,0xada82da8,0x2d13ae2f,0xac722ea7,0x2b8baf0e
.long 0xb0008000,0x2fd9a63e,0xaf642a1f,0x2ea7ac72,0xada8ada8,0x2f0e2b8b,0xafd9a63e,0x2ff6a246
.long 0xb000,0x2a1f2f64,0xada8ada8,0x2f642a1f,0x2da8ada8,0xa8a52fa8,0xa63eafd9,0x2d132e2f
.long 0x30000000,0xaea72c72,0x2a1faf64,0x263e2fd9,0x2da82da8,0xaff6a246,0x2ea7ac72,0xa8a52fa8
.long 0x3000,0xada8ada8,0x30000000,0xada82da8,0xada82da8,0xa246aff6,0x2ea72c72,0xafa828a5
.long 0xb0008000,0x2c72aea7,0x2a1f2f64,0xafd9a63e,0xada8ada8,0x2fa8a8a5,0xa63e2fd9,0xae2fad13
.long 0xb000,0x2f642a1f,0xada82da8,0xaa1faf64,0x2da8ada8,0x2b8b2f0e,0xafd9263e,0x2246aff6
.long 0x30000000,0xa63e2fd9,0xaf64aa1f,0x2c72aea7,0x2da82da8,0xae2f2d13,0xac72aea7,0x2f0eab8b
.long 0x3000,0xb000,0x3000,0xb000,0xaa1f2f64,0x28a5afa8,0xa63e2fd9,0x2246aff6
.long 0xada82da8,0x2c72aea7,0xaa1f2f64,0x263eafd9,0xaf642a1f,0x2e2fad13,0xac722ea7,0x28a5afa8
.long 0xb0008000,0x2f64aa1f,0xada82da8,0x2a1faf64,0xaf64aa1f,0x2ff6a246,0xaea72c72,0x2b8baf0e
.long 0xada8ada8,0x2fd9263e,0xaf642a1f,0x2c72aea7,0xaa1faf64,0x2f0e2b8b,0xafd9263e,0x2d13ae2f
.long 0xb000,0x2da82da8,0xb0008000,0x2da8ada8,0x2a1faf64,0x2b8b2f0e,0xafd9a63e,0x2e2fad13
.long 0x2da8ada8,0x263e2fd9,0xaf64aa1f,0x2ea7ac72,0x2f64aa1f,0xa2462ff6,0xaea7ac72,0x2f0eab8b
.long 0x30000000,0xaa1f2f64,0xada8ada8,0x2f64aa1f,0x2f642a1f,0xad132e2f,0xac72aea7,0x2fa8a8a5
.long 0x2da82da8,0xaea72c72,0xaa1faf64,0x2fd9a63e,0x2a1f2f64,0xafa828a5,0xa63eafd9,0x2ff6a246
.long 0x30008000,0xb0008000,0x30008000,0xb0008000,0x30008000,0xaff62246,0x2fd9a63e,0xafa828a5
.long 0x30008000,0xafd9263e,0x2f64aa1f,0xaea72c72,0x30008000,0xafa828a5,0x2ea7ac72,0xad132e2f
.long 0x30008000,0xaf642a1f,0x2da8ada8,0xaa1f2f64,0x30008000,0xaf0e2b8b,0x2c72aea7,0xa2462ff6
.long 0x30008000,0xaea72c72,0x2a1faf64,0x263e2fd9,0x30008000,0xae2f2d13,0x263eafd9,0x2b8b2f0e
.long 0x30008000,0xada82da8,0xb000,0x2da82da8,0x30008000,0xad132e2f,0xa63eafd9,0x2f0e2b8b
.long 0x30008000,0xac722ea7,0xaa1faf64,0x2fd9263e,0x30008000,0xab8b2f0e,0xac72aea7,0x2ff6a246
.long 0x30008000,0xaa1f2f64,0xada8ada8,0x2f64aa1f,0x30008000,0xa8a52fa8,0xaea7ac72,0x2e2fad13
.long 0x30008000,0xa63e2fd9,0xaf64aa1f,0x2c72aea7,0x30008000,0xa2462ff6,0xafd9a63e,0x28a5afa8
.long 0x30008000,0xb0008000,0x30008000,0xb0008000,0x2f64aa1f,0xaf0e2b8b,0x2ea7ac72,0xae2f2d13
.long 0x2da8ada8,0xac722ea7,0x2a1faf64,0xa63e2fd9,0x2a1faf64,0xa2462ff6,0xa63eafd9,0x2b8b2f0e
.long 0xb000,0x2a1f2f64,0xada8ada8,0x2f642a1f,0xaa1faf64,0x2e2f2d13,0xafd9a63e,0x2fa8a8a5
.long 0xada8ada8,0x2fd9263e,0xaf642a1f,0x2c72aea7,0xaf64aa1f,0x2fa8a8a5,0xac722ea7,0xa246aff6
.long 0xb0008000,0x2da8ada8,0x80003000,0xada8ada8,0xaf642a1f,0x28a5afa8,0x2c722ea7,0xaff6a246
.long 0xada82da8,0xa63eafd9,0x2f642a1f,0xaea72c72,0xaa1f2f64,0xad13ae2f,0x2fd9a63e,0xa8a52fa8
.long 0x80003000,0xaf64aa1f,0x2da8ada8,0x2a1f2f64,0x2a1f2f64,0xaff62246,0x263eafd9,0x2f0e2b8b
.long 0x2da82da8,0xaea72c72,0xaa1faf64,0x2fd9a63e,0x2f642a1f,0xab8b2f0e,0xaea7ac72,0x2d13ae2f
.long 0x30008000,0xb0008000,0x30008000,0xb0008000,0x2da8ada8,0xad132e2f,0x2c72aea7,0xab8b2f0e
.long 0xb000,0x263e2fd9,0xaa1faf64,0x2c722ea7,0xada8ada8,0x2f0e2b8b,0xafd9a63e,0x2ff6a246
.long 0xb0008000,0x2f64aa1f,0xada82da8,0x2a1faf64,0xada82da8,0x28a5afa8,0x263e2fd9,0xad13ae2f
.long 0x80003000,0xac72aea7,0x2f642a1f,0xafd9263e,0x2da82da8,0xaff6a246,0x2ea7ac72,0xa8a52fa8
.long 0x30008000,0xada82da8,0xb000,0x2da82da8,0x2da8ada8,0x22462ff6,0xaea7ac72,0x2fa8a8a5
.long 0xb000,0x2ea72c72,0xaf642a1f,0x263eafd9,0xada8ada8,0x2fa8a8a5,0xa63e2fd9,0xae2fad13
.long 0xb0008000,0x2a1faf64,0x2da82da8,0xaf642a1f,0xada82da8,0xab8baf0e,0x2fd9a63e,0xa2462ff6
.long 0x80003000,0xafd9a63e,0x2a1faf64,0x2ea72c72,0x2da82da8,0xae2f2d13,0xac72aea7,0x2f0eab8b
.long 0x30008000,0xb0008000,0x30008000,0xb0008000,0x2a1faf64,0xa8a52fa8,0x263eafd9,0xa2462ff6
.long 0xada8ada8,0x2ea72c72,0xaf64aa1f,0x2fd9263e,0xaf642a1f,0x2e2fad13,0xac722ea7,0x28a5afa8
.long 0x80003000,0xaa1faf64,0x2da82da8,0xaf64aa1f,0x2f642a1f,0xaff62246,0x2ea7ac72,0xab8b2f0e
.long 0x2da8ada8,0xa63e2fd9,0xaa1faf64,0x2ea72c72,0xaa1faf64,0x2f0e2b8b,0xafd9263e,0x2d13ae2f
.long 0xb0008000,0x2da8ada8,0x80003000,0xada8ada8,0xaa1f2f64,0xab8baf0e,0x2fd9263e,0xae2f2d13
.long 0x2da82da8,0xafd9263e,0x2a1faf64,0x2c722ea7,0x2f64aa1f,0xa2462ff6,0xaea7ac72,0x2f0eab8b
.long 0xb000,0x2f642a1f,0xada82da8,0xaa1faf64,0xaf64aa1f,0x2d13ae2f,0x2c722ea7,0xafa828a5
.long 0xada82da8,0xac72aea7,0x2f64aa1f,0x263e2fd9,0x2a1f2f64,0xafa828a5,0xa63eafd9,0x2ff6a246
.long 0x30008000,0xb0008000,0x30008000,0xb0008000,0xb000,0x22462ff6,0xa63eafd9,0x28a52fa8
.long 0xb0008000,0x2fd9a63e,0xaf642a1f,0x2ea7ac72,0x80003000,0xa8a5afa8,0x2c722ea7,0xae2fad13
.long 0x30008000,0xaf642a1f,0x2da8ada8,0xaa1f2f64,0xb000,0x2b8b2f0e,0xaea7ac72,0x2ff62246
.long 0xb0008000,0x2ea7ac72,0xaa1f2f64,0xa63eafd9,0x80003000,0xad13ae2f,0x2fd9263e,0xaf0e2b8b
.long 0x30008000,0xada82da8,0xb000,0x2da82da8,0xb000,0x2e2f2d13,0xafd9263e,0x2b8baf0e
.long 0xb0008000,0x2c72aea7,0x2a1f2f64,0xafd9a63e,0x80003000,0xaf0eab8b,0x2ea7ac72,0x22462ff6
.long 0x30008000,0xaa1f2f64,0xada8ada8,0x2f64aa1f,0xb000,0x2fa828a5,0xac722ea7,0xad13ae2f
.long 0xb0008000,0x263eafd9,0x2f642a1f,0xac722ea7,0x80003000,0xaff6a246,0x263eafd9,0x2fa828a5
.long 0x30008000,0xb0008000,0x30008000,0xb0008000,0xaa1faf64,0x2b8b2f0e,0xac72aea7,0x2d132e2f
.long 0xada82da8,0x2c72aea7,0xaa1f2f64,0x263eafd9,0x2f642a1f,0xaff6a246,0x2fd9a63e,0xaf0e2b8b
.long 0xb000,0x2a1f2f64,0xada8ada8,0x2f642a1f,0xaf642a1f,0x2d13ae2f,0xa63e2fd9,0xa8a5afa8
.long 0x2da82da8,0xafd9a63e,0x2f64aa1f,0xac722ea7,0x2a1faf64,0x28a52fa8,0xaea7ac72,0x2ff6a246
.long 0xb0008000,0x2da8ada8,0x80003000,0xada8ada8,0x2a1f2f64,0xafa8a8a5,0x2ea7ac72,0xa2462ff6
.long 0x2da8ada8,0x263e2fd9,0xaf64aa1f,0x2ea7ac72,0xaf64aa1f,0x2e2fad13,0x263e2fd9,0xafa8a8a5
.long 0x80003000,0xaf64aa1f,0x2da8ada8,0x2a1f2f64,0x2f64aa1f,0x22462ff6,0xafd9a63e,0x2b8baf0e
.long 0xada8ada8,0x2ea7ac72,0x2a1f2f64,0xafd9263e,0xaa1f2f64,0xaf0eab8b,0x2c72aea7,0x2e2f2d13
.long 0x30008000,0xb0008000,0x30008000,0xb0008000,0xada8ada8,0x2e2f2d13,0xaea7ac72,0x2f0e2b8b
.long 0x80003000,0xa63eafd9,0x2a1f2f64,0xac72aea7,0x2da8ada8,0xab8b2f0e,0x263eafd9,0x22462ff6
.long 0xb0008000,0x2f64aa1f,0xada82da8,0x2a1faf64,0x2da82da8,0xafa8a8a5,0x2fd9a63e,0xae2f2d13
.long 0xb000,0x2c722ea7,0xaf64aa1f,0x2fd9a63e,0xada82da8,0x2246aff6,0x2c722ea7,0xafa8a8a5
.long 0x30008000,0xada82da8,0xb000,0x2da82da8,0xada8ada8,0x2ff6a246,0xac722ea7,0xa8a5afa8
.long 0x80003000,0xaea7ac72,0x2f64aa1f,0xa63e2fd9,0x2da8ada8,0x28a52fa8,0xafd9a63e,0x2d13ae2f
.long 0xb0008000,0x2a1faf64,0x2da82da8,0xaf642a1f,0x2da82da8,0xaf0e2b8b,0xa63eafd9,0x2ff62246
.long 0xb000,0x2fd9263e,0xaa1f2f64,0xaea7ac72,0xada82da8,0xad13ae2f,0x2ea7ac72,0x2b8b2f0e
.long 0x30008000,0xb0008000,0x30008000,0xb0008000,0xaf64aa1f,0x2fa828a5,0xafd9a63e,0x2ff62246
.long 0x2da82da8,0xaea7ac72,0x2f642a1f,0xafd9a63e,0xaa1faf64,0x2d132e2f,0xaea7ac72,0x2fa828a5
.long 0x80003000,0xaa1faf64,0x2da82da8,0xaf64aa1f,0x2a1faf64,0x22462ff6,0xac72aea7,0x2f0e2b8b
.long 0xada82da8,0x263eafd9,0x2a1f2f64,0xaea7ac72,0x2f64aa1f,0xab8b2f0e,0xa63eafd9,0x2e2f2d13
.long 0xb0008000,0x2da8ada8,0x80003000,0xada8ada8,0x2f642a1f,0xaf0e2b8b,0x263eafd9,0x2d132e2f
.long 0xada8ada8,0x2fd9a63e,0xaa1f2f64,0xac72aea7,0x2a1f2f64,0xaff6a246,0x2c72aea7,0x2b8b2f0e
.long 0xb000,0x2f642a1f,0xada82da8,0xaa1faf64,0xaa1f2f64,0xae2fad13,0x2ea7ac72,0x28a52fa8
.long 0x2da8ada8,0x2c722ea7,0xaf642a1f,0xa63eafd9,0xaf642a1f,0xa8a5afa8,0x2fd9a63e,0x22462ff6
.long 0x30008000,0xb0008000,0x30008000,0xb0008000,0xb0008000,0x2ff6a246,0xafd9263e,0x2fa8a8a5
.long 0x30008000,0xafd9263e,0x2f64aa1f,0xaea72c72,0xb0008000,0x2fa8a8a5,0xaea72c72,0x2d13ae2f
.long 0x30008000,0xaf642a1f,0x2da8ada8,0xaa1f2f64,0xb0008000,0x2f0eab8b,0xac722ea7,0x2246aff6
.long 0x30008000,0xaea72c72,0x2a1faf64,0x263e2fd9,0xb0008000,0x2e2fad13,0xa63e2fd9,0xab8baf0e
.long 0x30008000,0xada82da8,0xb000,0x2da82da8,0xb0008000,0x2d13ae2f,0x263e2fd9,0xaf0eab8b
.long 0x30008000,0xac722ea7,0xaa1faf64,0x2fd9263e,0xb0008000,0x2b8baf0e,0x2c722ea7,0xaff62246
.long 0x30008000,0xaa1f2f64,0xada8ada8,0x2f64aa1f,0xb0008000,0x28a5afa8,0x2ea72c72,0xae2f2d13
.long 0x30008000,0xa63e2fd9,0xaf64aa1f,0x2c72aea7,0xb0008000,0x2246aff6,0x2fd9263e,0xa8a52fa8
.long 0x30008000,0xb0008000,0x30008000,0xb0008000,0xaf642a1f,0x2f0eab8b,0xaea72c72,0x2e2fad13
.long 0x2da8ada8,0xac722ea7,0x2a1faf64,0xa63e2fd9,0xaa1f2f64,0x2246aff6,0x263e2fd9,0xab8baf0e
.long 0xb000,0x2a1f2f64,0xada8ada8,0x2f642a1f,0x2a1f2f64,0xae2fad13,0x2fd9263e,0xafa828a5
.long 0xada8ada8,0x2fd9263e,0xaf642a1f,0x2c72aea7,0x2f642a1f,0xafa828a5,0x2c72aea7,0x22462ff6
.long 0xb0008000,0x2da8ada8,0x80003000,0xada8ada8,0x2f64aa1f,0xa8a52fa8,0xac72aea7,0x2ff62246
.long 0xada82da8,0xa63eafd9,0x2f642a1f,0xaea72c72,0x2a1faf64,0x2d132e2f,0xafd9263e,0x28a5afa8
.long 0x80003000,0xaf64aa1f,0x2da8ada8,0x2a1f2f64,0xaa1faf64,0x2ff6a246,0xa63e2fd9,0xaf0eab8b
.long 0x2da82da8,0xaea72c72,0xaa1faf64,0x2fd9a63e,0xaf64aa1f,0x2b8baf0e,0x2ea72c72,0xad132e2f
.long 0x30008000,0xb0008000,0x30008000,0xb0008000,0xada82da8,0x2d13ae2f,0xac722ea7,0x2b8baf0e
.long 0xb000,0x263e2fd9,0xaa1faf64,0x2c722ea7,0x2da82da8,0xaf0eab8b,0x2fd9263e,0xaff62246
.long 0xb0008000,0x2f64aa1f,0xada82da8,0x2a1faf64,0x2da8ada8,0xa8a52fa8,0xa63eafd9,0x2d132e2f
.long 0x80003000,0xac72aea7,0x2f642a1f,0xafd9263e,0xada8ada8,0x2ff62246,0xaea72c72,0x28a5afa8
.long 0x30008000,0xada82da8,0xb000,0x2da82da8,0xada82da8,0xa246aff6,0x2ea72c72,0xafa828a5
.long 0xb000,0x2ea72c72,0xaf642a1f,0x263eafd9,0x2da82da8,0xafa828a5,0x263eafd9,0x2e2f2d13
.long 0xb0008000,0x2a1faf64,0x2da82da8,0xaf642a1f,0x2da8ada8,0x2b8b2f0e,0xafd9263e,0x2246aff6
.long 0x80003000,0xafd9a63e,0x2a1faf64,0x2ea72c72,0xada8ada8,0x2e2fad13,0x2c722ea7,0xaf0e2b8b
.long 0x30008000,0xb0008000,0x30008000,0xb0008000,0xaa1f2f64,0x28a5afa8,0xa63e2fd9,0x2246aff6
.long 0xada8ada8,0x2ea72c72,0xaf64aa1f,0x2fd9263e,0x2f64aa1f,0xae2f2d13,0x2c72aea7,0xa8a52fa8
.long 0x80003000,0xaa1faf64,0x2da82da8,0xaf64aa1f,0xaf64aa1f,0x2ff6a246,0xaea72c72,0x2b8baf0e
.long 0x2da8ada8,0xa63e2fd9,0xaa1faf64,0x2ea72c72,0x2a1f2f64,0xaf0eab8b,0x2fd9a63e,0xad132e2f
.long 0xb0008000,0x2da8ada8,0x80003000,0xada8ada8,0x2a1faf64,0x2b8b2f0e,0xafd9a63e,0x2e2fad13
.long 0x2da82da8,0xafd9263e,0x2a1faf64,0x2c722ea7,0xaf642a1f,0x2246aff6,0x2ea72c72,0xaf0e2b8b
.long 0xb000,0x2f642a1f,0xada82da8,0xaa1faf64,0x2f642a1f,0xad132e2f,0xac72aea7,0x2fa8a8a5
.long 0xada82da8,0xac72aea7,0x2f64aa1f,0x263e2fd9,0xaa1faf64,0x2fa8a8a5,0x263e2fd9,0xaff62246
.long 0x30008000,0xb0008000,0x30008000,0xb0008000,0x80003000,0xa246aff6,0x263e2fd9,0xa8a5afa8
.long 0xb0008000,0x2fd9a63e,0xaf642a1f,0x2ea7ac72,0xb000,0x28a52fa8,0xac72aea7,0x2e2f2d13
.long 0x30008000,0xaf642a1f,0x2da8ada8,0xaa1f2f64,0x80003000,0xab8baf0e,0x2ea72c72,0xaff6a246
.long 0xb0008000,0x2ea7ac72,0xaa1f2f64,0xa63eafd9,0xb000,0x2d132e2f,0xafd9a63e,0x2f0eab8b
.long 0x30008000,0xada82da8,0xb000,0x2da82da8,0x80003000,0xae2fad13,0x2fd9a63e,0xab8b2f0e
.long 0xb0008000,0x2c72aea7,0x2a1f2f64,0xafd9a63e,0xb000,0x2f0e2b8b,0xaea72c72,0xa246aff6
.long 0x30008000,0xaa1f2f64,0xada8ada8,0x2f64aa1f,0x80003000,0xafa8a8a5,0x2c72aea7,0x2d132e2f
.long 0xb0008000,0x263eafd9,0x2f642a1f,0xac722ea7,0xb000,0x2ff62246,0xa63e2fd9,0xafa8a8a5
.long 0x30008000,0xb0008000,0x30008000,0xb0008000,0x2a1f2f64,0xab8baf0e,0x2c722ea7,0xad13ae2f
.long 0xada82da8,0x2c72aea7,0xaa1f2f64,0x263eafd9,0xaf64aa1f,0x2ff62246,0xafd9263e,0x2f0eab8b
.long 0xb000,0x2a1f2f64,0xada8ada8,0x2f642a1f,0x2f64aa1f,0xad132e2f,0x263eafd9,0x28a52fa8
.long 0x2da82da8,0xafd9a63e,0x2f64aa1f,0xac722ea7,0xaa1f2f64,0xa8a5afa8,0x2ea72c72,0xaff62246
.long 0xb0008000,0x2da8ada8,0x80003000,0xada8ada8,0xaa1faf64,0x2fa828a5,0xaea72c72,0x2246aff6
.long 0x2da8ada8,0x263e2fd9,0xaf64aa1f,0x2ea7ac72,0x2f642a1f,0xae2f2d13,0xa63eafd9,0x2fa828a5
.long 0x80003000,0xaf64aa1f,0x2da8ada8,0x2a1f2f64,0xaf642a1f,0xa246aff6,0x2fd9263e,0xab8b2f0e
.long 0xada8ada8,0x2ea7ac72,0x2a1f2f64,0xafd9263e,0x2a1faf64,0x2f0e2b8b,0xac722ea7,0xae2fad13
.long 0x30008000,0xb0008000,0x30008000,0xb0008000,0x2da82da8,0xae2fad13,0x2ea72c72,0xaf0eab8b
.long 0x80003000,0xa63eafd9,0x2a1f2f64,0xac72aea7,0xada82da8,0x2b8baf0e,0xa63e2fd9,0xa246aff6
.long 0xb0008000,0x2f64aa1f,0xada82da8,0x2a1faf64,0xada8ada8,0x2fa828a5,0xafd9263e,0x2e2fad13
.long 0xb000,0x2c722ea7,0xaf64aa1f,0x2fd9a63e,0x2da8ada8,0xa2462ff6,0xac72aea7,0x2fa828a5
.long 0x30008000,0xada82da8,0xb000,0x2da82da8,0x2da82da8,0xaff62246,0x2c72aea7,0x28a52fa8
.long 0x80003000,0xaea7ac72,0x2f64aa1f,0xa63e2fd9,0xada82da8,0xa8a5afa8,0x2fd9263e,0xad132e2f
.long 0xb0008000,0x2a1faf64,0x2da82da8,0xaf642a1f,0xada8ada8,0x2f0eab8b,0x263e2fd9,0xaff6a246
.long 0xb000,0x2fd9263e,0xaa1f2f64,0xaea7ac72,0x2da8ada8,0x2d132e2f,0xaea72c72,0xab8baf0e
.long 0x30008000,0xb0008000,0x30008000,0xb0008000,0x2f642a1f,0xafa8a8a5,0x2fd9263e,0xaff6a246
.long 0x2da82da8,0xaea7ac72,0x2f642a1f,0xafd9a63e,0x2a1f2f64,0xad13ae2f,0x2ea72c72,0xafa8a8a5
.long 0x80003000,0xaa1faf64,0x2da82da8,0xaf64aa1f,0xaa1f2f64,0xa246aff6,0x2c722ea7,0xaf0eab8b
.long 0xada82da8,0x263eafd9,0x2a1f2f64,0xaea7ac72,0xaf642a1f,0x2b8baf0e,0x263e2fd9,0xae2fad13
.long 0xb0008000,0x2da8ada8,0x80003000,0xada8ada8,0xaf64aa1f,0x2f0eab8b,0xa63e2fd9,0xad13ae2f
.long 0xada8ada8,0x2fd9a63e,0xaa1f2f64,0xac72aea7,0xaa1faf64,0x2ff62246,0xac722ea7,0xab8baf0e
.long 0xb000,0x2f642a1f,0xada82da8,0xaa1faf64,0x2a1faf64,0x2e2f2d13,0xaea72c72,0xa8a5afa8
.long 0x2da8ada8,0x2c722ea7,0xaf642a1f,0xa63eafd9,0x2f64aa1f,0x28a52fa8,0xafd9263e,0xa246aff6
.long 0x80003c00,0xae463bf6,0xb23e3bd9,0xb4a53ba8,0x80003c00,0xae783bf6,0xb26f3bd6,0xb4c93ba2
.long 0x80003c00,0xaeaa3bf5,0xb2a13bd4,0xb4ed3b9d,0x80003c00,0xaedc3bf4,0xb2d23bd1,0xb5113b97
.long 0x80003c00,0xaf0e3bf4,0xb3033bce,0xb5343b91,0x80003c00,0xaf403bf3,0xb3343bcb,0xb5583b8a
.long 0x80003c00,0xaf723bf2,0xb3653bc9,0xb57c3b84,0x80003c00,0xafa43bf1,0xb3963bc6,0xb59f3b7d
.long 0x80003c00,0xafd63bf1,0xb3c63bc3,0xb5c23b77,0x80003c00,0xb0043bf0,0xb3f73bc0,0xb5e53b70
.long 0x80003c00,0xb01d3bef,0xb4143bbc,0xb6083b69,0x80003c00,0xb0363bee,0xb42c3bb9,0xb62b3b62
.long 0x80003c00,0xb04e3bed,0xb4443bb6,0xb64e3b5a,0x80003c00,0xb0673bed,0xb45d3bb2,0xb6703b53
.long 0x80003c00,0xb0803bec,0xb4753baf,0xb6933b4b,0x80003c00,0xb0993beb,0xb48d3bab,0xb6b53b43
.long 0xb61f3b64,0xb78b3b0e,0xb8723aa7,0xb9133a2f,0xb64e3b5a,0xb7c23aff,0xb8913a92,0xb9353a13
.long 0xb67c3b50,0xb7f93af0,0xb8b03a7c,0xb95639f6,0xb6aa3b46,0xb8173ae0,0xb8ce3a65,0xb97639d8
.long 0xb6d73b3b,0xb8323ad0,0xb8ec3a4f,0xb99639ba,0xb7053b30,0xb84d3abf,0xb9093a37,0xb9b5399b
.long 0xb7323b25,0xb8673aae,0xb9273a1f,0xb9d4397b,0xb75e3b1a,0xb8813a9c,0xb9433a07,0xb9f2395b
.long 0xb78b3b0e,0xb89b3a8a,0xb95f39ed,0xba0f393a,0xb7b73b02,0xb8b53a78,0xb97b39d4,0xba2b3918
.long 0xb7e33af6,0xb8ce3a65,0xb99639ba,0xba4738f6,0xb8073ae9,0xb8e73a52,0xb9b1399f,0xba6238d3
.long 0xb81d3add,0xb9003a3f,0xb9cb3984,0xba7c38b0,0xb8323ad0,0xb9183a2b,0xb9e53969,0xba95388c
.long 0xb8483ac2,0xb9303a17,0xb9fe394d,0xbaae3867,0xb85d3ab5,0xb9483a02,0xba173930,0xbac63842
.long 0xb9a839a8,0xba2f3913,0xbaa73872,0xbb0e378b,0xb9cb3984,0xba5238e7,0xbac9383d,0xbb2e3710
.long 0xb9ed395f,0xba7438ba,0xbae93807,0xbb4b3693,0xba0f393a,0xba95388c,0xbb0837a1,0xbb673614
.long 0xba2f3913,0xbab5385d,0xbb253732,0xbb803593,0xba4f38ec,0xbad3382d,0xbb4136c1,0xbb973511
.long 0xba6d38c4,0xbaf037f9,0xbb5a364e,0xbbab348d,0xba8a389b,0xbb0b3796,0xbb7235da,0xbbbe3408
.long 0xbaa73872,0xbb253732,0xbb883564,0xbbce3303,0xbac23848,0xbb3e36cc,0xbb9d34ed,0xbbdc31f4
.long 0xbadd381d,0xbb553665,0xbbaf3475,0xbbe830e4,0xbaf637e3,0xbb6b35fd,0xbbc033f7,0xbbf12fa4
.long 0xbb0e378b,0xbb803593,0xbbce3303,0xbbf82d7e,0xbb253732,0xbb933529,0xbbdb320d,0xbbfd2aac
.long 0xbb3b36d7,0xbba434bd,0xbbe63115,0xbc0024b6,0xbb50367c,0xbbb43451,0xbbef301d,0xbc00a3db
.long 0xbb64361f,0xbba834a5,0xbbd9323e,0xbbf62e46,0xbb803593,0xbbbe3408,0xbbe830e4,0xbbfd2aac
.long 0xbb993505,0xbbd132d2,0xbbf42f0e,0xbc001e48,0xbbaf3475,0xbbe13191,0xbbfb2c51,0xbbfea91b
.long 0xbbc333c6,0xbbed304e,0xbbff2648,0xbbf8ad7e,0xbbd432a1,0xbbf72e14,0xbc00a4b6,0xbbeeb036
.long 0xbbe23179,0xbbfd2b11,0xbbfcabd9,0xbbe0b1aa,0xbbed304e,0xbc0023db,0xbbf5aeaa,0xbbcdb31b
.long 0xbbf62e46,0xbbffa648,0xbbeab0b2,0xbbb6b444,0xbbfc2bd9,0xbbfcac1f,0xbbdbb20d,0xbb9bb4f9
.long 0xbbff2648,0xbbf5aeaa,0xbbc9b365,0xbb7bb5ab,0xbc00a248,0xbbebb099,0xbbb2b45d,0xbb58b659
.long 0xbbfeaa48,0xbbddb1db,0xbb99b505,0xbb30b705,0xbbf8ad7e,0xbbcdb31b,0xbb7bb5ab,0xbb05b7ac
.long 0xbbf1afd6,0xbbb9b42c,0xbb5ab64e,0xbad6b828,0xbbe6b115,0xbba2b4c9,0xbb36b6ee,0xbaa3b877
.long 0xbc000000,0xbbf6ae46,0xbbd9b23e,0xbba8b4a5,0xbbfeaa48,0xbbe9b0cb,0xbbc0b3f7,0xbb82b587
.long 0xbbf6ae46,0xbbd6b26f,0xbba0b4d5,0xbb55b665,0xbbeab0b2,0xbbbeb408,0xbb7bb5ab,0xbb22b73d
.long 0xbbd9b23e,0xbba0b4d5,0xbb50b67c,0xbae9b807,0xbbc3b3c6,0xbb7db59f,0xbb20b748,0xbaaab86d
.long 0xbba8b4a5,0xbb55b665,0xbae9b807,0xba65b8ce,0xbb88b564,0xbb28b726,0xbaaeb867,0xba1bb92b
.long 0xbb64b61f,0xbaf6b7e3,0xba6db8c4,0xb9cbb984,0xbb3bb6d7,0xbabfb84d,0xba27b91d,0xb976b9d8
.long 0xbb0eb78b,0xba83b8a6,0xb9dcb972,0xb91dba27,0xbaddb81d,0xba43b8fb,0xb98db9c3,0xb8bfba71
.long 0xbaa7b872,0xb9feb94d,0xb93aba0f,0xb85dbab5,0xba6db8c4,0xb9b5b99b,0xb8e2ba56,0xb7eebaf3
.long 0xba2fb913,0xb969b9e5,0xb887ba99,0xb71bbb2b,0xb9edb95f,0xb918ba2b,0xb828bad6,0xb642bb5d
.long 0xbb64b61f,0xbb0eb78b,0xbaa7b872,0xba2fb913,0xbb30b705,0xbaccb838,0xba56b8e2,0xb9d0b980
.long 0xbaf6b7e3,0xba83b8a6,0xb9feb94d,0xb969b9e5,0xbab5b85d,0xba33b90e,0xb99fb9b1,0xb8fbba43
.long 0xba6db8c4,0xb9dcb972,0xb93aba0f,0xb887ba99,0xba1fb927,0xb980b9d0,0xb8ceba65,0xb80dbae6
.long 0xb9cbb984,0xb91dba27,0xb85dbab5,0xb71bbb2b,0xb972b9dc,0xb8b5ba78,0xb7cdbafc,0xb614bb67
.long 0xb913ba2f,0xb848bac2,0xb6d7bb3b,0xb505bb99,0xb8b0ba7c,0xb7acbb05,0xb5dabb72,0xb3dfbbc1
.long 0xb848bac2,0xb6c1bb41,0xb4d5bba0,0xb1aabbe0,0xb7b7bb02,0xb5cebb74,0xb396bbc6,0xaedcbbf4
.long 0xb6d7bb3b,0xb4d5bba0,0xb179bbe2,0xa8b6bbff,0xb5f1bb6e,0xb3aebbc4,0xaeaabbf5,0x2852bbff
.long 0xb505bb99,0xb1aabbe0,0xa8b6bbff,0x2eaabbf5,0xb414bbbc,0xaf40bbf3,0x27dabbff,0x3191bbe1
.long 0xb9a8b9a8,0xb913ba2f,0xb872baa7,0xb78bbb0e,0xb93aba0f,0xb896ba8e,0xb7cdbafc,0xb659bb58
.long 0xb8c4ba6d,0xb812bae3,0xb6aabb46,0xb51dbb95,0xb848bac2,0xb710bb2e,0xb57cbb84,0xb3aebbc4
.long 0xb78bbb0e,0xb5f1bb6e,0xb444bbb6,0xb115bbe6,0xb67cbb50,0xb4c9bba2,0xb20dbbdb,0xace7bbfa
.long 0xb564bb88,0xb334bbcb,0xaf0ebbf4,0x1e48bc00,0xb444bbb6,0xb0cbbbe9,0xa7dabbff,0x2db0bbf8
.long 0xb23ebbd9,0xacb5bbfa,0x2a48bbfe,0x3179bbe2,0xafd6bbf1,0x1a48bc00,0x301dbbef,0x3408bbbe
.long 0xaa48bbfe,0x2d1abbf9,0x32a1bbd4,0x354cbb8c,0x2648bbff,0x30fdbbe7,0x348dbbab,0x3687bb4e
.long 0x2e46bbf6,0x3365bbc9,0x35c2bb77,0x37b7bb02,0x3179bbe2,0x34e1bb9e,0x36eebb36,0x386dbaaa
.long 0x33c6bbc3,0x3608bb69,0x3807bae9,0x38f6ba47,0x3505bb99,0x3726bb28,0x3891ba92,0x3976b9d8
.long 0xb61fbb64,0xb4a5bba8,0xb23ebbd9,0xae46bbf6,0xb4d5bba0,0xb288bbd5,0xaeaabbf5,0x9a48bc00
.long 0xb303bbce,0xaf72bbf2,0xa248bc00,0x2de2bbf7,0xb04ebbed,0xa711bbff,0x2d1abbf9,0x31f4bbdc
.long 0xaa48bbfe,0x2bd9bbfc,0x3179bbe2,0x3475bbaf,0x28b6bbff,0x30cbbbe9,0x342cbbb9,0x35e5bb70
.long 0x2fd6bbf1,0x3396bbc6,0x3593bb80,0x3748bb20,0x32a1bbd4,0x3529bb93,0x36eebb36,0x384dbabf
.long 0x34a5bba8,0x367cbb50,0x381dbadd,0x38ecba4f,0x35f1bb6e,0x37c2baff,0x38baba74,0x3980b9d0
.long 0x3732bb25,0x387cbaa0,0x394db9fe,0x3a07b943,0x3832bad0,0x390eba33,0x39d4b97b,0x3a7fb8ab
.long 0x38c4ba6d,0x3996b9ba,0x3a4fb8ec,0x3ae9b807,0x394db9fe,0x3a13b935,0x3abcb852,0x3b43b6b5
.long 0x39cbb984,0x3a83b8a6,0x3b1ab75e,0x3b8cb54c,0x3a3fb900,0x3ae6b80d,0x3b69b608,0x3bc4b3ae
.long 0xafff3000,0xaffa2ffe,0xaff12ff6,0xafe22fea,0xaff13000,0xaf772fc3,0xae8a2f0e,0xad3a2ded
.long 0xafce3000,0xae4f2f3b,0xab322d13,0x9a4827c6,0xaf993000,0xac9b2e6d,0x1a4828a5,0x2ceca964
.long 0xaf503000,0xa9052d5f,0x2be3a246,0x2fceae6d,0xaef63000,0x9a482c1d,0x2ec2ab8b,0x2f25affe
.long 0xae8a3000,0x28442964,0x2ffaae2f,0x2a7caedd,0xae0f3000,0x2c4824b2,0x2f50afa8,0xa844aad7
.long 0xad843000,0x2e0f9e48,0x2cecaff6,0xae8a24b2,0xacec3000,0x2f50a7c6,0x2579af0e,0xaffa2d5f
.long 0xac483000,0x2ff1aad7,0xa905ad13,0xadcb2fc3,0xab323000,0x2fe2acc4,0xadcba8a5,0xa3d62f88
.long 0xa9c23000,0x2f25aded,0xafb62246,0x2c482cc4,0xa8443000,0x2dcbaedd,0xafce2b8b,0x2f991e48
.long 0xa5793000,0x2be3af88,0xae0f2e2f,0x2f77ac1d,0xa0b53000,0x2703afea,0xa9c22fa8,0x2be3af3b
.long 0xafce2fd9,0xafb62fc3,0xaf992fa8,0xaf772f88,0xab322c72,0xa7032964,0x1a482246,0x2844a4b2
.long 0x2a7ca63e,0x2e0facc4,0x2fb6af0e,0x2fe2affe,0x2fb6aea7,0x2f77affe,0x2c48ae2f,0xa0b5a7c6
.long 0x2e8aafd9,0x23d6ac1d,0xad3a28a5,0xafff2f3b,0x20b5ac72,0xae8a2ad7,0xaf502ff6,0xa3d62cc4
.long 0xadcb263e,0xaf252fea,0x23d62b8b,0x2fcead5f,0xaff12ea7,0x9a482d5f,0x2fe2ad13,0x2905aedd
.long 0xac482fd9,0x2ef6a7c6,0x2b32afa8,0xaf502964,0x29052c72,0x2ec2af88,0xadcba246,0xabe32fea
.long 0x2f77a63e,0xa0b5ae6d,0xaef62f0e,0x2e8a1e48,0x2ef6aea7,0xaf501e48,0x27032e2f,0x2d3aafc3
.long 0x2579afd9,0xae4f2edd,0x2ffaa8a5,0xad84aad7,0xad3aac72,0x25792f3b,0x29c2aff6,0xae4f2e6d
.long 0xafff263e,0x2f9924b2,0xae4fab8b,0x2c482ded,0xacec2ea7,0x2dcbaded,0xae8a2d13,0x2f25ac1d
.long 0xaf502f64,0xaf252f3b,0xaef62f0e,0xaec22edd,0x2be3aa1f,0x2d84acc4,0x2ec2ae2f,0x2f99af3b
.long 0x2e8aaf64,0x2be3ad5f,0x20b5a8a5,0xa9c224b2,0xad3a2a1f,0xafce2edd,0xaf502ff6,0xabe32ded
.long 0xad842f64,0x20b52964,0x2e4fab8b,0x2fe2afc3,0x2e4faa1f,0x2f77afea,0x2579ad13,0xae0f2964
.long 0x2c48af64,0xacec1e48,0xaf992fa8,0x9a482cc4,0xaf252a1f,0xac9b2fc3,0x2dcba246,0x2e4faffe
.long 0xa9c22f64,0x2f99aad7,0x2844af0e,0xafce2c1d,0x2fb6aa1f,0x1a48ae6d,0xafce2e2f,0x2b322ad7
.long 0x2579af64,0xafb62ded,0x2d3a28a5,0x2a7cafea,0xaffa2a1f,0x2c482c1d,0x29c2aff6,0xafb62d5f
.long 0x1a482f64,0x2d3aaf88,0xaff12b8b,0x2e8a27c6,0x2ff1aa1f,0xaf50a4b2,0x2c9b2d13,0xa0b5af88
.long 0xa703af64,0xa3d62ffe,0x2b32afa8,0xadcb2e6d,0xaf992a1f,0x2fe2a7c6,0xafff2246,0x2ff11e48
.long 0xae8a2ea7,0xae4f2e6d,0xae0f2e2f,0xadcb2ded,0x2ffaafd9,0x2fe2affe,0x2f50afa8,0x2e4faedd
.long 0xadcb2c72,0xaf992edd,0xaff12ff6,0xaec22f88,0x23d6263e,0x2d84aad7,0x2fe2af0e,0x2f25afea
.long 0x2c48aea7,0xa844a4b2,0xaf252d13,0xaf772ffe,0xaf992fd9,0xa7032d5f,0x2dcba8a5,0x2fb6afc3
.long 0x2f77ac72,0x2d3aafc3,0xabe3a246,0xafe22f3b,0xabe3a63e,0xaf772f88,0x27032b8b,0x2ffaae6d
.long 0xa5792ea7,0x2ff1acc4,0x20b5ae2f,0xafff2d5f,0x2e0fafd9,0xae8a1e48,0xa9c22fa8,0x2ff1ac1d
.long 0xafff2c72,0x2b322c1d,0x2cecaff6,0xafce2964,0x2e4f263e,0x1a48af3b,0xae8a2f0e,0x2f99a4b2
.long 0xa703aea7,0xabe32fea,0x2f99ad13,0xaf509e48,0xab322fd9,0x2ec2aded,0xafff28a5,0x2ef627c6
.long 0x2f50ac72,0xaffa27c6,0x2fb62246,0xae8aaad7,0xafb6a63e,0x2f502964,0xaec2ab8b,0x2e0f2cc4
.long 0xad842da8,0xad3a2d5f,0xacec2d13,0xac9b2cc4,0x2cecada8,0x2a7cac1d,0x2579a8a5,0xa0b59e48
.long 0xac482da8,0xa3d62964,0x2905a246,0x2d84ac1d,0x2b32ada8,0xa579a4b2,0xadcb2b8b,0xaff12f3b
.long 0xa9c22da8,0x2b329e48,0x2fb6ae2f,0x2ec2afea,0x2844ada8,0xad8427c6,0xafce2fa8,0xa9052ded
.long 0xa5792da8,0x2ef6aad7,0x2e0faff6,0xa9c2a7c6,0x20b5ada8,0xafce2cc4,0xa9c22f0e,0x2ef6a964
.long 0x1a482da8,0x2ffaaded,0xa3d6ad13,0xafe22e6d,0xa3d6ada8,0xaf772edd,0x2c9b28a5,0x2d3aaffe
.long 0x27032da8,0x2e4faf88,0xaf252246,0x9a482edd,0xa905ada8,0xac9b2fea,0x2fffab8b,0xacecaad7
.long 0x2a7c2da8,0x2905affe,0xaef62e2f,0x2fcea4b2,0xabe3ada8,0x9a482fc3,0x2c48afa8,0xaf252d5f
.long 0x2c9b2da8,0xa844af3b,0xa0b52ff6,0x2a7cafc3,0xad3aada8,0x2c482e6d,0xaa7caf0e,0x28442f88
.long 0xac482c72,0xabe32c1d,0xab322b8b,0xaa7c2ad7,0xa905263e,0xac482ad7,0xadcb2d13,0xaef62e6d
.long 0x2f77aea7,0x2ffaafea,0x2ef6afa8,0x2c9baded,0xaef62fd9,0xaa7c2d5f,0x27032246,0x2e0fac1d
.long 0x2579ac72,0xacec27c6,0xaffa2f0e,0xadcb2f88,0x2d3aa63e,0x2fe2af88,0x29c2ae2f,0xacec24b2
.long 0xafff2ea7,0xa9052e6d,0x2e4fa8a5,0x2ec2affe,0x2cecafd9,0xad841e48,0xae8a2ff6,0x2b3227c6
.long 0x27032c72,0x2fb6aedd,0xa905ab8b,0xaf772f3b,0xaf25263e,0xa7032f3b,0x2fffad13,0xa844acc4
.long 0x2f50aea7,0xae0fa4b2,0xa8442fa8,0x2fe2ad5f,0xa8442fd9,0x2f77aded,0xaec2a246,0x20b52edd
.long 0xac9bac72,0xa3d62fc3,0x2e0faf0e,0xafff2964,0x2ffaa63e,0xae8aa964,0x2a7c2e2f,0x23d6afea
.long 0xad842ea7,0x2f25acc4,0xaff128a5,0x2fce1e48,0xa3d6afd9,0x9a482ffe,0x2579aff6,0xa9052fc3
.long 0xa9c22a1f,0xa9052964,0xa84428a5,0xa70327c6,0xafb62f64,0xafff2fea,0xafce2ff6,0xaf252f88
.long 0x2579aa1f,0xa8441e48,0xad3a2b8b,0xaf502e6d,0x2ffaaf64,0x2ec2afc3,0x29c2ad13,0xa8449e48
.long 0x1a482a1f,0x2e0faad7,0x2ff1afa8,0x2c9baedd,0xaff12f64,0xaa7c2e6d,0x2c9ba246,0x2ffaaf3b
.long 0xa703aa1f,0xaff12ded,0xab322f0e,0x2d84a4b2,0x2f99af64,0xa579ac1d,0xafff2e2f,0xa3d62ded
.long 0x2a7c2a1f,0x2f25af88,0xabe3a8a5,0xaec22fc3,0xaef62f64,0x2d8424b2,0x2c48aff6,0xaf992964
.long 0xac9baa1f,0xabe32ffe,0x2ffaab8b,0xa9c2acc4,0x2e0faf64,0xafce27c6,0x2a7c2d13,0x2be3affe
.long 0x2dcb2a1f,0xa0b5af3b,0xacec2fa8,0x2fe2ac1d,0xacec2f64,0x2f77acc4,0xafe22246,0x2e0f2ad7
.long 0xaec2aa1f,0x2cec2d5f,0xa905af0e,0x9a482fea,0x2b32af64,0xac9b2edd,0x2d84ae2f,0xae4f2d5f
.long 0xa579263e,0xa3d624b2,0xa0b52246,0x9a481e48,0xae0f2ea7,0xac9b2d5f,0xa9c22b8b,0xa3d627c6
.long 0xafff2fd9,0xaf252fc3,0xacec2e2f,0xa7032ad7,0xae4f2c72,0xafff2f88,0xae8a2fa8,0xa9052cc4
.long 0xa703a63e,0xaef62cc4,0xaf992ff6,0xaa7c2ded,0x2b32aea7,0xac481e48,0xafff2f0e,0xabe32edd
.long 0x2f50afd9,0xa0b5ac1d,0xafb62d13,0xac9b2f88,0x2fb6ac72,0x2a7caf3b,0xaec228a5,0xad3a2fea
.long 0x2c9b263e,0x2e4fafea,0xad3aa246,0xadcb2ffe,0xa0b52ea7,0x2fe2aded,0xaa7cab8b,0xae4f2fc3
.long 0xad842fd9,0x2f99a7c6,0xa3d6ae2f,0xaec22f3b,0xaff12c72,0x2d842964,0x2579afa8,0xaf252e6d
.long 0xaec2a63e,0x28442e6d,0x2b32aff6,0xaf772d5f,0xa905aea7,0xa7032ffe,0x2d84af0e,0xafb62c1d
.long 0x29c2afd9,0xad3a2edd,0x2ef6ad13,0xafe22964,0x2ef6ac72,0xaf772ad7,0x2fcea8a5,0xaffa24b2
.long 0x1a488000,0x20b59e48,0x23d6a246,0x2579a4b2,0x23d68000,0x29c2a7c6,0x2c9bab8b,0x2e0fad5f
.long 0x27038000,0x2cecaad7,0x2f25ae2f,0x2fffafc3,0x29058000,0x2e8aacc4,0x2fffafa8,0x2e4faf88
.long 0x2a7c8000,0x2f99aded,0x2ef6aff6,0x2703acc4,0x2be38000,0x2fffaedd,0x2c48af0e,0xab329e48
.long 0x2c9b8000,0x2fb6af88,0x20b5ad13,0xaf502c1d,0x2d3a8000,0x2ec2afea,0xaa7ca8a5,0xafb62f3b
.long 0x2dcb8000,0x2d3aaffe,0xae4f2246,0xac9b2fea,0x2e4f8000,0x2a7cafc3,0xafe22b8b,0x20b52ded
.long 0x2ec28000,0x23d6af3b,0xaf992e2f,0x2d8427c6,0x2f258000,0xa579ae6d,0xad842fa8,0x2ff1a964
.long 0x2f778000,0xab32ad5f,0xa8442ff6,0x2ec2ae6d,0x2fb68000,0xad84ac1d,0x27032f0e,0x2905affe
.long 0x2fe28000,0xaef6a964,0x2d3a2d13,0xa9c2aedd,0x2ffa8000,0xafcea4b2,0x2f7728a5,0xaef6aad7
.long 0x2703a63e,0x2844a7c6,0x2905a8a5,0x29c2a964,0x2f25aea7,0x2fceaf88,0x2fffaff6,0x2fb6afea
.long 0x2f50afd9,0x2d3aae6d,0x2844ab8b,0xa5799e48,0x2844ac72,0xa9c21e48,0xaec22d13,0xaffa2fc3
.long 0xac9b263e,0xaff12edd,0xae0f2fa8,0x9a482ad7,0xaffa2ea7,0xac9b2f3b,0x2a7c2246,0x2ff1ae6d
.long 0xad842fd9,0x2b3224b2,0x2ff1af0e,0x2703aded,0x23d62c72,0x2fffaded,0x2579ae2f,0xaf992c1d
.long 0x2ec2a63e,0x2be3afc3,0xaf2528a5,0xaa7c2f88,0x2f99aea7,0xac48a964,0xad842ff6,0x2ef6a4b2
.long 0x29c2afd9,0xaffa2cc4,0x2be32b8b,0x2c9baffe,0xabe3ac72,0xaa7c2ffe,0x2fcead13,0xae0fa7c6
.long 0xafe2263e,0x2cec2c1d,0x20b5afa8,0xadcb2f3b,0xae0f2ea7,0x2fe2aad7,0xaf77a246,0x2cec2cc4
.long 0x1a482fd9,0x2905afea,0xacec2f0e,0x2ec2ad5f,0x2e4f2c72,0xad84ad5f,0x2c9b2e2f,0xab32aedd
.long 0x2a7caa1f,0x2b32aad7,0x2be3ab8b,0x2c48ac1d,0x2ef6af64,0x2dcbae6d,0x2c48ad13,0x2905aad7
.long 0xac9b2a1f,0xaef62ded,0xaffa2fa8,0xaf772fea,0xae0f2f64,0xa7032c1d,0x2a7ca246,0x2ef6ad5f
.long 0x2dcbaa1f,0x2ffaaf88,0x2cecaf0e,0xa579a7c6,0x2cecaf64,0xa9c2a4b2,0xafe22e2f,0xad3a2f88
.long 0xaec22a1f,0xae4f2ffe,0x290528a5,0x2fffae6d,0xab322f64,0x2e8aa7c6,0x2d84aff6,0xacec9e48
.long 0x2f77aa1f,0x2905af3b,0xafb62b8b,0xa7032edd,0x2844af64,0xafff2cc4,0x27032d13,0x2f25af3b
.long 0xafe22a1f,0x28442d5f,0x2e0fafa8,0xaf5024b2,0xa0b52f64,0x2ec2aedd,0xaf772246,0x28442ded
.long 0x2fffaa1f,0xae0fa964,0x23d62f0e,0x2c9bafc3,0xa3d6af64,0xaa7c2fea,0x2e8aae2f,0xaffa2964
.long 0xafce2a1f,0x2ff19e48,0xaf25a8a5,0x2d842cc4,0x29052f64,0xa579afc3,0x1a482ff6,0x23d6affe
.long 0x2c9bac72,0x2cecacc4,0x2d3aad13,0x2d84ad5f,0x20b5a63e,0xa5791e48,0xaa7c28a5,0xacec2c1d
.long 0xad842ea7,0xa9052c1d,0x23d62246,0x2c48a964,0x2ff1afd9,0x2dcbaf3b,0x2579ab8b,0xab3224b2
.long 0xaec22c72,0xafb62fea,0xab322e2f,0x29c21e48,0x2905263e,0x2fceaded,0x2d84afa8,0xa844a7c6
.long 0x29c2aea7,0xae0f27c6,0xaef62ff6,0x25792ad7,0xaef62fd9,0x29c22964,0x2fceaf0e,0xa0b5acc4
.long 0x2fe2ac72,0x23d6ae6d,0xaffa2d13,0x9a482ded,0xad3aa63e,0xac9b2ffe,0x2f77a8a5,0x23d6aedd
.long 0x1a482ea7,0x2f25aedd,0xae4fa246,0xa7032f88,0x2cecafd9,0xafff2ad7,0x2c9b2b8b,0x2905afea
.long 0xafce2c72,0x2ef624b2,0xa905ae2f,0xaa7c2ffe,0x2f25263e,0xac48ad5f,0x1a482fa8,0x2be3afc3
.long 0xaa7caea7,0x20b52fc3,0x2844aff6,0xac9b2f3b,0xa8442fd9,0x2a7caf88,0xac482f0e,0x2d3aae6d
.long 0x2dcbada8,0x2e0faded,0x2e4fae2f,0x2e8aae6d,0xae4f2da8,0xaf502edd,0xafe22fa8,0xaffa2ffe
.long 0x2ec2ada8,0x2ff1af88,0x2f99aff6,0x2dcbaedd,0xaf252da8,0xafe22fea,0xad842f0e,0xa3d62ad7
.long 0x2f77ada8,0x2f25affe,0x2844ad13,0xac4824b2,0xafb62da8,0xadcb2fc3,0x270328a5,0x2f99ad5f
.long 0x2fe2ada8,0x2be3af3b,0xad3a2246,0xaf772fc3,0xaffa2da8,0xa7032e6d,0x2f77ab8b,0x2be3af88
.long 0x2fffada8,0xa0b5ad5f,0xaff12e2f,0x25792cc4,0xaff12da8,0x29c22c1d,0x2e8aafa8,0xae0f9e48
.long 0x2fceada8,0xaceca964,0xab322ff6,0x2fffac1d,0xaf992da8,0x2e8a24b2,0x9a48af0e,0xae4f2f3b
.long 0x2f50ada8,0xaf991e48,0x2be32d13,0x2703afea,0xaef62da8,0x2fffa7c6,0xaec2a8a5,0x2b322ded
.long 0x2e8aada8,0xafb62ad7,0x2ffaa246,0xaf50a7c6,0xae0f2da8,0x2ec2acc4,0xaf502b8b,0x2fb6a964
.long 0x2ec2aea7,0x2ef6aedd,0x2f25af0e,0x2f50af3b,0xaf992fd9,0xaec22f3b,0xad842e2f,0xabe32cc4
.long 0x29c2ac72,0xa0b5a4b2,0xabe328a5,0xae8a2d5f,0x2be3a63e,0x2f50aded,0x2fceaff6,0x2d3aaedd
.long 0xafe22ea7,0xae4f2fc3,0xa0b52b8b,0x2d84a964,0x2e0fafd9,0xa579a964,0xaf772d13,0xae4f2fea
.long 0x1a482c72,0x2f99acc4,0x2cecafa8,0xac489e48,0xae4f263e,0xadcb2ffe,0x2c9b2246,0x2f25afc3
.long 0x2fceaea7,0xa844ac1d,0xaf992f0e,0x29c22ad7,0xab322fd9,0x2fceaad7,0x9a48ae2f,0xafb62e6d
.long 0xaa7cac72,0xad3a2fea,0x2fb6a8a5,0xa579aded,0x2fb6a63e,0xa9c2ad5f,0xac482ff6,0x2ffaac1d
.long 0xae8a2ea7,0x2ff1a7c6,0xad3aab8b,0x9a482f88,0x20b5afd9,0xac9b2f88,0x2f50ad13,0xaff124b2
.long 0x2dcb2c72,0xab32ae6d,0x23d62fa8,0x2703affe,0xaff1263e,0x2fff9e48,0xafe2a246,0x2f9927c6
.long 0x2f77af64,0x2f99af88,0x2fb6afa8,0x2fceafc3,0xa8442a1f,0x9a4824b2,0x2703a246,0x2b32a964
.long 0xafe22f64,0xafb62ffe,0xae0f2f0e,0xaa7c2cc4,0x20b5aa1f,0xac4827c6,0xaf772e2f,0xafb62ffe
.long 0x2fffaf64,0x2d3aaf3b,0xa3d6a8a5,0xae8a2c1d,0x23d62a1f,0x2f50acc4,0x2e8aaff6,0xa0b5aad7
.long 0xafce2f64,0xa3d62d5f,0x2f25ab8b,0x2dcbafea,0xa905aa1f,0xafe22edd,0x1a482d13,0x2ff1ad5f
.long 0x2f50af64,0xab32a964,0xaef62fa8,0x2c4827c6,0x2be32a1f,0x2dcbafea,0xaec22246,0xa9052f88
.long 0xae8a2f64,0x2ef69e48,0x20b5af0e,0xaf772e6d,0xad3aaa1f,0xa7032fc3,0x2f50ae2f,0xaef69e48
.long 0x2d84af64,0xaffa2ad7,0x2e4f28a5,0xa579aedd,0x2e4f2a1f,0xa9c2ae6d,0xa5792ff6,0x2d3aaf3b
.long 0xac482f64,0x2e4faded,0xaf992b8b,0x2fffa4b2,0xaf25aa1f,0x2e8a2c1d,0xadcbad13,0x2cec2ded
.long 0x2fe2afd9,0x2ff1afea,0x2ffaaff6,0x2fffaffe,0x2d3aac72,0x2e8aaded,0x2f77af0e,0x2ff1afc3
.long 0x1a48263e,0x2b32a7c6,0x2e4fad13,0x2fceaf3b,0xacec2ea7,0x9a482964,0x2c9ba8a5,0x2f99ae6d
.long 0xafce2fd9,0xabe32e6d,0x29052246,0x2f50ad5f,0xaf252c72,0xaec22ffe,0x1a482b8b,0x2ef6ac1d
.long 0xaa7ca63e,0xaffa2edd,0xa8442e2f,0x2e8aa964,0x2844aea7,0xaf502ad7,0xac482fa8,0x2e0fa4b2
.long 0x2e8aafd9,0xaceca4b2,0xae0f2ff6,0x2d841e48,0x2ffaac72,0xa579ad5f,0xaf502f0e,0x2cec27c6
.long 0x2dcb263e,0x2905afc3,0xaff12d13,0x2c482ad7,0x23d62ea7,0x2dcbaf88,0xafe228a5,0x2b322cc4
.long 0xac482fd9,0x2fb6acc4,0xaf25a246,0x29c22ded,0xaf992c72,0x2fce9e48,0xadcbab8b,0x28442edd
.long 0xaf77a63e,0x2e0f2c1d,0xabe3ae2f,0x25792f88,0xabe3aea7,0x29c22f3b,0xa703afa8,0x20b52fea
.long 0x39a839a8,0xb9a8b9a8,0x39a839a8,0xb9a8b9a8,0x39cb3984,0xba4fb8ec,0x3ac23848,0xbb25b732
.long 0x39ed395f,0xbaddb81d,0x3b883564,0xbbeab0b2,0x3a0f393a,0xbb50b67c,0x3bf12fd6,0xbbe23179
.long 0x3a2f3913,0xbba8b4a5,0x3bf6ae46,0xbb0e378b,0x3a4f38ec,0xbbe2b179,0x3b99b505,0xb98439cb
.long 0x3a6d38c4,0xbbfeaa48,0x3addb81d,0xb6d73b3b,0x3a8a389b,0xbbfa2cb5,0x39cbb984,0xafd63bf1
.long 0x3aa73872,0xbbd9323e,0x3872baa7,0x323e3bd9,0x3ac23848,0xbb993505,0x35c2bb77,0x37e33af6
.long 0x3add381d,0xbb3b36d7,0x30b2bbea,0x39ed395f,0x3af637e3,0xbac23848,0xacb5bbfa,0x3b50367c
.long 0x3b0e378b,0xba2f3913,0xb4a5bba8,0x3bf62e46,0x3b253732,0xb98439cb,0xb7e3baf6,0x3bceb303
.long 0x3b3b36d7,0xb8c43a6d,0xb95fb9ed,0x3addb81d,0x3b50367c,0xb7e33af6,0xba8ab89b,0x393aba0f
.long 0x39a839a8,0xb9a8b9a8,0x39a839a8,0xb9a8b9a8,0x3b7735c2,0xbbb6b444,0x3be23179,0xbbfaacb5
.long 0x3bfeaa48,0xbbc333c6,0x3b3bb6d7,0xba6d38c4,0x3b25b732,0xb9cb3984,0x37e3baf6,0xb3033bce
.long 0x3913ba2f,0xb4a53ba8,0xae46bbf6,0x378b3b0e,0x3444bbb6,0x33033bce,0xb93aba0f,0x3b7735c2
.long 0xb0b2bbea,0x395f39ed,0xbbc3b3c6,0x3b88b564,0xb848bac2,0x3b993505,0xbb7735c2,0x37e3baf6
.long 0xbaa7b872,0x3bd9b23e,0xb8723aa7,0xb23ebbd9,0xbbe2b179,0x3a0fb93a,0x26483bff,0xba4fb8ec
.long 0xbbc333c6,0x3564bb88,0x38c43a6d,0xbbfe2a48,0xba4f38ec,0xb179bbe2,0x3b993505,0xb9cb3984
.long 0xb78b3b0e,0xb913ba2f,0x3ba8b4a5,0xae463bf6,0xacb53bfa,0xbb77b5c2,0x38ecba4f,0x389b3a8a
.long 0x35643b88,0xbbea30b2,0x2a48bbfe,0x3bc333c6,0x398439cb,0xba4f38ec,0xb848bac2,0x3b25b732
.long 0x39a839a8,0xb9a8b9a8,0x39a839a8,0xb9a8b9a8,0x3bffa648,0xbbf12fd6,0x3bceb303,0xbb993505
.long 0x395fb9ed,0xb81d3add,0x3564bb88,0xb0b23bea,0xacb5bbfa,0x35c23b77,0xb8ecba4f,0x3a8a389b
.long 0xba2fb913,0x3ba834a5,0xbbf62e46,0x3b0eb78b,0xbbf12fd6,0x3a8ab89b,0xb7323b25,0xa648bbff
.long 0xb8c43a6d,0x2a48bbfe,0x381d3add,0xbb3bb6d7,0x31793be2,0xba0fb93a,0x3bff2648,0xba4f38ec
.long 0x3aa73872,0xbbd9323e,0x3872baa7,0x323e3bd9,0x3bceb303,0xb7323b25,0xb67cbb50,0x3bb63444
.long 0x381dbadd,0x36d73b3b,0xbbeab0b2,0x395fb9ed,0xb444bbb6,0x3bce3303,0xb93a3a0f,0xb5c2bb77
.long 0xbb0eb78b,0x3a2fb913,0x34a53ba8,0xbbf6ae46,0xbb993505,0xa648bbff,0x3bb63444,0xb8483ac2
.long 0xb6d73b3b,0xba6db8c4,0x39edb95f,0x381d3add,0x35c23b77,0xbbb63444,0xb179bbe2,0x3bfaacb5
.long 0x39a839a8,0xb9a8b9a8,0x39a839a8,0xb9a8b9a8,0x3b50b67c,0xbaf637e3,0x3a8ab89b,0xba0f393a
.long 0xaa48bbfe,0x33c63bc3,0xb6d7bb3b,0x38c43a6d,0xbb99b505,0x3bff2648,0xbbb63444,0x3ac2b848
.long 0xb9133a2f,0x34a5bba8,0x2e463bf6,0xb78bbb0e,0x37e33af6,0xbac2b848,0x3bfa2cb5,0xbb50367c
.long 0x3beab0b2,0xb9ed395f,0x33c6bbc3,0x35643b88,0x3303bbce,0x37323b25,0xbb50b67c,0x3bb6b444
.long 0xbaa7b872,0x3bd9b23e,0xb8723aa7,0xb23ebbd9,0xba8a389b,0x2cb5bbfa,0x39cb3984,0xbbf12fd6
.long 0x33c63bc3,0xbb88b564,0x3a6db8c4,0x2a483bfe,0x3bf12fd6,0xb89b3a8a,0xb732bb25,0x3bff2648
.long 0x378bbb0e,0x39133a2f,0xbba834a5,0x2e46bbf6,0xb93aba0f,0x3b50b67c,0x2fd63bf1,0xbbe2b179
.long 0xbb883564,0xb0b2bbea,0x3bfe2a48,0xb3c63bc3,0xa6483bff,0xbbf1afd6,0x3303bbce,0x3b993505
.long 0x39a839a8,0xb9a8b9a8,0x39a839a8,0xb9a8b9a8,0x3984b9cb,0xb8ec3a4f,0x3848bac2,0xb7323b25
.long 0xb9edb95f,0x3add381d,0xbb88b564,0x3bea30b2,0xb93a3a0f,0x367cbb50,0xafd63bf1,0xb179bbe2
.long 0x3a2f3913,0xbba8b4a5,0x3bf6ae46,0xbb0e378b,0x38ecba4f,0xb1793be2,0xb505bb99,0x39cb3984
.long 0xba6db8c4,0x3bfe2a48,0xbadd381d,0x36d7bb3b,0xb89b3a8a,0xacb5bbfa,0x398439cb,0xbbf1afd6
.long 0x3aa73872,0xbbd9323e,0x3872baa7,0x323e3bd9,0x3848bac2,0x35053b99,0xbb77b5c2,0x3af6b7e3
.long 0xbaddb81d,0x3b3bb6d7,0xb0b23bea,0xb9edb95f,0xb7e33af6,0xb848bac2,0x3bfaacb5,0xb67c3b50
.long 0x3b0e378b,0xba2f3913,0xb4a5bba8,0x3bf62e46,0x3732bb25,0x39cb3984,0xbaf637e3,0xb303bbce
.long 0xbb3bb6d7,0x38c4ba6d,0x395f39ed,0xbadd381d,0xb67c3b50,0xbaf6b7e3,0x389bba8a,0x3a0f393a
.long 0x39a839a8,0xb9a8b9a8,0x39a839a8,0xb9a8b9a8,0x35c2bb77,0xb4443bb6,0x3179bbe2,0xacb53bfa
.long 0xbbfe2a48,0x3bc3b3c6,0xbb3b36d7,0x3a6db8c4,0x37323b25,0xb984b9cb,0x3af637e3,0xbbceb303
.long 0x3913ba2f,0xb4a53ba8,0xae46bbf6,0x378b3b0e,0xbbb6b444,0x3bceb303,0xba0f393a,0x35c2bb77
.long 0x30b23bea,0xb95fb9ed,0x3bc333c6,0xbb883564,0x3ac2b848,0xb5053b99,0xb5c2bb77,0x3af637e3
.long 0xbaa7b872,0x3bd9b23e,0xb8723aa7,0xb23ebbd9,0xb1793be2,0xb93aba0f,0x3bffa648,0xb8ec3a4f
.long 0x3bc3b3c6,0xb5643b88,0xb8c4ba6d,0x3bfeaa48,0xb8ecba4f,0x3be2b179,0xb5053b99,0xb984b9cb
.long 0xb78b3b0e,0xb913ba2f,0x3ba8b4a5,0xae463bf6,0x3bfa2cb5,0xb5c23b77,0xba4fb8ec,0x3a8ab89b
.long 0xb564bb88,0x3beab0b2,0xaa483bfe,0xbbc3b3c6,0xb9cb3984,0xb8ecba4f,0x3ac2b848,0x37323b25
.long 0x39a839a8,0xb9a8b9a8,0x39a839a8,0xb9a8b9a8,0xa648bbff,0x2fd63bf1,0xb303bbce,0x35053b99
.long 0xb95f39ed,0x381dbadd,0xb5643b88,0x30b2bbea,0x3bfaacb5,0xbb7735c2,0x3a4fb8ec,0xb89b3a8a
.long 0xba2fb913,0x3ba834a5,0xbbf62e46,0x3b0eb78b,0x2fd63bf1,0xb89bba8a,0x3b253732,0xbbff2648
.long 0x38c4ba6d,0xaa483bfe,0xb81dbadd,0x3b3b36d7,0xbbe23179,0x393aba0f,0xa6483bff,0xb8ecba4f
.long 0x3aa73872,0xbbd9323e,0x3872baa7,0x323e3bd9,0xb303bbce,0x3b253732,0xbb50367c,0x3444bbb6
.long 0xb81d3add,0xb6d7bb3b,0x3bea30b2,0xb95f39ed,0x3bb6b444,0xb3033bce,0xba0fb93a,0x3b77b5c2
.long 0xbb0eb78b,0x3a2fb913,0x34a53ba8,0xbbf6ae46,0x35053b99,0xbbff2648,0x3444bbb6,0x3ac23848
.long 0x36d7bb3b,0x3a6d38c4,0xb9ed395f,0xb81dbadd,0xbb7735c2,0xb444bbb6,0x3be2b179,0x2cb53bfa
.long 0x39a839a8,0xb9a8b9a8,0x39a839a8,0xb9a8b9a8,0xb67cbb50,0x37e33af6,0xb89bba8a,0x393a3a0f
.long 0x2a483bfe,0xb3c6bbc3,0x36d73b3b,0xb8c4ba6d,0x3505bb99,0xa6483bff,0xb444bbb6,0x38483ac2
.long 0xb9133a2f,0x34a5bba8,0x2e463bf6,0xb78bbb0e,0x3af6b7e3,0xb8483ac2,0x2cb5bbfa,0x367c3b50
.long 0xbbea30b2,0x39edb95f,0xb3c63bc3,0xb564bb88,0x3bce3303,0xbb253732,0x367cbb50,0x34443bb6
.long 0xbaa7b872,0x3bd9b23e,0xb8723aa7,0xb23ebbd9,0x389b3a8a,0xbbfaacb5,0x3984b9cb,0x2fd63bf1
.long 0xb3c6bbc3,0x3b883564,0xba6d38c4,0xaa48bbfe,0xafd63bf1,0xba8ab89b,0x3b25b732,0xa6483bff
.long 0x378bbb0e,0x39133a2f,0xbba834a5,0x2e46bbf6,0xba0f393a,0xb67cbb50,0x3bf1afd6,0xb1793be2
.long 0x3b88b564,0x30b23bea,0xbbfeaa48,0x33c6bbc3,0xbbffa648,0x2fd6bbf1,0x3bce3303,0xb5053b99
.long 0x39a839a8,0xb9a8b9a8,0x39a839a8,0xb9a8b9a8,0xb9cbb984,0x3a4f38ec,0xbac2b848,0x3b253732
.long 0x39ed395f,0xbaddb81d,0x3b883564,0xbbeab0b2,0xba0fb93a,0x3b50367c,0xbbf1afd6,0x3be2b179
.long 0x3a2f3913,0xbba8b4a5,0x3bf6ae46,0xbb0e378b,0xba4fb8ec,0x3be23179,0xbb993505,0x3984b9cb
.long 0x3a6d38c4,0xbbfeaa48,0x3addb81d,0xb6d73b3b,0xba8ab89b,0x3bfaacb5,0xb9cb3984,0x2fd6bbf1
.long 0x3aa73872,0xbbd9323e,0x3872baa7,0x323e3bd9,0xbac2b848,0x3b99b505,0xb5c23b77,0xb7e3baf6
.long 0x3add381d,0xbb3b36d7,0x30b2bbea,0x39ed395f,0xbaf6b7e3,0x3ac2b848,0x2cb53bfa,0xbb50b67c
.long 0x3b0e378b,0xba2f3913,0xb4a5bba8,0x3bf62e46,0xbb25b732,0x3984b9cb,0x37e33af6,0xbbce3303
.long 0x3b3b36d7,0xb8c43a6d,0xb95fb9ed,0x3addb81d,0xbb50b67c,0x37e3baf6,0x3a8a389b,0xb93a3a0f
.long 0x39a839a8,0xb9a8b9a8,0x39a839a8,0xb9a8b9a8,0xbb77b5c2,0x3bb63444,0xbbe2b179,0x3bfa2cb5
.long 0x3bfeaa48,0xbbc333c6,0x3b3bb6d7,0xba6d38c4,0xbb253732,0x39cbb984,0xb7e33af6,0x3303bbce
.long 0x3913ba2f,0xb4a53ba8,0xae46bbf6,0x378b3b0e,0xb4443bb6,0xb303bbce,0x393a3a0f,0xbb77b5c2
.long 0xb0b2bbea,0x395f39ed,0xbbc3b3c6,0x3b88b564,0x38483ac2,0xbb99b505,0x3b77b5c2,0xb7e33af6
.long 0xbaa7b872,0x3bd9b23e,0xb8723aa7,0xb23ebbd9,0x3be23179,0xba0f393a,0xa648bbff,0x3a4f38ec
.long 0xbbc333c6,0x3564bb88,0x38c43a6d,0xbbfe2a48,0x3a4fb8ec,0x31793be2,0xbb99b505,0x39cbb984
.long 0xb78b3b0e,0xb913ba2f,0x3ba8b4a5,0xae463bf6,0x2cb5bbfa,0x3b7735c2,0xb8ec3a4f,0xb89bba8a
.long 0x35643b88,0xbbea30b2,0x2a48bbfe,0x3bc333c6,0xb984b9cb,0x3a4fb8ec,0x38483ac2,0xbb253732
.long 0x39a839a8,0xb9a8b9a8,0x39a839a8,0xb9a8b9a8,0xbbff2648,0x3bf1afd6,0xbbce3303,0x3b99b505
.long 0x395fb9ed,0xb81d3add,0x3564bb88,0xb0b23bea,0x2cb53bfa,0xb5c2bb77,0x38ec3a4f,0xba8ab89b
.long 0xba2fb913,0x3ba834a5,0xbbf62e46,0x3b0eb78b,0x3bf1afd6,0xba8a389b,0x3732bb25,0x26483bff
.long 0xb8c43a6d,0x2a48bbfe,0x381d3add,0xbb3bb6d7,0xb179bbe2,0x3a0f393a,0xbbffa648,0x3a4fb8ec
.long 0x3aa73872,0xbbd9323e,0x3872baa7,0x323e3bd9,0xbbce3303,0x3732bb25,0x367c3b50,0xbbb6b444
.long 0x381dbadd,0x36d73b3b,0xbbeab0b2,0x395fb9ed,0x34443bb6,0xbbceb303,0x393aba0f,0x35c23b77
.long 0xbb0eb78b,0x3a2fb913,0x34a53ba8,0xbbf6ae46,0x3b99b505,0x26483bff,0xbbb6b444,0x3848bac2
.long 0xb6d73b3b,0xba6db8c4,0x39edb95f,0x381d3add,0xb5c2bb77,0x3bb6b444,0x31793be2,0xbbfa2cb5
.long 0x39a839a8,0xb9a8b9a8,0x39a839a8,0xb9a8b9a8,0xbb50367c,0x3af6b7e3,0xba8a389b,0x3a0fb93a
.long 0xaa48bbfe,0x33c63bc3,0xb6d7bb3b,0x38c43a6d,0x3b993505,0xbbffa648,0x3bb6b444,0xbac23848
.long 0xb9133a2f,0x34a5bba8,0x2e463bf6,0xb78bbb0e,0xb7e3baf6,0x3ac23848,0xbbfaacb5,0x3b50b67c
.long 0x3beab0b2,0xb9ed395f,0x33c6bbc3,0x35643b88,0xb3033bce,0xb732bb25,0x3b50367c,0xbbb63444
.long 0xbaa7b872,0x3bd9b23e,0xb8723aa7,0xb23ebbd9,0x3a8ab89b,0xacb53bfa,0xb9cbb984,0x3bf1afd6
.long 0x33c63bc3,0xbb88b564,0x3a6db8c4,0x2a483bfe,0xbbf1afd6,0x389bba8a,0x37323b25,0xbbffa648
.long 0x378bbb0e,0x39133a2f,0xbba834a5,0x2e46bbf6,0x393a3a0f,0xbb50367c,0xafd6bbf1,0x3be23179
.long 0xbb883564,0xb0b2bbea,0x3bfe2a48,0xb3c63bc3,0x2648bbff,0x3bf12fd6,0xb3033bce,0xbb99b505
.long 0x39a839a8,0xb9a8b9a8,0x39a839a8,0xb9a8b9a8,0xb98439cb,0x38ecba4f,0xb8483ac2,0x3732bb25
.long 0xb9edb95f,0x3add381d,0xbb88b564,0x3bea30b2,0x393aba0f,0xb67c3b50,0x2fd6bbf1,0x31793be2
.long 0x3a2f3913,0xbba8b4a5,0x3bf6ae46,0xbb0e378b,0xb8ec3a4f,0x3179bbe2,0x35053b99,0xb9cbb984
.long 0xba6db8c4,0x3bfe2a48,0xbadd381d,0x36d7bb3b,0x389bba8a,0x2cb53bfa,0xb984b9cb,0x3bf12fd6
.long 0x3aa73872,0xbbd9323e,0x3872baa7,0x323e3bd9,0xb8483ac2,0xb505bb99,0x3b7735c2,0xbaf637e3
.long 0xbaddb81d,0x3b3bb6d7,0xb0b23bea,0xb9edb95f,0x37e3baf6,0x38483ac2,0xbbfa2cb5,0x367cbb50
.long 0x3b0e378b,0xba2f3913,0xb4a5bba8,0x3bf62e46,0xb7323b25,0xb9cbb984,0x3af6b7e3,0x33033bce
.long 0xbb3bb6d7,0x38c4ba6d,0x395f39ed,0xbadd381d,0x367cbb50,0x3af637e3,0xb89b3a8a,0xba0fb93a
.long 0x39a839a8,0xb9a8b9a8,0x39a839a8,0xb9a8b9a8,0xb5c23b77,0x3444bbb6,0xb1793be2,0x2cb5bbfa
.long 0xbbfe2a48,0x3bc3b3c6,0xbb3b36d7,0x3a6db8c4,0xb732bb25,0x398439cb,0xbaf6b7e3,0x3bce3303
.long 0x3913ba2f,0xb4a53ba8,0xae46bbf6,0x378b3b0e,0x3bb63444,0xbbce3303,0x3a0fb93a,0xb5c23b77
.long 0x30b23bea,0xb95fb9ed,0x3bc333c6,0xbb883564,0xbac23848,0x3505bb99,0x35c23b77,0xbaf6b7e3
.long 0xbaa7b872,0x3bd9b23e,0xb8723aa7,0xb23ebbd9,0x3179bbe2,0x393a3a0f,0xbbff2648,0x38ecba4f
.long 0x3bc3b3c6,0xb5643b88,0xb8c4ba6d,0x3bfeaa48,0x38ec3a4f,0xbbe23179,0x3505bb99,0x398439cb
.long 0xb78b3b0e,0xb913ba2f,0x3ba8b4a5,0xae463bf6,0xbbfaacb5,0x35c2bb77,0x3a4f38ec,0xba8a389b
.long 0xb564bb88,0x3beab0b2,0xaa483bfe,0xbbc3b3c6,0x39cbb984,0x38ec3a4f,0xbac23848,0xb732bb25
.long 0x39a839a8,0xb9a8b9a8,0x39a839a8,0xb9a8b9a8,0x26483bff,0xafd6bbf1,0x33033bce,0xb505bb99
.long 0xb95f39ed,0x381dbadd,0xb5643b88,0x30b2bbea,0xbbfa2cb5,0x3b77b5c2,0xba4f38ec,0x389bba8a
.long 0xba2fb913,0x3ba834a5,0xbbf62e46,0x3b0eb78b,0xafd6bbf1,0x389b3a8a,0xbb25b732,0x3bffa648
.long 0x38c4ba6d,0xaa483bfe,0xb81dbadd,0x3b3b36d7,0x3be2b179,0xb93a3a0f,0x2648bbff,0x38ec3a4f
.long 0x3aa73872,0xbbd9323e,0x3872baa7,0x323e3bd9,0x33033bce,0xbb25b732,0x3b50b67c,0xb4443bb6
.long 0xb81d3add,0xb6d7bb3b,0x3bea30b2,0xb95f39ed,0xbbb63444,0x3303bbce,0x3a0f393a,0xbb7735c2
.long 0xbb0eb78b,0x3a2fb913,0x34a53ba8,0xbbf6ae46,0xb505bb99,0x3bffa648,0xb4443bb6,0xbac2b848
.long 0x36d7bb3b,0x3a6d38c4,0xb9ed395f,0xb81dbadd,0x3b77b5c2,0x34443bb6,0xbbe23179,0xacb5bbfa
.long 0x39a839a8,0xb9a8b9a8,0x39a839a8,0xb9a8b9a8,0x367c3b50,0xb7e3baf6,0x389b3a8a,0xb93aba0f
.long 0x2a483bfe,0xb3c6bbc3,0x36d73b3b,0xb8c4ba6d,0xb5053b99,0x2648bbff,0x34443bb6,0xb848bac2
.long 0xb9133a2f,0x34a5bba8,0x2e463bf6,0xb78bbb0e,0xbaf637e3,0x3848bac2,0xacb53bfa,0xb67cbb50
.long 0xbbea30b2,0x39edb95f,0xb3c63bc3,0xb564bb88,0xbbceb303,0x3b25b732,0xb67c3b50,0xb444bbb6
.long 0xbaa7b872,0x3bd9b23e,0xb8723aa7,0xb23ebbd9,0xb89bba8a,0x3bfa2cb5,0xb98439cb,0xafd6bbf1
.long 0xb3c6bbc3,0x3b883564,0xba6d38c4,0xaa48bbfe,0x2fd6bbf1,0x3a8a389b,0xbb253732,0x2648bbff
.long 0x378bbb0e,0x39133a2f,0xbba834a5,0x2e46bbf6,0x3a0fb93a,0x367c3b50,0xbbf12fd6,0x3179bbe2
.long 0x3b88b564,0x30b23bea,0xbbfeaa48,0x33c6bbc3,0x3bff2648,0xafd63bf1,0xbbceb303,0x3505bb99
.long 0x80003c00,0xae523bf6,0xb24b3bd8,0xb4ae3ba6,0x80003c00,0xae843bf5,0xb27c3bd6,0xb4d23ba1
.long 0x80003c00,0xaeb63bf5,0xb2ad3bd3,0xb4f63b9b,0x80003c00,0xaee83bf4,0xb2de3bd0,0xb51a3b95
.long 0x80003c00,0xaf1a3bf3,0xb30f3bce,0xb53d3b8f,0x80003c00,0xaf4c3bf3,0xb3403bcb,0xb5613b89
.long 0x80003c00,0xaf7e3bf2,0xb3713bc8,0xb5843b82,0x80003c00,0xafb03bf1,0xb3a23bc5,0xb5a83b7c
.long 0x80003c00,0xafe23bf0,0xb3d33bc2,0xb5cb3b75,0x80003c00,0xb00a3bf0,0xb4023bbf,0xb5ee3b6e
.long 0x80003c00,0xb0233bef,0xb41a3bbc,0xb6113b67,0x80003c00,0xb03c3bee,0xb4323bb8,0xb6343b60
.long 0x80003c00,0xb0553bed,0xb44b3bb5,0xb6563b58,0x80003c00,0xb06e3bec,0xb4633bb2,0xb6793b51
.long 0x80003c00,0xb0863beb,0xb47b3bae,0xb69b3b49,0x80003c00,0xb09f3beb,0xb4933bab,0xb6be3b41
.long 0xb62b3b62,0xb7993b0a,0xb87a3aa2,0xb91c3a28,0xb6593b58,0xb7d03afb,0xb8993a8c,0xb93d3a0c
.long 0xb6873b4e,0xb8033aec,0xb8b73a76,0xb95e39ef,0xb6b53b43,0xb81e3adc,0xb8d63a60,0xb97e39d1
.long 0xb6e33b39,0xb8393acb,0xb8f33a49,0xb99e39b2,0xb7103b2e,0xb8543abb,0xb9113a31,0xb9bd3993
.long 0xb73d3b22,0xb86e3aa9,0xb92e3a19,0xb9db3973,0xb76a3b17,0xb8883a98,0xb94a3a00,0xb9f93953
.long 0xb7963b0b,0xb8a23a86,0xb96639e7,0xba163931,0xb7c23aff,0xb8bb3a73,0xb98239cd,0xba323910
.long 0xb7ee3af3,0xb8d43a61,0xb99d39b3,0xba4e38ed,0xb80d3ae6,0xb8ed3a4e,0xb9b83999,0xba6838ca
.long 0xb8223ad9,0xb9063a3a,0xb9d2397d,0xba8238a7,0xb8383acc,0xb91e3a26,0xb9eb3962,0xba9b3883
.long 0xb84d3abf,0xb9363a12,0xba043946,0xbab4385e,0xb8623ab1,0xb94e39fd,0xba1d3929,0xbacb3839
.long 0xb9b1399f,0xba383908,0xbab03865,0xbb16376c,0xb9d4397b,0xba5b38dc,0xbad13830,0xbb3536f1
.long 0xb9f63956,0xba7d38ae,0xbaf137f3,0xbb523673,0xba173930,0xba9d3880,0xbb103785,0xbb6d35f4
.long 0xba373909,0xbabc3851,0xbb2c3715,0xbb863573,0xba5638e2,0xbada3821,0xbb4736a4,0xbb9c34f0
.long 0xba7438ba,0xbaf737e0,0xbb603631,0xbbb0346c,0xba923891,0xbb12377d,0xbb7835bc,0xbbc233cd
.long 0xbaae3867,0xbb2c3718,0xbb8e3546,0xbbd232bf,0xbac9383d,0xbb4436b2,0xbba134cf,0xbbdf31b0
.long 0xbae33812,0xbb5b364b,0xbbb33457,0xbbeb309f,0xbafc37cd,0xbb7035e2,0xbbc333ba,0xbbf32f1a
.long 0xbb143775,0xbb853579,0xbbd232c6,0xbbfa2cf4,0xbb2b371b,0xbb97350e,0xbbde31cf,0xbbfe2998
.long 0xbb4136c1,0xbba834a2,0xbbe830d7,0xbc00211b,0xbb553665,0xbbb83435,0xbbf12fbd,0xbbffa616
.long 0xbb6b35fd,0xbbae347e,0xbbdd31e8,0xbbf82d8a,0xbb863570,0xbbc333c0,0xbbeb308d,0xbbfe2934
.long 0xbb9e34e1,0xbbd53282,0xbbf62e5f,0xbc009d7f,0xbbb43451,0xbbe43141,0xbbfd2b43,0xbbfdaa93
.long 0xbbc7337d,0xbbf02ffb,0xbc002311,0xbbf6ae39,0xbbd73257,0xbbf92d71,0xbbffa776,0xbbebb093
.long 0xbbe5312e,0xbbfe29ca,0xbbfbac9c,0xbbdbb207,0xbbf03004,0xbc001d7f,0xbbf2af59,0xbbc7b377
.long 0xbbf82db0,0xbbffa86b,0xbbe6b109,0xbbafb472,0xbbfd2aac,0xbbfaacc2,0xbbd7b263,0xbb93b526
.long 0xbc0023db,0xbbf3af4c,0xbbc3b3ba,0xbb73b5d7,0xbc00a57f,0xbbe8b0ea,0xbbacb487,0xbb4eb684
.long 0xbbfdab75,0xbbdab22c,0xbb92b52f,0xbb26b72f,0xbbf7ae14,0xbbc8b36b,0xbb73b5d4,0xbafab7d5
.long 0xbbeeb036,0xbbb4b454,0xbb52b676,0xbacab83c,0xbbe3b160,0xbb9cb4f0,0xbb2cb715,0xba96b88b
.long 0xbc00a248,0xbbf3af1a,0xbbd3b2ad,0xbb9fb4de,0xbbfcabd9,0xbbe5b134,0xbbb8b432,0xbb77b5bf
.long 0xbbf4af0e,0xbbd1b2d8,0xbb98b50b,0xbb49b69b,0xbbe6b115,0xbbb7b43b,0xbb71b5df,0xbb15b772
.long 0xbbd4b2a1,0xbb98b508,0xbb45b6af,0xbadab821,0xbbbcb414,0xbb74b5d1,0xbb13b77a,0xba9ab885
.long 0xbba0b4d5,0xbb4bb696,0xbadbb820,0xba53b8e6,0xbb80b593,0xbb1cb756,0xba9eb87f,0xba08b942
.long 0xbb5ab64e,0xbae9b809,0xba5cb8db,0xb9b7b99a,0xbb30b705,0xbab0b863,0xba15b933,0xb961b9ec
.long 0xbb02b7b7,0xba73b8bb,0xb9c9b986,0xb906ba3a,0xbad0b832,0xba32b910,0xb979b9d6,0xb8a7ba82
.long 0xba99b887,0xb9ecb961,0xb924ba21,0xb844bac5,0xba5eb8d8,0xb9a3b9ae,0xb8ccba67,0xb7babb01
.long 0xba1fb927,0xb955b9f7,0xb86fbaa9,0xb6e5bb38,0xb9dcb972,0xb903ba3c,0xb80fbae5,0xb60bbb68
.long 0xbb58b659,0xbafeb7c5,0xba93b88e,0xba18b92f,0xbb22b73d,0xbabbb854,0xba41b8fd,0xb9b7b99a
.long 0xbae6b80d,0xba70b8c0,0xb9e7b966,0xb94eb9fd,0xbaa3b877,0xba1eb928,0xb986b9c9,0xb8deba59
.long 0xba5ab8dd,0xb9c6b98a,0xb91fba25,0xb869baad,0xba0bb93e,0xb967b9e6,0xb8b2ba7a,0xb7dbbaf8
.long 0xb9b5b99b,0xb903ba3c,0xb840bac7,0xb6dabb3b,0xb95bb9f2,0xb89aba8b,0xb790bb0d,0xb5d1bb74
.long 0xb8fbba43,0xb82cbad4,0xb699bb4a,0xb4c0bba4,0xb896ba8e,0xb772bb15,0xb599bb7f,0xb352bbca
.long 0xb82dbad3,0xb684bb4e,0xb493bbab,0xb11cbbe6,0xb780bb11,0xb590bb80,0xb30fbbce,0xadbcbbf8
.long 0xb69ebb49,0xb496bbaa,0xb0f0bbe7,0xa4e9bc00,0xb5b6bb79,0xb32ebbcc,0xad97bbf8,0x2a93bbfd
.long 0xb4c9bba2,0xb128bbe5,0xa51bbc00,0x2fc9bbf1,0xb3aebbc4,0xae39bbf6,0x2a16bbfe,0x321fbbda
.long 0xb98db9c3,0xb8f5ba48,0xb850babd,0xb740bb22,0xb91dba27,0xb876baa4,0xb785bb10,0xb60bbb68
.long 0xb8a6ba83,0xb7e0baf7,0xb65fbb57,0xb4ccbba2,0xb828bad6,0xb6c9bb3f,0xb52fbb92,0xb309bbce
.long 0xb748bb20,0xb5a8bb7c,0xb3ebbbc0,0xb06ebbec,0xb637bb5f,0xb47ebbae,0xb16cbbe2,0xab2abbfd
.long 0xb51dbb95,0xb29bbbd4,0xadc9bbf8,0x26dfbbff,0xb3f7bbc0,0xb02fbbee,0xa17fbc00,0x2f01bbf4
.long 0xb1aabbe0,0xaaf8bbfd,0x2c6abbfb,0x321fbbda,0xaeaabbf5,0x25b2bbff,0x30bebbe9,0x345abbb3
.long 0xa7dabbff,0x2e52bbf6,0x3340bbcb,0x359cbb7e,0x297fbbfe,0x3197bbe0,0x34dbbb9f,0x36d4bb3c
.long 0x2f72bbf2,0x33fdbbbf,0x360ebb68,0x3800baed,0x320dbbdb,0x352cbb92,0x3737bb24,0x3890ba93
.long 0x342cbbb9,0x3651bb5a,0x382abad5,0x3917ba2c,0x354cbb8c,0x376cbb16,0x38b2ba7a,0x3995b9bb
.long 0xb5cebb74,0xb44ebbb5,0xb185bbe1,0xacc2bbfa,0xb481bbad,0xb1d5bbde,0xad33bbf9,0x254dbc00
.long 0xb257bbd7,0xae07bbf7,0x217fbc00,0x2f65bbf2,0xaf40bbf3,0x9d7fbc00,0x2e91bbf5,0x32b3bbd3
.long 0xa711bbff,0x2d58bbf9,0x3232bbd9,0x34d2bba1,0x2b75bbfd,0x317fbbe2,0x3487bbac,0x363fbb5d
.long 0x3099bbeb,0x3423bbba,0x35ebbb6f,0x379ebb09,0x334cbbca,0x357ebb83,0x3742bb21,0x3876baa4
.long 0x34f9bb9b,0x36cfbb3d,0x3845bac4,0x3912ba30,0x3642bb5d,0x3809bae9,0x38e0ba58,0x39a3b9ae
.long 0x3780bb11,0x38a2ba86,0x3970b9df,0x3a26b91e,0x3858bab8,0x3931ba16,0x39f4b958,0x3a9bb883
.long 0x38e7ba52,0x39b7b99a,0x3a6bb8c7,0x3b01b7ba,0x396db9e1,0x3a30b912,0x3ad5b82a,0x3b57b65c
.long 0x39e9b964,0x3a9db880,0x3b2fb70a,0x3b9cb4f0,0x3a5ab8dd,0x3afdb7ca,0x3b7ab5b1,0x3bcfb2f0
.long 0x3000,0xb0008000,0xb000,0x30000000,0x3000,0xaff62246,0xa63eafd9,0x2fa8a8a5
.long 0x3000,0xafd9263e,0xaa1faf64,0x2ea7ac72,0x3000,0xafa828a5,0xac72aea7,0x2d13ae2f
.long 0x3000,0xaf642a1f,0xada8ada8,0x2a1faf64,0x3000,0xaf0e2b8b,0xaea7ac72,0x2246aff6
.long 0x3000,0xaea72c72,0xaf64aa1f,0xa63eafd9,0x3000,0xae2f2d13,0xafd9a63e,0xab8baf0e
.long 0x3000,0xada82da8,0xb0008000,0xada8ada8,0x3000,0xad132e2f,0xafd9263e,0xaf0eab8b
.long 0x3000,0xac722ea7,0xaf642a1f,0xafd9a63e,0x3000,0xab8b2f0e,0xaea72c72,0xaff62246
.long 0x3000,0xaa1f2f64,0xada82da8,0xaf642a1f,0x3000,0xa8a52fa8,0xac722ea7,0xae2f2d13
.long 0x3000,0xa63e2fd9,0xaa1f2f64,0xac722ea7,0x3000,0xa2462ff6,0xa63e2fd9,0xa8a52fa8
.long 0x3000,0xb0008000,0xb000,0x30000000,0x2a1f2f64,0xaf0e2b8b,0xac72aea7,0x2e2fad13
.long 0x2da82da8,0xac722ea7,0xaf64aa1f,0x263eafd9,0x2f642a1f,0xa2462ff6,0xafd9263e,0xab8baf0e
.long 0x30000000,0x2a1f2f64,0xada82da8,0xaf64aa1f,0x2f64aa1f,0x2e2f2d13,0xa63e2fd9,0xafa828a5
.long 0x2da8ada8,0x2fd9263e,0x2a1f2f64,0xac722ea7,0x2a1faf64,0x2fa8a8a5,0x2ea72c72,0x22462ff6
.long 0xb000,0x2da8ada8,0x30000000,0x2da82da8,0xaa1faf64,0x28a5afa8,0x2ea7ac72,0x2ff62246
.long 0xada8ada8,0xa63eafd9,0x2a1faf64,0x2ea7ac72,0xaf64aa1f,0xad13ae2f,0xa63eafd9,0x28a5afa8
.long 0xb0008000,0xaf64aa1f,0xada8ada8,0xaa1faf64,0xaf642a1f,0xaff62246,0xafd9a63e,0xaf0eab8b
.long 0xada82da8,0xaea72c72,0xaf642a1f,0xafd9263e,0xaa1f2f64,0xab8b2f0e,0xac722ea7,0xad132e2f
.long 0x3000,0xb0008000,0xb000,0x30000000,0x2da82da8,0xad132e2f,0xaea7ac72,0x2b8baf0e
.long 0x30000000,0x263e2fd9,0xaf642a1f,0xac72aea7,0x2da8ada8,0x2f0e2b8b,0xa63e2fd9,0xaff62246
.long 0xb000,0x2f64aa1f,0x2da82da8,0xaa1f2f64,0xada8ada8,0x28a5afa8,0x2fd9a63e,0x2d132e2f
.long 0xb0008000,0xac72aea7,0x2a1faf64,0x2fd9a63e,0xada82da8,0xaff6a246,0xac72aea7,0x28a5afa8
.long 0x3000,0xada82da8,0xb0008000,0xada8ada8,0x2da82da8,0x22462ff6,0xac722ea7,0xafa828a5
.long 0x30000000,0x2ea72c72,0x2a1f2f64,0xa63e2fd9,0x2da8ada8,0x2fa8a8a5,0x2fd9263e,0x2e2f2d13
.long 0xb000,0x2a1faf64,0x2da8ada8,0x2f64aa1f,0xada8ada8,0xab8baf0e,0xa63eafd9,0x2246aff6
.long 0xb0008000,0xafd9a63e,0xaf64aa1f,0xaea7ac72,0xada82da8,0xae2f2d13,0xaea72c72,0xaf0e2b8b
.long 0x3000,0xb0008000,0xb000,0x30000000,0x2f642a1f,0xa8a52fa8,0xafd9a63e,0x2246aff6
.long 0x2da8ada8,0x2ea72c72,0xaa1f2f64,0xafd9a63e,0xaa1faf64,0x2e2fad13,0x2ea72c72,0xa8a52fa8
.long 0xb0008000,0xaa1faf64,0x2da8ada8,0x2f642a1f,0xaa1f2f64,0xaff62246,0xac72aea7,0x2b8baf0e
.long 0x2da82da8,0xa63e2fd9,0xaf642a1f,0xaea7ac72,0x2f64aa1f,0x2f0e2b8b,0x263e2fd9,0xad132e2f
.long 0xb000,0x2da8ada8,0x30000000,0x2da82da8,0xaf64aa1f,0xab8baf0e,0x263eafd9,0x2e2fad13
.long 0xada82da8,0xafd9263e,0xaf64aa1f,0xac72aea7,0x2a1f2f64,0xa2462ff6,0xac722ea7,0xaf0e2b8b
.long 0x30000000,0x2f642a1f,0x2da82da8,0x2a1f2f64,0x2a1faf64,0x2d13ae2f,0x2ea7ac72,0x2fa8a8a5
.long 0xada8ada8,0xac72aea7,0xaa1faf64,0xa63eafd9,0xaf642a1f,0xafa828a5,0xafd9263e,0xaff62246
.long 0x3000,0xb0008000,0xb000,0x30000000,0x30000000,0x22462ff6,0xafd9263e,0xa8a5afa8
.long 0xb000,0x2fd9a63e,0x2a1f2f64,0xaea72c72,0xb0008000,0xa8a5afa8,0x2ea7ac72,0x2e2f2d13
.long 0x3000,0xaf642a1f,0xada8ada8,0x2a1faf64,0x30000000,0x2b8b2f0e,0xac722ea7,0xaff6a246
.long 0xb000,0x2ea7ac72,0x2f642a1f,0x263e2fd9,0xb0008000,0xad13ae2f,0x263eafd9,0x2f0eab8b
.long 0x3000,0xada82da8,0xb0008000,0xada8ada8,0x30000000,0x2e2f2d13,0x263e2fd9,0xab8b2f0e
.long 0xb000,0x2c72aea7,0x2f64aa1f,0x2fd9263e,0xb0008000,0xaf0eab8b,0xac72aea7,0xa246aff6
.long 0x3000,0xaa1f2f64,0xada82da8,0xaf642a1f,0x30000000,0x2fa828a5,0x2ea72c72,0x2d132e2f
.long 0xb000,0x263eafd9,0x2a1faf64,0x2c72aea7,0xb0008000,0xaff6a246,0xafd9a63e,0xafa8a8a5
.long 0x3000,0xb0008000,0xb000,0x30000000,0x2f64aa1f,0x2b8b2f0e,0xaea72c72,0xad13ae2f
.long 0xada8ada8,0x2c72aea7,0x2f642a1f,0xa63e2fd9,0xaa1f2f64,0xaff6a246,0xa63eafd9,0x2f0eab8b
.long 0x30000000,0x2a1f2f64,0xada82da8,0xaf64aa1f,0xaa1faf64,0x2d13ae2f,0x2fd9263e,0x28a52fa8
.long 0xada82da8,0xafd9a63e,0xaa1faf64,0x2c72aea7,0x2f642a1f,0x28a52fa8,0xac722ea7,0xaff62246
.long 0xb000,0x2da8ada8,0x30000000,0x2da82da8,0xaf642a1f,0xafa8a8a5,0xac72aea7,0x2246aff6
.long 0x2da82da8,0x263e2fd9,0xaa1f2f64,0xaea72c72,0x2a1faf64,0x2e2fad13,0x2fd9a63e,0x2fa828a5
.long 0xb0008000,0xaf64aa1f,0xada8ada8,0xaa1faf64,0x2a1f2f64,0x22462ff6,0xa63e2fd9,0xab8b2f0e
.long 0x2da8ada8,0x2ea7ac72,0x2f64aa1f,0x2fd9a63e,0xaf64aa1f,0xaf0eab8b,0xaea7ac72,0xae2fad13
.long 0x3000,0xb0008000,0xb000,0x30000000,0x2da8ada8,0x2e2f2d13,0xac722ea7,0xaf0eab8b
.long 0xb0008000,0xa63eafd9,0x2f64aa1f,0x2c722ea7,0x2da82da8,0xab8b2f0e,0xafd9a63e,0xa246aff6
.long 0xb000,0x2f64aa1f,0x2da82da8,0xaa1f2f64,0xada82da8,0xafa8a8a5,0xa63eafd9,0x2e2fad13
.long 0x30000000,0x2c722ea7,0xaa1f2f64,0xafd9263e,0xada8ada8,0x2246aff6,0x2ea7ac72,0x2fa828a5
.long 0x3000,0xada82da8,0xb0008000,0xada8ada8,0x2da8ada8,0x2ff6a246,0x2ea72c72,0x28a52fa8
.long 0xb0008000,0xaea7ac72,0xaa1faf64,0x263eafd9,0x2da82da8,0x28a52fa8,0xa63e2fd9,0xad132e2f
.long 0xb000,0x2a1faf64,0x2da8ada8,0x2f64aa1f,0xada82da8,0xaf0e2b8b,0xafd9263e,0xaff6a246
.long 0x30000000,0x2fd9263e,0x2f642a1f,0x2ea72c72,0xada8ada8,0xad13ae2f,0xac72aea7,0xab8baf0e
.long 0x3000,0xb0008000,0xb000,0x30000000,0x2a1faf64,0x2fa828a5,0xa63e2fd9,0xaff6a246
.long 0xada82da8,0xaea7ac72,0x2a1faf64,0x2fd9263e,0x2f64aa1f,0x2d132e2f,0xac722ea7,0xafa8a8a5
.long 0xb0008000,0xaa1faf64,0x2da8ada8,0x2f642a1f,0x2f642a1f,0x22462ff6,0xaea72c72,0xaf0eab8b
.long 0xada8ada8,0x263eafd9,0x2f64aa1f,0x2ea72c72,0x2a1f2f64,0xab8b2f0e,0xafd9263e,0xae2fad13
.long 0xb000,0x2da8ada8,0x30000000,0x2da82da8,0xaa1f2f64,0xaf0e2b8b,0xafd9a63e,0xad13ae2f
.long 0x2da8ada8,0x2fd9a63e,0x2f642a1f,0x2c722ea7,0xaf642a1f,0xaff6a246,0xaea7ac72,0xab8baf0e
.long 0x30000000,0x2f642a1f,0x2da82da8,0x2a1f2f64,0xaf64aa1f,0xae2fad13,0xac72aea7,0xa8a5afa8
.long 0x2da82da8,0x2c722ea7,0x2a1f2f64,0x263e2fd9,0xaa1faf64,0xa8a5afa8,0xa63eafd9,0xa246aff6
.long 0x3000,0xb0008000,0xb000,0x30000000,0xb000,0x2ff6a246,0x263e2fd9,0xafa828a5
.long 0x3000,0xafd9263e,0xaa1faf64,0x2ea7ac72,0xb000,0x2fa8a8a5,0x2c722ea7,0xad132e2f
.long 0x3000,0xaf642a1f,0xada8ada8,0x2a1faf64,0xb000,0x2f0eab8b,0x2ea72c72,0xa2462ff6
.long 0x3000,0xaea72c72,0xaf64aa1f,0xa63eafd9,0xb000,0x2e2fad13,0x2fd9263e,0x2b8b2f0e
.long 0x3000,0xada82da8,0xb0008000,0xada8ada8,0xb000,0x2d13ae2f,0x2fd9a63e,0x2f0e2b8b
.long 0x3000,0xac722ea7,0xaf642a1f,0xafd9a63e,0xb000,0x2b8baf0e,0x2ea7ac72,0x2ff6a246
.long 0x3000,0xaa1f2f64,0xada82da8,0xaf642a1f,0xb000,0x28a5afa8,0x2c72aea7,0x2e2fad13
.long 0x3000,0xa63e2fd9,0xaa1f2f64,0xac722ea7,0xb000,0x2246aff6,0x263eafd9,0x28a5afa8
.long 0x3000,0xb0008000,0xb000,0x30000000,0xaa1faf64,0x2f0eab8b,0x2c722ea7,0xae2f2d13
.long 0x2da82da8,0xac722ea7,0xaf64aa1f,0x263eafd9,0xaf64aa1f,0x2246aff6,0x2fd9a63e,0x2b8b2f0e
.long 0x30000000,0x2a1f2f64,0xada82da8,0xaf64aa1f,0xaf642a1f,0xae2fad13,0x263eafd9,0x2fa8a8a5
.long 0x2da8ada8,0x2fd9263e,0x2a1f2f64,0xac722ea7,0xaa1f2f64,0xafa828a5,0xaea7ac72,0xa246aff6
.long 0xb000,0x2da8ada8,0x30000000,0x2da82da8,0x2a1f2f64,0xa8a52fa8,0xaea72c72,0xaff6a246
.long 0xada8ada8,0xa63eafd9,0x2a1faf64,0x2ea7ac72,0x2f642a1f,0x2d132e2f,0x263e2fd9,0xa8a52fa8
.long 0xb0008000,0xaf64aa1f,0xada8ada8,0xaa1faf64,0x2f64aa1f,0x2ff6a246,0x2fd9263e,0x2f0e2b8b
.long 0xada82da8,0xaea72c72,0xaf642a1f,0xafd9263e,0x2a1faf64,0x2b8baf0e,0x2c72aea7,0x2d13ae2f
.long 0x3000,0xb0008000,0xb000,0x30000000,0xada8ada8,0x2d13ae2f,0x2ea72c72,0xab8b2f0e
.long 0x30000000,0x263e2fd9,0xaf642a1f,0xac72aea7,0xada82da8,0xaf0eab8b,0x263eafd9,0x2ff6a246
.long 0xb000,0x2f64aa1f,0x2da82da8,0xaa1f2f64,0x2da82da8,0xa8a52fa8,0xafd9263e,0xad13ae2f
.long 0xb0008000,0xac72aea7,0x2a1faf64,0x2fd9a63e,0x2da8ada8,0x2ff62246,0x2c722ea7,0xa8a52fa8
.long 0x3000,0xada82da8,0xb0008000,0xada8ada8,0xada8ada8,0xa246aff6,0x2c72aea7,0x2fa8a8a5
.long 0x30000000,0x2ea72c72,0x2a1f2f64,0xa63e2fd9,0xada82da8,0xafa828a5,0xafd9a63e,0xae2fad13
.long 0xb000,0x2a1faf64,0x2da8ada8,0x2f64aa1f,0x2da82da8,0x2b8b2f0e,0x263e2fd9,0xa2462ff6
.long 0xb0008000,0xafd9a63e,0xaf64aa1f,0xaea7ac72,0x2da8ada8,0x2e2fad13,0x2ea7ac72,0x2f0eab8b
.long 0x3000,0xb0008000,0xb000,0x30000000,0xaf64aa1f,0x28a5afa8,0x2fd9263e,0xa2462ff6
.long 0x2da8ada8,0x2ea72c72,0xaa1f2f64,0xafd9a63e,0x2a1f2f64,0xae2f2d13,0xaea7ac72,0x28a5afa8
.long 0xb0008000,0xaa1faf64,0x2da8ada8,0x2f642a1f,0x2a1faf64,0x2ff6a246,0x2c722ea7,0xab8b2f0e
.long 0x2da82da8,0xa63e2fd9,0xaf642a1f,0xaea7ac72,0xaf642a1f,0xaf0eab8b,0xa63eafd9,0x2d13ae2f
.long 0xb000,0x2da8ada8,0x30000000,0x2da82da8,0x2f642a1f,0x2b8b2f0e,0xa63e2fd9,0xae2f2d13
.long 0xada82da8,0xafd9263e,0xaf64aa1f,0xac72aea7,0xaa1faf64,0x2246aff6,0x2c72aea7,0x2f0eab8b
.long 0x30000000,0x2f642a1f,0x2da82da8,0x2a1f2f64,0xaa1f2f64,0xad132e2f,0xaea72c72,0xafa828a5
.long 0xada8ada8,0xac72aea7,0xaa1faf64,0xa63eafd9,0x2f64aa1f,0x2fa8a8a5,0x2fd9a63e,0x2ff6a246
.long 0x3000,0xb0008000,0xb000,0x30000000,0xb0008000,0xa246aff6,0x2fd9a63e,0x28a52fa8
.long 0xb000,0x2fd9a63e,0x2a1f2f64,0xaea72c72,0x30000000,0x28a52fa8,0xaea72c72,0xae2fad13
.long 0x3000,0xaf642a1f,0xada8ada8,0x2a1faf64,0xb0008000,0xab8baf0e,0x2c72aea7,0x2ff62246
.long 0xb000,0x2ea7ac72,0x2f642a1f,0x263e2fd9,0x30000000,0x2d132e2f,0xa63e2fd9,0xaf0e2b8b
.long 0x3000,0xada82da8,0xb0008000,0xada8ada8,0xb0008000,0xae2fad13,0xa63eafd9,0x2b8baf0e
.long 0xb000,0x2c72aea7,0x2f64aa1f,0x2fd9263e,0x30000000,0x2f0e2b8b,0x2c722ea7,0x22462ff6
.long 0x3000,0xaa1f2f64,0xada82da8,0xaf642a1f,0xb0008000,0xafa8a8a5,0xaea7ac72,0xad13ae2f
.long 0xb000,0x263eafd9,0x2a1faf64,0x2c72aea7,0x30000000,0x2ff62246,0x2fd9263e,0x2fa828a5
.long 0x3000,0xb0008000,0xb000,0x30000000,0xaf642a1f,0xab8baf0e,0x2ea7ac72,0x2d132e2f
.long 0xada8ada8,0x2c72aea7,0x2f642a1f,0xa63e2fd9,0x2a1faf64,0x2ff62246,0x263e2fd9,0xaf0e2b8b
.long 0x30000000,0x2a1f2f64,0xada82da8,0xaf64aa1f,0x2a1f2f64,0xad132e2f,0xafd9a63e,0xa8a5afa8
.long 0xada82da8,0xafd9a63e,0xaa1faf64,0x2c72aea7,0xaf64aa1f,0xa8a5afa8,0x2c72aea7,0x2ff6a246
.long 0xb000,0x2da8ada8,0x30000000,0x2da82da8,0x2f64aa1f,0x2fa828a5,0x2c722ea7,0xa2462ff6
.long 0x2da82da8,0x263e2fd9,0xaa1f2f64,0xaea72c72,0xaa1f2f64,0xae2f2d13,0xafd9263e,0xafa8a8a5
.long 0xb0008000,0xaf64aa1f,0xada8ada8,0xaa1faf64,0xaa1faf64,0xa246aff6,0x263eafd9,0x2b8baf0e
.long 0x2da8ada8,0x2ea7ac72,0x2f64aa1f,0x2fd9a63e,0x2f642a1f,0x2f0e2b8b,0x2ea72c72,0x2e2f2d13
.long 0x3000,0xb0008000,0xb000,0x30000000,0xada82da8,0xae2fad13,0x2c72aea7,0x2f0e2b8b
.long 0xb0008000,0xa63eafd9,0x2f64aa1f,0x2c722ea7,0xada8ada8,0x2b8baf0e,0x2fd9263e,0x22462ff6
.long 0xb000,0x2f64aa1f,0x2da82da8,0xaa1f2f64,0x2da8ada8,0x2fa828a5,0x263e2fd9,0xae2f2d13
.long 0x30000000,0x2c722ea7,0xaa1f2f64,0xafd9263e,0x2da82da8,0xa2462ff6,0xaea72c72,0xafa8a8a5
.long 0x3000,0xada82da8,0xb0008000,0xada8ada8,0xada82da8,0xaff62246,0xaea7ac72,0xa8a5afa8
.long 0xb0008000,0xaea7ac72,0xaa1faf64,0x263eafd9,0xada8ada8,0xa8a5afa8,0x263eafd9,0x2d13ae2f
.long 0xb000,0x2a1faf64,0x2da8ada8,0x2f64aa1f,0x2da8ada8,0x2f0eab8b,0x2fd9a63e,0x2ff62246
.long 0x30000000,0x2fd9263e,0x2f642a1f,0x2ea72c72,0x2da82da8,0x2d132e2f,0x2c722ea7,0x2b8b2f0e
.long 0x3000,0xb0008000,0xb000,0x30000000,0xaa1f2f64,0xafa8a8a5,0x263eafd9,0x2ff62246
.long 0xada82da8,0xaea7ac72,0x2a1faf64,0x2fd9263e,0xaf642a1f,0xad13ae2f,0x2c72aea7,0x2fa828a5
.long 0xb0008000,0xaa1faf64,0x2da8ada8,0x2f642a1f,0xaf64aa1f,0xa246aff6,0x2ea7ac72,0x2f0e2b8b
.long 0xada8ada8,0x263eafd9,0x2f64aa1f,0x2ea72c72,0xaa1faf64,0x2b8baf0e,0x2fd9a63e,0x2e2f2d13
.long 0xb000,0x2da8ada8,0x30000000,0x2da82da8,0x2a1faf64,0x2f0eab8b,0x2fd9263e,0x2d132e2f
.long 0x2da8ada8,0x2fd9a63e,0x2f642a1f,0x2c722ea7,0x2f64aa1f,0x2ff62246,0x2ea72c72,0x2b8b2f0e
.long 0x30000000,0x2f642a1f,0x2da82da8,0x2a1f2f64,0x2f642a1f,0x2e2f2d13,0x2c722ea7,0x28a52fa8
.long 0x2da82da8,0x2c722ea7,0x2a1f2f64,0x263e2fd9,0x2a1f2f64,0x28a52fa8,0x263e2fd9,0x22462ff6
.long 0x30008000,0x80003000,0xb0008000,0xb000,0x30008000,0x22462ff6,0xafd9263e,0xa8a5afa8
.long 0x30008000,0x263e2fd9,0xaf642a1f,0xac72aea7,0x30008000,0x28a52fa8,0xaea72c72,0xae2fad13
.long 0x30008000,0x2a1f2f64,0xada82da8,0xaf64aa1f,0x30008000,0x2b8b2f0e,0xac722ea7,0xaff6a246
.long 0x30008000,0x2c722ea7,0xaa1f2f64,0xafd9263e,0x30008000,0x2d132e2f,0xa63e2fd9,0xaf0e2b8b
.long 0x30008000,0x2da82da8,0x80003000,0xada82da8,0x30008000,0x2e2f2d13,0x263e2fd9,0xab8b2f0e
.long 0x30008000,0x2ea72c72,0x2a1f2f64,0xa63e2fd9,0x30008000,0x2f0e2b8b,0x2c722ea7,0x22462ff6
.long 0x30008000,0x2f642a1f,0x2da82da8,0x2a1f2f64,0x30008000,0x2fa828a5,0x2ea72c72,0x2d132e2f
.long 0x30008000,0x2fd9263e,0x2f642a1f,0x2ea72c72,0x30008000,0x2ff62246,0x2fd9263e,0x2fa828a5
.long 0x30008000,0x80003000,0xb0008000,0xb000,0x2f64aa1f,0x2b8b2f0e,0xaea72c72,0xad13ae2f
.long 0x2da8ada8,0x2ea72c72,0xaa1f2f64,0xafd9a63e,0x2a1faf64,0x2ff62246,0x263e2fd9,0xaf0e2b8b
.long 0xb000,0x2f64aa1f,0x2da82da8,0xaa1f2f64,0xaa1faf64,0x2d13ae2f,0x2fd9263e,0x28a52fa8
.long 0xada8ada8,0x263eafd9,0x2f64aa1f,0x2ea72c72,0xaf64aa1f,0xa8a5afa8,0x2c72aea7,0x2ff6a246
.long 0xb0008000,0xada8ada8,0xb000,0x2da8ada8,0xaf642a1f,0xafa8a8a5,0xac72aea7,0x2246aff6
.long 0xada82da8,0xafd9263e,0xaf64aa1f,0xac72aea7,0xaa1f2f64,0xae2f2d13,0xafd9263e,0xafa8a8a5
.long 0x80003000,0xaa1f2f64,0xada82da8,0xaf642a1f,0x2a1f2f64,0x22462ff6,0xa63e2fd9,0xab8b2f0e
.long 0x2da82da8,0x2c722ea7,0x2a1f2f64,0x263e2fd9,0x2f642a1f,0x2f0e2b8b,0x2ea72c72,0x2e2f2d13
.long 0x30008000,0x80003000,0xb0008000,0xb000,0x2da8ada8,0x2e2f2d13,0xac722ea7,0xaf0eab8b
.long 0xb000,0x2fd9a63e,0x2a1f2f64,0xaea72c72,0xada8ada8,0x2b8baf0e,0x2fd9263e,0x22462ff6
.long 0xb0008000,0xaa1faf64,0x2da8ada8,0x2f642a1f,0xada82da8,0xafa8a8a5,0xa63eafd9,0x2e2fad13
.long 0x80003000,0xaea72c72,0xaf64aa1f,0xa63eafd9,0x2da82da8,0xa2462ff6,0xaea72c72,0xafa8a8a5
.long 0x30008000,0x2da82da8,0x80003000,0xada82da8,0x2da8ada8,0x2ff6a246,0x2ea72c72,0x28a52fa8
.long 0xb000,0x2c72aea7,0x2f64aa1f,0x2fd9263e,0xada8ada8,0xa8a5afa8,0x263eafd9,0x2d13ae2f
.long 0xb0008000,0xaf64aa1f,0xada8ada8,0xaa1faf64,0xada82da8,0xaf0e2b8b,0xafd9263e,0xaff6a246
.long 0x80003000,0xa63e2fd9,0xaa1f2f64,0xac722ea7,0x2da82da8,0x2d132e2f,0x2c722ea7,0x2b8b2f0e
.long 0x30008000,0x80003000,0xb0008000,0xb000,0x2a1faf64,0x2fa828a5,0xa63e2fd9,0xaff6a246
.long 0xada8ada8,0x2c72aea7,0x2f642a1f,0xa63e2fd9,0xaf642a1f,0xad13ae2f,0x2c72aea7,0x2fa828a5
.long 0x80003000,0xaf642a1f,0xada8ada8,0x2a1faf64,0x2f642a1f,0x22462ff6,0xaea72c72,0xaf0eab8b
.long 0x2da8ada8,0x2fd9263e,0x2a1f2f64,0xac722ea7,0xaa1faf64,0x2b8baf0e,0x2fd9a63e,0x2e2f2d13
.long 0xb0008000,0xada8ada8,0xb000,0x2da8ada8,0xaa1f2f64,0xaf0e2b8b,0xafd9a63e,0xad13ae2f
.long 0x2da82da8,0x263e2fd9,0xaa1f2f64,0xaea72c72,0x2f64aa1f,0x2ff62246,0x2ea72c72,0x2b8b2f0e
.long 0xb000,0x2a1faf64,0x2da8ada8,0x2f64aa1f,0xaf64aa1f,0xae2fad13,0xac72aea7,0xa8a5afa8
.long 0xada82da8,0xaea72c72,0xaf642a1f,0xafd9263e,0x2a1f2f64,0x28a52fa8,0x263e2fd9,0x22462ff6
.long 0x30008000,0x80003000,0xb0008000,0xb000,0xb000,0x2ff6a246,0x263e2fd9,0xafa828a5
.long 0xb0008000,0xa63eafd9,0x2f64aa1f,0x2c722ea7,0x80003000,0xafa828a5,0xac72aea7,0x2d13ae2f
.long 0x30008000,0x2a1f2f64,0xada82da8,0xaf64aa1f,0xb000,0x2f0eab8b,0x2ea72c72,0xa2462ff6
.long 0xb0008000,0xac72aea7,0x2a1faf64,0x2fd9a63e,0x80003000,0xae2f2d13,0xafd9a63e,0xab8baf0e
.long 0x30008000,0x2da82da8,0x80003000,0xada82da8,0xb000,0x2d13ae2f,0x2fd9a63e,0x2f0e2b8b
.long 0xb0008000,0xaea7ac72,0xaa1faf64,0x263eafd9,0x80003000,0xab8b2f0e,0xaea72c72,0xaff62246
.long 0x30008000,0x2f642a1f,0x2da82da8,0x2a1f2f64,0xb000,0x28a5afa8,0x2c72aea7,0x2e2fad13
.long 0xb0008000,0xafd9a63e,0xaf64aa1f,0xaea7ac72,0x80003000,0xa2462ff6,0xa63e2fd9,0xa8a52fa8
.long 0x30008000,0x80003000,0xb0008000,0xb000,0xaa1faf64,0x2f0eab8b,0x2c722ea7,0xae2f2d13
.long 0xada82da8,0xaea7ac72,0x2a1faf64,0x2fd9263e,0x2f642a1f,0xa2462ff6,0xafd9263e,0xab8baf0e
.long 0xb000,0x2f64aa1f,0x2da82da8,0xaa1f2f64,0xaf642a1f,0xae2fad13,0x263eafd9,0x2fa8a8a5
.long 0x2da82da8,0xa63e2fd9,0xaf642a1f,0xaea7ac72,0x2a1faf64,0x2fa8a8a5,0x2ea72c72,0x22462ff6
.long 0xb0008000,0xada8ada8,0xb000,0x2da8ada8,0x2a1f2f64,0xa8a52fa8,0xaea72c72,0xaff6a246
.long 0x2da8ada8,0x2fd9a63e,0x2f642a1f,0x2c722ea7,0xaf64aa1f,0xad13ae2f,0xa63eafd9,0x28a5afa8
.long 0x80003000,0xaa1f2f64,0xada82da8,0xaf642a1f,0x2f64aa1f,0x2ff6a246,0x2fd9263e,0x2f0e2b8b
.long 0xada8ada8,0xac72aea7,0xaa1faf64,0xa63eafd9,0xaa1f2f64,0xab8b2f0e,0xac722ea7,0xad132e2f
.long 0x30008000,0x80003000,0xb0008000,0xb000,0xada8ada8,0x2d13ae2f,0x2ea72c72,0xab8b2f0e
.long 0x80003000,0xafd9263e,0xaa1faf64,0x2ea7ac72,0x2da8ada8,0x2f0e2b8b,0xa63e2fd9,0xaff62246
.long 0xb0008000,0xaa1faf64,0x2da8ada8,0x2f642a1f,0x2da82da8,0xa8a52fa8,0xafd9263e,0xad13ae2f
.long 0xb000,0x2ea7ac72,0x2f642a1f,0x263e2fd9,0xada82da8,0xaff6a246,0xac72aea7,0x28a5afa8
.long 0x30008000,0x2da82da8,0x80003000,0xada82da8,0xada8ada8,0xa246aff6,0x2c72aea7,0x2fa8a8a5
.long 0x80003000,0xac722ea7,0xaf642a1f,0xafd9a63e,0x2da8ada8,0x2fa8a8a5,0x2fd9263e,0x2e2f2d13
.long 0xb0008000,0xaf64aa1f,0xada8ada8,0xaa1faf64,0x2da82da8,0x2b8b2f0e,0x263e2fd9,0xa2462ff6
.long 0xb000,0x263eafd9,0x2a1faf64,0x2c72aea7,0xada82da8,0xae2f2d13,0xaea72c72,0xaf0e2b8b
.long 0x30008000,0x80003000,0xb0008000,0xb000,0xaf64aa1f,0x28a5afa8,0x2fd9263e,0xa2462ff6
.long 0x2da82da8,0xac722ea7,0xaf64aa1f,0x263eafd9,0xaa1faf64,0x2e2fad13,0x2ea72c72,0xa8a52fa8
.long 0x80003000,0xaf642a1f,0xada8ada8,0x2a1faf64,0x2a1faf64,0x2ff6a246,0x2c722ea7,0xab8b2f0e
.long 0xada82da8,0xafd9a63e,0xaa1faf64,0x2c72aea7,0x2f64aa1f,0x2f0e2b8b,0x263e2fd9,0xad132e2f
.long 0xb0008000,0xada8ada8,0xb000,0x2da8ada8,0x2f642a1f,0x2b8b2f0e,0xa63e2fd9,0xae2f2d13
.long 0xada8ada8,0xa63eafd9,0x2a1faf64,0x2ea7ac72,0x2a1f2f64,0xa2462ff6,0xac722ea7,0xaf0e2b8b
.long 0xb000,0x2a1faf64,0x2da8ada8,0x2f64aa1f,0xaa1f2f64,0xad132e2f,0xaea72c72,0xafa828a5
.long 0x2da8ada8,0x2ea7ac72,0x2f64aa1f,0x2fd9a63e,0xaf642a1f,0xafa828a5,0xafd9263e,0xaff62246
.long 0x30008000,0x80003000,0xb0008000,0xb000,0xb0008000,0xa246aff6,0x2fd9a63e,0x28a52fa8
.long 0x30008000,0x263e2fd9,0xaf642a1f,0xac72aea7,0xb0008000,0xa8a5afa8,0x2ea7ac72,0x2e2f2d13
.long 0x30008000,0x2a1f2f64,0xada82da8,0xaf64aa1f,0xb0008000,0xab8baf0e,0x2c72aea7,0x2ff62246
.long 0x30008000,0x2c722ea7,0xaa1f2f64,0xafd9263e,0xb0008000,0xad13ae2f,0x263eafd9,0x2f0eab8b
.long 0x30008000,0x2da82da8,0x80003000,0xada82da8,0xb0008000,0xae2fad13,0xa63eafd9,0x2b8baf0e
.long 0x30008000,0x2ea72c72,0x2a1f2f64,0xa63e2fd9,0xb0008000,0xaf0eab8b,0xac72aea7,0xa246aff6
.long 0x30008000,0x2f642a1f,0x2da82da8,0x2a1f2f64,0xb0008000,0xafa8a8a5,0xaea7ac72,0xad13ae2f
.long 0x30008000,0x2fd9263e,0x2f642a1f,0x2ea72c72,0xb0008000,0xaff6a246,0xafd9a63e,0xafa8a8a5
.long 0x30008000,0x80003000,0xb0008000,0xb000,0xaf642a1f,0xab8baf0e,0x2ea7ac72,0x2d132e2f
.long 0x2da8ada8,0x2ea72c72,0xaa1f2f64,0xafd9a63e,0xaa1f2f64,0xaff6a246,0xa63eafd9,0x2f0eab8b
.long 0xb000,0x2f64aa1f,0x2da82da8,0xaa1f2f64,0x2a1f2f64,0xad132e2f,0xafd9a63e,0xa8a5afa8
.long 0xada8ada8,0x263eafd9,0x2f64aa1f,0x2ea72c72,0x2f642a1f,0x28a52fa8,0xac722ea7,0xaff62246
.long 0xb0008000,0xada8ada8,0xb000,0x2da8ada8,0x2f64aa1f,0x2fa828a5,0x2c722ea7,0xa2462ff6
.long 0xada82da8,0xafd9263e,0xaf64aa1f,0xac72aea7,0x2a1faf64,0x2e2fad13,0x2fd9a63e,0x2fa828a5
.long 0x80003000,0xaa1f2f64,0xada82da8,0xaf642a1f,0xaa1faf64,0xa246aff6,0x263eafd9,0x2b8baf0e
.long 0x2da82da8,0x2c722ea7,0x2a1f2f64,0x263e2fd9,0xaf64aa1f,0xaf0eab8b,0xaea7ac72,0xae2fad13
.long 0x30008000,0x80003000,0xb0008000,0xb000,0xada82da8,0xae2fad13,0x2c72aea7,0x2f0e2b8b
.long 0xb000,0x2fd9a63e,0x2a1f2f64,0xaea72c72,0x2da82da8,0xab8b2f0e,0xafd9a63e,0xa246aff6
.long 0xb0008000,0xaa1faf64,0x2da8ada8,0x2f642a1f,0x2da8ada8,0x2fa828a5,0x263e2fd9,0xae2f2d13
.long 0x80003000,0xaea72c72,0xaf64aa1f,0xa63eafd9,0xada8ada8,0x2246aff6,0x2ea7ac72,0x2fa828a5
.long 0x30008000,0x2da82da8,0x80003000,0xada82da8,0xada82da8,0xaff62246,0xaea7ac72,0xa8a5afa8
.long 0xb000,0x2c72aea7,0x2f64aa1f,0x2fd9263e,0x2da82da8,0x28a52fa8,0xa63e2fd9,0xad132e2f
.long 0xb0008000,0xaf64aa1f,0xada8ada8,0xaa1faf64,0x2da8ada8,0x2f0eab8b,0x2fd9a63e,0x2ff62246
.long 0x80003000,0xa63e2fd9,0xaa1f2f64,0xac722ea7,0xada8ada8,0xad13ae2f,0xac72aea7,0xab8baf0e
.long 0x30008000,0x80003000,0xb0008000,0xb000,0xaa1f2f64,0xafa8a8a5,0x263eafd9,0x2ff62246
.long 0xada8ada8,0x2c72aea7,0x2f642a1f,0xa63e2fd9,0x2f64aa1f,0x2d132e2f,0xac722ea7,0xafa8a8a5
.long 0x80003000,0xaf642a1f,0xada8ada8,0x2a1faf64,0xaf64aa1f,0xa246aff6,0x2ea7ac72,0x2f0e2b8b
.long 0x2da8ada8,0x2fd9263e,0x2a1f2f64,0xac722ea7,0x2a1f2f64,0xab8b2f0e,0xafd9263e,0xae2fad13
.long 0xb0008000,0xada8ada8,0xb000,0x2da8ada8,0x2a1faf64,0x2f0eab8b,0x2fd9263e,0x2d132e2f
.long 0x2da82da8,0x263e2fd9,0xaa1f2f64,0xaea72c72,0xaf642a1f,0xaff6a246,0xaea7ac72,0xab8baf0e
.long 0xb000,0x2a1faf64,0x2da8ada8,0x2f64aa1f,0x2f642a1f,0x2e2f2d13,0x2c722ea7,0x28a52fa8
.long 0xada82da8,0xaea72c72,0xaf642a1f,0xafd9263e,0xaa1faf64,0xa8a5afa8,0xa63eafd9,0xa246aff6
.long 0x30008000,0x80003000,0xb0008000,0xb000,0x80003000,0xaff62246,0xa63eafd9,0x2fa8a8a5
.long 0xb0008000,0xa63eafd9,0x2f64aa1f,0x2c722ea7,0xb000,0x2fa8a8a5,0x2c722ea7,0xad132e2f
.long 0x30008000,0x2a1f2f64,0xada82da8,0xaf64aa1f,0x80003000,0xaf0e2b8b,0xaea7ac72,0x2246aff6
.long 0xb0008000,0xac72aea7,0x2a1faf64,0x2fd9a63e,0xb000,0x2e2fad13,0x2fd9263e,0x2b8b2f0e
.long 0x30008000,0x2da82da8,0x80003000,0xada82da8,0x80003000,0xad132e2f,0xafd9263e,0xaf0eab8b
.long 0xb0008000,0xaea7ac72,0xaa1faf64,0x263eafd9,0xb000,0x2b8baf0e,0x2ea7ac72,0x2ff6a246
.long 0x30008000,0x2f642a1f,0x2da82da8,0x2a1f2f64,0x80003000,0xa8a52fa8,0xac722ea7,0xae2f2d13
.long 0xb0008000,0xafd9a63e,0xaf64aa1f,0xaea7ac72,0xb000,0x2246aff6,0x263eafd9,0x28a5afa8
.long 0x30008000,0x80003000,0xb0008000,0xb000,0x2a1f2f64,0xaf0e2b8b,0xac72aea7,0x2e2fad13
.long 0xada82da8,0xaea7ac72,0x2a1faf64,0x2fd9263e,0xaf64aa1f,0x2246aff6,0x2fd9a63e,0x2b8b2f0e
.long 0xb000,0x2f64aa1f,0x2da82da8,0xaa1f2f64,0x2f64aa1f,0x2e2f2d13,0xa63e2fd9,0xafa828a5
.long 0x2da82da8,0xa63e2fd9,0xaf642a1f,0xaea7ac72,0xaa1f2f64,0xafa828a5,0xaea7ac72,0xa246aff6
.long 0xb0008000,0xada8ada8,0xb000,0x2da8ada8,0xaa1faf64,0x28a5afa8,0x2ea7ac72,0x2ff62246
.long 0x2da8ada8,0x2fd9a63e,0x2f642a1f,0x2c722ea7,0x2f642a1f,0x2d132e2f,0x263e2fd9,0xa8a52fa8
.long 0x80003000,0xaa1f2f64,0xada82da8,0xaf642a1f,0xaf642a1f,0xaff62246,0xafd9a63e,0xaf0eab8b
.long 0xada8ada8,0xac72aea7,0xaa1faf64,0xa63eafd9,0x2a1faf64,0x2b8baf0e,0x2c72aea7,0x2d13ae2f
.long 0x30008000,0x80003000,0xb0008000,0xb000,0x2da82da8,0xad132e2f,0xaea7ac72,0x2b8baf0e
.long 0x80003000,0xafd9263e,0xaa1faf64,0x2ea7ac72,0xada82da8,0xaf0eab8b,0x263eafd9,0x2ff6a246
.long 0xb0008000,0xaa1faf64,0x2da8ada8,0x2f642a1f,0xada8ada8,0x28a5afa8,0x2fd9a63e,0x2d132e2f
.long 0xb000,0x2ea7ac72,0x2f642a1f,0x263e2fd9,0x2da8ada8,0x2ff62246,0x2c722ea7,0xa8a52fa8
.long 0x30008000,0x2da82da8,0x80003000,0xada82da8,0x2da82da8,0x22462ff6,0xac722ea7,0xafa828a5
.long 0x80003000,0xac722ea7,0xaf642a1f,0xafd9a63e,0xada82da8,0xafa828a5,0xafd9a63e,0xae2fad13
.long 0xb0008000,0xaf64aa1f,0xada8ada8,0xaa1faf64,0xada8ada8,0xab8baf0e,0xa63eafd9,0x2246aff6
.long 0xb000,0x263eafd9,0x2a1faf64,0x2c72aea7,0x2da8ada8,0x2e2fad13,0x2ea7ac72,0x2f0eab8b
.long 0x30008000,0x80003000,0xb0008000,0xb000,0x2f642a1f,0xa8a52fa8,0xafd9a63e,0x2246aff6
.long 0x2da82da8,0xac722ea7,0xaf64aa1f,0x263eafd9,0x2a1f2f64,0xae2f2d13,0xaea7ac72,0x28a5afa8
.long 0x80003000,0xaf642a1f,0xada8ada8,0x2a1faf64,0xaa1f2f64,0xaff62246,0xac72aea7,0x2b8baf0e
.long 0xada82da8,0xafd9a63e,0xaa1faf64,0x2c72aea7,0xaf642a1f,0xaf0eab8b,0xa63eafd9,0x2d13ae2f
.long 0xb0008000,0xada8ada8,0xb000,0x2da8ada8,0xaf64aa1f,0xab8baf0e,0x263eafd9,0x2e2fad13
.long 0xada8ada8,0xa63eafd9,0x2a1faf64,0x2ea7ac72,0xaa1faf64,0x2246aff6,0x2c72aea7,0x2f0eab8b
.long 0xb000,0x2a1faf64,0x2da8ada8,0x2f64aa1f,0x2a1faf64,0x2d13ae2f,0x2ea7ac72,0x2fa8a8a5
.long 0x2da8ada8,0x2ea7ac72,0x2f64aa1f,0x2fd9a63e,0x2f64aa1f,0x2fa8a8a5,0x2fd9a63e,0x2ff6a246
.long 0x80003c00,0xb0b23bea,0xb4a53ba8,0xb6d73b3b,0x80003c00,0xb0cb3be9,0xb4bd3ba4,0xb6f93b33
.long 0x80003c00,0xb0e43be8,0xb4d53ba0,0xb71b3b2b,0x80003c00,0xb0fd3be7,0xb4ed3b9d,0xb73d3b22
.long 0x80003c00,0xb1153be6,0xb5053b99,0xb75e3b1a,0x80003c00,0xb12e3be5,0xb51d3b95,0xb7803b11
.long 0x80003c00,0xb1473be4,0xb5343b91,0xb7a13b08,0x80003c00,0xb1603be3,0xb54c3b8c,0xb7c23aff
.long 0x80003c00,0xb1793be2,0xb5643b88,0xb7e33af6,0x80003c00,0xb1913be1,0xb57c3b84,0xb8023aed
.long 0x80003c00,0xb1aa3be0,0xb5933b80,0xb8123ae3,0x80003c00,0xb1c33bdf,0xb5ab3b7b,0xb8223ad9
.long 0x80003c00,0xb1db3bdd,0xb5c23b77,0xb8323ad0,0x80003c00,0xb1f43bdc,0xb5da3b72,0xb8423ac6
.long 0x80003c00,0xb20d3bdb,0xb5f13b6e,0xb8523abc,0x80003c00,0xb2263bda,0xb6083b69,0xb8623ab1
.long 0xb8723aa7,0xb95f39ed,0xba2f3913,0xbadd381d,0xb8873a99,0xb97639d8,0xba4738f6,0xbaf337ee
.long 0xb89b3a8a,0xb98d39c3,0xba5e38d8,0xbb0837a1,0xb8b03a7c,0xb9a439ad,0xba7438ba,0xbb1d3753
.long 0xb8c43a6d,0xb9ba3996,0xba8a389b,0xbb303705,0xb8d83a5e,0xb9d03980,0xbaa0387c,0xbb4336b5
.long 0xb8ec3a4f,0xb9e53969,0xbab5385d,0xbb553665,0xb9003a3f,0xb9fa3951,0xbac9383d,0xbb673614
.long 0xb9133a2f,0xba0f393a,0xbadd381d,0xbb7735c2,0xb9273a1f,0xba233922,0xbaf037f9,0xbb863570
.long 0xb93a3a0f,0xba373909,0xbb0237b7,0xbb95351d,0xb94d39fe,0xba4b38f1,0xbb143775,0xbba234c9
.long 0xb95f39ed,0xba5e38d8,0xbb253732,0xbbaf3475,0xb97239dc,0xba7138bf,0xbb3636ee,0xbbbb3420
.long 0xb98439cb,0xba8338a6,0xbb4636aa,0xbbc63396,0xb99639ba,0xba95388c,0xbb553665,0xbbd032ea
.long 0xbb64361f,0xbbc333c6,0xbbf62e46,0xbbfeaa48,0xbb7735c2,0xbbd032ea,0xbbfb2c51,0xbbf9ad4c
.long 0xbb883564,0xbbdb320d,0xbbff28b6,0xbbf2af72,0xbb993505,0xbbe5312e,0xbc001e48,0xbbe9b0cb
.long 0xbba834a5,0xbbed304e,0xbbffa648,0xbbddb1db,0xbbb63444,0xbbf42edc,0xbbfdab11,0xbbd0b2ea
.long 0xbbc333c6,0xbbf92d1a,0xbbf8ad7e,0xbbc0b3f7,0xbbce3303,0xbbfd2aac,0xbbf2af72,0xbbadb481
.long 0xbbd9323e,0xbbff2648,0xbbeab0b2,0xbb99b505,0xbbe23179,0xbc009a48,0xbbe0b1aa,0xbb82b587
.long 0xbbea30b2,0xbbffa7da,0xbbd4b2a1,0xbb69b608,0xbbf12fd6,0xbbfdab75,0xbbc6b396,0xbb4eb687
.long 0xbbf62e46,0xbbf8ad7e,0xbbb6b444,0xbb30b705,0xbbfa2cb5,0xbbf3af40,0xbba4b4bd,0xbb11b780
.long 0xbbfe2a48,0xbbecb080,0xbb91b534,0xbaf0b7f9,0xbbff2648,0xbbe3b160,0xbb7bb5ab,0xbaccb838
.long 0xbbd9b23e,0xbb88b564,0xbb0eb78b,0xba6db8c4,0xbbc9b365,0xbb6bb5fd,0xbae3b812,0xba33b90e
.long 0xbbb6b444,0xbb4bb693,0xbab5b85d,0xb9f6b956,0xbba0b4d5,0xbb28b726,0xba83b8a6,0xb9b5b99b
.long 0xbb88b564,0xbb02b7b7,0xba4fb8ec,0xb972b9dc,0xbb6eb5f1,0xbad9b822,0xba17b930,0xb92bba1b
.long 0xbb50b67c,0xbaaeb867,0xb9dcb972,0xb8e2ba56,0xbb30b705,0xba7fb8ab,0xb99fb9b1,0xb896ba8e
.long 0xbb0eb78b,0xba4fb8ec,0xb95fb9ed,0xb848bac2,0xbae9b807,0xba1bb92b,0xb91dba27,0xb7eebaf3
.long 0xbac2b848,0xb9e5b969,0xb8d8ba5e,0xb748bb20,0xba99b887,0xb9adb9a4,0xb891ba92,0xb69ebb49
.long 0xba6db8c4,0xb972b9dc,0xb848bac2,0xb5f1bb6e,0xba3fb900,0xb935ba13,0xb7f9baf0,0xb540bb8f
.long 0xba0fb93a,0xb8f6ba47,0xb75ebb1a,0xb48dbbab,0xb9dcb972,0xb8b5ba78,0xb6c1bb41,0xb3aebbc4
.long 0xb9a8b9a8,0xb8c4ba6d,0xb78bbb0e,0xb564bb88,0xb95fb9ed,0xb86dbaaa,0xb6c1bb41,0xb481bbad
.long 0xb913ba2f,0xb812bae3,0xb5f1bb6e,0xb334bbcb,0xb8c4ba6d,0xb76abb17,0xb51dbb95,0xb160bbe3
.long 0xb872baa7,0xb6aabb46,0xb444bbb6,0xaf0ebbf4,0xb81dbadd,0xb5e5bb70,0xb2d2bbd1,0xaaacbbfd
.long 0xb78bbb0e,0xb51dbb95,0xb115bbe6,0x1e48bc00,0xb6d7bb3b,0xb451bbb4,0xaeaabbf5,0x2c1fbbfc
.long 0xb61fbb64,0xb303bbce,0xaa48bbfe,0x2fd6bbf1,0xb564bb88,0xb160bbe3,0x1e48bc00,0x31c3bbdf
.long 0xb4a5bba8,0xaf72bbf2,0x2bd9bbfc,0x3396bbc6,0xb3c6bbc3,0xac1fbbfc,0x2f72bbf2,0x34b1bba6
.long 0xb23ebbd9,0xa248bc00,0x3179bbe2,0x3593bb80,0xb0b2bbea,0x291bbbfe,0x3334bbcb,0x3670bb53
.long 0xae46bbf6,0x2de2bbf7,0x3475bbaf,0x3748bb20,0xaa48bbfe,0x3099bbeb,0x354cbb8c,0x380dbae6
.long 0xb23ebbd9,0xaa48bbfe,0x2e46bbf6,0x33c6bbc3,0xb04ebbed,0x23dbbc00,0x3147bbe4,0x34f9bb9b
.long 0xacb5bbfa,0x2d1abbf9,0x3365bbc9,0x3608bb69,0xa248bc00,0x3099bbeb,0x34bdbba4,0x3710bb2e
.long 0x2a48bbfe,0x32a1bbd4,0x35c2bb77,0x3807bae9,0x2f0ebbf4,0x3451bbb4,0x36c1bb41,0x3881ba9c
.long 0x3179bbe2,0x354cbb8c,0x37b7bb02,0x38f6ba47,0x3365bbc9,0x3642bb5d,0x3852babc,0x3964b9e9
.long 0x34a5bba8,0x3732bb25,0x38c4ba6d,0x39cbb984,0x3593bb80,0x380dbae6,0x3930ba17,0x3a2bb918
.long 0x367cbb50,0x387cbaa0,0x3996b9ba,0x3a83b8a6,0x375ebb1a,0x38e7ba52,0x39f6b956,0x3ad3b82d
.long 0x381dbadd,0x394db9fe,0x3a4fb8ec,0x3b1ab75e,0x3887ba99,0x39adb9a4,0x3aa0b87c,0x3b58b659
.long 0x38ecba4f,0x3a07b943,0x3ae9b807,0x3b8cb54c,0x394db9fe,0x3a5ab8dd,0x3b2bb71b,0x3bb7b438
.long 0x361fbb64,0x381dbadd,0x3913ba2f,0x39edb95f,0x3732bb25,0x38a0ba87,0x398db9c3,0x3a5ab8dd
.long 0x381dbadd,0x391dba27,0x39feb94d,0x3abcb852,0x389bba8a,0x3992b9be,0x3a65b8ce,0x3b11b780
.long 0x3913ba2f,0x39feb94d,0x3ac2b848,0x3b5ab64e,0x3984b9cb,0x3a62b8d3,0x3b14b775,0x3b97b511
.long 0x39edb95f,0x3abcb852,0x3b5ab64e,0x3bc6b396,0x3a4fb8ec,0x3b0bb796,0x3b95b51d,0x3be7b0fd
.long 0x3aa7b872,0x3b50b67c,0x3bc3b3c6,0x3bfaacb5,0x3af6b7e3,0x3b8ab558,0x3be4b147,0x3c0020b6
.long 0x3b3bb6d7,0x3bb9b42c,0x3bf8ad7e,0x3bf72de2,0x3b77b5c2,0x3bdcb1f4,0x3c009e48,0x3be13191
.long 0x3ba8b4a5,0x3bf4af0e,0x3bfa2cb5,0x3bbc3414,0x3bceb303,0x3bffa852,0x3be830e4,0x3b8a3558
.long 0x3beab0b2,0x3bfe297f,0x3bc93365,0x3b4b3693,0x3bfaacb5,0x3bf12fa4,0x3b9d34ed,0x3aff37c2
.long 0x3aa7b872,0x3b3bb6d7,0x3ba8b4a5,0x3beab0b2,0x3b02b7b7,0x3b82b587,0x3bd6b26f,0x3bfdaaac
.long 0x3b50b67c,0x3bb9b42c,0x3bf4af0e,0x3bfe297f,0x3b91b534,0x3be1b191,0x3c00a4b6,0x3bed3067
.long 0x3bc3b3c6,0x3bf8ad7e,0x3bfa2cb5,0x3bc93365,0x3be6b115,0x3c001a48,0x3be43147,0x3b933529
.long 0x3bfaacb5,0x3bf72de2,0x3bbc3414,0x3b4b3693,0x3c002248,0x3bdf31c3,0x3b84357c,0x3af337ee
.long 0x3bf62e46,0x3bb63444,0x3b3b36d7,0x3a8a389b,0x3bdd31db,0x3b7d359f,0x3ae33812,0x3a133935
.long 0x3bb63444,0x3b3636ee,0x3a7c38b0,0x398d39c3,0x3b803593,0x3ae03817,0x3a073943,0x38fb3a43
.long 0x3b3b36d7,0x3a7c38b0,0x398439cb,0x385d3ab5,0x3ae93807,0x3a0b393e,0x38f63a47,0x376a3b17
.long 0x3a8a389b,0x398d39c3,0x385d3ab5,0x36083b69,0x3a1f3927,0x39053a3b,0x37753b14,0x34993baa
.long 0x1a483000,0xa0b5affe,0x23d62ff6,0xa579afea,0x23d63000,0xa9c2afc3,0x2c9b2f0e,0xae0faded
.long 0x27033000,0xacecaf3b,0x2f252d13,0xafffa7c6,0x29053000,0xae8aae6d,0x2fff28a5,0xae4f2964
.long 0x2a7c3000,0xaf99ad5f,0x2ef6a246,0xa7032e6d,0x2be33000,0xafffac1d,0x2c48ab8b,0x2b322ffe
.long 0x2c9b3000,0xafb6a964,0x20b5ae2f,0x2f502edd,0x2d3a3000,0xaec2a4b2,0xaa7cafa8,0x2fb62ad7
.long 0x2dcb3000,0xad3a1e48,0xae4faff6,0x2c9ba4b2,0x2e4f3000,0xaa7c27c6,0xafe2af0e,0xa0b5ad5f
.long 0x2ec23000,0xa3d62ad7,0xaf99ad13,0xad84afc3,0x2f253000,0x25792cc4,0xad84a8a5,0xaff1af88
.long 0x2f773000,0x2b322ded,0xa8442246,0xaec2acc4,0x2fb63000,0x2d842edd,0x27032b8b,0xa9059e48
.long 0x2fe23000,0x2ef62f88,0x2d3a2e2f,0x29c22c1d,0x2ffa3000,0x2fce2fea,0x2f772fa8,0x2ef62f3b
.long 0x27032fd9,0xa844afc3,0x29052fa8,0xa9c2af88,0x2f252c72,0xafcea964,0x2fff2246,0xafb624b2
.long 0x2f50a63e,0xad3a2cc4,0x2844af0e,0x25792ffe,0x2844aea7,0x29c22ffe,0xaec2ae2f,0x2ffa27c6
.long 0xac9bafd9,0x2ff12c1d,0xae0f28a5,0x1a48af3b,0xaffaac72,0x2c9baad7,0x2a7c2ff6,0xaff1acc4
.long 0xad84263e,0xab32afea,0x2ff12b8b,0xa7032d5f,0x23d62ea7,0xafffad5f,0x2579ad13,0x2f992edd
.long 0x2ec22fd9,0xabe327c6,0xaf25afa8,0x2a7ca964,0x2f992c72,0x2c482f88,0xad84a246,0xaef6afea
.long 0x29c2a63e,0x2ffa2e6d,0x2be32f0e,0xac9b9e48,0xabe3aea7,0x2a7c9e48,0x2fce2e2f,0x2e0f2fc3
.long 0xafe2afd9,0xacecaedd,0x20b5a8a5,0x2dcb2ad7,0xae0fac72,0xafe2af3b,0xaf77aff6,0xacecae6d
.long 0x1a48263e,0xa905a4b2,0xacecab8b,0xaec2aded,0x2e4f2ea7,0x2d842ded,0x2c9b2d13,0x2b322c1d
.long 0x2a7c2f64,0xab32af3b,0x2be32f0e,0xac48aedd,0x2ef6aa1f,0xadcb2cc4,0x2c48ae2f,0xa9052f3b
.long 0xac9baf64,0x2ef62d5f,0xaffaa8a5,0x2f77a4b2,0xae0f2a1f,0x2703aedd,0x2a7c2ff6,0xaef6aded
.long 0x2dcb2f64,0xaffaa964,0x2cecab8b,0x25792fc3,0x2cecaa1f,0x29c22fea,0xafe2ad13,0x2d3aa964
.long 0xaec2af64,0x2e4f9e48,0x29052fa8,0xafffacc4,0xab322a1f,0xae8aafc3,0x2d84a246,0x2cec2ffe
.long 0x2f772f64,0xa9052ad7,0xafb6af0e,0x2703ac1d,0x2844aa1f,0x2fff2e6d,0x27032e2f,0xaf25aad7
.long 0xafe2af64,0xa844aded,0x2e0f28a5,0x2f502fea,0xa0b52a1f,0xaec2ac1d,0xaf77aff6,0xa844ad5f
.long 0x2fff2f64,0x2e0f2f88,0x23d62b8b,0xac9ba7c6,0xa3d6aa1f,0x2a7c24b2,0x2e8a2d13,0x2ffa2f88
.long 0xafceaf64,0xaff1affe,0xaf25afa8,0xad84ae6d,0x29052a1f,0x257927c6,0x1a482246,0xa3d69e48
.long 0x2c9b2ea7,0xacecae6d,0x2d3a2e2f,0xad84aded,0x20b5afd9,0x25792ffe,0xaa7cafa8,0x2cec2edd
.long 0xad842c72,0x2905aedd,0x23d62ff6,0xac48af88,0x2ff1263e,0xadcb2ad7,0x2579af0e,0x2b322fea
.long 0xaec2aea7,0x2fb624b2,0xab322d13,0xa9c2affe,0x29052fd9,0xafcead5f,0x2d84a8a5,0x28442fc3
.long 0x29c2ac72,0x2e0f2fc3,0xaef6a246,0xa579af3b,0xaef6a63e,0xa9c2af88,0x2fce2b8b,0x20b52e6d
.long 0x2fe22ea7,0xa3d62cc4,0xaffaae2f,0x1a48ad5f,0xad3aafd9,0x2c9b9e48,0x2f772fa8,0xa3d62c1d
.long 0x1a482c72,0xaf25ac1d,0xae4faff6,0x2703a964,0x2cec263e,0x2fff2f3b,0x2c9b2f0e,0xa90524b2
.long 0xafceaea7,0xaef6afea,0xa905ad13,0x2a7c1e48,0x2f252fd9,0x2c482ded,0x1a4828a5,0xabe3a7c6
.long 0xaa7cac72,0xa0b5a7c6,0x28442246,0x2c9b2ad7,0xa844a63e,0xaa7ca964,0xac48ab8b,0xad3aacc4
.long 0x2dcb2da8,0xae0fad5f,0x2e4f2d13,0xae8aacc4,0xae4fada8,0x2f502c1d,0xafe2a8a5,0x2ffa1e48
.long 0x2ec22da8,0xaff1a964,0x2f99a246,0xadcb2c1d,0xaf25ada8,0x2fe224b2,0xad842b8b,0x23d6af3b
.long 0x2f772da8,0xaf251e48,0x2844ae2f,0x2c482fea,0xafb6ada8,0x2dcba7c6,0x27032fa8,0xaf99aded
.long 0x2fe22da8,0xabe32ad7,0xad3aaff6,0x2f7727c6,0xaffaada8,0x2703acc4,0x2f772f0e,0xabe32964
.long 0x2fff2da8,0x20b52ded,0xaff1ad13,0xa579ae6d,0xaff1ada8,0xa9c2aedd,0x2e8a28a5,0x2e0f2ffe
.long 0x2fce2da8,0x2cec2f88,0xab322246,0xafffaedd,0xaf99ada8,0xae8aafea,0x9a48ab8b,0x2e4f2ad7
.long 0x2f502da8,0x2f992ffe,0x2be32e2f,0xa70324b2,0xaef6ada8,0xafffafc3,0xaec2afa8,0xab32ad5f
.long 0x2e8a2da8,0x2fb62f3b,0x2ffa2ff6,0x2f502fc3,0xae0fada8,0xaec2ae6d,0xaf50af0e,0xafb6af88
.long 0x2ec22c72,0xaef6ac1d,0x2f252b8b,0xaf50aad7,0xaf99263e,0x2ec2aad7,0xad842d13,0x2be3ae6d
.long 0x29c2aea7,0x20b52fea,0xabe3afa8,0x2e8a2ded,0x2be32fd9,0xaf50ad5f,0x2fce2246,0xad3a2c1d
.long 0xafe2ac72,0x2e4fa7c6,0xa0b52f0e,0xad84af88,0x2e0fa63e,0x25792f88,0xaf77ae2f,0x2e4fa4b2
.long 0x1a482ea7,0xaf99ae6d,0x2ceca8a5,0x2c482ffe,0xae4fafd9,0x2dcb9e48,0x2c9b2ff6,0xaf25a7c6
.long 0x2fce2c72,0x28442edd,0xaf99ab8b,0xa9c2af3b,0xab32263e,0xafceaf3b,0x9a48ad13,0x2fb62cc4
.long 0xaa7caea7,0x2d3a24b2,0x2fb62fa8,0x25792d5f,0x2fb62fd9,0x29c22ded,0xac48a246,0xaffaaedd
.long 0xae8aac72,0xaff1afc3,0xad3aaf0e,0x1a48a964,0x20b5a63e,0x2c9b2964,0x2f502e2f,0x2ff12fea
.long 0x2dcb2ea7,0x2b322cc4,0x23d628a5,0xa7039e48,0xaff1afd9,0xafffaffe,0xafe2aff6,0xaf99afc3
.long 0x2f772a1f,0xaf99a964,0x2fb628a5,0xafcea7c6,0xa8442f64,0x1a48afea,0x27032ff6,0xab32af88
.long 0xafe2aa1f,0x2fb69e48,0xae0f2b8b,0x2a7cae6d,0x20b5af64,0x2c482fc3,0xaf77ad13,0x2fb61e48
.long 0x2fff2a1f,0xad3a2ad7,0xa3d6afa8,0x2e8a2edd,0x23d62f64,0xaf50ae6d,0x2e8aa246,0x20b52f3b
.long 0xafceaa1f,0x23d6aded,0x2f252f0e,0xadcb24b2,0xa905af64,0x2fe22c1d,0x1a482e2f,0xaff1aded
.long 0x2f502a1f,0x2b322f88,0xaef6a8a5,0xac48afc3,0x2be32f64,0xadcba4b2,0xaec2aff6,0x2905a964
.long 0xae8aaa1f,0xaef6affe,0x20b5ab8b,0x2f772cc4,0xad3aaf64,0x2703a7c6,0x2f502d13,0x2ef62ffe
.long 0x2d842a1f,0x2ffa2f3b,0x2e4f2fa8,0x25792c1d,0x2e4f2f64,0x29c22cc4,0xa5792246,0xad3aaad7
.long 0xac48aa1f,0xae4fad5f,0xaf99af0e,0xafffafea,0xaf25af64,0xae8aaedd,0xadcbae2f,0xacecad5f
.long 0x2fe2263e,0xaff1a4b2,0x2ffa2246,0xafff9e48,0x2d3a2ea7,0xae8aad5f,0x2f772b8b,0xaff1a7c6
.long 0x1a482fd9,0xab32afc3,0x2e4f2e2f,0xafceaad7,0xacec2c72,0x1a48af88,0x2c9b2fa8,0xaf99acc4
.long 0xafcea63e,0x2be3acc4,0x29052ff6,0xaf50aded,0xaf25aea7,0x2ec29e48,0x1a482f0e,0xaef6aedd
.long 0xaa7cafd9,0x2ffa2c1d,0xa8442d13,0xae8aaf88,0x2844ac72,0x2f502f3b,0xac4828a5,0xae0fafea
.long 0x2e8a263e,0x2cec2fea,0xae0fa246,0xad84affe,0x2ffa2ea7,0x25792ded,0xaf50ab8b,0xacecafc3
.long 0x2dcb2fd9,0xa90527c6,0xaff1ae2f,0xac48af3b,0x23d62c72,0xadcba964,0xafe2afa8,0xab32ae6d
.long 0xac48a63e,0xafb6ae6d,0xaf25aff6,0xa9c2ad5f,0xaf99aea7,0xafceaffe,0xadcbaf0e,0xa844ac1d
.long 0xaf77afd9,0xae0faedd,0xabe3ad13,0xa579a964,0xabe3ac72,0xa9c2aad7,0xa703a8a5,0xa0b5a4b2
.long 0x2fff8000,0xaffa1e48,0x2ff1a246,0xafe224b2,0x2ff18000,0xaf7727c6,0x2e8aab8b,0xad3a2d5f
.long 0x2fce8000,0xae4f2ad7,0x2b32ae2f,0x9a482fc3,0x2f998000,0xac9b2cc4,0x9a48afa8,0x2cec2f88
.long 0x2f508000,0xa9052ded,0xabe3aff6,0x2fce2cc4,0x2ef68000,0x9a482edd,0xaec2af0e,0x2f251e48
.long 0x2e8a8000,0x28442f88,0xaffaad13,0x2a7cac1d,0x2e0f8000,0x2c482fea,0xaf50a8a5,0xa844af3b
.long 0x2d848000,0x2e0f2ffe,0xacec2246,0xae8aafea,0x2cec8000,0x2f502fc3,0xa5792b8b,0xaffaaded
.long 0x2c488000,0x2ff12f3b,0x29052e2f,0xadcba7c6,0x2b328000,0x2fe22e6d,0x2dcb2fa8,0xa3d62964
.long 0x29c28000,0x2f252d5f,0x2fb62ff6,0x2c482e6d,0x28448000,0x2dcb2c1d,0x2fce2f0e,0x2f992ffe
.long 0x25798000,0x2be32964,0x2e0f2d13,0x2f772edd,0x20b58000,0x270324b2,0x29c228a5,0x2be32ad7
.long 0x2fcea63e,0xafb627c6,0x2f99a8a5,0xaf772964,0x2b32aea7,0xa7032f88,0x9a48aff6,0x28442fea
.long 0xaa7cafd9,0x2e0f2e6d,0xafb6ab8b,0x2fe21e48,0xafb6ac72,0x2f779e48,0xac482d13,0xa0b5afc3
.long 0xae8a263e,0x23d6aedd,0x2d3a2fa8,0xafffaad7,0xa0b52ea7,0xae8aaf3b,0x2f502246,0xa3d62e6d
.long 0x2dcb2fd9,0xaf25a4b2,0xa3d6af0e,0x2fce2ded,0x2ff12c72,0x9a482ded,0xafe2ae2f,0x2905ac1d
.long 0x2c48a63e,0x2ef62fc3,0xab3228a5,0xaf50af88,0xa905aea7,0x2ec22964,0x2dcb2ff6,0xabe324b2
.long 0xaf77afd9,0xa0b5acc4,0x2ef62b8b,0x2e8a2ffe,0xaef6ac72,0xaf50affe,0xa703ad13,0x2d3a27c6
.long 0xa579263e,0xae4fac1d,0xaffaafa8,0xad84af3b,0x2d3a2ea7,0x25792ad7,0xa9c2a246,0xae4facc4
.long 0x2fff2fd9,0x2f992fea,0x2e4f2f0e,0x2c482d5f,0x2cec2c72,0x2dcb2d5f,0x2e8a2e2f,0x2f252edd
.long 0x2f50aa1f,0xaf252ad7,0x2ef6ab8b,0xaec22c1d,0xabe3af64,0x2d842e6d,0xaec2ad13,0x2f992ad7
.long 0xae8a2a1f,0x2be3aded,0xa0b52fa8,0xa9c2afea,0x2d3a2f64,0xafceac1d,0x2f50a246,0xabe32d5f
.long 0x2d84aa1f,0x20b52f88,0xae4faf0e,0x2fe227c6,0xae4faf64,0x2f7724b2,0xa5792e2f,0xae0faf88
.long 0xac482a1f,0xacecaffe,0x2f9928a5,0x9a482e6d,0x2f252f64,0xac9b27c6,0xadcbaff6,0x2e4f1e48
.long 0x29c2aa1f,0x2f992f3b,0xa8442b8b,0xafceaedd,0xafb6af64,0x1a48acc4,0x2fce2d13,0x2b322f3b
.long 0xa5792a1f,0xafb6ad5f,0xad3aafa8,0x2a7ca4b2,0x2ffa2f64,0x2c482edd,0xa9c22246,0xafb6aded
.long 0x9a48aa1f,0x2d3a2964,0x2ff12f0e,0x2e8a2fc3,0xaff1af64,0xaf50afea,0xac9bae2f,0xa0b5a964
.long 0x27032a1f,0xa3d61e48,0xab32a8a5,0xadcbacc4,0x2f992f64,0x2fe22fc3,0x2fff2ff6,0x2ff12ffe
.long 0x2e8aac72,0xae4f2cc4,0x2e0fad13,0xadcb2d5f,0xaffaa63e,0x2fe29e48,0xaf5028a5,0x2e4fac1d
.long 0x2dcb2ea7,0xaf99ac1d,0x2ff12246,0xaec22964,0xa3d6afd9,0x2d842f3b,0xafe2ab8b,0x2f25a4b2
.long 0xac482c72,0xa844afea,0x2f252e2f,0xaf779e48,0x2f99263e,0xa7032ded,0xadcbafa8,0x2fb627c6
.long 0xaf77aea7,0x2d3aa7c6,0x2be32ff6,0xafe2aad7,0x2be32fd9,0xaf77a964,0xa703af0e,0x2ffa2cc4
.long 0x2579ac72,0x2ff12e6d,0xa0b52d13,0xafffaded,0xae0fa63e,0xae8aaffe,0x29c2a8a5,0x2ff12edd
.long 0x2fff2ea7,0x2b322edd,0xaceca246,0xafceaf88,0xae4fafd9,0x1a48aad7,0x2e8a2b8b,0x2f992fea
.long 0x27032c72,0xabe3a4b2,0xaf99ae2f,0xaf50affe,0x2b32263e,0x2ec22d5f,0x2fff2fa8,0x2ef62fc3
.long 0xaf50aea7,0xaffaafc3,0xafb6aff6,0xae8aaf3b,0x2fb62fd9,0x2f502f88,0x2ec22f0e,0x2e0f2e6d
.long 0x2d84ada8,0xad3a2ded,0x2cecae2f,0xac9b2e6d,0xacec2da8,0x2a7caedd,0xa5792fa8,0xa0b5affe
.long 0x2c48ada8,0xa3d62f88,0xa905aff6,0x2d842edd,0xab322da8,0xa579afea,0x2dcb2f0e,0xaff1aad7
.long 0x29c2ada8,0x2b322ffe,0xafb6ad13,0x2ec2a4b2,0xa8442da8,0xad84afc3,0x2fce28a5,0xa9052d5f
.long 0x2579ada8,0x2ef62f3b,0xae0f2246,0xa9c2afc3,0xa0b52da8,0xafceae6d,0x29c2ab8b,0x2ef62f88
.long 0x9a48ada8,0x2ffa2d5f,0x23d62e2f,0xafe2acc4,0x23d62da8,0xaf77ac1d,0xac9bafa8,0x2d3a1e48
.long 0xa703ada8,0x2e4f2964,0x2f252ff6,0x9a482c1d,0x29052da8,0xac9ba4b2,0xafffaf0e,0xacecaf3b
.long 0xaa7cada8,0x29059e48,0x2ef62d13,0x2fce2fea,0x2be32da8,0x9a4827c6,0xac48a8a5,0xaf25aded
.long 0xac9bada8,0xa844aad7,0x20b5a246,0x2a7c27c6,0x2d3a2da8,0x2c482cc4,0x2a7c2b8b,0x28442964
.long 0x2c48aea7,0xabe32edd,0x2b32af0e,0xaa7c2f3b,0x29052fd9,0xac48af3b,0x2dcb2e2f,0xaef6acc4
.long 0xaf77ac72,0x2ffa24b2,0xaef628a5,0x2c9bad5f,0x2ef6a63e,0xaa7c2ded,0xa703aff6,0x2e0f2edd
.long 0xa5792ea7,0xacecafc3,0x2ffa2b8b,0xadcb2964,0xad3aafd9,0x2fe22964,0xa9c22d13,0xacecafea
.long 0x2fff2c72,0xa9052cc4,0xae4fafa8,0x2ec21e48,0xacec263e,0xad84affe,0x2e8a2246,0x2b322fc3
.long 0xa703aea7,0x2fb62c1d,0x29052f0e,0xaf77aad7,0x2f252fd9,0xa7032ad7,0xafffae2f,0xa844ae6d
.long 0xaf50ac72,0xae0fafea,0x2844a8a5,0x2fe22ded,0x2844a63e,0x2f772d5f,0x2ec22ff6,0x20b52c1d
.long 0x2c9b2ea7,0xa3d627c6,0xae0fab8b,0xafffaf88,0xaffaafd9,0xae8aaf88,0xaa7cad13,0x23d6a4b2
.long 0x2d842c72,0x2f252e6d,0x2ff12fa8,0x2fce2ffe,0x23d6263e,0x9a481e48,0xa579a246,0xa905a7c6
.long 0x29c2af64,0xa9052f88,0x2844afa8,0xa7032fc3,0x2fb62a1f,0xafffa4b2,0x2fcea246,0xaf252964
.long 0xa5792f64,0xa844affe,0x2d3a2f0e,0xaf50acc4,0xaffaaa1f,0x2ec2a7c6,0xa9c22e2f,0xa844affe
.long 0x9a48af64,0x2e0f2f3b,0xaff1a8a5,0x2c9bac1d,0x2ff12a1f,0xaa7c2cc4,0xac9baff6,0x2ffa2ad7
.long 0x27032f64,0xaff1ad5f,0x2b32ab8b,0x2d842fea,0xaf99aa1f,0xa579aedd,0x2fff2d13,0xa3d62d5f
.long 0xaa7caf64,0x2f252964,0x2be32fa8,0xaec2a7c6,0x2ef62a1f,0x2d842fea,0xac482246,0xaf99af88
.long 0x2c9b2f64,0xabe31e48,0xaffaaf0e,0xa9c2ae6d,0xae0faa1f,0xafceafc3,0xaa7cae2f,0x2be31e48
.long 0xadcbaf64,0xa0b5aad7,0x2cec28a5,0x2fe22edd,0x2cec2a1f,0x2f772e6d,0x2fe22ff6,0x2e0f2f3b
.long 0x2ec22f64,0x2cec2ded,0x29052b8b,0x9a4824b2,0xab32aa1f,0xac9bac1d,0xad84ad13,0xae4faded
.long 0x2579afd9,0xa3d62fea,0x20b5aff6,0x9a482ffe,0x2e0fac72,0xac9b2ded,0x29c2af0e,0xa3d62fc3
.long 0x2fff263e,0xaf2527c6,0x2cecad13,0xa7032f3b,0x2e4f2ea7,0xafffa964,0x2e8aa8a5,0xa9052e6d
.long 0x27032fd9,0xaef6ae6d,0x2f992246,0xaa7c2d5f,0xab322c72,0xac48affe,0x2fff2b8b,0xabe32c1d
.long 0xaf50a63e,0xa0b5aedd,0x2fb62e2f,0xac9b2964,0xafb6aea7,0x2a7caad7,0x2ec22fa8,0xad3a24b2
.long 0xac9bafd9,0x2e4f24b2,0x2d3a2ff6,0xadcb9e48,0x20b5ac72,0x2fe22d5f,0x2a7c2f0e,0xae4fa7c6
.long 0x2d84263e,0x2f992fc3,0x23d62d13,0xaec2aad7,0x2ff12ea7,0x2d842f88,0xa57928a5,0xaf25acc4
.long 0x2ec22fd9,0x28442cc4,0xab32a246,0xaf77aded,0x29052c72,0xa7031e48,0xad84ab8b,0xafb6aedd
.long 0xa9c2a63e,0xad3aac1d,0xaef6ae2f,0xafe2af88,0xaef6aea7,0xaf77af3b,0xafceafa8,0xaffaafea
.long 0x3b64361f,0xb61f3b64,0xbb64b61f,0x361fbb64,0x3b7735c2,0xb4443bb6,0xbbe2b179,0x2cb5bbfa
.long 0x3b883564,0xb0b23bea,0xbbfe2a48,0xb3c6bbc3,0x3b993505,0xa6483bff,0xbbb63444,0xb848bac2
.long 0x3ba834a5,0x2e463bf6,0xbb0e378b,0xba2fb913,0x3bb63444,0x33033bce,0xba0f393a,0xbb77b5c2
.long 0x3bc333c6,0x35643b88,0xb8c43a6d,0xbbfeaa48,0x3bce3303,0x37323b25,0xb67c3b50,0xbbb63444
.long 0x3bd9323e,0x38723aa7,0xb23e3bd9,0xbaa73872,0x3be23179,0x393a3a0f,0x26483bff,0xb8ec3a4f
.long 0x3bea30b2,0x39ed395f,0x33c63bc3,0xb5643b88,0x3bf12fd6,0x3a8a389b,0x37323b25,0xa6483bff
.long 0x3bf62e46,0x3b0e378b,0x39133a2f,0x34a53ba8,0x3bfa2cb5,0x3b7735c2,0x3a4f38ec,0x389b3a8a
.long 0x3bfe2a48,0x3bc333c6,0x3b3b36d7,0x3a6d38c4,0x3bff2648,0x3bf12fd6,0x3bce3303,0x3b993505
.long 0x3b64361f,0xb61f3b64,0xbb64b61f,0x361fbb64,0x3bffa648,0x2fd63bf1,0xbbce3303,0xb505bb99
.long 0x3b3bb6d7,0x38c43a6d,0xb95f39ed,0xbaddb81d,0x393aba0f,0x3b50367c,0xafd63bf1,0xbbe23179
.long 0x34a5bba8,0x3bf6ae46,0x378b3b0e,0xb9133a2f,0xafd6bbf1,0x3a8ab89b,0x3b253732,0x26483bff
.long 0xb81dbadd,0x36d7bb3b,0x3beab0b2,0x395f39ed,0xba8ab89b,0xacb5bbfa,0x39cbb984,0x3bf12fd6
.long 0xbbd9b23e,0xb872baa7,0x323ebbd9,0x3aa7b872,0xbbce3303,0xbb25b732,0xb67cbb50,0x3444bbb6
.long 0xba6d38c4,0xbbfe2a48,0xbaddb81d,0xb6d7bb3b,0xb7e33af6,0xbac23848,0xbbfa2cb5,0xbb50b67c
.long 0xae463bf6,0xb78b3b0e,0xba2f3913,0xbba834a5,0x35053b99,0x26483bff,0xb4443bb6,0xb8483ac2
.long 0x395f39ed,0x381d3add,0x35643b88,0x30b23bea,0x3b50367c,0x3af637e3,0x3a8a389b,0x3a0f393a
.long 0x3b64361f,0xb61f3b64,0xbb64b61f,0x361fbb64,0x3b50b67c,0x37e33af6,0xba8a389b,0xb93aba0f
.long 0x3564bb88,0x3bea30b2,0x2a483bfe,0xbbc333c6,0xb732bb25,0x39cbb984,0x3af637e3,0xb3033bce
.long 0xbba8b4a5,0xae46bbf6,0x3b0eb78b,0x3a2f3913,0xbaf637e3,0xbac2b848,0x2cb5bbfa,0x3b50b67c
.long 0xb3c63bc3,0xbb883564,0xba6db8c4,0x2a48bbfe,0x38483ac2,0xb5053b99,0xbb7735c2,0xbaf6b7e3
.long 0x3bd9323e,0x38723aa7,0xb23e3bd9,0xbaa73872,0x3a8ab89b,0x3bfa2cb5,0x39cb3984,0x2fd63bf1
.long 0x30b2bbea,0x395fb9ed,0x3bc3b3c6,0x3b883564,0xb8ecba4f,0xb179bbe2,0x3505bb99,0x39cbb984
.long 0xbbf6ae46,0xbb0eb78b,0xb913ba2f,0xb4a5bba8,0xba0f393a,0xbb50367c,0xbbf12fd6,0xbbe2b179
.long 0xaa483bfe,0xb3c63bc3,0xb6d73b3b,0xb8c43a6d,0x398439cb,0x38ec3a4f,0x38483ac2,0x37323b25
.long 0x3b64361f,0xb61f3b64,0xbb64b61f,0x361fbb64,0x3984b9cb,0x3a4f38ec,0xb8483ac2,0xbb25b732
.long 0xb6d7bb3b,0x3a6db8c4,0x39ed395f,0xb81d3add,0xbbfa2cb5,0xb5c2bb77,0x3a4fb8ec,0x3a8a389b
.long 0xb4a53ba8,0xbbf62e46,0xb78bbb0e,0x3913ba2f,0x3a4f38ec,0xb1793be2,0xbb993505,0xb9cbb984
.long 0x3addb81d,0x3b3b36d7,0x30b23bea,0xb9ed395f,0xb179bbe2,0x393aba0f,0x3bff2648,0x38ec3a4f
.long 0xbbd9b23e,0xb872baa7,0x323ebbd9,0x3aa7b872,0xb8483ac2,0xbb993505,0xbb77b5c2,0xb7e3baf6
.long 0x38c43a6d,0x2a483bfe,0xb81d3add,0xbb3b36d7,0x3bb6b444,0x3bce3303,0x3a0f393a,0x35c23b77
.long 0x2e46bbf6,0x378bbb0e,0x3a2fb913,0x3ba8b4a5,0xbb25b732,0xb9cbb984,0xb7e3baf6,0xb303bbce
.long 0xb9ed395f,0xbadd381d,0xbb883564,0xbbea30b2,0x35c23b77,0x34443bb6,0x31793be2,0x2cb53bfa
.long 0x3b64361f,0xb61f3b64,0xbb64b61f,0x361fbb64,0x35c2bb77,0x3bb63444,0xb1793be2,0xbbfaacb5
.long 0xbb88b564,0x30b2bbea,0x3bfeaa48,0x33c63bc3,0xb5053b99,0xbbffa648,0xb444bbb6,0x3ac2b848
.long 0x3ba834a5,0x2e463bf6,0xbb0e378b,0xba2fb913,0x3444bbb6,0x3bceb303,0x393a3a0f,0xb5c23b77
.long 0xbbc3b3c6,0xb564bb88,0x38c4ba6d,0x3bfe2a48,0xb3033bce,0xbb253732,0xbb50b67c,0xb444bbb6
.long 0x3bd9323e,0x38723aa7,0xb23e3bd9,0xbaa73872,0x3179bbe2,0x3a0fb93a,0x3bffa648,0x3a4f38ec
.long 0xbbeab0b2,0xb9edb95f,0xb3c6bbc3,0x3564bb88,0xafd63bf1,0xb89b3a8a,0xbb253732,0xbbffa648
.long 0x3bf62e46,0x3b0e378b,0x39133a2f,0x34a53ba8,0x2cb5bbfa,0x35c2bb77,0x38ecba4f,0x3a8ab89b
.long 0xbbfeaa48,0xbbc3b3c6,0xbb3bb6d7,0xba6db8c4,0xa6483bff,0xafd63bf1,0xb3033bce,0xb5053b99
.long 0x3b64361f,0xb61f3b64,0xbb64b61f,0x361fbb64,0xa648bbff,0x3bf1afd6,0x33033bce,0xbb993505
.long 0xbb3b36d7,0xb8c4ba6d,0x395fb9ed,0x3add381d,0x3a0f393a,0xb67c3b50,0xbbf1afd6,0xb179bbe2
.long 0x34a5bba8,0x3bf6ae46,0x378b3b0e,0xb9133a2f,0xbbf12fd6,0xb89bba8a,0x3732bb25,0x3bffa648
.long 0x381d3add,0xb6d73b3b,0xbbea30b2,0xb95fb9ed,0x389bba8a,0x3bfaacb5,0x398439cb,0xafd63bf1
.long 0xbbd9b23e,0xb872baa7,0x323ebbd9,0x3aa7b872,0x33033bce,0xb7323b25,0xbb50367c,0xbbb6b444
.long 0x3a6db8c4,0x3bfeaa48,0x3add381d,0x36d73b3b,0xbaf6b7e3,0xb848bac2,0xacb5bbfa,0x367cbb50
.long 0xae463bf6,0xb78b3b0e,0xba2f3913,0xbba834a5,0x3b99b505,0x3bffa648,0x3bb63444,0x3ac23848
.long 0xb95fb9ed,0xb81dbadd,0xb564bb88,0xb0b2bbea,0xb67c3b50,0xb7e33af6,0xb89b3a8a,0xb93a3a0f
.long 0x3b64361f,0xb61f3b64,0xbb64b61f,0x361fbb64,0xb67cbb50,0x3af6b7e3,0x389b3a8a,0xba0f393a
.long 0xb5643b88,0xbbeab0b2,0xaa48bbfe,0x3bc3b3c6,0x3b25b732,0x398439cb,0xb7e33af6,0xbbceb303
.long 0xbba8b4a5,0xae46bbf6,0x3b0eb78b,0x3a2f3913,0x37e33af6,0xb8483ac2,0xbbfaacb5,0xb67cbb50
.long 0x33c6bbc3,0x3b88b564,0x3a6d38c4,0xaa483bfe,0xbac23848,0xbb99b505,0xb5c2bb77,0x37e3baf6
.long 0x3bd9323e,0x38723aa7,0xb23e3bd9,0xbaa73872,0xb89bba8a,0x2cb5bbfa,0x3984b9cb,0x3bf1afd6
.long 0xb0b23bea,0xb95f39ed,0xbbc333c6,0xbb88b564,0x3a4fb8ec,0x3be2b179,0x3b993505,0x398439cb
.long 0xbbf6ae46,0xbb0eb78b,0xb913ba2f,0xb4a5bba8,0x393a3a0f,0x367c3b50,0x2fd63bf1,0xb1793be2
.long 0x2a48bbfe,0x33c6bbc3,0x36d7bb3b,0x38c4ba6d,0xb9cb3984,0xba4f38ec,0xbac23848,0xbb253732
.long 0x3b64361f,0xb61f3b64,0xbb64b61f,0x361fbb64,0xb9cbb984,0x38ecba4f,0x3ac23848,0xb7323b25
.long 0x36d73b3b,0xba6d38c4,0xb9edb95f,0x381dbadd,0xacb5bbfa,0x3b77b5c2,0x38ec3a4f,0xb89b3a8a
.long 0xb4a53ba8,0xbbf62e46,0xb78bbb0e,0x3913ba2f,0x38ecba4f,0x3be23179,0x35053b99,0xb98439cb
.long 0xbadd381d,0xbb3bb6d7,0xb0b2bbea,0x39edb95f,0x3be2b179,0x3a0f393a,0xa6483bff,0xba4f38ec
.long 0xbbd9b23e,0xb872baa7,0x323ebbd9,0x3aa7b872,0x3ac23848,0x35053b99,0xb5c23b77,0xbaf637e3
.long 0xb8c4ba6d,0xaa48bbfe,0x381dbadd,0x3b3bb6d7,0x34443bb6,0xb3033bce,0xb93a3a0f,0xbb7735c2
.long 0x2e46bbf6,0x378bbb0e,0x3a2fb913,0x3ba8b4a5,0xb7323b25,0xb98439cb,0xbaf637e3,0xbbce3303
.long 0x39edb95f,0x3addb81d,0x3b88b564,0x3beab0b2,0xbb7735c2,0xbbb63444,0xbbe23179,0xbbfa2cb5
.long 0x3b64361f,0xb61f3b64,0xbb64b61f,0x361fbb64,0xbb77b5c2,0x3444bbb6,0x3be23179,0xacb53bfa
.long 0x3b883564,0xb0b23bea,0xbbfe2a48,0xb3c6bbc3,0xbb99b505,0x2648bbff,0x3bb6b444,0x38483ac2
.long 0x3ba834a5,0x2e463bf6,0xbb0e378b,0xba2fb913,0xbbb6b444,0xb303bbce,0x3a0fb93a,0x3b7735c2
.long 0x3bc333c6,0x35643b88,0xb8c43a6d,0xbbfeaa48,0xbbceb303,0xb732bb25,0x367cbb50,0x3bb6b444
.long 0x3bd9323e,0x38723aa7,0xb23e3bd9,0xbaa73872,0xbbe2b179,0xb93aba0f,0xa648bbff,0x38ecba4f
.long 0x3bea30b2,0x39ed395f,0x33c63bc3,0xb5643b88,0xbbf1afd6,0xba8ab89b,0xb732bb25,0x2648bbff
.long 0x3bf62e46,0x3b0e378b,0x39133a2f,0x34a53ba8,0xbbfaacb5,0xbb77b5c2,0xba4fb8ec,0xb89bba8a
.long 0x3bfe2a48,0x3bc333c6,0x3b3b36d7,0x3a6d38c4,0xbbffa648,0xbbf1afd6,0xbbceb303,0xbb99b505
.long 0x3b64361f,0xb61f3b64,0xbb64b61f,0x361fbb64,0xbbff2648,0xafd6bbf1,0x3bceb303,0x35053b99
.long 0x3b3bb6d7,0x38c43a6d,0xb95f39ed,0xbaddb81d,0xb93a3a0f,0xbb50b67c,0x2fd6bbf1,0x3be2b179
.long 0x34a5bba8,0x3bf6ae46,0x378b3b0e,0xb9133a2f,0x2fd63bf1,0xba8a389b,0xbb25b732,0xa648bbff
.long 0xb81dbadd,0x36d7bb3b,0x3beab0b2,0x395f39ed,0x3a8a389b,0x2cb53bfa,0xb9cb3984,0xbbf1afd6
.long 0xbbd9b23e,0xb872baa7,0x323ebbd9,0x3aa7b872,0x3bceb303,0x3b253732,0x367c3b50,0xb4443bb6
.long 0xba6d38c4,0xbbfe2a48,0xbaddb81d,0xb6d7bb3b,0x37e3baf6,0x3ac2b848,0x3bfaacb5,0x3b50367c
.long 0xae463bf6,0xb78b3b0e,0xba2f3913,0xbba834a5,0xb505bb99,0xa648bbff,0x3444bbb6,0x3848bac2
.long 0x395f39ed,0x381d3add,0x35643b88,0x30b23bea,0xbb50b67c,0xbaf6b7e3,0xba8ab89b,0xba0fb93a
.long 0x3b64361f,0xb61f3b64,0xbb64b61f,0x361fbb64,0xbb50367c,0xb7e3baf6,0x3a8ab89b,0x393a3a0f
.long 0x3564bb88,0x3bea30b2,0x2a483bfe,0xbbc333c6,0x37323b25,0xb9cb3984,0xbaf6b7e3,0x3303bbce
.long 0xbba8b4a5,0xae46bbf6,0x3b0eb78b,0x3a2f3913,0x3af6b7e3,0x3ac23848,0xacb53bfa,0xbb50367c
.long 0xb3c63bc3,0xbb883564,0xba6db8c4,0x2a48bbfe,0xb848bac2,0x3505bb99,0x3b77b5c2,0x3af637e3
.long 0x3bd9323e,0x38723aa7,0xb23e3bd9,0xbaa73872,0xba8a389b,0xbbfaacb5,0xb9cbb984,0xafd6bbf1
.long 0x30b2bbea,0x395fb9ed,0x3bc3b3c6,0x3b883564,0x38ec3a4f,0x31793be2,0xb5053b99,0xb9cb3984
.long 0xbbf6ae46,0xbb0eb78b,0xb913ba2f,0xb4a5bba8,0x3a0fb93a,0x3b50b67c,0x3bf1afd6,0x3be23179
.long 0xaa483bfe,0xb3c63bc3,0xb6d73b3b,0xb8c43a6d,0xb984b9cb,0xb8ecba4f,0xb848bac2,0xb732bb25
.long 0x3b64361f,0xb61f3b64,0xbb64b61f,0x361fbb64,0xb98439cb,0xba4fb8ec,0x3848bac2,0x3b253732
.long 0xb6d7bb3b,0x3a6db8c4,0x39ed395f,0xb81d3add,0x3bfaacb5,0x35c23b77,0xba4f38ec,0xba8ab89b
.long 0xb4a53ba8,0xbbf62e46,0xb78bbb0e,0x3913ba2f,0xba4fb8ec,0x3179bbe2,0x3b99b505,0x39cb3984
.long 0x3addb81d,0x3b3b36d7,0x30b23bea,0xb9ed395f,0x31793be2,0xb93a3a0f,0xbbffa648,0xb8ecba4f
.long 0xbbd9b23e,0xb872baa7,0x323ebbd9,0x3aa7b872,0x3848bac2,0x3b99b505,0x3b7735c2,0x37e33af6
.long 0x38c43a6d,0x2a483bfe,0xb81d3add,0xbb3b36d7,0xbbb63444,0xbbceb303,0xba0fb93a,0xb5c2bb77
.long 0x2e46bbf6,0x378bbb0e,0x3a2fb913,0x3ba8b4a5,0x3b253732,0x39cb3984,0x37e33af6,0x33033bce
.long 0xb9ed395f,0xbadd381d,0xbb883564,0xbbea30b2,0xb5c2bb77,0xb444bbb6,0xb179bbe2,0xacb5bbfa
.long 0x3b64361f,0xb61f3b64,0xbb64b61f,0x361fbb64,0xb5c23b77,0xbbb6b444,0x3179bbe2,0x3bfa2cb5
.long 0xbb88b564,0x30b2bbea,0x3bfeaa48,0x33c63bc3,0x3505bb99,0x3bff2648,0x34443bb6,0xbac23848
.long 0x3ba834a5,0x2e463bf6,0xbb0e378b,0xba2fb913,0xb4443bb6,0xbbce3303,0xb93aba0f,0x35c2bb77
.long 0xbbc3b3c6,0xb564bb88,0x38c4ba6d,0x3bfe2a48,0x3303bbce,0x3b25b732,0x3b50367c,0x34443bb6
.long 0x3bd9323e,0x38723aa7,0xb23e3bd9,0xbaa73872,0xb1793be2,0xba0f393a,0xbbff2648,0xba4fb8ec
.long 0xbbeab0b2,0xb9edb95f,0xb3c6bbc3,0x3564bb88,0x2fd6bbf1,0x389bba8a,0x3b25b732,0x3bff2648
.long 0x3bf62e46,0x3b0e378b,0x39133a2f,0x34a53ba8,0xacb53bfa,0xb5c23b77,0xb8ec3a4f,0xba8a389b
.long 0xbbfeaa48,0xbbc3b3c6,0xbb3bb6d7,0xba6db8c4,0x2648bbff,0x2fd6bbf1,0x3303bbce,0x3505bb99
.long 0x3b64361f,0xb61f3b64,0xbb64b61f,0x361fbb64,0x26483bff,0xbbf12fd6,0xb303bbce,0x3b99b505
.long 0xbb3b36d7,0xb8c4ba6d,0x395fb9ed,0x3add381d,0xba0fb93a,0x367cbb50,0x3bf12fd6,0x31793be2
.long 0x34a5bba8,0x3bf6ae46,0x378b3b0e,0xb9133a2f,0x3bf1afd6,0x389b3a8a,0xb7323b25,0xbbff2648
.long 0x381d3add,0xb6d73b3b,0xbbea30b2,0xb95fb9ed,0xb89b3a8a,0xbbfa2cb5,0xb984b9cb,0x2fd6bbf1
.long 0xbbd9b23e,0xb872baa7,0x323ebbd9,0x3aa7b872,0xb303bbce,0x3732bb25,0x3b50b67c,0x3bb63444
.long 0x3a6db8c4,0x3bfeaa48,0x3add381d,0x36d73b3b,0x3af637e3,0x38483ac2,0x2cb53bfa,0xb67c3b50
.long 0xae463bf6,0xb78b3b0e,0xba2f3913,0xbba834a5,0xbb993505,0xbbff2648,0xbbb6b444,0xbac2b848
.long 0xb95fb9ed,0xb81dbadd,0xb564bb88,0xb0b2bbea,0x367cbb50,0x37e3baf6,0x389bba8a,0x393aba0f
.long 0x3b64361f,0xb61f3b64,0xbb64b61f,0x361fbb64,0x367c3b50,0xbaf637e3,0xb89bba8a,0x3a0fb93a
.long 0xb5643b88,0xbbeab0b2,0xaa48bbfe,0x3bc3b3c6,0xbb253732,0xb984b9cb,0x37e3baf6,0x3bce3303
.long 0xbba8b4a5,0xae46bbf6,0x3b0eb78b,0x3a2f3913,0xb7e3baf6,0x3848bac2,0x3bfa2cb5,0x367c3b50
.long 0x33c6bbc3,0x3b88b564,0x3a6d38c4,0xaa483bfe,0x3ac2b848,0x3b993505,0x35c23b77,0xb7e33af6
.long 0x3bd9323e,0x38723aa7,0xb23e3bd9,0xbaa73872,0x389b3a8a,0xacb53bfa,0xb98439cb,0xbbf12fd6
.long 0xb0b23bea,0xb95f39ed,0xbbc333c6,0xbb88b564,0xba4f38ec,0xbbe23179,0xbb99b505,0xb984b9cb
.long 0xbbf6ae46,0xbb0eb78b,0xb913ba2f,0xb4a5bba8,0xb93aba0f,0xb67cbb50,0xafd6bbf1,0x3179bbe2
.long 0x2a48bbfe,0x33c6bbc3,0x36d7bb3b,0x38c4ba6d,0x39cbb984,0x3a4fb8ec,0x3ac2b848,0x3b25b732
.long 0x3b64361f,0xb61f3b64,0xbb64b61f,0x361fbb64,0x39cb3984,0xb8ec3a4f,0xbac2b848,0x3732bb25
.long 0x36d73b3b,0xba6d38c4,0xb9edb95f,0x381dbadd,0x2cb53bfa,0xbb7735c2,0xb8ecba4f,0x389bba8a
.long 0xb4a53ba8,0xbbf62e46,0xb78bbb0e,0x3913ba2f,0xb8ec3a4f,0xbbe2b179,0xb505bb99,0x3984b9cb
.long 0xbadd381d,0xbb3bb6d7,0xb0b2bbea,0x39edb95f,0xbbe23179,0xba0fb93a,0x2648bbff,0x3a4fb8ec
.long 0xbbd9b23e,0xb872baa7,0x323ebbd9,0x3aa7b872,0xbac2b848,0xb505bb99,0x35c2bb77,0x3af6b7e3
.long 0xb8c4ba6d,0xaa48bbfe,0x381dbadd,0x3b3bb6d7,0xb444bbb6,0x3303bbce,0x393aba0f,0x3b77b5c2
.long 0x2e46bbf6,0x378bbb0e,0x3a2fb913,0x3ba8b4a5,0x3732bb25,0x3984b9cb,0x3af6b7e3,0x3bceb303
.long 0x39edb95f,0x3addb81d,0x3b88b564,0x3beab0b2,0x3b77b5c2,0x3bb6b444,0x3be2b179,0x3bfaacb5
.long 0x80003c00,0xb0b83bea,0xb4ab3ba7,0xb6e03b39,0x80003c00,0xb0d13be9,0xb4c33ba3,0xb7023b31
.long 0x80003c00,0xb0ea3be8,0xb4db3b9f,0xb7243b29,0x80003c00,0xb1033be7,0xb4f33b9c,0xb7453b20
.long 0x80003c00,0xb11c3be6,0xb50b3b98,0xb7673b18,0x80003c00,0xb1343be5,0xb5233b94,0xb7883b0f
.long 0x80003c00,0xb14d3be4,0xb53a3b90,0xb7a93b06,0x80003c00,0xb1663be3,0xb5523b8b,0xb7ca3afd
.long 0x80003c00,0xb17f3be2,0xb56a3b87,0xb7eb3af4,0x80003c00,0xb1973be0,0xb5813b83,0xb8063aea
.long 0x80003c00,0xb1b03bdf,0xb5993b7f,0xb8163ae1,0x80003c00,0xb1c93bde,0xb5b13b7a,0xb8263ad7
.long 0x80003c00,0xb1e23bdd,0xb5c83b76,0xb8363acd,0x80003c00,0xb1fa3bdc,0xb5df3b71,0xb8463ac3
.long 0x80003c00,0xb2133bdb,0xb5f73b6c,0xb8563ab9,0x80003c00,0xb22c3bda,0xb60e3b68,0xb8663aaf
.long 0xb8773aa3,0xb96539e8,0xba35390c,0xbae23813,0xb88c3a95,0xb97c39d3,0xba4d38ee,0xbaf837db
.long 0xb8a03a87,0xb99339bd,0xba6438d1,0xbb0d378e,0xb8b53a78,0xb9a939a7,0xba7a38b2,0xbb223740
.long 0xb8c93a69,0xb9bf3991,0xba903894,0xbb3536f1,0xb8dd3a5a,0xb9d5397a,0xbaa53874,0xbb4836a1
.long 0xb8f13a4b,0xb9ea3963,0xbaba3855,0xbb5a3651,0xb9053a3b,0xb9ff394b,0xbace3835,0xbb6b35ff
.long 0xb9183a2b,0xba143934,0xbae13815,0xbb7b35ae,0xb92b3a1b,0xba28391c,0xbaf437e8,0xbb8a355b
.long 0xb93e3a0b,0xba3c3903,0xbb0737a6,0xbb983508,0xb95139fa,0xba4f38eb,0xbb183764,0xbba634b4
.long 0xb96439e9,0xba6338d2,0xbb2a3721,0xbbb23460,0xb97639d8,0xba7538b9,0xbb3a36dd,0xbbbe340b
.long 0xb98939c7,0xba88389f,0xbb4a3699,0xbbc8336b,0xb99b39b5,0xba9a3885,0xbb593654,0xbbd232bf
.long 0xbb693608,0xbbc63390,0xbbf82dc9,0xbbfdab5c,0xbb7b35ab,0xbbd332b3,0xbbfc2ba7,0xbbf7add5
.long 0xbb8c354c,0xbbde31d5,0xbbff2776,0xbbf0affb,0xbb9d34ed,0xbbe730f6,0xbc009648,0xbbe6b10f
.long 0xbbab348d,0xbbef3016,0xbbffa81f,0xbbdab21f,0xbbb9342c,0xbbf62e6b,0xbbfcac06,0xbbccb32e
.long 0xbbc63396,0xbbfb2ca9,0xbbf7adfb,0xbbbbb41d,0xbbd132d2,0xbbfe29ca,0xbbf0afef,0xbba8b4a2
.long 0xbbdb320d,0xbc002484,0xbbe7b0f0,0xbb93b526,0xbbe43147,0xbc00a11b,0xbbddb1e8,0xbb7cb5a8
.long 0xbbec3080,0xbbffa8cf,0xbbd0b2de,0xbb62b628,0xbbf22f72,0xbbfcac2b,0xbbc2b3d3,0xbb47b6a7
.long 0xbbf72de2,0xbbf7adee,0xbbb2b463,0xbb29b724,0xbbfb2c51,0xbbf1afb0,0xbb9fb4db,0xbb09b79e
.long 0xbbfe297f,0xbbeab0b8,0xbb8bb552,0xbae7b80b,0xbc0024b6,0xbbe0b197,0xbb76b5c8,0xbac3b846
.long 0xbbd5b288,0xbb81b58a,0xbb04b7b2,0xba5fb8d7,0xbbc4b3ae,0xbb64b622,0xbad8b825,0xba24b921
.long 0xbbb1b469,0xbb43b6b8,0xbaa9b86f,0xb9e6b967,0xbb9bb4f9,0xbb1fb74b,0xba76b8b7,0xb9a5b9ab
.long 0xbb82b587,0xbaf8b7db,0xba41b8fd,0xb961b9ec,0xbb67b614,0xbacfb834,0xba09b941,0xb919ba2a
.long 0xbb49b69e,0xbaa2b878,0xb9cdb982,0xb8cfba65,0xbb28b726,0xba73b8bb,0xb990b9c0,0xb883ba9b
.long 0xbb05b7ac,0xba42b8fc,0xb94fb9fc,0xb834bacf,0xbae0b817,0xba0eb93b,0xb90cba35,0xb7c5bafe
.long 0xbab8b858,0xb9d7b978,0xb8c7ba6b,0xb71ebb2a,0xba8eb896,0xb99eb9b2,0xb87fba9e,0xb673bb52
.long 0xba62b8d3,0xb963b9ea,0xb835bace,0xb5c5bb76,0xba33b90e,0xb925ba20,0xb7d2bafb,0xb514bb96
.long 0xba02b948,0xb8e6ba53,0xb737bb24,0xb460bbb2,0xb9d0b980,0xb8a4ba84,0xb699bb4a,0xb352bbca
.long 0xb996b9ba,0xb8aeba7d,0xb759bb1b,0xb52cbb92,0xb94db9fe,0xb856bab9,0xb68dbb4c,0xb447bbb5
.long 0xb900ba3f,0xb7f6baf0,0xb5bcbb78,0xb2bfbbd2,0xb8b0ba7c,0xb73abb23,0xb4e7bb9e,0xb0eabbe8
.long 0xb85dbab5,0xb679bb51,0xb40ebbbd,0xae20bbf7,0xb807bae9,0xb5b3bb7a,0xb263bbd7,0xa8cfbbff
.long 0xb75ebb1a,0xb4eabb9d,0xb0a6bbea,0x254dbc00,0xb6aabb46,0xb41dbbbb,0xadc9bbf8,0x2d0dbbfa
.long 0xb5f1bb6e,0xb29bbbd4,0xa884bbff,0x3061bbed,0xb534bb91,0xb0f6bbe7,0x251bbc00,0x3238bbd9
.long 0xb475bbaf,0xae9dbbf5,0x2ccebbfa,0x3405bbbe,0xb365bbc9,0xaa93bbfd,0x3029bbef,0x34eabb9d
.long 0xb1dbbbdd,0x1248bc00,0x31e8bbdd,0x35cbbb75,0xb04ebbed,0x2ac5bbfd,0x33a2bbc5,0x36a7bb47
.long 0xad7ebbf8,0x2eb6bbf5,0x34abbba7,0x377dbb12,0xa8b6bbff,0x3103bbe7,0x3581bb83,0x3826bad7
.long 0xb1c3bbdf,0xa839bbff,0x2f59bbf2,0x3429bbba,0xafa4bbf1,0x2806bbff,0x31cfbbde,0x353dbb8f
.long 0xab75bbfd,0x2e20bbf7,0x33ebbbc0,0x364bbb5b,0x1a48bc00,0x311cbbe6,0x34ffbb9a,0x3750bb1d
.long 0x2c1fbbfc,0x3322bbcd,0x3602bb6a,0x3826bad7,0x3004bbf0,0x3490bbab,0x36ffbb32,0x389fba88
.long 0x31f4bbdc,0x358abb81,0x37f3baf1,0x3912ba30,0x33dfbbc1,0x367fbb50,0x386fbaa9,0x397eb9d1
.long 0x34e1bb9e,0x376cbb16,0x38e0ba58,0x39e4b96a,0x35cebb74,0x3829bad5,0x394aba00,0x3a42b8fc
.long 0x36b5bb43,0x3897ba8d,0x39afb9a1,0x3a98b888,0x3796bb0b,0x3901ba3e,0x3a0db93c,0x3ae5b80e
.long 0x3838bacc,0x3965b9e8,0x3a64b8d1,0x3b2ab71e,0x38a0ba87,0x39c4b98c,0x3ab3b85f,0x3b66b617
.long 0x3905ba3b,0x3a1cb92a,0x3afbb7d2,0x3b98b508,0x3964b9e9,0x3a6eb8c3,0x3b3ab6dd,0x3bc1b3e5
.long 0x3665bb55,0x383ebac8,0x3933ba15,0x3a0ab940,0x3775bb14,0x38c0ba70,0x39aab9a6,0x3a73b8bb
.long 0x383dbac9,0x393bba0e,0x3a19b92e,0x3ad2b82e,0x38baba74,0x39aeb9a3,0x3a7eb8ad,0x3b25b734
.long 0x3930ba17,0x3a18b92f,0x3ad8b825,0x3b6bb5ff,0x399fb9b1,0x3a79b8b4,0x3b27b72c,0x3ba4b4c0
.long 0x3a07b943,0x3ad0b831,0x3b6ab602,0x3bcfb2f0,0x3a65b8ce,0x3b1db750,0x3ba1b4cf,0x3bedb055
.long 0x3abcb852,0x3b60b634,0x3bccb328,0x3bfdaac5,0x3b08b7a1,0x3b97b50e,0x3beab0a6,0x3bff27a8
.long 0x3b4bb693,0x3bc3b3c0,0x3bfcac38,0x3bf32f33,0x3b84b57c,0x3be3b15a,0x3c002311,0x3bd93238
.long 0x3bb2b45d,0x3bf7add5,0x3bf72dfb,0x3bb13466,0x3bd6b26f,0x3c00a376,0x3be13185,0x3b7c35a8
.long 0x3befb01d,0x3bfc2bf2,0x3bbf3402,0x3b3936e0,0x3bfdab11,0x3bec306e,0x3b90353a,0x3aea3806
.long 0x3abfb84d,0x3b4eb684,0x3bb5b44b,0x3bf0afe2,0x3b17b76a,0x3b91b531,0x3bdfb1b6,0x3bffa744
.long 0x3b62b62b,0x3bc5b3a8,0x3bf8ad97,0x3bfb2c44,0x3b9eb4e1,0x3be8b0de,0x3c001cb6,0x3be53128
.long 0x3bcdb31b,0x3bfcac12,0x3bf62e2d,0x3bbd3411,0x3bedb067,0x3bff267b,0x3bdc3201,0x3b823584
.long 0x3bfdaaac,0x3bf32f4c,0x3bb0346f,0x3b3736eb,0x3bff2852,0x3bd63276,0x3b7335d4,0x3ada3821
.long 0x3bf12fa4,0x3ba9349c,0x3b27372c,0x3a6e38c3,0x3bd53288,0x3b6d35f4,0x3acb383a,0x39f3395a
.long 0x3baa3499,0x3b223740,0x3a6038d6,0x396a39e4,0x3b7035e5,0x3ac8383e,0x39e73966,0x38d43a61
.long 0x3b283726,0x3a6138d4,0x396239eb,0x38343acf,0x3ad3382d,0x39ec3961,0x38d13a64,0x37133b2d
.long 0x3a7138bf,0x396c39e2,0x38353ace,0x35ae3b7b,0x3a023948,0x38e13a57,0x37213b2a,0x343b3bb7
.size dft_tables, 108544
.section .rodata,"a"
.p2align 6
.amdhsa_kernel interleave_layers__spectral_gfnet__ssm_conv_s4__prompt_kernel
  .amdhsa_next_free_vgpr 472
  .amdhsa_next_free_sgpr 102
  .amdhsa_accum_offset 256
  .amdhsa_group_segment_fixed_size 0
  .amdhsa_kernarg_size 120
  .amdhsa_user_sgpr_count 2
  .amdhsa_user_sgpr_kernarg_segment_ptr 1
  .amdhsa_system_sgpr_workgroup_id_x 1
  .amdhsa_float_denorm_mode_32 3
.end_amdhsa_kernel
```
